```python
import torch

def _softmax(x, axis=-1):
    return torch.softmax(x, dim=axis)
def _gelu(x):
    return torch.nn.functional.gelu(x, approximate="tanh")
def _silu(x):
    return torch.nn.functional.silu(x)
def _sigmoid(x):
    return torch.sigmoid(x)
def _layernorm(x, axis=-1, eps=1e-5):
    m = x.mean(dim=axis, keepdim=True)
    v = x.var(dim=axis, keepdim=True, unbiased=False)
    return (x - m) / torch.sqrt(v + eps)
def _scatter_add(tgt, idx, src, axis=0):
    return tgt.clone().index_add_(axis, idx, src)
def _segment_sum(src, seg, n):
    out = torch.zeros((n,) + src.shape[1:], dtype=src.dtype)
    return out.index_add_(0, seg, src)
def _pad(x, pw):
    flat = tuple(v for pair in reversed(pw) for v in pair)
    return torch.nn.functional.pad(x, flat)

kernel_name = 'gated_mix__compressed_kv_cla__mixer_token_mlp__prompt'

def setup_inputs():

    _w = (lambda a: (lambda t: t.to(torch.bfloat16) if t.is_floating_point() else t)(torch.as_tensor(a)))
    def _A_setup():
        B, H, Sq, Sk, D, M = 1, 32, 2048, 2048, 128, 512
        Dc = 4 * D
        return {
            "x": _w((lambda *s: torch.randn(*s, dtype=torch.bfloat16) * 0.05)(B, Sq, M)),
            "c_kv": _w((lambda *s: torch.randn(*s, dtype=torch.bfloat16) * 0.8)(B, Sk, Dc)),
            "w_q": _w((lambda *s: torch.randn(*s, dtype=torch.bfloat16) * 6.4)(M, H, D) * (M ** -0.5)),
            "w_uk": _w((lambda *s: torch.randn(*s, dtype=torch.bfloat16) * 6.4)(Dc, H, D) * (Dc ** -0.5)),
            "w_uv": _w((lambda *s: torch.randn(*s, dtype=torch.bfloat16) * 0.8)(Dc, H, D) * (Dc ** -0.5)),
            "w_o": _w((lambda *s: torch.randn(*s, dtype=torch.bfloat16) * 0.8)(H, D, M) * ((H * D) ** -0.5)),
        }
    _A_in = _A_setup()

    def _B_setup():
        B, S, D, F = 1, 2048, 512, 1792
        return {
            "x": _w((lambda *s: torch.randn(*s, dtype=torch.bfloat16) * 0.05)(B, S, D)),
            "w1": _w((lambda *s: torch.randn(*s, dtype=torch.bfloat16) * 3.2)(S, F) * (S ** -0.5)),
            "b1": _w((lambda *s: torch.randn(*s, dtype=torch.bfloat16) * 3.2)(F) * 0.02),
            "w2": _w((lambda *s: torch.randn(*s, dtype=torch.bfloat16) * 0.1)(F, S) * (F ** -0.5)),
            "b2": _w((lambda *s: torch.randn(*s, dtype=torch.bfloat16) * 0.1)(S) * 0.02),
        }
    _B_in = _B_setup()

    return {
        "A_x": _A_in["x"],
        "A_c_kv": _A_in["c_kv"],
        "A_w_q": _A_in["w_q"],
        "A_w_uk": _A_in["w_uk"],
        "A_w_uv": _A_in["w_uv"],
        "A_w_o": _A_in["w_o"],
        "B_x": _B_in["x"],
        "B_w1": _B_in["w1"],
        "B_b1": _B_in["b1"],
        "B_w2": _B_in["w2"],
        "B_b2": _B_in["b2"],
        "gate_w": _w((lambda *s: torch.randn(*s, dtype=torch.bfloat16) * 0.05)(512) * 16.0),
    }

def reference(A_x, A_c_kv, A_w_q, A_w_uk, A_w_uv, A_w_o, B_x, B_w1, B_b1, B_w2, B_b2, gate_w):
    def _A_ref(x, c_kv, w_q, w_uk, w_uv, w_o):
        B, Sq, M = x.shape[0], x.shape[1], x.shape[2]
        Sk = c_kv.shape[1]
        H, D = w_q.shape[1], w_q.shape[2]
        q = torch.einsum("bqm,mhd->bhqd", x, w_q)
        k = torch.einsum("bkc,chd->bhkd", c_kv, w_uk)
        v = torch.einsum("bkc,chd->bhkd", c_kv, w_uv)
        scores = torch.einsum("bhqd,bhkd->bhqk", q, k) * (D ** -0.5)
        off = Sk - Sq
        qi = torch.arange(Sq)[:, None]
        kj = torch.arange(Sk)[None, :]
        cmask = kj <= (qi + off)
        scores = torch.where(cmask[None, None], scores, -1e9)
        p = _softmax(scores, axis=-1)
        ctx = torch.einsum("bhqk,bhkd->bhqd", p, v)
        return torch.einsum("bhqd,hdm->bqm", ctx, w_o)

    def _B_ref(x, w1, b1, w2, b2):
        B, S, D = x.shape
        h = _layernorm(x, axis=-1)
        u = torch.einsum("bsd,sf->bdf", h, w1) + b1
        u = _gelu(u)
        y = torch.einsum("bdf,fs->bds", u, w2) + b2
        return (lambda x, *d: x.permute(*d))(y, 0, 2, 1)

    x = A_x
    g = _sigmoid((x * gate_w).sum(-1, keepdims=True))
    a = _A_ref(x, A_c_kv, A_w_q, A_w_uk, A_w_uv, A_w_o)
    b = _B_ref(x, B_w1, B_b1, B_w2, B_b2)
    return g * a + (1 - g) * b
```

```asm
; @launch grid=(256,1,1) block=(256,1,1) lds=163840
.amdgcn_target "amdgcn-amd-amdhsa--gfx950"
.text
.globl gated_mix__compressed_kv_cla__mixer_token_mlp__prompt_kernel
.p2align 8
.type gated_mix__compressed_kv_cla__mixer_token_mlp__prompt_kernel,@function
gated_mix__compressed_kv_cla__mixer_token_mlp__prompt_kernel:
s_cmp_ge_u32 s2, 256
s_cbranch_scc1 END_main
s_load_dwordx16 s[4:19], s[0:1], 0
s_load_dwordx8 s[20:27], s[0:1], 64
s_load_dwordx4 s[28:31], s[0:1], 96
s_load_dwordx2 s[32:33], s[0:1], 112
v_lshrrev_b32 v1, 6, v0
v_and_b32 v0, 63, v0
v_readfirstlane_b32 s34, v1
s_waitcnt lgkmcnt(0)
s_mov_b32 s48, s32
s_mov_b32 s49, s33
s_mov_b32 s50, 0x5000000
s_mov_b32 s51, 0x20000
s_and_b32 s65, s2, 7
s_lshl_b32 s65, s65, 2
s_bfe_u32 s64, s2, 0x20003
s_add_u32 s65, s65, s64
s_lshr_b32 s64, s2, 5
s_mov_b32 s36, s6
s_mov_b32 s37, s7
s_mov_b32 s38, 0x200000
s_mov_b32 s39, 0x20000
s_mov_b32 s40, s10
s_mov_b32 s41, s11
s_mov_b32 s42, 0x400000
s_mov_b32 s43, 0x20000
s_mov_b32 s44, s12
s_mov_b32 s45, s13
s_mov_b32 s46, 0x400000
s_mov_b32 s47, 0x20000
s_lshr_b32 s52, s2, 3
s_lshl_b32 s52, s52, 2
s_add_u32 s52, s52, s34
v_and_b32 v2, 15, v0
v_lshlrev_b32 v2, 10, v2
v_bfe_u32 v3, v0, 4, 1
v_lshl_add_u32 v2, v3, 7, v2
s_lshl_b32 s53, s52, 14
buffer_load_dword v112, v2, s[36:39], s53 offen
s_lshr_b32 s53, s52, 1
s_lshl_b32 s53, s53, 13
s_and_b32 s54, s52, 1
s_lshl_b32 s54, s54, 9
s_add_u32 s53, s53, s54
s_and_b32 s54, s2, 7
s_lshl_b32 s54, s54, 10
s_add_u32 s53, s53, s54
v_and_b32 v3, 3, v0
v_lshlrev_b32 v3, 7, v3
v_bfe_u32 v4, v0, 2, 0
v_lshl_add_u32 v3, v4, 19, v3
buffer_load_dword v113, v3, s[40:43], s53 offen
buffer_load_dword v114, v3, s[44:47], s53 offen
s_mov_b32 s40, s4
s_mov_b32 s41, s5
s_mov_b32 s42, 0x200000
s_mov_b32 s43, 0x20000
s_mov_b32 s44, s26
s_mov_b32 s45, s27
s_mov_b32 s46, 1024
s_mov_b32 s47, 0x20000
s_lshl_b32 s92, s2, 3
s_lshl_b32 s93, s34, 1
s_add_u32 s92, s92, s93
s_lshl_b32 s93, s92, 10
v_lshlrev_b32 v30, 4, v0
buffer_load_dwordx4 v[32:35], v30, s[40:43], s93 offen
buffer_load_dwordx4 v[36:39], v30, s[40:43], s93 offen offset:1024
buffer_load_dwordx4 v[48:51], v30, s[44:47], 0 offen
s_lshl_b32 s100, s65, 3
s_add_u32 s100, s100, s64
s_lshl_b32 s100, s100, 2
s_add_u32 s100, s100, 2293760
s_lshl_b32 s101, s64, 5
s_add_u32 s101, s101, s65
s_lshl_b32 s101, s101, 2
s_add_u32 s101, s101, 2297856
s_lshr_b32 s52, s2, 3
s_and_b32 s53, s2, 7
s_mul_i32 s35, s53, 28
s_add_u32 s35, s35, s52
s_and_b32 s54, s35, 7
s_lshr_b32 s35, s35, 3
s_cmp_ge_u32 s52, 28
s_cselect_b32 s54, s53, s54
s_cselect_b32 s35, s52, s35
s_lshl_b32 s54, s54, 5
s_add_u32 s35, s35, s54
s_lshl_b32 s35, s35, 2
s_add_u32 s35, s35, 2301952
s_lshr_b32 s52, s2, 3
s_and_b32 s53, s52, 3
s_lshr_b32 s54, s52, 2
s_and_b32 s55, s2, 1
s_mul_i32 s55, s55, 7
s_add_u32 s54, s54, s55
s_bfe_u32 s55, s2, 0x20001
s_lshl_b32 s56, s54, 2
s_add_u32 s56, s56, s53
s_lshl_b32 s54, s54, 1
s_lshr_b32 s57, s55, 1
s_add_u32 s54, s54, s57
s_lshl_b32 s53, s53, 1
s_and_b32 s57, s55, 1
s_add_u32 s53, s53, s57
s_lshl_b32 s53, s53, 5
s_add_u32 s53, s53, s54
s_lshl_b32 s53, s53, 2
s_add_u32 s53, s53, 2301952
s_cmp_ge_u32 s52, 28
s_cselect_b32 s35, s35, s53
s_and_b32 s57, s2, 7
s_add_u32 s57, s57, 56
s_cmp_ge_u32 s52, 28
s_cselect_b32 s56, s57, s56
s_lshl_b32 s56, s56, 6
s_lshl_b32 s55, s55, 2
s_add_u32 s88, s56, s55
s_add_u32 s88, s88, 2310144
s_mov_b32 s36, s6
s_mov_b32 s37, s7
s_mov_b32 s38, 0x200000
s_mov_b32 s39, 0x20000
s_mov_b32 s40, s10
s_mov_b32 s41, s11
s_mov_b32 s42, 0x400000
s_mov_b32 s43, 0x20000
s_mov_b32 s44, s12
s_mov_b32 s45, s13
s_mov_b32 s46, 0x400000
s_mov_b32 s47, 0x20000
v_lshrrev_b32 v24, 4, v0
v_lshlrev_b32 v25, 2, v24
v_and_b32 v26, 15, v0
v_xor_b32 v26, v26, v25
v_lshlrev_b32 v26, 4, v26
v_lshl_add_u32 v26, v24, 13, v26
s_lshl_b32 s61, s34, 16
v_add_u32 v6, s61, v26
v_add_u32 v7, 31744, v6
v_and_b32 v25, 7, v0
v_xor_b32 v25, v25, v24
v_lshlrev_b32 v25, 4, v25
v_lshrrev_b32 v26, 3, v0
v_lshl_add_u32 v2, v26, 10, v25
v_xor_b32 v25, 64, v2
v_add_u32 v3, 7168, v25
v_add_u32 v4, 14336, v2
v_add_u32 v5, 21504, v25
s_mul_i32 s58, s34, 24576
s_lshl_b32 s57, s34, 11
s_add_u32 s57, s57, 98304
v_and_b32 v24, 31, v0
v_lshrrev_b32 v25, 5, v0
v_bfe_u32 v26, v0, 1, 3
v_xor_b32 v26, v26, v25
v_lshlrev_b32 v26, 4, v26
v_lshl_add_u32 v26, v24, 7, v26
v_add_u32 v8, s58, v26
v_xor_b32 v9, 32, v8
v_xor_b32 v10, 64, v8
v_xor_b32 v11, 96, v8
v_bfe_u32 v24, v0, 2, 2
v_lshrrev_b32 v25, 5, v0
v_lshl_add_u32 v25, v25, 3, v24
v_lshlrev_b32 v25, 8, v25
v_bfe_u32 v26, v0, 4, 1
v_lshlrev_b32 v26, 5, v26
v_and_b32 v27, 3, v0
v_lshl_add_u32 v26, v27, 3, v26
v_add_u32 v25, v25, v26
v_add_u32 v25, 98304, v25
v_lshlrev_b32 v24, 6, v24
v_xor_b32 v26, 0, v24
v_add_u32 v12, v25, v26
v_xor_b32 v26, 64, v24
v_add_u32 v13, v25, v26
v_xor_b32 v26, 128, v24
v_add_u32 v14, v25, v26
v_xor_b32 v26, 192, v24
v_add_u32 v15, v25, v26
s_lshl_b32 s59, s64, 18
s_lshl_b32 s61, s34, 16
s_add_u32 s59, s59, s61
s_add_u32 s60, s59, 32768
s_and_b32 s52, s65, 3
s_mul_i32 s52, s52, 0
s_mul_i32 s61, s64, 0
s_add_u32 s52, s52, s61
s_and_b32 s52, s52, 7
s_lshl_b32 s53, s52, 19
s_lshl_b32 s61, s65, 8
s_add_u32 s53, s53, s61
s_lshl_b32 s52, s52, 7
s_mov_b32 s55, 0
s_mov_b32 s54, 0
s_add_u32 s61, s59, s52
s_add_u32 m0, s58, s55
s_nop 0
buffer_load_dwordx4 v2, s[36:39], s61 offen lds
buffer_load_dwordx4 v3, s[36:39], s61 offen offset:1024 lds
buffer_load_dwordx4 v4, s[36:39], s61 offen offset:2048 lds
buffer_load_dwordx4 v5, s[36:39], s61 offen offset:3072 lds
s_add_u32 m0, s58, s55
s_add_u32 m0, m0, 4096
s_add_u32 s61, s60, s52
buffer_load_dwordx4 v2, s[36:39], s61 offen lds
buffer_load_dwordx4 v3, s[36:39], s61 offen offset:1024 lds
buffer_load_dwordx4 v4, s[36:39], s61 offen offset:2048 lds
buffer_load_dwordx4 v5, s[36:39], s61 offen offset:3072 lds
s_add_u32 s52, s52, 128
s_and_b32 s52, s52, 1023
s_add_u32 s55, s55, 8192
s_cmp_eq_u32 s55, 24576
s_cselect_b32 s55, 0, s55
s_add_u32 m0, s54, s57
s_nop 0
buffer_load_dwordx4 v6, s[40:43], s53 offen lds
buffer_load_dwordx4 v7, s[40:43], s53 offen offset:1024 lds
s_add_u32 m0, m0, 8192
s_nop 0
buffer_load_dwordx4 v6, s[44:47], s53 offen lds
buffer_load_dwordx4 v7, s[44:47], s53 offen offset:1024 lds
s_add_u32 s53, s53, 262144
s_and_b32 s53, s53, 0x3fffff
s_add_u32 s54, s54, 16384
s_and_b32 s54, s54, 65535
s_add_u32 m0, s54, s57
s_nop 0
buffer_load_dwordx4 v6, s[40:43], s53 offen lds
buffer_load_dwordx4 v7, s[40:43], s53 offen offset:1024 lds
s_add_u32 m0, m0, 8192
s_nop 0
buffer_load_dwordx4 v6, s[44:47], s53 offen lds
buffer_load_dwordx4 v7, s[44:47], s53 offen offset:1024 lds
s_add_u32 s53, s53, 262144
s_and_b32 s53, s53, 0x3fffff
s_add_u32 s54, s54, 16384
s_and_b32 s54, s54, 65535
s_add_u32 s61, s59, s52
s_add_u32 m0, s58, s55
s_nop 0
buffer_load_dwordx4 v2, s[36:39], s61 offen lds
buffer_load_dwordx4 v3, s[36:39], s61 offen offset:1024 lds
buffer_load_dwordx4 v4, s[36:39], s61 offen offset:2048 lds
buffer_load_dwordx4 v5, s[36:39], s61 offen offset:3072 lds
s_add_u32 m0, s58, s55
s_add_u32 m0, m0, 4096
s_add_u32 s61, s60, s52
buffer_load_dwordx4 v2, s[36:39], s61 offen lds
buffer_load_dwordx4 v3, s[36:39], s61 offen offset:1024 lds
buffer_load_dwordx4 v4, s[36:39], s61 offen offset:2048 lds
buffer_load_dwordx4 v5, s[36:39], s61 offen offset:3072 lds
s_add_u32 s52, s52, 128
s_and_b32 s52, s52, 1023
s_add_u32 s55, s55, 8192
s_cmp_eq_u32 s55, 24576
s_cselect_b32 s55, 0, s55
s_add_u32 m0, s54, s57
s_nop 0
buffer_load_dwordx4 v6, s[40:43], s53 offen lds
buffer_load_dwordx4 v7, s[40:43], s53 offen offset:1024 lds
s_add_u32 m0, m0, 8192
s_nop 0
buffer_load_dwordx4 v6, s[44:47], s53 offen lds
buffer_load_dwordx4 v7, s[44:47], s53 offen offset:1024 lds
s_add_u32 s53, s53, 262144
s_and_b32 s53, s53, 0x3fffff
s_add_u32 s54, s54, 16384
s_and_b32 s54, s54, 65535
s_and_b32 s90, s2, 1
s_lshl_b32 s90, s90, 3
s_lshr_b32 s91, s2, 5
s_add_u32 s90, s90, s91
s_lshl_b32 s90, s90, 2
s_bfe_u32 s91, s2, 0x20003
s_add_u32 s90, s90, s91
s_lshl_b32 s90, s90, 4
s_bfe_u32 s91, s2, 0x20001
s_add_u32 s90, s90, s91
s_lshl_b32 s90, s90, 2
s_add_u32 s90, s90, 2306048
v_lshlrev_b32 v127, 4, v0
s_cmp_lg_u32 s34, 0
s_cbranch_scc1 W1
v_mov_b32 v126, 0
s_mov_b64 exec, 1
buffer_store_dword v126, v126, s[48:51], s100 offen sc1
buffer_store_dword v126, v126, s[48:51], s101 offen sc1
buffer_store_dword v126, v126, s[48:51], s35 offen sc1
s_mov_b64 exec, 15
buffer_store_dword v126, v127, s[48:51], s90 offen sc1
buffer_store_dword v126, v127, s[48:51], s88 offen sc1
s_mov_b64 exec, -1
W1:
s_lshr_b32 s67, s2, 3
s_lshl_b32 s67, s67, 2
s_add_u32 s67, s67, s34
s_and_b32 s66, s2, 7
s_mul_i32 s96, s67, 56
v_add_u32 v125, s96, v0
s_mov_b32 s96, 9363
v_mul_lo_u32 v122, v125, s96
v_lshrrev_b32 v122, 17, v122
v_mul_u32_u24 v121, 14, v122
v_sub_u32 v125, v125, v121
v_lshlrev_b32 v125, 7, v125
v_mul_u32_u24 v122, 3584, v122
v_add_u32 v125, v125, v122
s_lshr_b32 s96, s66, 1
s_mul_i32 s96, s96, 1835008
s_and_b32 s97, s66, 1
s_mul_i32 s97, s97, 1792
s_add_u32 s96, s96, s97
v_add_u32 v125, s96, v125
v_bfe_u32 v123, v0, 3, 2
v_lshlrev_b32 v123, 13, v123
v_and_b32 v122, 7, v0
v_lshl_add_u32 v123, v122, 7, v123
s_lshl_b32 s96, s67, 15
s_lshl_b32 s97, s66, 10
s_add_u32 s96, s96, s97
v_add_u32 v123, s96, v123
v_lshlrev_b32 v124, 7, v0
s_lshl_b32 s96, s67, 14
s_add_u32 s96, s96, 65536
v_add_u32 v124, s96, v124
v_mov_b32 v16, v8
v_mov_b32 v20, v12
v_mov_b32 v17, v9
v_mov_b32 v21, v13
v_mov_b32 v18, v10
v_mov_b32 v22, v14
v_mov_b32 v19, v11
v_mov_b32 v23, v15
s_mov_b32 s62, 0
s_mov_b32 s63, 0
s_waitcnt vmcnt(16)
s_barrier
ds_read_b128 a[128:131], v16
ds_read_b128 a[132:135], v16 offset:4096
ds_read_b64_tr_b16 a[136:137], v20
ds_read_b64_tr_b16 a[138:139], v20 offset:1024
ds_read_b64_tr_b16 a[152:153], v20 offset:8192
ds_read_b64_tr_b16 a[154:155], v20 offset:9216
ds_read_b64_tr_b16 a[140:141], v21
ds_read_b64_tr_b16 a[142:143], v21 offset:1024
ds_read_b64_tr_b16 a[156:157], v21 offset:8192
ds_read_b64_tr_b16 a[158:159], v21 offset:9216
ds_read_b64_tr_b16 a[144:145], v22
ds_read_b64_tr_b16 a[146:147], v22 offset:1024
ds_read_b64_tr_b16 a[160:161], v22 offset:8192
ds_read_b64_tr_b16 a[162:163], v22 offset:9216
ds_read_b64_tr_b16 a[148:149], v23
ds_read_b64_tr_b16 a[150:151], v23 offset:1024
ds_read_b64_tr_b16 a[164:165], v23 offset:8192
ds_read_b64_tr_b16 a[166:167], v23 offset:9216
s_add_u32 m0, s54, s57
s_nop 0
buffer_load_dwordx4 v6, s[40:43], s53 offen lds
buffer_load_dwordx4 v7, s[40:43], s53 offen offset:1024 lds
s_add_u32 m0, m0, 8192
s_nop 0
buffer_load_dwordx4 v6, s[44:47], s53 offen lds
buffer_load_dwordx4 v7, s[44:47], s53 offen offset:1024 lds
s_waitcnt lgkmcnt(0)
v_mfma_f32_32x32x16_bf16 v[128:143], a[136:139], a[128:131], 0
ds_read_b128 a[168:171], v17
ds_read_b128 a[172:175], v17 offset:4096
s_add_u32 s53, s53, 262144
s_and_b32 s53, s53, 0x3fffff
s_add_u32 s54, s54, 16384
s_and_b32 s54, s54, 65535
v_mfma_f32_32x32x16_bf16 v[192:207], a[136:139], a[132:135], 0
ds_read_b64_tr_b16 a[176:177], v20 offset:4096
ds_read_b64_tr_b16 a[178:179], v20 offset:5120
s_add_u32 s61, s59, s52
s_add_u32 m0, s58, s55
v_mfma_f32_32x32x16_bf16 a[0:15], a[128:131], a[152:155], 0
buffer_load_dwordx4 v2, s[36:39], s61 offen lds
ds_read_b64_tr_b16 a[192:193], v20 offset:12288
v_mfma_f32_32x32x16_bf16 a[64:79], a[132:135], a[152:155], 0
ds_read_b64_tr_b16 a[194:195], v20 offset:13312
ds_read_b64_tr_b16 a[180:181], v21 offset:4096
v_mfma_f32_32x32x16_bf16 v[144:159], a[140:143], a[128:131], 0
ds_read_b64_tr_b16 a[182:183], v21 offset:5120
ds_read_b64_tr_b16 a[196:197], v21 offset:12288
v_mfma_f32_32x32x16_bf16 v[208:223], a[140:143], a[132:135], 0
buffer_load_dwordx4 v3, s[36:39], s61 offen offset:1024 lds
ds_read_b64_tr_b16 a[198:199], v21 offset:13312
v_mfma_f32_32x32x16_bf16 a[16:31], a[128:131], a[156:159], 0
ds_read_b64_tr_b16 a[184:185], v22 offset:4096
ds_read_b64_tr_b16 a[186:187], v22 offset:5120
v_mfma_f32_32x32x16_bf16 a[80:95], a[132:135], a[156:159], 0
ds_read_b64_tr_b16 a[200:201], v22 offset:12288
ds_read_b64_tr_b16 a[202:203], v22 offset:13312
v_mfma_f32_32x32x16_bf16 v[160:175], a[144:147], a[128:131], 0
ds_read_b64_tr_b16 a[188:189], v23 offset:4096
buffer_load_dwordx4 v4, s[36:39], s61 offen offset:2048 lds
v_mfma_f32_32x32x16_bf16 v[224:239], a[144:147], a[132:135], 0
ds_read_b64_tr_b16 a[190:191], v23 offset:5120
ds_read_b64_tr_b16 a[204:205], v23 offset:12288
v_mfma_f32_32x32x16_bf16 a[32:47], a[128:131], a[160:163], 0
ds_read_b64_tr_b16 a[206:207], v23 offset:13312
s_add_u32 s62, s62, 16384
s_and_b32 s62, s62, 65535
v_add_u32 v20, s62, v12
v_add_u32 v21, s62, v13
v_add_u32 v22, s62, v14
v_mfma_f32_32x32x16_bf16 a[96:111], a[132:135], a[160:163], 0
buffer_load_dwordx4 v5, s[36:39], s61 offen offset:3072 lds
v_add_u32 v23, s62, v15
v_mfma_f32_32x32x16_bf16 v[176:191], a[148:151], a[128:131], 0
v_mfma_f32_32x32x16_bf16 v[240:255], a[148:151], a[132:135], 0
v_mfma_f32_32x32x16_bf16 a[48:63], a[128:131], a[164:167], 0
v_mfma_f32_32x32x16_bf16 a[112:127], a[132:135], a[164:167], 0
s_waitcnt lgkmcnt(0)
v_mfma_f32_32x32x16_bf16 v[128:143], a[176:179], a[168:171], v[128:143]
s_waitcnt vmcnt(20)
s_barrier
v_mfma_f32_32x32x16_bf16 v[192:207], a[176:179], a[172:175], v[192:207]
ds_read_b128 a[128:131], v18
ds_read_b128 a[132:135], v18 offset:4096
v_mov_b32 v98, 0x3b000000
v_mov_b32 v99, 0x3727c5ac
s_add_u32 m0, s54, s57
v_mov_b32 v100, 0xbfb8aa3b
v_mfma_f32_32x32x16_bf16 a[0:15], a[168:171], a[192:195], a[0:15]
ds_read_b64_tr_b16 a[136:137], v20
ds_read_b64_tr_b16 a[138:139], v20 offset:1024
v_mov_b32 v104, 0
v_lshlrev_b32 v52, 16, v32
v_and_b32 v53, 0xffff0000, v32
v_lshlrev_b32 v54, 16, v33
v_mfma_f32_32x32x16_bf16 a[64:79], a[172:175], a[192:195], a[64:79]
buffer_load_dwordx4 v6, s[40:43], s53 offen lds
ds_read_b64_tr_b16 a[152:153], v20 offset:8192
v_and_b32 v55, 0xffff0000, v33
v_lshlrev_b32 v56, 16, v34
v_and_b32 v57, 0xffff0000, v34
v_mfma_f32_32x32x16_bf16 v[144:159], a[180:183], a[168:171], v[144:159]
ds_read_b64_tr_b16 a[154:155], v20 offset:9216
ds_read_b64_tr_b16 a[140:141], v21
v_lshlrev_b32 v58, 16, v35
v_and_b32 v59, 0xffff0000, v35
v_lshlrev_b32 v60, 16, v36
v_and_b32 v61, 0xffff0000, v36
v_mfma_f32_32x32x16_bf16 v[208:223], a[180:183], a[172:175], v[208:223]
ds_read_b64_tr_b16 a[142:143], v21 offset:1024
ds_read_b64_tr_b16 a[156:157], v21 offset:8192
v_lshlrev_b32 v62, 16, v37
v_and_b32 v63, 0xffff0000, v37
v_lshlrev_b32 v64, 16, v38
v_and_b32 v65, 0xffff0000, v38
v_mfma_f32_32x32x16_bf16 a[16:31], a[168:171], a[196:199], a[16:31]
ds_read_b64_tr_b16 a[158:159], v21 offset:9216
buffer_load_dwordx4 v7, s[40:43], s53 offen offset:1024 lds
v_lshlrev_b32 v66, 16, v39
v_and_b32 v67, 0xffff0000, v39
v_lshlrev_b32 v84, 16, v48
v_mfma_f32_32x32x16_bf16 a[80:95], a[172:175], a[196:199], a[80:95]
ds_read_b64_tr_b16 a[144:145], v22
ds_read_b64_tr_b16 a[146:147], v22 offset:1024
v_and_b32 v85, 0xffff0000, v48
v_lshlrev_b32 v86, 16, v49
v_and_b32 v87, 0xffff0000, v49
v_lshlrev_b32 v88, 16, v50
v_mfma_f32_32x32x16_bf16 v[160:175], a[184:187], a[168:171], v[160:175]
ds_read_b64_tr_b16 a[160:161], v22 offset:8192
ds_read_b64_tr_b16 a[162:163], v22 offset:9216
v_and_b32 v89, 0xffff0000, v50
s_add_u32 m0, m0, 8192
v_lshlrev_b32 v90, 16, v51
v_and_b32 v91, 0xffff0000, v51
v_mfma_f32_32x32x16_bf16 v[224:239], a[184:187], a[172:175], v[224:239]
ds_read_b64_tr_b16 a[148:149], v23
ds_read_b64_tr_b16 a[150:151], v23 offset:1024
v_add_f32 v92, v52, v53
v_add_f32 v93, v60, v61
v_mul_f32 v94, v52, v84
v_mul_f32 v95, v60, v84
v_mfma_f32_32x32x16_bf16 a[32:47], a[168:171], a[200:203], a[32:47]
ds_read_b64_tr_b16 a[164:165], v23 offset:8192
buffer_load_dwordx4 v6, s[44:47], s53 offen lds
v_add_f32 v92, v92, v54
v_add_f32 v93, v93, v62
v_add_f32 v92, v92, v55
v_mfma_f32_32x32x16_bf16 a[96:111], a[172:175], a[200:203], a[96:111]
ds_read_b64_tr_b16 a[166:167], v23 offset:9216
v_add_f32 v93, v93, v63
v_add_f32 v92, v92, v56
v_add_f32 v93, v93, v64
v_add_f32 v92, v92, v57
v_mfma_f32_32x32x16_bf16 v[176:191], a[188:191], a[168:171], v[176:191]
buffer_load_dwordx4 v7, s[44:47], s53 offen offset:1024 lds
v_add_f32 v93, v93, v65
v_add_f32 v92, v92, v58
v_add_f32 v93, v93, v66
v_add_f32 v92, v92, v59
v_mfma_f32_32x32x16_bf16 v[240:255], a[188:191], a[172:175], v[240:255]
v_add_f32 v93, v93, v67
v_fmac_f32 v94, v53, v85
v_fmac_f32 v95, v61, v85
v_mfma_f32_32x32x16_bf16 a[48:63], a[168:171], a[204:207], a[48:63]
v_fmac_f32 v94, v54, v86
v_mfma_f32_32x32x16_bf16 a[112:127], a[172:175], a[204:207], a[112:127]
s_waitcnt lgkmcnt(0)
v_mfma_f32_32x32x16_bf16 v[128:143], a[136:139], a[128:131], v[128:143]
ds_read_b128 a[168:171], v19
ds_read_b128 a[172:175], v19 offset:4096
v_fmac_f32 v95, v62, v86
v_fmac_f32 v94, v55, v87
v_fmac_f32 v95, v63, v87
v_fmac_f32 v94, v56, v88
v_mfma_f32_32x32x16_bf16 v[192:207], a[136:139], a[132:135], v[192:207]
ds_read_b64_tr_b16 a[176:177], v20 offset:4096
v_fmac_f32 v95, v64, v88
v_fmac_f32 v94, v57, v89
s_add_u32 s53, s53, 262144
s_and_b32 s53, s53, 0x3fffff
s_add_u32 s54, s54, 16384
v_mfma_f32_32x32x16_bf16 a[0:15], a[128:131], a[152:155], a[0:15]
ds_read_b64_tr_b16 a[178:179], v20 offset:5120
s_and_b32 s54, s54, 65535
s_add_u32 m0, s58, s55
s_add_u32 m0, m0, 4096
s_add_u32 s61, s60, s52
v_fmac_f32 v95, v65, v89
v_mfma_f32_32x32x16_bf16 a[64:79], a[132:135], a[152:155], a[64:79]
buffer_load_dwordx4 v2, s[36:39], s61 offen lds
ds_read_b64_tr_b16 a[192:193], v20 offset:12288
v_fmac_f32 v94, v58, v90
v_fmac_f32 v95, v66, v90
v_fmac_f32 v94, v59, v91
v_mfma_f32_32x32x16_bf16 v[144:159], a[140:143], a[128:131], v[144:159]
ds_read_b64_tr_b16 a[194:195], v20 offset:13312
ds_read_b64_tr_b16 a[180:181], v21 offset:4096
v_fmac_f32 v95, v67, v91
s_nop 1
v_add_f32_dpp v92, v92, v92 quad_perm:[1,0,3,2] row_mask:0xf bank_mask:0xf
v_mfma_f32_32x32x16_bf16 v[208:223], a[140:143], a[132:135], v[208:223]
ds_read_b64_tr_b16 a[182:183], v21 offset:5120
ds_read_b64_tr_b16 a[196:197], v21 offset:12288
v_add_f32_dpp v93, v93, v93 quad_perm:[1,0,3,2] row_mask:0xf bank_mask:0xf
v_add_f32_dpp v94, v94, v94 quad_perm:[1,0,3,2] row_mask:0xf bank_mask:0xf
v_add_f32_dpp v95, v95, v95 quad_perm:[1,0,3,2] row_mask:0xf bank_mask:0xf
v_add_f32_dpp v92, v92, v92 quad_perm:[2,3,0,1] row_mask:0xf bank_mask:0xf
v_mfma_f32_32x32x16_bf16 a[16:31], a[128:131], a[156:159], a[16:31]
buffer_load_dwordx4 v3, s[36:39], s61 offen offset:1024 lds
ds_read_b64_tr_b16 a[198:199], v21 offset:13312
v_add_f32_dpp v93, v93, v93 quad_perm:[2,3,0,1] row_mask:0xf bank_mask:0xf
v_add_f32_dpp v94, v94, v94 quad_perm:[2,3,0,1] row_mask:0xf bank_mask:0xf
v_add_f32_dpp v95, v95, v95 quad_perm:[2,3,0,1] row_mask:0xf bank_mask:0xf
v_mfma_f32_32x32x16_bf16 a[80:95], a[132:135], a[156:159], a[80:95]
ds_read_b64_tr_b16 a[184:185], v22 offset:4096
ds_read_b64_tr_b16 a[186:187], v22 offset:5120
v_add_f32_dpp v92, v92, v92 row_half_mirror row_mask:0xf bank_mask:0xf
v_add_f32_dpp v93, v93, v93 row_half_mirror row_mask:0xf bank_mask:0xf
v_add_f32_dpp v94, v94, v94 row_half_mirror row_mask:0xf bank_mask:0xf
v_add_f32_dpp v95, v95, v95 row_half_mirror row_mask:0xf bank_mask:0xf
v_mfma_f32_32x32x16_bf16 v[160:175], a[144:147], a[128:131], v[160:175]
ds_read_b64_tr_b16 a[200:201], v22 offset:12288
ds_read_b64_tr_b16 a[202:203], v22 offset:13312
v_add_f32_dpp v92, v92, v92 row_mirror row_mask:0xf bank_mask:0xf
v_add_f32_dpp v93, v93, v93 row_mirror row_mask:0xf bank_mask:0xf
v_add_f32_dpp v94, v94, v94 row_mirror row_mask:0xf bank_mask:0xf
v_add_f32_dpp v95, v95, v95 row_mirror row_mask:0xf bank_mask:0xf
v_mfma_f32_32x32x16_bf16 v[224:239], a[144:147], a[132:135], v[224:239]
ds_read_b64_tr_b16 a[188:189], v23 offset:4096
ds_read_b64_tr_b16 a[190:191], v23 offset:5120
v_add_f32_dpp v92, v92, v92 row_bcast:15 row_mask:0xa bank_mask:0xf
v_add_f32_dpp v93, v93, v93 row_bcast:15 row_mask:0xa bank_mask:0xf
v_add_f32_dpp v94, v94, v94 row_bcast:15 row_mask:0xa bank_mask:0xf
v_add_f32_dpp v95, v95, v95 row_bcast:15 row_mask:0xa bank_mask:0xf
v_mfma_f32_32x32x16_bf16 a[32:47], a[128:131], a[160:163], a[32:47]
buffer_load_dwordx4 v4, s[36:39], s61 offen offset:2048 lds
ds_read_b64_tr_b16 a[204:205], v23 offset:12288
v_add_f32_dpp v92, v92, v92 row_bcast:31 row_mask:0xc bank_mask:0xf
v_add_f32_dpp v93, v93, v93 row_bcast:31 row_mask:0xc bank_mask:0xf
v_add_f32_dpp v94, v94, v94 row_bcast:31 row_mask:0xc bank_mask:0xf
v_mfma_f32_32x32x16_bf16 a[96:111], a[132:135], a[160:163], a[96:111]
ds_read_b64_tr_b16 a[206:207], v23 offset:13312
v_add_f32_dpp v95, v95, v95 row_bcast:31 row_mask:0xc bank_mask:0xf
s_add_u32 s62, s62, 16384
s_and_b32 s62, s62, 65535
v_add_u32 v20, s62, v12
v_add_u32 v21, s62, v13
v_mfma_f32_32x32x16_bf16 v[176:191], a[148:151], a[128:131], v[176:191]
v_add_u32 v22, s62, v14
v_add_u32 v23, s62, v15
s_add_u32 s63, s63, 8192
s_cmp_eq_u32 s63, 24576
s_cselect_b32 s63, 0, s63
v_add_u32 v16, s63, v8
v_mfma_f32_32x32x16_bf16 v[240:255], a[148:151], a[132:135], v[240:255]
v_add_u32 v17, s63, v9
v_add_u32 v18, s63, v10
v_add_u32 v19, s63, v11
s_nop 0
v_readlane_b32 s94, v92, 63
v_readlane_b32 s95, v93, 63
v_mfma_f32_32x32x16_bf16 a[48:63], a[128:131], a[164:167], a[48:63]
buffer_load_dwordx4 v5, s[36:39], s61 offen offset:3072 lds
v_readlane_b32 s96, v94, 63
v_readlane_b32 s97, v95, 63
s_nop 1
v_mfma_f32_32x32x16_bf16 a[112:127], a[132:135], a[164:167], a[112:127]
v_mul_f32 v96, s94, v98
v_mul_f32 v97, s95, v98
v_mul_f32 v102, s96, v100
v_mul_f32 v103, s97, v100
v_sub_f32 v52, v52, v96
s_add_u32 s52, s52, 128
s_and_b32 s52, s52, 1023
s_add_u32 s55, s55, 8192
s_cmp_eq_u32 s55, 24576
s_cselect_b32 s55, 0, s55
s_waitcnt lgkmcnt(0)
v_mfma_f32_32x32x16_bf16 v[128:143], a[176:179], a[168:171], v[128:143]
s_waitcnt vmcnt(16)
s_barrier
v_mfma_f32_32x32x16_bf16 v[192:207], a[176:179], a[172:175], v[192:207]
ds_read_b128 a[128:131], v16
ds_read_b128 a[132:135], v16 offset:4096
v_sub_f32 v60, v60, v97
v_sub_f32 v53, v53, v96
s_add_u32 m0, s54, s57
v_sub_f32 v61, v61, v97
v_mfma_f32_32x32x16_bf16 a[0:15], a[168:171], a[192:195], a[0:15]
ds_read_b64_tr_b16 a[136:137], v20
ds_read_b64_tr_b16 a[138:139], v20 offset:1024
v_sub_f32 v54, v54, v96
v_sub_f32 v62, v62, v97
v_sub_f32 v55, v55, v96
v_sub_f32 v63, v63, v97
v_mfma_f32_32x32x16_bf16 a[64:79], a[172:175], a[192:195], a[64:79]
buffer_load_dwordx4 v6, s[40:43], s53 offen lds
ds_read_b64_tr_b16 a[152:153], v20 offset:8192
v_sub_f32 v56, v56, v96
v_sub_f32 v64, v64, v97
v_sub_f32 v57, v57, v96
v_mfma_f32_32x32x16_bf16 v[144:159], a[180:183], a[168:171], v[144:159]
ds_read_b64_tr_b16 a[154:155], v20 offset:9216
ds_read_b64_tr_b16 a[140:141], v21
v_sub_f32 v65, v65, v97
v_sub_f32 v58, v58, v96
v_sub_f32 v66, v66, v97
v_sub_f32 v59, v59, v96
v_mfma_f32_32x32x16_bf16 v[208:223], a[180:183], a[172:175], v[208:223]
ds_read_b64_tr_b16 a[142:143], v21 offset:1024
ds_read_b64_tr_b16 a[156:157], v21 offset:8192
v_sub_f32 v67, v67, v97
v_exp_f32 v102, v102
v_mfma_f32_32x32x16_bf16 a[16:31], a[168:171], a[196:199], a[16:31]
ds_read_b64_tr_b16 a[158:159], v21 offset:9216
buffer_load_dwordx4 v7, s[40:43], s53 offen offset:1024 lds
v_exp_f32 v103, v103
v_mul_f32 v92, v52, v52
v_mfma_f32_32x32x16_bf16 a[80:95], a[172:175], a[196:199], a[80:95]
ds_read_b64_tr_b16 a[144:145], v22
ds_read_b64_tr_b16 a[146:147], v22 offset:1024
v_mul_f32 v93, v60, v60
v_fmac_f32 v92, v53, v53
v_fmac_f32 v93, v61, v61
v_fmac_f32 v92, v54, v54
v_mfma_f32_32x32x16_bf16 v[160:175], a[184:187], a[168:171], v[160:175]
ds_read_b64_tr_b16 a[160:161], v22 offset:8192
ds_read_b64_tr_b16 a[162:163], v22 offset:9216
v_fmac_f32 v93, v62, v62
v_fmac_f32 v92, v55, v55
v_fmac_f32 v93, v63, v63
v_fmac_f32 v92, v56, v56
v_mfma_f32_32x32x16_bf16 v[224:239], a[184:187], a[172:175], v[224:239]
ds_read_b64_tr_b16 a[148:149], v23
ds_read_b64_tr_b16 a[150:151], v23 offset:1024
s_add_u32 m0, m0, 8192
v_fmac_f32 v93, v64, v64
v_fmac_f32 v92, v57, v57
v_fmac_f32 v93, v65, v65
v_mfma_f32_32x32x16_bf16 a[32:47], a[168:171], a[200:203], a[32:47]
ds_read_b64_tr_b16 a[164:165], v23 offset:8192
buffer_load_dwordx4 v6, s[44:47], s53 offen lds
v_fmac_f32 v92, v58, v58
v_fmac_f32 v93, v66, v66
v_fmac_f32 v92, v59, v59
v_mfma_f32_32x32x16_bf16 a[96:111], a[172:175], a[200:203], a[96:111]
ds_read_b64_tr_b16 a[166:167], v23 offset:9216
v_fmac_f32 v93, v67, v67
v_add_f32 v102, 1.0, v102
v_add_f32 v103, 1.0, v103
s_nop 1
v_mfma_f32_32x32x16_bf16 v[176:191], a[188:191], a[168:171], v[176:191]
v_add_f32_dpp v92, v92, v92 quad_perm:[1,0,3,2] row_mask:0xf bank_mask:0xf
v_add_f32_dpp v93, v93, v93 quad_perm:[1,0,3,2] row_mask:0xf bank_mask:0xf
s_nop 0
v_add_f32_dpp v92, v92, v92 quad_perm:[2,3,0,1] row_mask:0xf bank_mask:0xf
v_add_f32_dpp v93, v93, v93 quad_perm:[2,3,0,1] row_mask:0xf bank_mask:0xf
s_nop 0
v_mfma_f32_32x32x16_bf16 v[240:255], a[188:191], a[172:175], v[240:255]
buffer_load_dwordx4 v7, s[44:47], s53 offen offset:1024 lds
v_add_f32_dpp v92, v92, v92 row_half_mirror row_mask:0xf bank_mask:0xf
v_add_f32_dpp v93, v93, v93 row_half_mirror row_mask:0xf bank_mask:0xf
s_nop 0
v_add_f32_dpp v92, v92, v92 row_mirror row_mask:0xf bank_mask:0xf
v_mfma_f32_32x32x16_bf16 a[48:63], a[168:171], a[204:207], a[48:63]
v_add_f32_dpp v93, v93, v93 row_mirror row_mask:0xf bank_mask:0xf
v_mfma_f32_32x32x16_bf16 a[112:127], a[172:175], a[204:207], a[112:127]
s_waitcnt lgkmcnt(0)
v_mfma_f32_32x32x16_bf16 v[128:143], a[136:139], a[128:131], v[128:143]
ds_read_b128 a[168:171], v17
ds_read_b128 a[172:175], v17 offset:4096
s_nop 0
v_add_f32_dpp v92, v92, v92 row_bcast:15 row_mask:0xa bank_mask:0xf
v_add_f32_dpp v93, v93, v93 row_bcast:15 row_mask:0xa bank_mask:0xf
s_nop 0
v_mfma_f32_32x32x16_bf16 v[192:207], a[136:139], a[132:135], v[192:207]
ds_read_b64_tr_b16 a[176:177], v20 offset:4096
v_add_f32_dpp v92, v92, v92 row_bcast:31 row_mask:0xc bank_mask:0xf
v_add_f32_dpp v93, v93, v93 row_bcast:31 row_mask:0xc bank_mask:0xf
s_add_u32 s53, s53, 262144
s_and_b32 s53, s53, 0x3fffff
s_add_u32 s54, s54, 16384
v_mfma_f32_32x32x16_bf16 a[0:15], a[128:131], a[152:155], a[0:15]
ds_read_b64_tr_b16 a[178:179], v20 offset:5120
s_and_b32 s54, s54, 65535
s_add_u32 s61, s59, s52
s_add_u32 m0, s58, s55
s_nop 0
s_nop 0
v_mfma_f32_32x32x16_bf16 a[64:79], a[132:135], a[152:155], a[64:79]
buffer_load_dwordx4 v2, s[36:39], s61 offen lds
ds_read_b64_tr_b16 a[192:193], v20 offset:12288
v_readlane_b32 s94, v92, 63
v_readlane_b32 s95, v93, 63
v_mfma_f32_32x32x16_bf16 v[144:159], a[140:143], a[128:131], v[144:159]
ds_read_b64_tr_b16 a[194:195], v20 offset:13312
ds_read_b64_tr_b16 a[180:181], v21 offset:4096
v_rcp_f32 v102, v102
v_rcp_f32 v103, v103
v_mfma_f32_32x32x16_bf16 v[208:223], a[140:143], a[132:135], v[208:223]
ds_read_b64_tr_b16 a[182:183], v21 offset:5120
ds_read_b64_tr_b16 a[196:197], v21 offset:12288
v_fma_f32 v96, s94, v98, v99
v_fma_f32 v97, s95, v98, v99
v_rsq_f32 v96, v96
v_mfma_f32_32x32x16_bf16 a[16:31], a[128:131], a[156:159], a[16:31]
buffer_load_dwordx4 v3, s[36:39], s61 offen offset:1024 lds
v_rsq_f32 v97, v97
s_nop 0
v_mul_f32 v52, v52, v96
v_mfma_f32_32x32x16_bf16 a[80:95], a[132:135], a[156:159], a[80:95]
ds_read_b64_tr_b16 a[198:199], v21 offset:13312
ds_read_b64_tr_b16 a[184:185], v22 offset:4096
v_mul_f32 v60, v60, v97
v_mul_f32 v53, v53, v96
v_mul_f32 v61, v61, v97
v_mul_f32 v54, v54, v96
v_mfma_f32_32x32x16_bf16 v[160:175], a[144:147], a[128:131], v[160:175]
ds_read_b64_tr_b16 a[186:187], v22 offset:5120
ds_read_b64_tr_b16 a[200:201], v22 offset:12288
v_mul_f32 v62, v62, v97
v_mul_f32 v55, v55, v96
v_mul_f32 v63, v63, v97
v_mul_f32 v56, v56, v96
v_mfma_f32_32x32x16_bf16 v[224:239], a[144:147], a[132:135], v[224:239]
ds_read_b64_tr_b16 a[202:203], v22 offset:13312
ds_read_b64_tr_b16 a[188:189], v23 offset:4096
v_mul_f32 v64, v64, v97
v_mul_f32 v57, v57, v96
v_mul_f32 v65, v65, v97
v_mul_f32 v58, v58, v96
v_mfma_f32_32x32x16_bf16 a[32:47], a[128:131], a[160:163], a[32:47]
ds_read_b64_tr_b16 a[190:191], v23 offset:5120
buffer_load_dwordx4 v4, s[36:39], s61 offen offset:2048 lds
v_mul_f32 v66, v66, v97
v_mul_f32 v59, v59, v96
v_mul_f32 v67, v67, v97
v_mfma_f32_32x32x16_bf16 a[96:111], a[132:135], a[160:163], a[96:111]
ds_read_b64_tr_b16 a[204:205], v23 offset:12288
ds_read_b64_tr_b16 a[206:207], v23 offset:13312
v_cvt_pk_bf16_f32 v32, v52, v53
v_cvt_pk_bf16_f32 v36, v60, v61
v_cvt_pk_bf16_f32 v33, v54, v55
s_add_u32 s62, s62, 16384
v_mfma_f32_32x32x16_bf16 v[176:191], a[148:151], a[128:131], v[176:191]
s_and_b32 s62, s62, 65535
v_add_u32 v20, s62, v12
v_add_u32 v21, s62, v13
v_add_u32 v22, s62, v14
v_add_u32 v23, s62, v15
v_cvt_pk_bf16_f32 v37, v62, v63
v_mfma_f32_32x32x16_bf16 v[240:255], a[148:151], a[132:135], v[240:255]
buffer_load_dwordx4 v5, s[36:39], s61 offen offset:3072 lds
v_cvt_pk_bf16_f32 v34, v56, v57
v_cvt_pk_bf16_f32 v38, v64, v65
v_cvt_pk_bf16_f32 v35, v58, v59
v_cvt_pk_bf16_f32 v39, v66, v67
v_mfma_f32_32x32x16_bf16 a[48:63], a[128:131], a[164:167], a[48:63]
s_add_u32 s93, s93, 65536
s_lshl_b32 s98, s92, 2
s_add_u32 s98, s98, 2228224
v_mfma_f32_32x32x16_bf16 a[112:127], a[132:135], a[164:167], a[112:127]
buffer_store_dwordx4 v[32:35], v30, s[48:51], s93 offen sc1
buffer_store_dwordx4 v[36:39], v30, s[48:51], s93 offen offset:1024 sc1
s_mov_b64 exec, 1
buffer_store_dwordx2 v[102:103], v104, s[48:51], s98 offen sc1
s_mov_b64 exec, -1
s_waitcnt lgkmcnt(0)
v_mfma_f32_32x32x16_bf16 v[128:143], a[176:179], a[168:171], v[128:143]
s_waitcnt vmcnt(23)
s_barrier
v_mfma_f32_32x32x16_bf16 v[192:207], a[176:179], a[172:175], v[192:207]
ds_read_b128 a[128:131], v18
ds_read_b128 a[132:135], v18 offset:4096
s_add_u32 m0, s54, s57
v_mfma_f32_32x32x16_bf16 a[0:15], a[168:171], a[192:195], a[0:15]
ds_read_b64_tr_b16 a[136:137], v20
ds_read_b64_tr_b16 a[138:139], v20 offset:1024
v_mfma_f32_32x32x16_bf16 a[64:79], a[172:175], a[192:195], a[64:79]
buffer_load_dwordx4 v6, s[40:43], s53 offen lds
ds_read_b64_tr_b16 a[152:153], v20 offset:8192
v_mfma_f32_32x32x16_bf16 v[144:159], a[180:183], a[168:171], v[144:159]
ds_read_b64_tr_b16 a[154:155], v20 offset:9216
ds_read_b64_tr_b16 a[140:141], v21
v_mfma_f32_32x32x16_bf16 v[208:223], a[180:183], a[172:175], v[208:223]
ds_read_b64_tr_b16 a[142:143], v21 offset:1024
ds_read_b64_tr_b16 a[156:157], v21 offset:8192
v_mfma_f32_32x32x16_bf16 a[16:31], a[168:171], a[196:199], a[16:31]
ds_read_b64_tr_b16 a[158:159], v21 offset:9216
buffer_load_dwordx4 v7, s[40:43], s53 offen offset:1024 lds
v_mfma_f32_32x32x16_bf16 a[80:95], a[172:175], a[196:199], a[80:95]
ds_read_b64_tr_b16 a[144:145], v22
ds_read_b64_tr_b16 a[146:147], v22 offset:1024
s_add_u32 m0, m0, 8192
v_mfma_f32_32x32x16_bf16 v[160:175], a[184:187], a[168:171], v[160:175]
ds_read_b64_tr_b16 a[160:161], v22 offset:8192
ds_read_b64_tr_b16 a[162:163], v22 offset:9216
v_mfma_f32_32x32x16_bf16 v[224:239], a[184:187], a[172:175], v[224:239]
ds_read_b64_tr_b16 a[148:149], v23
ds_read_b64_tr_b16 a[150:151], v23 offset:1024
v_mfma_f32_32x32x16_bf16 a[32:47], a[168:171], a[200:203], a[32:47]
ds_read_b64_tr_b16 a[164:165], v23 offset:8192
buffer_load_dwordx4 v6, s[44:47], s53 offen lds
v_mfma_f32_32x32x16_bf16 a[96:111], a[172:175], a[200:203], a[96:111]
ds_read_b64_tr_b16 a[166:167], v23 offset:9216
v_mfma_f32_32x32x16_bf16 v[176:191], a[188:191], a[168:171], v[176:191]
buffer_load_dwordx4 v7, s[44:47], s53 offen offset:1024 lds
v_mfma_f32_32x32x16_bf16 v[240:255], a[188:191], a[172:175], v[240:255]
v_mfma_f32_32x32x16_bf16 a[48:63], a[168:171], a[204:207], a[48:63]
v_mfma_f32_32x32x16_bf16 a[112:127], a[172:175], a[204:207], a[112:127]
s_waitcnt lgkmcnt(0)
v_mfma_f32_32x32x16_bf16 v[128:143], a[136:139], a[128:131], v[128:143]
ds_read_b128 a[168:171], v19
ds_read_b128 a[172:175], v19 offset:4096
s_mov_b32 s68, s8
s_mov_b32 s69, s9
s_add_u32 s53, s53, 262144
s_and_b32 s53, s53, 0x3fffff
v_mfma_f32_32x32x16_bf16 v[192:207], a[136:139], a[132:135], v[192:207]
ds_read_b64_tr_b16 a[176:177], v20 offset:4096
s_add_u32 s54, s54, 16384
s_and_b32 s54, s54, 65535
s_add_u32 m0, s58, s55
s_add_u32 m0, m0, 4096
s_add_u32 s61, s60, s52
v_mfma_f32_32x32x16_bf16 a[0:15], a[128:131], a[152:155], a[0:15]
buffer_load_dwordx4 v2, s[36:39], s61 offen lds
ds_read_b64_tr_b16 a[178:179], v20 offset:5120
s_mov_b32 s70, 4194304
s_mov_b32 s71, 0x20000
s_mov_b32 s99, 0
v_mfma_f32_32x32x16_bf16 a[64:79], a[132:135], a[152:155], a[64:79]
ds_read_b64_tr_b16 a[192:193], v20 offset:12288
ds_read_b64_tr_b16 a[194:195], v20 offset:13312
v_mfma_f32_32x32x16_bf16 v[144:159], a[140:143], a[128:131], v[144:159]
ds_read_b64_tr_b16 a[180:181], v21 offset:4096
ds_read_b64_tr_b16 a[182:183], v21 offset:5120
v_mfma_f32_32x32x16_bf16 v[208:223], a[140:143], a[132:135], v[208:223]
ds_read_b64_tr_b16 a[196:197], v21 offset:12288
s_mov_b32 exec_lo, 0xffff
s_mov_b32 exec_hi, 0x0
buffer_load_dword v120, v123, s[68:71], s99 offen
s_mov_b64 exec, -1
v_mfma_f32_32x32x16_bf16 a[16:31], a[128:131], a[156:159], a[16:31]
buffer_load_dwordx4 v3, s[36:39], s61 offen offset:1024 lds
ds_read_b64_tr_b16 a[198:199], v21 offset:13312
v_mfma_f32_32x32x16_bf16 a[80:95], a[132:135], a[156:159], a[80:95]
ds_read_b64_tr_b16 a[184:185], v22 offset:4096
ds_read_b64_tr_b16 a[186:187], v22 offset:5120
v_mfma_f32_32x32x16_bf16 v[160:175], a[144:147], a[128:131], v[160:175]
ds_read_b64_tr_b16 a[200:201], v22 offset:12288
ds_read_b64_tr_b16 a[202:203], v22 offset:13312
v_mfma_f32_32x32x16_bf16 v[224:239], a[144:147], a[132:135], v[224:239]
ds_read_b64_tr_b16 a[188:189], v23 offset:4096
ds_read_b64_tr_b16 a[190:191], v23 offset:5120
v_mfma_f32_32x32x16_bf16 a[32:47], a[128:131], a[160:163], a[32:47]
buffer_load_dwordx4 v4, s[36:39], s61 offen offset:2048 lds
ds_read_b64_tr_b16 a[204:205], v23 offset:12288
v_mfma_f32_32x32x16_bf16 a[96:111], a[132:135], a[160:163], a[96:111]
ds_read_b64_tr_b16 a[206:207], v23 offset:13312
s_add_u32 s62, s62, 16384
s_and_b32 s62, s62, 65535
v_add_u32 v20, s62, v12
v_add_u32 v21, s62, v13
v_add_u32 v22, s62, v14
v_mfma_f32_32x32x16_bf16 v[176:191], a[148:151], a[128:131], v[176:191]
v_add_u32 v23, s62, v15
s_add_u32 s63, s63, 8192
s_cmp_eq_u32 s63, 24576
s_cselect_b32 s63, 0, s63
v_add_u32 v16, s63, v8
v_add_u32 v17, s63, v9
v_mfma_f32_32x32x16_bf16 v[240:255], a[148:151], a[132:135], v[240:255]
buffer_load_dwordx4 v5, s[36:39], s61 offen offset:3072 lds
v_add_u32 v18, s63, v10
v_add_u32 v19, s63, v11
v_mfma_f32_32x32x16_bf16 a[48:63], a[128:131], a[164:167], a[48:63]
s_add_u32 s52, s52, 128
s_and_b32 s52, s52, 1023
s_add_u32 s55, s55, 8192
s_cmp_eq_u32 s55, 24576
s_cselect_b32 s55, 0, s55
v_mfma_f32_32x32x16_bf16 a[112:127], a[132:135], a[164:167], a[112:127]
s_waitcnt lgkmcnt(0)
v_mfma_f32_32x32x16_bf16 v[128:143], a[176:179], a[168:171], v[128:143]
s_waitcnt vmcnt(20)
s_barrier
v_mfma_f32_32x32x16_bf16 v[192:207], a[176:179], a[172:175], v[192:207]
ds_read_b128 a[128:131], v16
ds_read_b128 a[132:135], v16 offset:4096
s_add_u32 m0, s54, s57
v_mfma_f32_32x32x16_bf16 a[0:15], a[168:171], a[192:195], a[0:15]
ds_read_b64_tr_b16 a[136:137], v20
ds_read_b64_tr_b16 a[138:139], v20 offset:1024
v_mfma_f32_32x32x16_bf16 a[64:79], a[172:175], a[192:195], a[64:79]
buffer_load_dwordx4 v6, s[40:43], s53 offen lds
ds_read_b64_tr_b16 a[152:153], v20 offset:8192
v_mfma_f32_32x32x16_bf16 v[144:159], a[180:183], a[168:171], v[144:159]
ds_read_b64_tr_b16 a[154:155], v20 offset:9216
ds_read_b64_tr_b16 a[140:141], v21
v_mfma_f32_32x32x16_bf16 v[208:223], a[180:183], a[172:175], v[208:223]
ds_read_b64_tr_b16 a[142:143], v21 offset:1024
ds_read_b64_tr_b16 a[156:157], v21 offset:8192
v_mfma_f32_32x32x16_bf16 a[16:31], a[168:171], a[196:199], a[16:31]
ds_read_b64_tr_b16 a[158:159], v21 offset:9216
buffer_load_dwordx4 v7, s[40:43], s53 offen offset:1024 lds
v_mfma_f32_32x32x16_bf16 a[80:95], a[172:175], a[196:199], a[80:95]
ds_read_b64_tr_b16 a[144:145], v22
ds_read_b64_tr_b16 a[146:147], v22 offset:1024
s_add_u32 m0, m0, 8192
v_mfma_f32_32x32x16_bf16 v[160:175], a[184:187], a[168:171], v[160:175]
ds_read_b64_tr_b16 a[160:161], v22 offset:8192
ds_read_b64_tr_b16 a[162:163], v22 offset:9216
v_mfma_f32_32x32x16_bf16 v[224:239], a[184:187], a[172:175], v[224:239]
ds_read_b64_tr_b16 a[148:149], v23
ds_read_b64_tr_b16 a[150:151], v23 offset:1024
v_mfma_f32_32x32x16_bf16 a[32:47], a[168:171], a[200:203], a[32:47]
ds_read_b64_tr_b16 a[164:165], v23 offset:8192
buffer_load_dwordx4 v6, s[44:47], s53 offen lds
v_mfma_f32_32x32x16_bf16 a[96:111], a[172:175], a[200:203], a[96:111]
ds_read_b64_tr_b16 a[166:167], v23 offset:9216
v_mfma_f32_32x32x16_bf16 v[176:191], a[188:191], a[168:171], v[176:191]
buffer_load_dwordx4 v7, s[44:47], s53 offen offset:1024 lds
v_mfma_f32_32x32x16_bf16 v[240:255], a[188:191], a[172:175], v[240:255]
v_mfma_f32_32x32x16_bf16 a[48:63], a[168:171], a[204:207], a[48:63]
v_mfma_f32_32x32x16_bf16 a[112:127], a[172:175], a[204:207], a[112:127]
s_waitcnt lgkmcnt(0)
v_mfma_f32_32x32x16_bf16 v[128:143], a[136:139], a[128:131], v[128:143]
ds_read_b128 a[168:171], v17
ds_read_b128 a[172:175], v17 offset:4096
s_add_u32 s53, s53, 262144
s_and_b32 s53, s53, 0x3fffff
s_add_u32 s54, s54, 16384
s_and_b32 s54, s54, 65535
v_mfma_f32_32x32x16_bf16 v[192:207], a[136:139], a[132:135], v[192:207]
ds_read_b64_tr_b16 a[176:177], v20 offset:4096
ds_read_b64_tr_b16 a[178:179], v20 offset:5120
s_add_u32 s61, s59, s52
s_add_u32 m0, s58, s55
s_mov_b32 s99, 0
v_mfma_f32_32x32x16_bf16 a[0:15], a[128:131], a[152:155], a[0:15]
buffer_load_dwordx4 v2, s[36:39], s61 offen lds
ds_read_b64_tr_b16 a[192:193], v20 offset:12288
v_mfma_f32_32x32x16_bf16 a[64:79], a[132:135], a[152:155], a[64:79]
ds_read_b64_tr_b16 a[194:195], v20 offset:13312
ds_read_b64_tr_b16 a[180:181], v21 offset:4096
v_mfma_f32_32x32x16_bf16 v[144:159], a[140:143], a[128:131], v[144:159]
ds_read_b64_tr_b16 a[182:183], v21 offset:5120
ds_read_b64_tr_b16 a[196:197], v21 offset:12288
v_mfma_f32_32x32x16_bf16 v[208:223], a[140:143], a[132:135], v[208:223]
ds_read_b64_tr_b16 a[198:199], v21 offset:13312
s_mov_b32 exec_lo, 0xffff0000
s_mov_b32 exec_hi, 0x0
buffer_load_dword v120, v123, s[68:71], s99 offen
s_mov_b64 exec, -1
v_mfma_f32_32x32x16_bf16 a[16:31], a[128:131], a[156:159], a[16:31]
buffer_load_dwordx4 v3, s[36:39], s61 offen offset:1024 lds
ds_read_b64_tr_b16 a[184:185], v22 offset:4096
v_mfma_f32_32x32x16_bf16 a[80:95], a[132:135], a[156:159], a[80:95]
ds_read_b64_tr_b16 a[186:187], v22 offset:5120
ds_read_b64_tr_b16 a[200:201], v22 offset:12288
v_mfma_f32_32x32x16_bf16 v[160:175], a[144:147], a[128:131], v[160:175]
ds_read_b64_tr_b16 a[202:203], v22 offset:13312
ds_read_b64_tr_b16 a[188:189], v23 offset:4096
v_mfma_f32_32x32x16_bf16 v[224:239], a[144:147], a[132:135], v[224:239]
ds_read_b64_tr_b16 a[190:191], v23 offset:5120
buffer_load_dwordx4 v4, s[36:39], s61 offen offset:2048 lds
v_mfma_f32_32x32x16_bf16 a[32:47], a[128:131], a[160:163], a[32:47]
ds_read_b64_tr_b16 a[204:205], v23 offset:12288
ds_read_b64_tr_b16 a[206:207], v23 offset:13312
s_add_u32 s62, s62, 16384
s_and_b32 s62, s62, 65535
v_add_u32 v20, s62, v12
v_add_u32 v21, s62, v13
v_mfma_f32_32x32x16_bf16 a[96:111], a[132:135], a[160:163], a[96:111]
buffer_load_dwordx4 v5, s[36:39], s61 offen offset:3072 lds
v_add_u32 v22, s62, v14
v_add_u32 v23, s62, v15
v_mfma_f32_32x32x16_bf16 v[176:191], a[148:151], a[128:131], v[176:191]
v_mfma_f32_32x32x16_bf16 v[240:255], a[148:151], a[132:135], v[240:255]
v_mfma_f32_32x32x16_bf16 a[48:63], a[128:131], a[164:167], a[48:63]
v_mfma_f32_32x32x16_bf16 a[112:127], a[132:135], a[164:167], a[112:127]
s_waitcnt lgkmcnt(0)
v_mfma_f32_32x32x16_bf16 v[128:143], a[176:179], a[168:171], v[128:143]
s_waitcnt vmcnt(22)
s_barrier
v_mfma_f32_32x32x16_bf16 v[192:207], a[176:179], a[172:175], v[192:207]
ds_read_b128 a[128:131], v18
ds_read_b128 a[132:135], v18 offset:4096
s_add_u32 m0, s54, s57
v_mfma_f32_32x32x16_bf16 a[0:15], a[168:171], a[192:195], a[0:15]
ds_read_b64_tr_b16 a[136:137], v20
ds_read_b64_tr_b16 a[138:139], v20 offset:1024
v_mfma_f32_32x32x16_bf16 a[64:79], a[172:175], a[192:195], a[64:79]
buffer_load_dwordx4 v6, s[40:43], s53 offen lds
ds_read_b64_tr_b16 a[152:153], v20 offset:8192
v_mfma_f32_32x32x16_bf16 v[144:159], a[180:183], a[168:171], v[144:159]
ds_read_b64_tr_b16 a[154:155], v20 offset:9216
ds_read_b64_tr_b16 a[140:141], v21
v_mfma_f32_32x32x16_bf16 v[208:223], a[180:183], a[172:175], v[208:223]
ds_read_b64_tr_b16 a[142:143], v21 offset:1024
ds_read_b64_tr_b16 a[156:157], v21 offset:8192
v_mfma_f32_32x32x16_bf16 a[16:31], a[168:171], a[196:199], a[16:31]
ds_read_b64_tr_b16 a[158:159], v21 offset:9216
buffer_load_dwordx4 v7, s[40:43], s53 offen offset:1024 lds
v_mfma_f32_32x32x16_bf16 a[80:95], a[172:175], a[196:199], a[80:95]
ds_read_b64_tr_b16 a[144:145], v22
ds_read_b64_tr_b16 a[146:147], v22 offset:1024
s_add_u32 m0, m0, 8192
v_mfma_f32_32x32x16_bf16 v[160:175], a[184:187], a[168:171], v[160:175]
ds_read_b64_tr_b16 a[160:161], v22 offset:8192
ds_read_b64_tr_b16 a[162:163], v22 offset:9216
v_mfma_f32_32x32x16_bf16 v[224:239], a[184:187], a[172:175], v[224:239]
ds_read_b64_tr_b16 a[148:149], v23
ds_read_b64_tr_b16 a[150:151], v23 offset:1024
v_mfma_f32_32x32x16_bf16 a[32:47], a[168:171], a[200:203], a[32:47]
ds_read_b64_tr_b16 a[164:165], v23 offset:8192
buffer_load_dwordx4 v6, s[44:47], s53 offen lds
v_mfma_f32_32x32x16_bf16 a[96:111], a[172:175], a[200:203], a[96:111]
ds_read_b64_tr_b16 a[166:167], v23 offset:9216
v_mfma_f32_32x32x16_bf16 v[176:191], a[188:191], a[168:171], v[176:191]
buffer_load_dwordx4 v7, s[44:47], s53 offen offset:1024 lds
v_mfma_f32_32x32x16_bf16 v[240:255], a[188:191], a[172:175], v[240:255]
v_mfma_f32_32x32x16_bf16 a[48:63], a[168:171], a[204:207], a[48:63]
v_mfma_f32_32x32x16_bf16 a[112:127], a[172:175], a[204:207], a[112:127]
s_waitcnt lgkmcnt(0)
v_mfma_f32_32x32x16_bf16 v[128:143], a[136:139], a[128:131], v[128:143]
ds_read_b128 a[168:171], v19
ds_read_b128 a[172:175], v19 offset:4096
s_add_u32 s53, s53, 262144
s_and_b32 s53, s53, 0x3fffff
s_add_u32 s54, s54, 16384
s_and_b32 s54, s54, 65535
v_mfma_f32_32x32x16_bf16 v[192:207], a[136:139], a[132:135], v[192:207]
ds_read_b64_tr_b16 a[176:177], v20 offset:4096
ds_read_b64_tr_b16 a[178:179], v20 offset:5120
s_add_u32 m0, s58, s55
s_add_u32 m0, m0, 4096
s_add_u32 s61, s60, s52
v_mfma_f32_32x32x16_bf16 a[0:15], a[128:131], a[152:155], a[0:15]
buffer_load_dwordx4 v2, s[36:39], s61 offen lds
ds_read_b64_tr_b16 a[192:193], v20 offset:12288
v_mfma_f32_32x32x16_bf16 a[64:79], a[132:135], a[152:155], a[64:79]
ds_read_b64_tr_b16 a[194:195], v20 offset:13312
ds_read_b64_tr_b16 a[180:181], v21 offset:4096
v_mfma_f32_32x32x16_bf16 v[144:159], a[140:143], a[128:131], v[144:159]
ds_read_b64_tr_b16 a[182:183], v21 offset:5120
ds_read_b64_tr_b16 a[196:197], v21 offset:12288
v_mfma_f32_32x32x16_bf16 v[208:223], a[140:143], a[132:135], v[208:223]
buffer_load_dwordx4 v3, s[36:39], s61 offen offset:1024 lds
ds_read_b64_tr_b16 a[198:199], v21 offset:13312
v_mfma_f32_32x32x16_bf16 a[16:31], a[128:131], a[156:159], a[16:31]
ds_read_b64_tr_b16 a[184:185], v22 offset:4096
ds_read_b64_tr_b16 a[186:187], v22 offset:5120
v_mfma_f32_32x32x16_bf16 a[80:95], a[132:135], a[156:159], a[80:95]
ds_read_b64_tr_b16 a[200:201], v22 offset:12288
ds_read_b64_tr_b16 a[202:203], v22 offset:13312
v_mfma_f32_32x32x16_bf16 v[160:175], a[144:147], a[128:131], v[160:175]
ds_read_b64_tr_b16 a[188:189], v23 offset:4096
ds_read_b64_tr_b16 a[190:191], v23 offset:5120
v_mfma_f32_32x32x16_bf16 v[224:239], a[144:147], a[132:135], v[224:239]
buffer_load_dwordx4 v4, s[36:39], s61 offen offset:2048 lds
ds_read_b64_tr_b16 a[204:205], v23 offset:12288
v_mfma_f32_32x32x16_bf16 a[32:47], a[128:131], a[160:163], a[32:47]
ds_read_b64_tr_b16 a[206:207], v23 offset:13312
s_add_u32 s62, s62, 16384
s_and_b32 s62, s62, 65535
v_add_u32 v20, s62, v12
v_add_u32 v21, s62, v13
v_add_u32 v22, s62, v14
v_mfma_f32_32x32x16_bf16 a[96:111], a[132:135], a[160:163], a[96:111]
v_add_u32 v23, s62, v15
s_add_u32 s63, s63, 8192
s_cmp_eq_u32 s63, 24576
s_cselect_b32 s63, 0, s63
v_add_u32 v16, s63, v8
v_add_u32 v17, s63, v9
v_mfma_f32_32x32x16_bf16 v[176:191], a[148:151], a[128:131], v[176:191]
buffer_load_dwordx4 v5, s[36:39], s61 offen offset:3072 lds
v_add_u32 v18, s63, v10
v_add_u32 v19, s63, v11
v_mfma_f32_32x32x16_bf16 v[240:255], a[148:151], a[132:135], v[240:255]
v_mfma_f32_32x32x16_bf16 a[48:63], a[128:131], a[164:167], a[48:63]
s_add_u32 s52, s52, 128
s_and_b32 s52, s52, 1023
s_add_u32 s55, s55, 8192
s_cmp_eq_u32 s55, 24576
s_cselect_b32 s55, 0, s55
v_mfma_f32_32x32x16_bf16 a[112:127], a[132:135], a[164:167], a[112:127]
s_waitcnt lgkmcnt(0)
v_mfma_f32_32x32x16_bf16 v[128:143], a[176:179], a[168:171], v[128:143]
s_waitcnt vmcnt(17)
s_barrier
v_mfma_f32_32x32x16_bf16 v[192:207], a[176:179], a[172:175], v[192:207]
ds_read_b128 a[128:131], v16
ds_read_b128 a[132:135], v16 offset:4096
s_add_u32 m0, s54, s57
v_mfma_f32_32x32x16_bf16 a[0:15], a[168:171], a[192:195], a[0:15]
ds_read_b64_tr_b16 a[136:137], v20
ds_read_b64_tr_b16 a[138:139], v20 offset:1024
v_mfma_f32_32x32x16_bf16 a[64:79], a[172:175], a[192:195], a[64:79]
buffer_load_dwordx4 v6, s[40:43], s53 offen lds
ds_read_b64_tr_b16 a[152:153], v20 offset:8192
v_mfma_f32_32x32x16_bf16 v[144:159], a[180:183], a[168:171], v[144:159]
ds_read_b64_tr_b16 a[154:155], v20 offset:9216
ds_read_b64_tr_b16 a[140:141], v21
v_mfma_f32_32x32x16_bf16 v[208:223], a[180:183], a[172:175], v[208:223]
ds_read_b64_tr_b16 a[142:143], v21 offset:1024
ds_read_b64_tr_b16 a[156:157], v21 offset:8192
v_mfma_f32_32x32x16_bf16 a[16:31], a[168:171], a[196:199], a[16:31]
ds_read_b64_tr_b16 a[158:159], v21 offset:9216
buffer_load_dwordx4 v7, s[40:43], s53 offen offset:1024 lds
v_mfma_f32_32x32x16_bf16 a[80:95], a[172:175], a[196:199], a[80:95]
ds_read_b64_tr_b16 a[144:145], v22
ds_read_b64_tr_b16 a[146:147], v22 offset:1024
s_add_u32 m0, m0, 8192
v_mfma_f32_32x32x16_bf16 v[160:175], a[184:187], a[168:171], v[160:175]
ds_read_b64_tr_b16 a[160:161], v22 offset:8192
ds_read_b64_tr_b16 a[162:163], v22 offset:9216
v_mfma_f32_32x32x16_bf16 v[224:239], a[184:187], a[172:175], v[224:239]
ds_read_b64_tr_b16 a[148:149], v23
ds_read_b64_tr_b16 a[150:151], v23 offset:1024
v_mfma_f32_32x32x16_bf16 a[32:47], a[168:171], a[200:203], a[32:47]
ds_read_b64_tr_b16 a[164:165], v23 offset:8192
buffer_load_dwordx4 v6, s[44:47], s53 offen lds
v_mfma_f32_32x32x16_bf16 a[96:111], a[172:175], a[200:203], a[96:111]
ds_read_b64_tr_b16 a[166:167], v23 offset:9216
v_mfma_f32_32x32x16_bf16 v[176:191], a[188:191], a[168:171], v[176:191]
buffer_load_dwordx4 v7, s[44:47], s53 offen offset:1024 lds
v_mfma_f32_32x32x16_bf16 v[240:255], a[188:191], a[172:175], v[240:255]
v_mfma_f32_32x32x16_bf16 a[48:63], a[168:171], a[204:207], a[48:63]
v_mfma_f32_32x32x16_bf16 a[112:127], a[172:175], a[204:207], a[112:127]
s_waitcnt lgkmcnt(0)
v_mfma_f32_32x32x16_bf16 v[128:143], a[136:139], a[128:131], v[128:143]
ds_read_b128 a[168:171], v17
ds_read_b128 a[172:175], v17 offset:4096
s_add_u32 s53, s53, 262144
s_and_b32 s53, s53, 0x3fffff
s_add_u32 s54, s54, 16384
s_and_b32 s54, s54, 65535
v_mfma_f32_32x32x16_bf16 v[192:207], a[136:139], a[132:135], v[192:207]
ds_read_b64_tr_b16 a[176:177], v20 offset:4096
ds_read_b64_tr_b16 a[178:179], v20 offset:5120
s_add_u32 s61, s59, s52
s_add_u32 m0, s58, s55
v_mfma_f32_32x32x16_bf16 a[0:15], a[128:131], a[152:155], a[0:15]
buffer_load_dwordx4 v2, s[36:39], s61 offen lds
ds_read_b64_tr_b16 a[192:193], v20 offset:12288
v_mfma_f32_32x32x16_bf16 a[64:79], a[132:135], a[152:155], a[64:79]
ds_read_b64_tr_b16 a[194:195], v20 offset:13312
ds_read_b64_tr_b16 a[180:181], v21 offset:4096
v_mfma_f32_32x32x16_bf16 v[144:159], a[140:143], a[128:131], v[144:159]
ds_read_b64_tr_b16 a[182:183], v21 offset:5120
ds_read_b64_tr_b16 a[196:197], v21 offset:12288
v_mfma_f32_32x32x16_bf16 v[208:223], a[140:143], a[132:135], v[208:223]
buffer_load_dwordx4 v3, s[36:39], s61 offen offset:1024 lds
ds_read_b64_tr_b16 a[198:199], v21 offset:13312
v_mfma_f32_32x32x16_bf16 a[16:31], a[128:131], a[156:159], a[16:31]
ds_read_b64_tr_b16 a[184:185], v22 offset:4096
ds_read_b64_tr_b16 a[186:187], v22 offset:5120
v_mfma_f32_32x32x16_bf16 a[80:95], a[132:135], a[156:159], a[80:95]
ds_read_b64_tr_b16 a[200:201], v22 offset:12288
ds_read_b64_tr_b16 a[202:203], v22 offset:13312
v_mfma_f32_32x32x16_bf16 v[160:175], a[144:147], a[128:131], v[160:175]
ds_read_b64_tr_b16 a[188:189], v23 offset:4096
ds_read_b64_tr_b16 a[190:191], v23 offset:5120
v_mfma_f32_32x32x16_bf16 v[224:239], a[144:147], a[132:135], v[224:239]
buffer_load_dwordx4 v4, s[36:39], s61 offen offset:2048 lds
ds_read_b64_tr_b16 a[204:205], v23 offset:12288
v_mfma_f32_32x32x16_bf16 a[32:47], a[128:131], a[160:163], a[32:47]
ds_read_b64_tr_b16 a[206:207], v23 offset:13312
s_add_u32 s62, s62, 16384
s_and_b32 s62, s62, 65535
v_add_u32 v20, s62, v12
v_add_u32 v21, s62, v13
v_add_u32 v22, s62, v14
v_mfma_f32_32x32x16_bf16 a[96:111], a[132:135], a[160:163], a[96:111]
buffer_load_dwordx4 v5, s[36:39], s61 offen offset:3072 lds
v_add_u32 v23, s62, v15
v_mfma_f32_32x32x16_bf16 v[176:191], a[148:151], a[128:131], v[176:191]
v_mfma_f32_32x32x16_bf16 v[240:255], a[148:151], a[132:135], v[240:255]
v_mfma_f32_32x32x16_bf16 a[48:63], a[128:131], a[164:167], a[48:63]
v_mfma_f32_32x32x16_bf16 a[112:127], a[132:135], a[164:167], a[112:127]
s_cmp_lg_u32 s34, 0
s_cbranch_scc1 W2
s_mov_b32 s92, s30
s_mov_b32 s93, s31
s_mov_b32 s94, 256
s_mov_b32 s95, 0x20000
s_and_b32 s96, s2, 1
s_lshl_b32 s96, s96, 7
v_mov_b32 v126, 1
v_mov_b32 v127, 0
s_mov_b64 exec, 1
buffer_atomic_add v126, v127, s[92:95], s96 offen
s_mov_b64 exec, -1
W2:
s_waitcnt lgkmcnt(0)
v_mfma_f32_32x32x16_bf16 v[128:143], a[176:179], a[168:171], v[128:143]
s_waitcnt vmcnt(20)
s_barrier
v_mfma_f32_32x32x16_bf16 v[192:207], a[176:179], a[172:175], v[192:207]
ds_read_b128 a[128:131], v18
ds_read_b128 a[132:135], v18 offset:4096
s_add_u32 m0, s54, s57
v_mfma_f32_32x32x16_bf16 a[0:15], a[168:171], a[192:195], a[0:15]
ds_read_b64_tr_b16 a[136:137], v20
ds_read_b64_tr_b16 a[138:139], v20 offset:1024
v_mfma_f32_32x32x16_bf16 a[64:79], a[172:175], a[192:195], a[64:79]
buffer_load_dwordx4 v6, s[40:43], s53 offen lds
ds_read_b64_tr_b16 a[152:153], v20 offset:8192
v_mfma_f32_32x32x16_bf16 v[144:159], a[180:183], a[168:171], v[144:159]
ds_read_b64_tr_b16 a[154:155], v20 offset:9216
ds_read_b64_tr_b16 a[140:141], v21
v_mfma_f32_32x32x16_bf16 v[208:223], a[180:183], a[172:175], v[208:223]
ds_read_b64_tr_b16 a[142:143], v21 offset:1024
ds_read_b64_tr_b16 a[156:157], v21 offset:8192
v_mfma_f32_32x32x16_bf16 a[16:31], a[168:171], a[196:199], a[16:31]
ds_read_b64_tr_b16 a[158:159], v21 offset:9216
buffer_load_dwordx4 v7, s[40:43], s53 offen offset:1024 lds
v_mfma_f32_32x32x16_bf16 a[80:95], a[172:175], a[196:199], a[80:95]
ds_read_b64_tr_b16 a[144:145], v22
ds_read_b64_tr_b16 a[146:147], v22 offset:1024
s_add_u32 m0, m0, 8192
v_mfma_f32_32x32x16_bf16 v[160:175], a[184:187], a[168:171], v[160:175]
ds_read_b64_tr_b16 a[160:161], v22 offset:8192
ds_read_b64_tr_b16 a[162:163], v22 offset:9216
v_mfma_f32_32x32x16_bf16 v[224:239], a[184:187], a[172:175], v[224:239]
ds_read_b64_tr_b16 a[148:149], v23
ds_read_b64_tr_b16 a[150:151], v23 offset:1024
v_mfma_f32_32x32x16_bf16 a[32:47], a[168:171], a[200:203], a[32:47]
ds_read_b64_tr_b16 a[164:165], v23 offset:8192
buffer_load_dwordx4 v6, s[44:47], s53 offen lds
v_mfma_f32_32x32x16_bf16 a[96:111], a[172:175], a[200:203], a[96:111]
ds_read_b64_tr_b16 a[166:167], v23 offset:9216
v_mfma_f32_32x32x16_bf16 v[176:191], a[188:191], a[168:171], v[176:191]
buffer_load_dwordx4 v7, s[44:47], s53 offen offset:1024 lds
v_mfma_f32_32x32x16_bf16 v[240:255], a[188:191], a[172:175], v[240:255]
v_mfma_f32_32x32x16_bf16 a[48:63], a[168:171], a[204:207], a[48:63]
v_mfma_f32_32x32x16_bf16 a[112:127], a[172:175], a[204:207], a[112:127]
s_waitcnt lgkmcnt(0)
v_mfma_f32_32x32x16_bf16 v[128:143], a[136:139], a[128:131], v[128:143]
ds_read_b128 a[168:171], v19
ds_read_b128 a[172:175], v19 offset:4096
s_add_u32 s53, s53, 262144
s_and_b32 s53, s53, 0x3fffff
s_add_u32 s54, s54, 16384
s_and_b32 s54, s54, 65535
v_mfma_f32_32x32x16_bf16 v[192:207], a[136:139], a[132:135], v[192:207]
ds_read_b64_tr_b16 a[176:177], v20 offset:4096
ds_read_b64_tr_b16 a[178:179], v20 offset:5120
s_add_u32 m0, s58, s55
s_add_u32 m0, m0, 4096
s_add_u32 s61, s60, s52
v_mfma_f32_32x32x16_bf16 a[0:15], a[128:131], a[152:155], a[0:15]
buffer_load_dwordx4 v2, s[36:39], s61 offen lds
ds_read_b64_tr_b16 a[192:193], v20 offset:12288
v_mfma_f32_32x32x16_bf16 a[64:79], a[132:135], a[152:155], a[64:79]
ds_read_b64_tr_b16 a[194:195], v20 offset:13312
ds_read_b64_tr_b16 a[180:181], v21 offset:4096
v_mfma_f32_32x32x16_bf16 v[144:159], a[140:143], a[128:131], v[144:159]
ds_read_b64_tr_b16 a[182:183], v21 offset:5120
ds_read_b64_tr_b16 a[196:197], v21 offset:12288
v_mfma_f32_32x32x16_bf16 v[208:223], a[140:143], a[132:135], v[208:223]
buffer_load_dwordx4 v3, s[36:39], s61 offen offset:1024 lds
ds_read_b64_tr_b16 a[198:199], v21 offset:13312
v_mfma_f32_32x32x16_bf16 a[16:31], a[128:131], a[156:159], a[16:31]
ds_read_b64_tr_b16 a[184:185], v22 offset:4096
ds_read_b64_tr_b16 a[186:187], v22 offset:5120
v_mfma_f32_32x32x16_bf16 a[80:95], a[132:135], a[156:159], a[80:95]
ds_read_b64_tr_b16 a[200:201], v22 offset:12288
ds_read_b64_tr_b16 a[202:203], v22 offset:13312
v_mfma_f32_32x32x16_bf16 v[160:175], a[144:147], a[128:131], v[160:175]
ds_read_b64_tr_b16 a[188:189], v23 offset:4096
ds_read_b64_tr_b16 a[190:191], v23 offset:5120
v_mfma_f32_32x32x16_bf16 v[224:239], a[144:147], a[132:135], v[224:239]
buffer_load_dwordx4 v4, s[36:39], s61 offen offset:2048 lds
ds_read_b64_tr_b16 a[204:205], v23 offset:12288
v_mfma_f32_32x32x16_bf16 a[32:47], a[128:131], a[160:163], a[32:47]
ds_read_b64_tr_b16 a[206:207], v23 offset:13312
s_add_u32 s62, s62, 16384
s_and_b32 s62, s62, 65535
v_add_u32 v20, s62, v12
v_add_u32 v21, s62, v13
v_add_u32 v22, s62, v14
v_mfma_f32_32x32x16_bf16 a[96:111], a[132:135], a[160:163], a[96:111]
v_add_u32 v23, s62, v15
s_add_u32 s63, s63, 8192
s_cmp_eq_u32 s63, 24576
s_cselect_b32 s63, 0, s63
v_add_u32 v16, s63, v8
v_add_u32 v17, s63, v9
v_mfma_f32_32x32x16_bf16 v[176:191], a[148:151], a[128:131], v[176:191]
buffer_load_dwordx4 v5, s[36:39], s61 offen offset:3072 lds
v_add_u32 v18, s63, v10
v_add_u32 v19, s63, v11
v_mfma_f32_32x32x16_bf16 v[240:255], a[148:151], a[132:135], v[240:255]
v_mfma_f32_32x32x16_bf16 a[48:63], a[128:131], a[164:167], a[48:63]
s_add_u32 s52, s52, 128
s_and_b32 s52, s52, 1023
s_add_u32 s55, s55, 8192
s_cmp_eq_u32 s55, 24576
s_cselect_b32 s55, 0, s55
v_mfma_f32_32x32x16_bf16 a[112:127], a[132:135], a[164:167], a[112:127]
s_waitcnt lgkmcnt(0)
v_mfma_f32_32x32x16_bf16 v[128:143], a[176:179], a[168:171], v[128:143]
s_waitcnt vmcnt(16)
s_barrier
v_mfma_f32_32x32x16_bf16 v[192:207], a[176:179], a[172:175], v[192:207]
ds_read_b128 a[128:131], v16
ds_read_b128 a[132:135], v16 offset:4096
s_add_u32 m0, s54, s57
v_mfma_f32_32x32x16_bf16 a[0:15], a[168:171], a[192:195], a[0:15]
ds_read_b64_tr_b16 a[136:137], v20
ds_read_b64_tr_b16 a[138:139], v20 offset:1024
v_mfma_f32_32x32x16_bf16 a[64:79], a[172:175], a[192:195], a[64:79]
buffer_load_dwordx4 v6, s[40:43], s53 offen lds
ds_read_b64_tr_b16 a[152:153], v20 offset:8192
v_mfma_f32_32x32x16_bf16 v[144:159], a[180:183], a[168:171], v[144:159]
ds_read_b64_tr_b16 a[154:155], v20 offset:9216
ds_read_b64_tr_b16 a[140:141], v21
v_mfma_f32_32x32x16_bf16 v[208:223], a[180:183], a[172:175], v[208:223]
ds_read_b64_tr_b16 a[142:143], v21 offset:1024
ds_read_b64_tr_b16 a[156:157], v21 offset:8192
v_mfma_f32_32x32x16_bf16 a[16:31], a[168:171], a[196:199], a[16:31]
ds_read_b64_tr_b16 a[158:159], v21 offset:9216
buffer_load_dwordx4 v7, s[40:43], s53 offen offset:1024 lds
v_mfma_f32_32x32x16_bf16 a[80:95], a[172:175], a[196:199], a[80:95]
ds_read_b64_tr_b16 a[144:145], v22
ds_read_b64_tr_b16 a[146:147], v22 offset:1024
s_add_u32 m0, m0, 8192
v_mfma_f32_32x32x16_bf16 v[160:175], a[184:187], a[168:171], v[160:175]
ds_read_b64_tr_b16 a[160:161], v22 offset:8192
ds_read_b64_tr_b16 a[162:163], v22 offset:9216
v_mfma_f32_32x32x16_bf16 v[224:239], a[184:187], a[172:175], v[224:239]
ds_read_b64_tr_b16 a[148:149], v23
ds_read_b64_tr_b16 a[150:151], v23 offset:1024
v_mfma_f32_32x32x16_bf16 a[32:47], a[168:171], a[200:203], a[32:47]
ds_read_b64_tr_b16 a[164:165], v23 offset:8192
buffer_load_dwordx4 v6, s[44:47], s53 offen lds
v_mfma_f32_32x32x16_bf16 a[96:111], a[172:175], a[200:203], a[96:111]
ds_read_b64_tr_b16 a[166:167], v23 offset:9216
v_mfma_f32_32x32x16_bf16 v[176:191], a[188:191], a[168:171], v[176:191]
buffer_load_dwordx4 v7, s[44:47], s53 offen offset:1024 lds
v_mfma_f32_32x32x16_bf16 v[240:255], a[188:191], a[172:175], v[240:255]
v_mfma_f32_32x32x16_bf16 a[48:63], a[168:171], a[204:207], a[48:63]
v_mfma_f32_32x32x16_bf16 a[112:127], a[172:175], a[204:207], a[112:127]
s_waitcnt lgkmcnt(0)
v_mfma_f32_32x32x16_bf16 v[128:143], a[136:139], a[128:131], v[128:143]
ds_read_b128 a[168:171], v17
ds_read_b128 a[172:175], v17 offset:4096
s_mov_b32 s68, s18
s_mov_b32 s69, s19
s_add_u32 s53, s53, 262144
s_and_b32 s53, s53, 0x3fffff
v_mfma_f32_32x32x16_bf16 v[192:207], a[136:139], a[132:135], v[192:207]
ds_read_b64_tr_b16 a[176:177], v20 offset:4096
s_add_u32 s54, s54, 16384
s_and_b32 s54, s54, 65535
s_add_u32 s61, s59, s52
s_add_u32 m0, s58, s55
s_mov_b32 s70, 7340032
v_mfma_f32_32x32x16_bf16 a[0:15], a[128:131], a[152:155], a[0:15]
buffer_load_dwordx4 v2, s[36:39], s61 offen lds
ds_read_b64_tr_b16 a[178:179], v20 offset:5120
s_mov_b32 s71, 0x20000
s_mov_b32 s99, 0
v_mfma_f32_32x32x16_bf16 a[64:79], a[132:135], a[152:155], a[64:79]
ds_read_b64_tr_b16 a[192:193], v20 offset:12288
ds_read_b64_tr_b16 a[194:195], v20 offset:13312
v_mfma_f32_32x32x16_bf16 v[144:159], a[140:143], a[128:131], v[144:159]
ds_read_b64_tr_b16 a[180:181], v21 offset:4096
ds_read_b64_tr_b16 a[182:183], v21 offset:5120
v_mfma_f32_32x32x16_bf16 v[208:223], a[140:143], a[132:135], v[208:223]
ds_read_b64_tr_b16 a[196:197], v21 offset:12288
s_mov_b32 exec_lo, 0x3fff
s_mov_b32 exec_hi, 0x0
buffer_load_dword v119, v125, s[68:71], s99 offen
s_mov_b64 exec, -1
v_mfma_f32_32x32x16_bf16 a[16:31], a[128:131], a[156:159], a[16:31]
buffer_load_dwordx4 v3, s[36:39], s61 offen offset:1024 lds
ds_read_b64_tr_b16 a[198:199], v21 offset:13312
v_mfma_f32_32x32x16_bf16 a[80:95], a[132:135], a[156:159], a[80:95]
ds_read_b64_tr_b16 a[184:185], v22 offset:4096
ds_read_b64_tr_b16 a[186:187], v22 offset:5120
v_mfma_f32_32x32x16_bf16 v[160:175], a[144:147], a[128:131], v[160:175]
ds_read_b64_tr_b16 a[200:201], v22 offset:12288
ds_read_b64_tr_b16 a[202:203], v22 offset:13312
v_mfma_f32_32x32x16_bf16 v[224:239], a[144:147], a[132:135], v[224:239]
ds_read_b64_tr_b16 a[188:189], v23 offset:4096
ds_read_b64_tr_b16 a[190:191], v23 offset:5120
v_mfma_f32_32x32x16_bf16 a[32:47], a[128:131], a[160:163], a[32:47]
buffer_load_dwordx4 v4, s[36:39], s61 offen offset:2048 lds
ds_read_b64_tr_b16 a[204:205], v23 offset:12288
v_mfma_f32_32x32x16_bf16 a[96:111], a[132:135], a[160:163], a[96:111]
ds_read_b64_tr_b16 a[206:207], v23 offset:13312
s_add_u32 s62, s62, 16384
s_and_b32 s62, s62, 65535
v_add_u32 v20, s62, v12
v_add_u32 v21, s62, v13
v_add_u32 v22, s62, v14
v_mfma_f32_32x32x16_bf16 v[176:191], a[148:151], a[128:131], v[176:191]
buffer_load_dwordx4 v5, s[36:39], s61 offen offset:3072 lds
v_add_u32 v23, s62, v15
v_mfma_f32_32x32x16_bf16 v[240:255], a[148:151], a[132:135], v[240:255]
v_mfma_f32_32x32x16_bf16 a[48:63], a[128:131], a[164:167], a[48:63]
v_mfma_f32_32x32x16_bf16 a[112:127], a[132:135], a[164:167], a[112:127]
s_waitcnt lgkmcnt(0)
v_mfma_f32_32x32x16_bf16 v[128:143], a[176:179], a[168:171], v[128:143]
s_waitcnt vmcnt(21)
s_barrier
v_mfma_f32_32x32x16_bf16 v[192:207], a[176:179], a[172:175], v[192:207]
ds_read_b128 a[128:131], v18
ds_read_b128 a[132:135], v18 offset:4096
s_add_u32 m0, s54, s57
v_mfma_f32_32x32x16_bf16 a[0:15], a[168:171], a[192:195], a[0:15]
ds_read_b64_tr_b16 a[136:137], v20
ds_read_b64_tr_b16 a[138:139], v20 offset:1024
v_mfma_f32_32x32x16_bf16 a[64:79], a[172:175], a[192:195], a[64:79]
buffer_load_dwordx4 v6, s[40:43], s53 offen lds
ds_read_b64_tr_b16 a[152:153], v20 offset:8192
v_mfma_f32_32x32x16_bf16 v[144:159], a[180:183], a[168:171], v[144:159]
ds_read_b64_tr_b16 a[154:155], v20 offset:9216
ds_read_b64_tr_b16 a[140:141], v21
v_mfma_f32_32x32x16_bf16 v[208:223], a[180:183], a[172:175], v[208:223]
ds_read_b64_tr_b16 a[142:143], v21 offset:1024
ds_read_b64_tr_b16 a[156:157], v21 offset:8192
v_mfma_f32_32x32x16_bf16 a[16:31], a[168:171], a[196:199], a[16:31]
ds_read_b64_tr_b16 a[158:159], v21 offset:9216
buffer_load_dwordx4 v7, s[40:43], s53 offen offset:1024 lds
v_mfma_f32_32x32x16_bf16 a[80:95], a[172:175], a[196:199], a[80:95]
ds_read_b64_tr_b16 a[144:145], v22
ds_read_b64_tr_b16 a[146:147], v22 offset:1024
s_add_u32 m0, m0, 8192
v_mfma_f32_32x32x16_bf16 v[160:175], a[184:187], a[168:171], v[160:175]
ds_read_b64_tr_b16 a[160:161], v22 offset:8192
ds_read_b64_tr_b16 a[162:163], v22 offset:9216
v_mfma_f32_32x32x16_bf16 v[224:239], a[184:187], a[172:175], v[224:239]
ds_read_b64_tr_b16 a[148:149], v23
ds_read_b64_tr_b16 a[150:151], v23 offset:1024
v_mfma_f32_32x32x16_bf16 a[32:47], a[168:171], a[200:203], a[32:47]
ds_read_b64_tr_b16 a[164:165], v23 offset:8192
buffer_load_dwordx4 v6, s[44:47], s53 offen lds
v_mfma_f32_32x32x16_bf16 a[96:111], a[172:175], a[200:203], a[96:111]
ds_read_b64_tr_b16 a[166:167], v23 offset:9216
v_mfma_f32_32x32x16_bf16 v[176:191], a[188:191], a[168:171], v[176:191]
buffer_load_dwordx4 v7, s[44:47], s53 offen offset:1024 lds
v_mfma_f32_32x32x16_bf16 v[240:255], a[188:191], a[172:175], v[240:255]
v_mfma_f32_32x32x16_bf16 a[48:63], a[168:171], a[204:207], a[48:63]
v_mfma_f32_32x32x16_bf16 a[112:127], a[172:175], a[204:207], a[112:127]
s_waitcnt lgkmcnt(0)
v_mfma_f32_32x32x16_bf16 v[128:143], a[136:139], a[128:131], v[128:143]
ds_read_b128 a[168:171], v19
ds_read_b128 a[172:175], v19 offset:4096
s_add_u32 s53, s53, 262144
s_and_b32 s53, s53, 0x3fffff
s_add_u32 s54, s54, 16384
s_and_b32 s54, s54, 65535
v_mfma_f32_32x32x16_bf16 v[192:207], a[136:139], a[132:135], v[192:207]
ds_read_b64_tr_b16 a[176:177], v20 offset:4096
ds_read_b64_tr_b16 a[178:179], v20 offset:5120
s_add_u32 m0, s58, s55
s_add_u32 m0, m0, 4096
s_add_u32 s61, s60, s52
s_mov_b32 s99, 0
v_mfma_f32_32x32x16_bf16 a[0:15], a[128:131], a[152:155], a[0:15]
buffer_load_dwordx4 v2, s[36:39], s61 offen lds
ds_read_b64_tr_b16 a[192:193], v20 offset:12288
v_mfma_f32_32x32x16_bf16 a[64:79], a[132:135], a[152:155], a[64:79]
ds_read_b64_tr_b16 a[194:195], v20 offset:13312
ds_read_b64_tr_b16 a[180:181], v21 offset:4096
v_mfma_f32_32x32x16_bf16 v[144:159], a[140:143], a[128:131], v[144:159]
ds_read_b64_tr_b16 a[182:183], v21 offset:5120
ds_read_b64_tr_b16 a[196:197], v21 offset:12288
v_mfma_f32_32x32x16_bf16 v[208:223], a[140:143], a[132:135], v[208:223]
ds_read_b64_tr_b16 a[198:199], v21 offset:13312
s_mov_b32 exec_lo, 0xfffc000
s_mov_b32 exec_hi, 0x0
buffer_load_dword v119, v125, s[68:71], s99 offen
s_mov_b64 exec, -1
v_mfma_f32_32x32x16_bf16 a[16:31], a[128:131], a[156:159], a[16:31]
buffer_load_dwordx4 v3, s[36:39], s61 offen offset:1024 lds
ds_read_b64_tr_b16 a[184:185], v22 offset:4096
v_mfma_f32_32x32x16_bf16 a[80:95], a[132:135], a[156:159], a[80:95]
ds_read_b64_tr_b16 a[186:187], v22 offset:5120
ds_read_b64_tr_b16 a[200:201], v22 offset:12288
v_mfma_f32_32x32x16_bf16 v[160:175], a[144:147], a[128:131], v[160:175]
ds_read_b64_tr_b16 a[202:203], v22 offset:13312
ds_read_b64_tr_b16 a[188:189], v23 offset:4096
v_mfma_f32_32x32x16_bf16 v[224:239], a[144:147], a[132:135], v[224:239]
ds_read_b64_tr_b16 a[190:191], v23 offset:5120
buffer_load_dwordx4 v4, s[36:39], s61 offen offset:2048 lds
v_mfma_f32_32x32x16_bf16 a[32:47], a[128:131], a[160:163], a[32:47]
ds_read_b64_tr_b16 a[204:205], v23 offset:12288
ds_read_b64_tr_b16 a[206:207], v23 offset:13312
s_add_u32 s62, s62, 16384
s_and_b32 s62, s62, 65535
v_add_u32 v20, s62, v12
v_add_u32 v21, s62, v13
v_mfma_f32_32x32x16_bf16 a[96:111], a[132:135], a[160:163], a[96:111]
v_add_u32 v22, s62, v14
v_add_u32 v23, s62, v15
s_add_u32 s63, s63, 8192
s_cmp_eq_u32 s63, 24576
s_cselect_b32 s63, 0, s63
v_add_u32 v16, s63, v8
v_mfma_f32_32x32x16_bf16 v[176:191], a[148:151], a[128:131], v[176:191]
buffer_load_dwordx4 v5, s[36:39], s61 offen offset:3072 lds
v_add_u32 v17, s63, v9
v_add_u32 v18, s63, v10
v_add_u32 v19, s63, v11
v_mfma_f32_32x32x16_bf16 v[240:255], a[148:151], a[132:135], v[240:255]
v_mfma_f32_32x32x16_bf16 a[48:63], a[128:131], a[164:167], a[48:63]
s_add_u32 s52, s52, 128
s_and_b32 s52, s52, 1023
s_add_u32 s55, s55, 8192
s_cmp_eq_u32 s55, 24576
s_cselect_b32 s55, 0, s55
v_mfma_f32_32x32x16_bf16 a[112:127], a[132:135], a[164:167], a[112:127]
s_cmp_lg_u32 s34, 0
s_cbranch_scc1 W3
s_mov_b32 s92, s30
s_mov_b32 s93, s31
s_mov_b32 s94, 256
s_mov_b32 s95, 0x20000
v_lshlrev_b32 v127, 2, v0
s_mov_b32 exec_lo, 1
s_mov_b32 exec_hi, 1
buffer_load_dword v115, v127, s[92:95], 0 offen sc1
s_mov_b64 exec, -1
W3:
s_waitcnt lgkmcnt(0)
v_mfma_f32_32x32x16_bf16 v[128:143], a[176:179], a[168:171], v[128:143]
s_waitcnt vmcnt(18)
s_barrier
v_mfma_f32_32x32x16_bf16 v[192:207], a[176:179], a[172:175], v[192:207]
ds_read_b128 a[128:131], v16
ds_read_b128 a[132:135], v16 offset:4096
s_add_u32 m0, s54, s57
v_mfma_f32_32x32x16_bf16 a[0:15], a[168:171], a[192:195], a[0:15]
ds_read_b64_tr_b16 a[136:137], v20
ds_read_b64_tr_b16 a[138:139], v20 offset:1024
v_mfma_f32_32x32x16_bf16 a[64:79], a[172:175], a[192:195], a[64:79]
buffer_load_dwordx4 v6, s[40:43], s53 offen lds
ds_read_b64_tr_b16 a[152:153], v20 offset:8192
v_mfma_f32_32x32x16_bf16 v[144:159], a[180:183], a[168:171], v[144:159]
ds_read_b64_tr_b16 a[154:155], v20 offset:9216
ds_read_b64_tr_b16 a[140:141], v21
v_mfma_f32_32x32x16_bf16 v[208:223], a[180:183], a[172:175], v[208:223]
ds_read_b64_tr_b16 a[142:143], v21 offset:1024
ds_read_b64_tr_b16 a[156:157], v21 offset:8192
v_mfma_f32_32x32x16_bf16 a[16:31], a[168:171], a[196:199], a[16:31]
ds_read_b64_tr_b16 a[158:159], v21 offset:9216
buffer_load_dwordx4 v7, s[40:43], s53 offen offset:1024 lds
v_mfma_f32_32x32x16_bf16 a[80:95], a[172:175], a[196:199], a[80:95]
ds_read_b64_tr_b16 a[144:145], v22
ds_read_b64_tr_b16 a[146:147], v22 offset:1024
s_add_u32 m0, m0, 8192
v_mfma_f32_32x32x16_bf16 v[160:175], a[184:187], a[168:171], v[160:175]
ds_read_b64_tr_b16 a[160:161], v22 offset:8192
ds_read_b64_tr_b16 a[162:163], v22 offset:9216
v_mfma_f32_32x32x16_bf16 v[224:239], a[184:187], a[172:175], v[224:239]
ds_read_b64_tr_b16 a[148:149], v23
ds_read_b64_tr_b16 a[150:151], v23 offset:1024
v_mfma_f32_32x32x16_bf16 a[32:47], a[168:171], a[200:203], a[32:47]
ds_read_b64_tr_b16 a[164:165], v23 offset:8192
buffer_load_dwordx4 v6, s[44:47], s53 offen lds
v_mfma_f32_32x32x16_bf16 a[96:111], a[172:175], a[200:203], a[96:111]
ds_read_b64_tr_b16 a[166:167], v23 offset:9216
v_mfma_f32_32x32x16_bf16 v[176:191], a[188:191], a[168:171], v[176:191]
buffer_load_dwordx4 v7, s[44:47], s53 offen offset:1024 lds
v_mfma_f32_32x32x16_bf16 v[240:255], a[188:191], a[172:175], v[240:255]
v_mfma_f32_32x32x16_bf16 a[48:63], a[168:171], a[204:207], a[48:63]
v_mfma_f32_32x32x16_bf16 a[112:127], a[172:175], a[204:207], a[112:127]
s_waitcnt lgkmcnt(0)
v_mfma_f32_32x32x16_bf16 v[128:143], a[136:139], a[128:131], v[128:143]
ds_read_b128 a[168:171], v17
ds_read_b128 a[172:175], v17 offset:4096
s_add_u32 s53, s53, 262144
s_and_b32 s53, s53, 0x3fffff
s_add_u32 s54, s54, 16384
s_and_b32 s54, s54, 65535
v_mfma_f32_32x32x16_bf16 v[192:207], a[136:139], a[132:135], v[192:207]
ds_read_b64_tr_b16 a[176:177], v20 offset:4096
ds_read_b64_tr_b16 a[178:179], v20 offset:5120
s_add_u32 s61, s59, s52
s_add_u32 m0, s58, s55
s_mov_b32 s99, 0
v_mfma_f32_32x32x16_bf16 a[0:15], a[128:131], a[152:155], a[0:15]
buffer_load_dwordx4 v2, s[36:39], s61 offen lds
ds_read_b64_tr_b16 a[192:193], v20 offset:12288
v_mfma_f32_32x32x16_bf16 a[64:79], a[132:135], a[152:155], a[64:79]
ds_read_b64_tr_b16 a[194:195], v20 offset:13312
ds_read_b64_tr_b16 a[180:181], v21 offset:4096
v_mfma_f32_32x32x16_bf16 v[144:159], a[140:143], a[128:131], v[144:159]
ds_read_b64_tr_b16 a[182:183], v21 offset:5120
ds_read_b64_tr_b16 a[196:197], v21 offset:12288
v_mfma_f32_32x32x16_bf16 v[208:223], a[140:143], a[132:135], v[208:223]
ds_read_b64_tr_b16 a[198:199], v21 offset:13312
s_mov_b32 exec_lo, 0xf0000000
s_mov_b32 exec_hi, 0x3ff
buffer_load_dword v119, v125, s[68:71], s99 offen
s_mov_b64 exec, -1
v_mfma_f32_32x32x16_bf16 a[16:31], a[128:131], a[156:159], a[16:31]
buffer_load_dwordx4 v3, s[36:39], s61 offen offset:1024 lds
ds_read_b64_tr_b16 a[184:185], v22 offset:4096
v_mfma_f32_32x32x16_bf16 a[80:95], a[132:135], a[156:159], a[80:95]
ds_read_b64_tr_b16 a[186:187], v22 offset:5120
ds_read_b64_tr_b16 a[200:201], v22 offset:12288
v_mfma_f32_32x32x16_bf16 v[160:175], a[144:147], a[128:131], v[160:175]
ds_read_b64_tr_b16 a[202:203], v22 offset:13312
ds_read_b64_tr_b16 a[188:189], v23 offset:4096
v_mfma_f32_32x32x16_bf16 v[224:239], a[144:147], a[132:135], v[224:239]
ds_read_b64_tr_b16 a[190:191], v23 offset:5120
buffer_load_dwordx4 v4, s[36:39], s61 offen offset:2048 lds
v_mfma_f32_32x32x16_bf16 a[32:47], a[128:131], a[160:163], a[32:47]
ds_read_b64_tr_b16 a[204:205], v23 offset:12288
ds_read_b64_tr_b16 a[206:207], v23 offset:13312
s_add_u32 s62, s62, 16384
s_and_b32 s62, s62, 65535
v_add_u32 v20, s62, v12
v_add_u32 v21, s62, v13
v_mfma_f32_32x32x16_bf16 a[96:111], a[132:135], a[160:163], a[96:111]
buffer_load_dwordx4 v5, s[36:39], s61 offen offset:3072 lds
v_add_u32 v22, s62, v14
v_add_u32 v23, s62, v15
v_mfma_f32_32x32x16_bf16 v[176:191], a[148:151], a[128:131], v[176:191]
v_mfma_f32_32x32x16_bf16 v[240:255], a[148:151], a[132:135], v[240:255]
v_mfma_f32_32x32x16_bf16 a[48:63], a[128:131], a[164:167], a[48:63]
v_mfma_f32_32x32x16_bf16 a[112:127], a[132:135], a[164:167], a[112:127]
s_waitcnt lgkmcnt(0)
v_mfma_f32_32x32x16_bf16 v[128:143], a[176:179], a[168:171], v[128:143]
s_waitcnt vmcnt(22)
s_barrier
v_mfma_f32_32x32x16_bf16 v[192:207], a[176:179], a[172:175], v[192:207]
ds_read_b128 a[128:131], v18
ds_read_b128 a[132:135], v18 offset:4096
s_add_u32 m0, s54, s57
v_mfma_f32_32x32x16_bf16 a[0:15], a[168:171], a[192:195], a[0:15]
ds_read_b64_tr_b16 a[136:137], v20
ds_read_b64_tr_b16 a[138:139], v20 offset:1024
v_mfma_f32_32x32x16_bf16 a[64:79], a[172:175], a[192:195], a[64:79]
buffer_load_dwordx4 v6, s[40:43], s53 offen lds
ds_read_b64_tr_b16 a[152:153], v20 offset:8192
v_mfma_f32_32x32x16_bf16 v[144:159], a[180:183], a[168:171], v[144:159]
ds_read_b64_tr_b16 a[154:155], v20 offset:9216
ds_read_b64_tr_b16 a[140:141], v21
v_mfma_f32_32x32x16_bf16 v[208:223], a[180:183], a[172:175], v[208:223]
ds_read_b64_tr_b16 a[142:143], v21 offset:1024
ds_read_b64_tr_b16 a[156:157], v21 offset:8192
v_mfma_f32_32x32x16_bf16 a[16:31], a[168:171], a[196:199], a[16:31]
ds_read_b64_tr_b16 a[158:159], v21 offset:9216
buffer_load_dwordx4 v7, s[40:43], s53 offen offset:1024 lds
v_mfma_f32_32x32x16_bf16 a[80:95], a[172:175], a[196:199], a[80:95]
ds_read_b64_tr_b16 a[144:145], v22
ds_read_b64_tr_b16 a[146:147], v22 offset:1024
s_add_u32 m0, m0, 8192
v_mfma_f32_32x32x16_bf16 v[160:175], a[184:187], a[168:171], v[160:175]
ds_read_b64_tr_b16 a[160:161], v22 offset:8192
ds_read_b64_tr_b16 a[162:163], v22 offset:9216
v_mfma_f32_32x32x16_bf16 v[224:239], a[184:187], a[172:175], v[224:239]
ds_read_b64_tr_b16 a[148:149], v23
ds_read_b64_tr_b16 a[150:151], v23 offset:1024
v_mfma_f32_32x32x16_bf16 a[32:47], a[168:171], a[200:203], a[32:47]
ds_read_b64_tr_b16 a[164:165], v23 offset:8192
buffer_load_dwordx4 v6, s[44:47], s53 offen lds
v_mfma_f32_32x32x16_bf16 a[96:111], a[172:175], a[200:203], a[96:111]
ds_read_b64_tr_b16 a[166:167], v23 offset:9216
v_mfma_f32_32x32x16_bf16 v[176:191], a[188:191], a[168:171], v[176:191]
buffer_load_dwordx4 v7, s[44:47], s53 offen offset:1024 lds
v_mfma_f32_32x32x16_bf16 v[240:255], a[188:191], a[172:175], v[240:255]
v_mfma_f32_32x32x16_bf16 a[48:63], a[168:171], a[204:207], a[48:63]
v_mfma_f32_32x32x16_bf16 a[112:127], a[172:175], a[204:207], a[112:127]
s_waitcnt lgkmcnt(0)
v_mfma_f32_32x32x16_bf16 v[128:143], a[136:139], a[128:131], v[128:143]
ds_read_b128 a[168:171], v19
ds_read_b128 a[172:175], v19 offset:4096
s_add_u32 s53, s53, 262144
s_and_b32 s53, s53, 0x3fffff
s_add_u32 s54, s54, 16384
s_and_b32 s54, s54, 65535
v_mfma_f32_32x32x16_bf16 v[192:207], a[136:139], a[132:135], v[192:207]
ds_read_b64_tr_b16 a[176:177], v20 offset:4096
ds_read_b64_tr_b16 a[178:179], v20 offset:5120
s_add_u32 m0, s58, s55
s_add_u32 m0, m0, 4096
s_add_u32 s61, s60, s52
s_mov_b32 s99, 0
v_mfma_f32_32x32x16_bf16 a[0:15], a[128:131], a[152:155], a[0:15]
buffer_load_dwordx4 v2, s[36:39], s61 offen lds
ds_read_b64_tr_b16 a[192:193], v20 offset:12288
v_mfma_f32_32x32x16_bf16 a[64:79], a[132:135], a[152:155], a[64:79]
ds_read_b64_tr_b16 a[194:195], v20 offset:13312
ds_read_b64_tr_b16 a[180:181], v21 offset:4096
v_mfma_f32_32x32x16_bf16 v[144:159], a[140:143], a[128:131], v[144:159]
ds_read_b64_tr_b16 a[182:183], v21 offset:5120
ds_read_b64_tr_b16 a[196:197], v21 offset:12288
v_mfma_f32_32x32x16_bf16 v[208:223], a[140:143], a[132:135], v[208:223]
ds_read_b64_tr_b16 a[198:199], v21 offset:13312
s_mov_b32 exec_lo, 0x0
s_mov_b32 exec_hi, 0xfffc00
buffer_load_dword v119, v125, s[68:71], s99 offen
s_mov_b64 exec, -1
v_mfma_f32_32x32x16_bf16 a[16:31], a[128:131], a[156:159], a[16:31]
buffer_load_dwordx4 v3, s[36:39], s61 offen offset:1024 lds
ds_read_b64_tr_b16 a[184:185], v22 offset:4096
v_mfma_f32_32x32x16_bf16 a[80:95], a[132:135], a[156:159], a[80:95]
ds_read_b64_tr_b16 a[186:187], v22 offset:5120
ds_read_b64_tr_b16 a[200:201], v22 offset:12288
v_mfma_f32_32x32x16_bf16 v[160:175], a[144:147], a[128:131], v[160:175]
ds_read_b64_tr_b16 a[202:203], v22 offset:13312
ds_read_b64_tr_b16 a[188:189], v23 offset:4096
v_mfma_f32_32x32x16_bf16 v[224:239], a[144:147], a[132:135], v[224:239]
ds_read_b64_tr_b16 a[190:191], v23 offset:5120
buffer_load_dwordx4 v4, s[36:39], s61 offen offset:2048 lds
v_mfma_f32_32x32x16_bf16 a[32:47], a[128:131], a[160:163], a[32:47]
ds_read_b64_tr_b16 a[204:205], v23 offset:12288
ds_read_b64_tr_b16 a[206:207], v23 offset:13312
s_add_u32 s62, s62, 16384
s_and_b32 s62, s62, 65535
v_add_u32 v20, s62, v12
v_add_u32 v21, s62, v13
v_mfma_f32_32x32x16_bf16 a[96:111], a[132:135], a[160:163], a[96:111]
v_add_u32 v22, s62, v14
v_add_u32 v23, s62, v15
s_add_u32 s63, s63, 8192
s_cmp_eq_u32 s63, 24576
s_cselect_b32 s63, 0, s63
v_add_u32 v16, s63, v8
v_mfma_f32_32x32x16_bf16 v[176:191], a[148:151], a[128:131], v[176:191]
buffer_load_dwordx4 v5, s[36:39], s61 offen offset:3072 lds
v_add_u32 v17, s63, v9
v_add_u32 v18, s63, v10
v_add_u32 v19, s63, v11
v_mfma_f32_32x32x16_bf16 v[240:255], a[148:151], a[132:135], v[240:255]
v_mfma_f32_32x32x16_bf16 a[48:63], a[128:131], a[164:167], a[48:63]
s_add_u32 s52, s52, 128
s_and_b32 s52, s52, 1023
s_add_u32 s55, s55, 8192
s_cmp_eq_u32 s55, 24576
s_cselect_b32 s55, 0, s55
v_mfma_f32_32x32x16_bf16 a[112:127], a[132:135], a[164:167], a[112:127]
s_cmp_lg_u32 s34, 0
s_cbranch_scc1 W4
s_waitcnt vmcnt(16)
s_mov_b32 exec_lo, 1
s_mov_b32 exec_hi, 1
v_cmp_gt_u32 vcc, 128, v115
s_mov_b64 exec, -1
s_cbranch_vccz ZK5
s_mov_b32 s91, 0
s_mov_b32 s92, s30
s_mov_b32 s93, s31
s_mov_b32 s94, 256
s_mov_b32 s95, 0x20000
v_lshlrev_b32 v25, 2, v0
s_mov_b32 s90, 200000
s_mov_b32 exec_lo, 1
s_mov_b32 exec_hi, 1
PL6:
buffer_load_dword v24, v25, s[92:95], s91 offen sc1
s_waitcnt vmcnt(0)
v_cmp_gt_u32 vcc, 128, v24
s_cbranch_vccz PD7
s_sub_u32 s90, s90, 1
s_cbranch_scc1 PD7
s_sleep 1
s_branch PL6
PD7:
s_mov_b64 exec, -1
ZK5:
W4:
s_waitcnt lgkmcnt(0)
v_mfma_f32_32x32x16_bf16 v[128:143], a[176:179], a[168:171], v[128:143]
s_waitcnt vmcnt(18)
s_barrier
v_mfma_f32_32x32x16_bf16 v[192:207], a[176:179], a[172:175], v[192:207]
ds_read_b128 a[128:131], v16
ds_read_b128 a[132:135], v16 offset:4096
s_add_u32 m0, s54, s57
v_mfma_f32_32x32x16_bf16 a[0:15], a[168:171], a[192:195], a[0:15]
ds_read_b64_tr_b16 a[136:137], v20
ds_read_b64_tr_b16 a[138:139], v20 offset:1024
v_mfma_f32_32x32x16_bf16 a[64:79], a[172:175], a[192:195], a[64:79]
ds_read_b64_tr_b16 a[152:153], v20 offset:8192
ds_read_b64_tr_b16 a[154:155], v20 offset:9216
v_mfma_f32_32x32x16_bf16 v[144:159], a[180:183], a[168:171], v[144:159]
buffer_load_dwordx4 v6, s[40:43], s53 offen lds
ds_read_b64_tr_b16 a[140:141], v21
v_mfma_f32_32x32x16_bf16 v[208:223], a[180:183], a[172:175], v[208:223]
ds_read_b64_tr_b16 a[142:143], v21 offset:1024
ds_read_b64_tr_b16 a[156:157], v21 offset:8192
v_mfma_f32_32x32x16_bf16 a[16:31], a[168:171], a[196:199], a[16:31]
ds_read_b64_tr_b16 a[158:159], v21 offset:9216
ds_read_b64_tr_b16 a[144:145], v22
v_mfma_f32_32x32x16_bf16 a[80:95], a[172:175], a[196:199], a[80:95]
ds_read_b64_tr_b16 a[146:147], v22 offset:1024
ds_read_b64_tr_b16 a[160:161], v22 offset:8192
v_mfma_f32_32x32x16_bf16 v[160:175], a[184:187], a[168:171], v[160:175]
ds_read_b64_tr_b16 a[162:163], v22 offset:9216
ds_read_b64_tr_b16 a[148:149], v23
v_mfma_f32_32x32x16_bf16 v[224:239], a[184:187], a[172:175], v[224:239]
ds_read_b64_tr_b16 a[150:151], v23 offset:1024
ds_read_b64_tr_b16 a[164:165], v23 offset:8192
v_mfma_f32_32x32x16_bf16 a[32:47], a[168:171], a[200:203], a[32:47]
ds_read_b64_tr_b16 a[166:167], v23 offset:9216
buffer_load_dwordx4 v7, s[40:43], s53 offen offset:1024 lds
v_mfma_f32_32x32x16_bf16 a[96:111], a[172:175], a[200:203], a[96:111]
v_mfma_f32_32x32x16_bf16 v[176:191], a[188:191], a[168:171], v[176:191]
v_mfma_f32_32x32x16_bf16 v[240:255], a[188:191], a[172:175], v[240:255]
v_mfma_f32_32x32x16_bf16 a[48:63], a[168:171], a[204:207], a[48:63]
v_mfma_f32_32x32x16_bf16 a[112:127], a[172:175], a[204:207], a[112:127]
s_waitcnt lgkmcnt(0)
v_mfma_f32_32x32x16_bf16 v[128:143], a[136:139], a[128:131], v[128:143]
ds_read_b128 a[168:171], v17
ds_read_b128 a[172:175], v17 offset:4096
s_add_u32 m0, m0, 8192
v_mfma_f32_32x32x16_bf16 v[192:207], a[136:139], a[132:135], v[192:207]
ds_read_b64_tr_b16 a[176:177], v20 offset:4096
ds_read_b64_tr_b16 a[178:179], v20 offset:5120
v_mfma_f32_32x32x16_bf16 a[0:15], a[128:131], a[152:155], a[0:15]
ds_read_b64_tr_b16 a[192:193], v20 offset:12288
buffer_load_dwordx4 v6, s[44:47], s53 offen lds
v_mfma_f32_32x32x16_bf16 a[64:79], a[132:135], a[152:155], a[64:79]
ds_read_b64_tr_b16 a[194:195], v20 offset:13312
ds_read_b64_tr_b16 a[180:181], v21 offset:4096
v_mfma_f32_32x32x16_bf16 v[144:159], a[140:143], a[128:131], v[144:159]
ds_read_b64_tr_b16 a[182:183], v21 offset:5120
ds_read_b64_tr_b16 a[196:197], v21 offset:12288
v_mfma_f32_32x32x16_bf16 v[208:223], a[140:143], a[132:135], v[208:223]
ds_read_b64_tr_b16 a[198:199], v21 offset:13312
ds_read_b64_tr_b16 a[184:185], v22 offset:4096
v_mfma_f32_32x32x16_bf16 a[16:31], a[128:131], a[156:159], a[16:31]
ds_read_b64_tr_b16 a[186:187], v22 offset:5120
ds_read_b64_tr_b16 a[200:201], v22 offset:12288
v_mfma_f32_32x32x16_bf16 a[80:95], a[132:135], a[156:159], a[80:95]
ds_read_b64_tr_b16 a[202:203], v22 offset:13312
ds_read_b64_tr_b16 a[188:189], v23 offset:4096
v_mfma_f32_32x32x16_bf16 v[160:175], a[144:147], a[128:131], v[160:175]
ds_read_b64_tr_b16 a[190:191], v23 offset:5120
ds_read_b64_tr_b16 a[204:205], v23 offset:12288
v_mfma_f32_32x32x16_bf16 v[224:239], a[144:147], a[132:135], v[224:239]
ds_read_b64_tr_b16 a[206:207], v23 offset:13312
buffer_load_dwordx4 v7, s[44:47], s53 offen offset:1024 lds
s_add_u32 s62, s62, 16384
s_and_b32 s62, s62, 65535
v_add_u32 v20, s62, v12
v_mfma_f32_32x32x16_bf16 a[32:47], a[128:131], a[160:163], a[32:47]
v_add_u32 v21, s62, v13
v_add_u32 v22, s62, v14
v_add_u32 v23, s62, v15
v_mfma_f32_32x32x16_bf16 a[96:111], a[132:135], a[160:163], a[96:111]
v_mfma_f32_32x32x16_bf16 v[176:191], a[148:151], a[128:131], v[176:191]
v_mfma_f32_32x32x16_bf16 v[240:255], a[148:151], a[132:135], v[240:255]
v_mfma_f32_32x32x16_bf16 a[48:63], a[128:131], a[164:167], a[48:63]
v_mfma_f32_32x32x16_bf16 a[112:127], a[132:135], a[164:167], a[112:127]
s_add_u32 s53, s53, 262144
s_and_b32 s53, s53, 0x3fffff
s_add_u32 s54, s54, 16384
s_and_b32 s54, s54, 65535
s_waitcnt lgkmcnt(0)
v_mfma_f32_32x32x16_bf16 v[128:143], a[176:179], a[168:171], v[128:143]
s_waitcnt vmcnt(17)
s_barrier
v_mfma_f32_32x32x16_bf16 v[192:207], a[176:179], a[172:175], v[192:207]
ds_read_b128 a[128:131], v18
ds_read_b128 a[132:135], v18 offset:4096
s_mov_b32 s40, s4
s_mov_b32 s41, s5
s_mov_b32 s42, 0x200000
s_mov_b32 s43, 0x20000
v_mfma_f32_32x32x16_bf16 a[0:15], a[168:171], a[192:195], a[0:15]
ds_read_b64_tr_b16 a[136:137], v20
ds_read_b64_tr_b16 a[138:139], v20 offset:1024
s_mov_b32 s44, s8
s_mov_b32 s45, s9
s_mov_b32 s46, 0x400000
v_mfma_f32_32x32x16_bf16 a[64:79], a[172:175], a[192:195], a[64:79]
ds_read_b64_tr_b16 a[152:153], v20 offset:8192
ds_read_b64_tr_b16 a[154:155], v20 offset:9216
s_mov_b32 s47, 0x20000
v_lshrrev_b32 v24, 4, v0
v_lshlrev_b32 v25, 2, v24
v_mfma_f32_32x32x16_bf16 v[144:159], a[180:183], a[168:171], v[144:159]
ds_read_b64_tr_b16 a[140:141], v21
ds_read_b64_tr_b16 a[142:143], v21 offset:1024
v_and_b32 v26, 15, v0
v_xor_b32 v26, v26, v25
v_lshlrev_b32 v26, 4, v26
v_mfma_f32_32x32x16_bf16 v[208:223], a[180:183], a[172:175], v[208:223]
ds_read_b64_tr_b16 a[156:157], v21 offset:8192
ds_read_b64_tr_b16 a[158:159], v21 offset:9216
v_lshl_add_u32 v26, v24, 13, v26
s_lshl_b32 s71, s34, 16
v_add_u32 v34, s71, v26
v_mfma_f32_32x32x16_bf16 a[16:31], a[168:171], a[196:199], a[16:31]
ds_read_b64_tr_b16 a[144:145], v22
ds_read_b64_tr_b16 a[146:147], v22 offset:1024
v_add_u32 v35, 31744, v34
v_and_b32 v25, 7, v0
v_xor_b32 v25, v25, v24
v_mfma_f32_32x32x16_bf16 a[80:95], a[172:175], a[196:199], a[80:95]
ds_read_b64_tr_b16 a[160:161], v22 offset:8192
ds_read_b64_tr_b16 a[162:163], v22 offset:9216
v_lshlrev_b32 v25, 4, v25
v_lshrrev_b32 v26, 3, v0
v_mfma_f32_32x32x16_bf16 v[160:175], a[184:187], a[168:171], v[160:175]
ds_read_b64_tr_b16 a[148:149], v23
ds_read_b64_tr_b16 a[150:151], v23 offset:1024
v_lshl_add_u32 v30, v26, 10, v25
v_xor_b32 v25, 64, v30
v_add_u32 v31, 7168, v25
v_mfma_f32_32x32x16_bf16 v[224:239], a[184:187], a[172:175], v[224:239]
ds_read_b64_tr_b16 a[164:165], v23 offset:8192
ds_read_b64_tr_b16 a[166:167], v23 offset:9216
v_add_u32 v32, 14336, v30
v_add_u32 v33, 21504, v25
s_mul_i32 s98, s34, 24576
v_mfma_f32_32x32x16_bf16 a[32:47], a[168:171], a[200:203], a[32:47]
s_lshl_b32 s97, s34, 11
s_add_u32 s97, s97, 98304
s_lshl_b32 s99, s64, 7
v_mfma_f32_32x32x16_bf16 a[96:111], a[172:175], a[200:203], a[96:111]
s_lshl_b32 s71, s34, 5
s_sub_u32 s70, 1920, s99
s_add_u32 s99, s99, s71
v_mfma_f32_32x32x16_bf16 v[176:191], a[188:191], a[168:171], v[176:191]
s_add_u32 s70, s70, s71
s_lshl_b32 s99, s99, 10
v_mfma_f32_32x32x16_bf16 v[240:255], a[188:191], a[172:175], v[240:255]
s_lshl_b32 s70, s70, 10
s_and_b32 s92, s65, 3
s_mul_i32 s92, s92, 0
v_mfma_f32_32x32x16_bf16 a[48:63], a[168:171], a[204:207], a[48:63]
s_mul_i32 s71, s64, 0
v_mfma_f32_32x32x16_bf16 a[112:127], a[172:175], a[204:207], a[112:127]
s_waitcnt lgkmcnt(0)
v_mfma_f32_32x32x16_bf16 v[128:143], a[136:139], a[128:131], v[128:143]
ds_read_b128 a[168:171], v19
ds_read_b128 a[172:175], v19 offset:4096
s_add_u32 s92, s92, s71
s_and_b32 s92, s92, 7
s_lshl_b32 s93, s92, 19
s_lshl_b32 s71, s65, 8
v_mfma_f32_32x32x16_bf16 v[192:207], a[136:139], a[132:135], v[192:207]
ds_read_b64_tr_b16 a[176:177], v20 offset:4096
ds_read_b64_tr_b16 a[178:179], v20 offset:5120
s_add_u32 s93, s93, s71
s_lshl_b32 s92, s92, 7
s_mov_b32 s95, 16384
s_mov_b32 s94, 0
v_mfma_f32_32x32x16_bf16 a[0:15], a[128:131], a[152:155], a[0:15]
ds_read_b64_tr_b16 a[192:193], v20 offset:12288
ds_read_b64_tr_b16 a[194:195], v20 offset:13312
s_add_u32 s71, s99, s92
s_add_u32 m0, s98, s95
v_mfma_f32_32x32x16_bf16 a[64:79], a[132:135], a[152:155], a[64:79]
ds_read_b64_tr_b16 a[180:181], v21 offset:4096
buffer_load_dwordx4 v30, s[40:43], s71 offen lds
v_mfma_f32_32x32x16_bf16 v[144:159], a[140:143], a[128:131], v[144:159]
buffer_load_dwordx4 v31, s[40:43], s71 offen offset:1024 lds
ds_read_b64_tr_b16 a[182:183], v21 offset:5120
v_mfma_f32_32x32x16_bf16 v[208:223], a[140:143], a[132:135], v[208:223]
buffer_load_dwordx4 v32, s[40:43], s71 offen offset:2048 lds
ds_read_b64_tr_b16 a[196:197], v21 offset:12288
v_mfma_f32_32x32x16_bf16 a[16:31], a[128:131], a[156:159], a[16:31]
buffer_load_dwordx4 v33, s[40:43], s71 offen offset:3072 lds
ds_read_b64_tr_b16 a[198:199], v21 offset:13312
s_add_u32 m0, s98, s95
s_add_u32 m0, m0, 4096
s_add_u32 s71, s70, s92
v_mfma_f32_32x32x16_bf16 a[80:95], a[132:135], a[156:159], a[80:95]
ds_read_b64_tr_b16 a[184:185], v22 offset:4096
buffer_load_dwordx4 v30, s[40:43], s71 offen lds
v_mfma_f32_32x32x16_bf16 v[160:175], a[144:147], a[128:131], v[160:175]
ds_read_b64_tr_b16 a[186:187], v22 offset:5120
buffer_load_dwordx4 v31, s[40:43], s71 offen offset:1024 lds
v_mfma_f32_32x32x16_bf16 v[224:239], a[144:147], a[132:135], v[224:239]
buffer_load_dwordx4 v32, s[40:43], s71 offen offset:2048 lds
ds_read_b64_tr_b16 a[200:201], v22 offset:12288
v_mfma_f32_32x32x16_bf16 a[32:47], a[128:131], a[160:163], a[32:47]
buffer_load_dwordx4 v33, s[40:43], s71 offen offset:3072 lds
ds_read_b64_tr_b16 a[202:203], v22 offset:13312
s_add_u32 s92, s92, 128
s_and_b32 s92, s92, 1023
s_add_u32 s95, s95, 8192
v_mfma_f32_32x32x16_bf16 a[96:111], a[132:135], a[160:163], a[96:111]
ds_read_b64_tr_b16 a[188:189], v23 offset:4096
ds_read_b64_tr_b16 a[190:191], v23 offset:5120
s_cmp_eq_u32 s95, 24576
s_cselect_b32 s95, 0, s95
s_add_u32 m0, s94, s97
v_mfma_f32_32x32x16_bf16 v[176:191], a[148:151], a[128:131], v[176:191]
buffer_load_dwordx4 v34, s[44:47], s93 offen lds
ds_read_b64_tr_b16 a[204:205], v23 offset:12288
v_mfma_f32_32x32x16_bf16 v[240:255], a[148:151], a[132:135], v[240:255]
buffer_load_dwordx4 v35, s[44:47], s93 offen offset:1024 lds
ds_read_b64_tr_b16 a[206:207], v23 offset:13312
s_add_u32 s93, s93, 262144
s_and_b32 s93, s93, 0x3fffff
s_add_u32 s94, s94, 8192
v_mfma_f32_32x32x16_bf16 a[48:63], a[128:131], a[164:167], a[48:63]
s_add_u32 s62, s62, 16384
s_and_b32 s62, s62, 65535
v_add_u32 v20, s62, v12
v_add_u32 v21, s62, v13
v_add_u32 v22, s62, v14
v_add_u32 v23, s62, v15
v_mfma_f32_32x32x16_bf16 a[112:127], a[132:135], a[164:167], a[112:127]
s_add_u32 s63, s63, 8192
s_cmp_eq_u32 s63, 24576
s_cselect_b32 s63, 0, s63
v_add_u32 v16, s63, v8
v_add_u32 v17, s63, v9
v_add_u32 v18, s63, v10
v_add_u32 v19, s63, v11
s_and_b32 s94, s94, 32767
s_add_u32 m0, s94, s97
s_nop 0
buffer_load_dwordx4 v34, s[44:47], s93 offen lds
buffer_load_dwordx4 v35, s[44:47], s93 offen offset:1024 lds
s_add_u32 s93, s93, 262144
s_and_b32 s93, s93, 0x3fffff
s_add_u32 s94, s94, 8192
s_and_b32 s94, s94, 32767
s_waitcnt lgkmcnt(0)
v_mfma_f32_32x32x16_bf16 v[128:143], a[176:179], a[168:171], v[128:143]
s_waitcnt vmcnt(16)
s_barrier
v_mfma_f32_32x32x16_bf16 v[192:207], a[176:179], a[172:175], v[192:207]
ds_read_b128 a[128:131], v16
ds_read_b128 a[132:135], v16 offset:4096
s_add_u32 s71, s99, s92
s_add_u32 m0, s98, s95
v_mfma_f32_32x32x16_bf16 a[0:15], a[168:171], a[192:195], a[0:15]
ds_read_b64_tr_b16 a[136:137], v20
ds_read_b64_tr_b16 a[138:139], v20 offset:1024
v_mfma_f32_32x32x16_bf16 a[64:79], a[172:175], a[192:195], a[64:79]
ds_read_b64_tr_b16 a[152:153], v20 offset:8192
ds_read_b64_tr_b16 a[154:155], v20 offset:9216
v_mfma_f32_32x32x16_bf16 v[144:159], a[180:183], a[168:171], v[144:159]
buffer_load_dwordx4 v30, s[40:43], s71 offen lds
ds_read_b64_tr_b16 a[140:141], v21
v_mfma_f32_32x32x16_bf16 v[208:223], a[180:183], a[172:175], v[208:223]
ds_read_b64_tr_b16 a[142:143], v21 offset:1024
buffer_load_dwordx4 v31, s[40:43], s71 offen offset:1024 lds
v_mfma_f32_32x32x16_bf16 a[16:31], a[168:171], a[196:199], a[16:31]
ds_read_b64_tr_b16 a[156:157], v21 offset:8192
ds_read_b64_tr_b16 a[158:159], v21 offset:9216
v_mfma_f32_32x32x16_bf16 a[80:95], a[172:175], a[196:199], a[80:95]
buffer_load_dwordx4 v32, s[40:43], s71 offen offset:2048 lds
ds_read_b64_tr_b16 a[144:145], v22
v_mfma_f32_32x32x16_bf16 v[160:175], a[184:187], a[168:171], v[160:175]
ds_read_b64_tr_b16 a[146:147], v22 offset:1024
buffer_load_dwordx4 v33, s[40:43], s71 offen offset:3072 lds
s_add_u32 m0, s98, s95
s_add_u32 m0, m0, 4096
v_mfma_f32_32x32x16_bf16 v[224:239], a[184:187], a[172:175], v[224:239]
ds_read_b64_tr_b16 a[160:161], v22 offset:8192
ds_read_b64_tr_b16 a[162:163], v22 offset:9216
s_add_u32 s71, s70, s92
v_mfma_f32_32x32x16_bf16 a[32:47], a[168:171], a[200:203], a[32:47]
ds_read_b64_tr_b16 a[148:149], v23
ds_read_b64_tr_b16 a[150:151], v23 offset:1024
v_mfma_f32_32x32x16_bf16 a[96:111], a[172:175], a[200:203], a[96:111]
ds_read_b64_tr_b16 a[164:165], v23 offset:8192
ds_read_b64_tr_b16 a[166:167], v23 offset:9216
v_mfma_f32_32x32x16_bf16 v[176:191], a[188:191], a[168:171], v[176:191]
buffer_load_dwordx4 v30, s[40:43], s71 offen lds
buffer_load_dwordx4 v31, s[40:43], s71 offen offset:1024 lds
v_mfma_f32_32x32x16_bf16 v[240:255], a[188:191], a[172:175], v[240:255]
buffer_load_dwordx4 v32, s[40:43], s71 offen offset:2048 lds
v_mfma_f32_32x32x16_bf16 a[48:63], a[168:171], a[204:207], a[48:63]
v_mfma_f32_32x32x16_bf16 a[112:127], a[172:175], a[204:207], a[112:127]
s_waitcnt lgkmcnt(0)
v_mfma_f32_32x32x16_bf16 v[128:143], a[136:139], a[128:131], v[128:143]
ds_read_b128 a[168:171], v17
buffer_load_dwordx4 v33, s[40:43], s71 offen offset:3072 lds
s_add_u32 s92, s92, 128
s_and_b32 s92, s92, 1023
v_mfma_f32_32x32x16_bf16 v[192:207], a[136:139], a[132:135], v[192:207]
ds_read_b128 a[172:175], v17 offset:4096
ds_read_b64_tr_b16 a[176:177], v20 offset:4096
v_mfma_f32_32x32x16_bf16 a[0:15], a[128:131], a[152:155], a[0:15]
ds_read_b64_tr_b16 a[178:179], v20 offset:5120
ds_read_b64_tr_b16 a[192:193], v20 offset:12288
s_add_u32 s95, s95, 8192
v_mfma_f32_32x32x16_bf16 a[64:79], a[132:135], a[152:155], a[64:79]
ds_read_b64_tr_b16 a[194:195], v20 offset:13312
ds_read_b64_tr_b16 a[180:181], v21 offset:4096
s_cmp_eq_u32 s95, 24576
s_cselect_b32 s95, 0, s95
v_mfma_f32_32x32x16_bf16 v[144:159], a[140:143], a[128:131], v[144:159]
ds_read_b64_tr_b16 a[182:183], v21 offset:5120
ds_read_b64_tr_b16 a[196:197], v21 offset:12288
s_add_u32 m0, s94, s97
v_mfma_f32_32x32x16_bf16 v[208:223], a[140:143], a[132:135], v[208:223]
ds_read_b64_tr_b16 a[198:199], v21 offset:13312
ds_read_b64_tr_b16 a[184:185], v22 offset:4096
v_mfma_f32_32x32x16_bf16 a[16:31], a[128:131], a[156:159], a[16:31]
ds_read_b64_tr_b16 a[186:187], v22 offset:5120
ds_read_b64_tr_b16 a[200:201], v22 offset:12288
v_mfma_f32_32x32x16_bf16 a[80:95], a[132:135], a[156:159], a[80:95]
buffer_load_dwordx4 v34, s[44:47], s93 offen lds
ds_read_b64_tr_b16 a[202:203], v22 offset:13312
v_mfma_f32_32x32x16_bf16 v[160:175], a[144:147], a[128:131], v[160:175]
ds_read_b64_tr_b16 a[188:189], v23 offset:4096
buffer_load_dwordx4 v35, s[44:47], s93 offen offset:1024 lds
s_add_u32 s93, s93, 262144
v_mfma_f32_32x32x16_bf16 v[224:239], a[144:147], a[132:135], v[224:239]
ds_read_b64_tr_b16 a[190:191], v23 offset:5120
ds_read_b64_tr_b16 a[204:205], v23 offset:12288
s_and_b32 s93, s93, 0x3fffff
v_mfma_f32_32x32x16_bf16 a[32:47], a[128:131], a[160:163], a[32:47]
ds_read_b64_tr_b16 a[206:207], v23 offset:13312
s_add_u32 s62, s62, 16384
s_and_b32 s62, s62, 65535
v_add_u32 v20, s62, v12
v_add_u32 v21, s62, v13
v_add_u32 v22, s62, v14
v_mfma_f32_32x32x16_bf16 a[96:111], a[132:135], a[160:163], a[96:111]
v_add_u32 v23, s62, v15
s_add_u32 s94, s94, 8192
s_and_b32 s94, s94, 32767
v_mfma_f32_32x32x16_bf16 v[176:191], a[148:151], a[128:131], v[176:191]
v_mfma_f32_32x32x16_bf16 v[240:255], a[148:151], a[132:135], v[240:255]
v_mfma_f32_32x32x16_bf16 a[48:63], a[128:131], a[164:167], a[48:63]
v_mfma_f32_32x32x16_bf16 a[112:127], a[132:135], a[164:167], a[112:127]
s_waitcnt lgkmcnt(0)
v_mfma_f32_32x32x16_bf16 v[128:143], a[176:179], a[168:171], v[128:143]
s_waitcnt vmcnt(22)
s_barrier
v_mfma_f32_32x32x16_bf16 v[192:207], a[176:179], a[172:175], v[192:207]
ds_read_b128 a[128:131], v18
ds_read_b128 a[132:135], v18 offset:4096
v_mfma_f32_32x32x16_bf16 a[0:15], a[168:171], a[192:195], a[0:15]
ds_read_b64_tr_b16 a[136:137], v20
ds_read_b64_tr_b16 a[138:139], v20 offset:1024
v_mfma_f32_32x32x16_bf16 a[64:79], a[172:175], a[192:195], a[64:79]
ds_read_b64_tr_b16 a[152:153], v20 offset:8192
ds_read_b64_tr_b16 a[154:155], v20 offset:9216
v_mfma_f32_32x32x16_bf16 v[144:159], a[180:183], a[168:171], v[144:159]
ds_read_b64_tr_b16 a[140:141], v21
ds_read_b64_tr_b16 a[142:143], v21 offset:1024
v_mfma_f32_32x32x16_bf16 v[208:223], a[180:183], a[172:175], v[208:223]
ds_read_b64_tr_b16 a[156:157], v21 offset:8192
ds_read_b64_tr_b16 a[158:159], v21 offset:9216
v_mfma_f32_32x32x16_bf16 a[16:31], a[168:171], a[196:199], a[16:31]
ds_read_b64_tr_b16 a[144:145], v22
ds_read_b64_tr_b16 a[146:147], v22 offset:1024
v_mfma_f32_32x32x16_bf16 a[80:95], a[172:175], a[196:199], a[80:95]
ds_read_b64_tr_b16 a[160:161], v22 offset:8192
ds_read_b64_tr_b16 a[162:163], v22 offset:9216
v_mfma_f32_32x32x16_bf16 v[160:175], a[184:187], a[168:171], v[160:175]
ds_read_b64_tr_b16 a[148:149], v23
ds_read_b64_tr_b16 a[150:151], v23 offset:1024
v_mfma_f32_32x32x16_bf16 v[224:239], a[184:187], a[172:175], v[224:239]
ds_read_b64_tr_b16 a[164:165], v23 offset:8192
ds_read_b64_tr_b16 a[166:167], v23 offset:9216
v_mfma_f32_32x32x16_bf16 a[32:47], a[168:171], a[200:203], a[32:47]
v_mfma_f32_32x32x16_bf16 a[96:111], a[172:175], a[200:203], a[96:111]
v_mfma_f32_32x32x16_bf16 v[176:191], a[188:191], a[168:171], v[176:191]
v_mfma_f32_32x32x16_bf16 v[240:255], a[188:191], a[172:175], v[240:255]
v_mfma_f32_32x32x16_bf16 a[48:63], a[168:171], a[204:207], a[48:63]
v_mfma_f32_32x32x16_bf16 a[112:127], a[172:175], a[204:207], a[112:127]
s_waitcnt lgkmcnt(0)
v_mfma_f32_32x32x16_bf16 v[128:143], a[136:139], a[128:131], v[128:143]
ds_read_b128 a[168:171], v19
ds_read_b128 a[172:175], v19 offset:4096
v_mfma_f32_32x32x16_bf16 v[192:207], a[136:139], a[132:135], v[192:207]
ds_read_b64_tr_b16 a[176:177], v20 offset:4096
ds_read_b64_tr_b16 a[178:179], v20 offset:5120
v_mfma_f32_32x32x16_bf16 a[0:15], a[128:131], a[152:155], a[0:15]
ds_read_b64_tr_b16 a[192:193], v20 offset:12288
ds_read_b64_tr_b16 a[194:195], v20 offset:13312
v_mfma_f32_32x32x16_bf16 a[64:79], a[132:135], a[152:155], a[64:79]
ds_read_b64_tr_b16 a[180:181], v21 offset:4096
ds_read_b64_tr_b16 a[182:183], v21 offset:5120
v_mfma_f32_32x32x16_bf16 v[144:159], a[140:143], a[128:131], v[144:159]
ds_read_b64_tr_b16 a[196:197], v21 offset:12288
ds_read_b64_tr_b16 a[198:199], v21 offset:13312
v_mfma_f32_32x32x16_bf16 v[208:223], a[140:143], a[132:135], v[208:223]
ds_read_b64_tr_b16 a[184:185], v22 offset:4096
ds_read_b64_tr_b16 a[186:187], v22 offset:5120
v_mfma_f32_32x32x16_bf16 a[16:31], a[128:131], a[156:159], a[16:31]
ds_read_b64_tr_b16 a[200:201], v22 offset:12288
ds_read_b64_tr_b16 a[202:203], v22 offset:13312
v_mfma_f32_32x32x16_bf16 a[80:95], a[132:135], a[156:159], a[80:95]
ds_read_b64_tr_b16 a[188:189], v23 offset:4096
ds_read_b64_tr_b16 a[190:191], v23 offset:5120
v_mfma_f32_32x32x16_bf16 v[160:175], a[144:147], a[128:131], v[160:175]
ds_read_b64_tr_b16 a[204:205], v23 offset:12288
ds_read_b64_tr_b16 a[206:207], v23 offset:13312
v_mfma_f32_32x32x16_bf16 v[224:239], a[144:147], a[132:135], v[224:239]
v_mfma_f32_32x32x16_bf16 a[32:47], a[128:131], a[160:163], a[32:47]
v_mfma_f32_32x32x16_bf16 a[96:111], a[132:135], a[160:163], a[96:111]
v_mfma_f32_32x32x16_bf16 v[176:191], a[148:151], a[128:131], v[176:191]
v_mfma_f32_32x32x16_bf16 v[240:255], a[148:151], a[132:135], v[240:255]
v_mfma_f32_32x32x16_bf16 a[48:63], a[128:131], a[164:167], a[48:63]
v_mfma_f32_32x32x16_bf16 a[112:127], a[132:135], a[164:167], a[112:127]
s_waitcnt lgkmcnt(0)
s_barrier
v_and_b32 v24, 31, v0
v_lshrrev_b32 v25, 5, v0
v_bfe_u32 v26, v0, 1, 3
v_xor_b32 v26, v26, v25
v_lshlrev_b32 v26, 4, v26
v_lshl_add_u32 v26, v24, 7, v26
v_add_u32 v8, s98, v26
v_xor_b32 v9, 32, v8
v_xor_b32 v10, 64, v8
v_xor_b32 v11, 96, v8
v_bfe_u32 v24, v0, 2, 2
v_lshrrev_b32 v25, 5, v0
v_lshl_add_u32 v25, v25, 3, v24
v_lshlrev_b32 v25, 8, v25
v_bfe_u32 v26, v0, 4, 1
v_lshlrev_b32 v26, 5, v26
v_and_b32 v27, 3, v0
v_lshl_add_u32 v26, v27, 3, v26
v_add_u32 v25, v25, v26
v_add_u32 v25, 98304, v25
v_lshlrev_b32 v24, 6, v24
v_xor_b32 v26, 0, v24
v_add_u32 v12, v25, v26
v_xor_b32 v26, 64, v24
v_add_u32 v13, v25, v26
v_xor_b32 v26, 128, v24
v_add_u32 v14, v25, v26
v_xor_b32 v26, 192, v24
v_add_u32 v15, v25, v26
s_lshr_b32 s66, s99, 10
s_lshr_b32 s67, s70, 10
v_and_b32 v24, 31, v0
v_lshlrev_b32 v25, 2, v24
s_lshl_b32 s90, s66, 2
s_add_u32 s90, s90, 2228224
s_lshl_b32 s91, s67, 2
s_add_u32 s91, s91, 2228224
buffer_load_dword v38, v25, s[48:51], s90 offen
buffer_load_dword v39, v25, s[48:51], s91 offen
v_lshrrev_b32 v25, 5, v0
v_lshlrev_b32 v25, 2, v25
v_sub_u32 v24, v24, v25
v_add_u32 v44, s66, v24
v_add_u32 v45, s67, v24
v_mfma_f32_32x32x16_bf16 v[128:143], a[176:179], a[168:171], v[128:143]
v_mfma_f32_32x32x16_bf16 v[192:207], a[176:179], a[172:175], v[192:207]
v_mfma_f32_32x32x16_bf16 a[0:15], a[168:171], a[192:195], a[0:15]
v_mfma_f32_32x32x16_bf16 a[64:79], a[172:175], a[192:195], a[64:79]
v_mfma_f32_32x32x16_bf16 v[144:159], a[180:183], a[168:171], v[144:159]
v_mfma_f32_32x32x16_bf16 v[208:223], a[180:183], a[172:175], v[208:223]
v_mfma_f32_32x32x16_bf16 a[16:31], a[168:171], a[196:199], a[16:31]
v_mfma_f32_32x32x16_bf16 a[80:95], a[172:175], a[196:199], a[80:95]
v_mfma_f32_32x32x16_bf16 v[160:175], a[184:187], a[168:171], v[160:175]
v_mfma_f32_32x32x16_bf16 v[224:239], a[184:187], a[172:175], v[224:239]
v_mfma_f32_32x32x16_bf16 a[32:47], a[168:171], a[200:203], a[32:47]
v_mfma_f32_32x32x16_bf16 a[96:111], a[172:175], a[200:203], a[96:111]
v_mfma_f32_32x32x16_bf16 v[176:191], a[188:191], a[168:171], v[176:191]
v_mfma_f32_32x32x16_bf16 v[240:255], a[188:191], a[172:175], v[240:255]
v_mfma_f32_32x32x16_bf16 a[48:63], a[168:171], a[204:207], a[48:63]
v_mfma_f32_32x32x16_bf16 a[112:127], a[172:175], a[204:207], a[112:127]
s_lshl_b32 s66, s65, 5
s_lshl_b32 s67, s64, 2
s_add_u32 s66, s66, s67
s_add_u32 s66, s66, s34
s_lshl_b32 s66, s66, 15
s_add_u32 s66, s66, 8388608
v_lshlrev_b32 v28, 4, v0
v_add_u32 v16, 16384, v8
v_mov_b32 v20, v12
v_add_u32 v17, 16384, v9
v_mov_b32 v21, v13
v_add_u32 v18, 16384, v10
v_mov_b32 v22, v14
v_add_u32 v19, 16384, v11
v_mov_b32 v23, v15
s_mov_b32 s68, 0
s_mov_b32 s69, 16384
s_waitcnt vmcnt(12)
s_barrier
ds_read_b128 v[48:51], v16
ds_read_b128 v[52:55], v16 offset:4096
ds_read_b64_tr_b16 v[56:57], v20
ds_read_b64_tr_b16 v[58:59], v20 offset:1024
ds_read_b64_tr_b16 v[60:61], v21
ds_read_b64_tr_b16 v[62:63], v21 offset:1024
ds_read_b64_tr_b16 v[64:65], v22
ds_read_b64_tr_b16 v[66:67], v22 offset:1024
ds_read_b64_tr_b16 v[68:69], v23
ds_read_b64_tr_b16 v[70:71], v23 offset:1024
s_add_u32 m0, s94, s97
s_nop 0
buffer_load_dwordx4 v34, s[44:47], s93 offen lds
buffer_load_dwordx4 v35, s[44:47], s93 offen offset:1024 lds
s_add_u32 s93, s93, 262144
s_and_b32 s93, s93, 0x3fffff
s_add_u32 s94, s94, 8192
s_and_b32 s94, s94, 32767
s_add_u32 s71, s99, s92
s_add_u32 m0, s98, s95
s_nop 0
buffer_load_dwordx4 v30, s[40:43], s71 offen lds
v_cvt_pk_bf16_f32 v96, v128, v129
v_cvt_pk_bf16_f32 v97, v130, v131
v_cvt_pk_bf16_f32 v98, v132, v133
s_waitcnt lgkmcnt(0)
v_mfma_f32_32x32x16_bf16 a[128:143], v[56:59], v[48:51], 0
ds_read_b128 v[72:75], v17
ds_read_b128 v[76:79], v17 offset:4096
v_cvt_pk_bf16_f32 v99, v134, v135
v_mfma_f32_32x32x16_bf16 a[192:207], v[56:59], v[52:55], 0
buffer_load_dwordx4 v31, s[40:43], s71 offen offset:1024 lds
ds_read_b64_tr_b16 v[80:81], v20 offset:4096
v_mfma_f32_32x32x16_bf16 a[144:159], v[60:63], v[48:51], 0
ds_read_b64_tr_b16 v[82:83], v20 offset:5120
ds_read_b64_tr_b16 v[84:85], v21 offset:4096
v_mfma_f32_32x32x16_bf16 a[208:223], v[60:63], v[52:55], 0
ds_read_b64_tr_b16 v[86:87], v21 offset:5120
buffer_load_dwordx4 v32, s[40:43], s71 offen offset:2048 lds
v_mfma_f32_32x32x16_bf16 a[160:175], v[64:67], v[48:51], 0
ds_read_b64_tr_b16 v[88:89], v22 offset:4096
ds_read_b64_tr_b16 v[90:91], v22 offset:5120
v_mfma_f32_32x32x16_bf16 a[224:239], v[64:67], v[52:55], 0
buffer_store_dwordx4 v[96:99], v28, s[48:51], s66 offen sc1
ds_read_b64_tr_b16 v[92:93], v23 offset:4096
v_mfma_f32_32x32x16_bf16 a[176:191], v[68:71], v[48:51], 0
ds_read_b64_tr_b16 v[94:95], v23 offset:5120
buffer_load_dwordx4 v33, s[40:43], s71 offen offset:3072 lds
s_add_u32 s68, s68, 8192
s_and_b32 s68, s68, 32767
v_add_u32 v20, s68, v12
v_mfma_f32_32x32x16_bf16 a[240:255], v[68:71], v[52:55], 0
v_add_u32 v21, s68, v13
v_add_u32 v22, s68, v14
v_add_u32 v23, s68, v15
s_waitcnt lgkmcnt(0)
v_mfma_f32_32x32x16_bf16 a[128:143], v[80:83], v[72:75], a[128:143]
s_waitcnt vmcnt(17)
s_barrier
v_mfma_f32_32x32x16_bf16 a[192:207], v[80:83], v[76:79], a[192:207]
ds_read_b128 v[48:51], v18
ds_read_b128 v[52:55], v18 offset:4096
v_cvt_pk_bf16_f32 v100, v136, v137
s_add_u32 m0, s94, s97
v_mfma_f32_32x32x16_bf16 a[144:159], v[84:87], v[72:75], a[144:159]
ds_read_b64_tr_b16 v[56:57], v20
ds_read_b64_tr_b16 v[58:59], v20 offset:1024
v_cvt_pk_bf16_f32 v101, v138, v139
v_mfma_f32_32x32x16_bf16 a[208:223], v[84:87], v[76:79], a[208:223]
buffer_load_dwordx4 v34, s[44:47], s93 offen lds
ds_read_b64_tr_b16 v[60:61], v21
v_mfma_f32_32x32x16_bf16 a[160:175], v[88:91], v[72:75], a[160:175]
ds_read_b64_tr_b16 v[62:63], v21 offset:1024
ds_read_b64_tr_b16 v[64:65], v22
v_mfma_f32_32x32x16_bf16 a[224:239], v[88:91], v[76:79], a[224:239]
ds_read_b64_tr_b16 v[66:67], v22 offset:1024
ds_read_b64_tr_b16 v[68:69], v23
v_cvt_pk_bf16_f32 v102, v140, v141
v_mfma_f32_32x32x16_bf16 a[176:191], v[92:95], v[72:75], a[176:191]
ds_read_b64_tr_b16 v[70:71], v23 offset:1024
buffer_load_dwordx4 v35, s[44:47], s93 offen offset:1024 lds
s_add_u32 s93, s93, 262144
s_and_b32 s93, s93, 0x3fffff
s_add_u32 s94, s94, 8192
v_mfma_f32_32x32x16_bf16 a[240:255], v[92:95], v[76:79], a[240:255]
s_and_b32 s94, s94, 32767
s_add_u32 m0, s98, s95
s_add_u32 m0, m0, 4096
s_add_u32 s71, s70, s92
buffer_load_dwordx4 v30, s[40:43], s71 offen lds
s_waitcnt lgkmcnt(0)
v_mfma_f32_32x32x16_bf16 a[128:143], v[56:59], v[48:51], a[128:143]
ds_read_b128 v[72:75], v19
ds_read_b128 v[76:79], v19 offset:4096
v_cvt_pk_bf16_f32 v103, v142, v143
v_mfma_f32_32x32x16_bf16 a[192:207], v[56:59], v[52:55], a[192:207]
ds_read_b64_tr_b16 v[80:81], v20 offset:4096
buffer_load_dwordx4 v31, s[40:43], s71 offen offset:1024 lds
v_mfma_f32_32x32x16_bf16 a[144:159], v[60:63], v[48:51], a[144:159]
ds_read_b64_tr_b16 v[82:83], v20 offset:5120
ds_read_b64_tr_b16 v[84:85], v21 offset:4096
v_mfma_f32_32x32x16_bf16 a[208:223], v[60:63], v[52:55], a[208:223]
ds_read_b64_tr_b16 v[86:87], v21 offset:5120
ds_read_b64_tr_b16 v[88:89], v22 offset:4096
v_mfma_f32_32x32x16_bf16 a[160:175], v[64:67], v[48:51], a[160:175]
buffer_load_dwordx4 v32, s[40:43], s71 offen offset:2048 lds
ds_read_b64_tr_b16 v[90:91], v22 offset:5120
v_mfma_f32_32x32x16_bf16 a[224:239], v[64:67], v[52:55], a[224:239]
buffer_store_dwordx4 v[100:103], v28, s[48:51], s66 offen offset:1024 sc1
ds_read_b64_tr_b16 v[92:93], v23 offset:4096
v_mfma_f32_32x32x16_bf16 a[176:191], v[68:71], v[48:51], a[176:191]
ds_read_b64_tr_b16 v[94:95], v23 offset:5120
buffer_load_dwordx4 v33, s[40:43], s71 offen offset:3072 lds
s_add_u32 s68, s68, 8192
s_and_b32 s68, s68, 32767
v_add_u32 v20, s68, v12
v_mfma_f32_32x32x16_bf16 a[240:255], v[68:71], v[52:55], a[240:255]
v_add_u32 v21, s68, v13
v_add_u32 v22, s68, v14
v_add_u32 v23, s68, v15
s_add_u32 s69, s69, 8192
s_cmp_eq_u32 s69, 24576
s_cselect_b32 s69, 0, s69
v_add_u32 v16, s69, v8
v_add_u32 v17, s69, v9
v_add_u32 v18, s69, v10
v_add_u32 v19, s69, v11
s_add_u32 s92, s92, 128
s_and_b32 s92, s92, 1023
s_add_u32 s95, s95, 8192
s_cmp_eq_u32 s95, 24576
s_cselect_b32 s95, 0, s95
s_waitcnt lgkmcnt(0)
v_mfma_f32_32x32x16_bf16 a[128:143], v[80:83], v[72:75], a[128:143]
s_waitcnt vmcnt(14)
s_barrier
v_mfma_f32_32x32x16_bf16 a[192:207], v[80:83], v[76:79], a[192:207]
ds_read_b128 v[48:51], v16
ds_read_b128 v[52:55], v16 offset:4096
v_cvt_pk_bf16_f32 v104, v144, v145
s_add_u32 m0, s94, s97
v_mfma_f32_32x32x16_bf16 a[144:159], v[84:87], v[72:75], a[144:159]
ds_read_b64_tr_b16 v[56:57], v20
ds_read_b64_tr_b16 v[58:59], v20 offset:1024
v_cvt_pk_bf16_f32 v105, v146, v147
v_mfma_f32_32x32x16_bf16 a[208:223], v[84:87], v[76:79], a[208:223]
buffer_load_dwordx4 v34, s[44:47], s93 offen lds
ds_read_b64_tr_b16 v[60:61], v21
v_mfma_f32_32x32x16_bf16 a[160:175], v[88:91], v[72:75], a[160:175]
ds_read_b64_tr_b16 v[62:63], v21 offset:1024
ds_read_b64_tr_b16 v[64:65], v22
v_mfma_f32_32x32x16_bf16 a[224:239], v[88:91], v[76:79], a[224:239]
ds_read_b64_tr_b16 v[66:67], v22 offset:1024
ds_read_b64_tr_b16 v[68:69], v23
v_cvt_pk_bf16_f32 v106, v148, v149
v_mfma_f32_32x32x16_bf16 a[176:191], v[92:95], v[72:75], a[176:191]
ds_read_b64_tr_b16 v[70:71], v23 offset:1024
buffer_load_dwordx4 v35, s[44:47], s93 offen offset:1024 lds
s_add_u32 s93, s93, 262144
s_and_b32 s93, s93, 0x3fffff
s_add_u32 s94, s94, 8192
v_mfma_f32_32x32x16_bf16 a[240:255], v[92:95], v[76:79], a[240:255]
s_and_b32 s94, s94, 32767
s_add_u32 s71, s99, s92
s_add_u32 m0, s98, s95
s_nop 0
buffer_load_dwordx4 v30, s[40:43], s71 offen lds
s_waitcnt lgkmcnt(0)
v_mfma_f32_32x32x16_bf16 a[128:143], v[56:59], v[48:51], a[128:143]
ds_read_b128 v[72:75], v17
ds_read_b128 v[76:79], v17 offset:4096
v_cvt_pk_bf16_f32 v107, v150, v151
v_mfma_f32_32x32x16_bf16 a[192:207], v[56:59], v[52:55], a[192:207]
ds_read_b64_tr_b16 v[80:81], v20 offset:4096
buffer_load_dwordx4 v31, s[40:43], s71 offen offset:1024 lds
v_mfma_f32_32x32x16_bf16 a[144:159], v[60:63], v[48:51], a[144:159]
ds_read_b64_tr_b16 v[82:83], v20 offset:5120
ds_read_b64_tr_b16 v[84:85], v21 offset:4096
v_mfma_f32_32x32x16_bf16 a[208:223], v[60:63], v[52:55], a[208:223]
ds_read_b64_tr_b16 v[86:87], v21 offset:5120
ds_read_b64_tr_b16 v[88:89], v22 offset:4096
v_mfma_f32_32x32x16_bf16 a[160:175], v[64:67], v[48:51], a[160:175]
buffer_load_dwordx4 v32, s[40:43], s71 offen offset:2048 lds
ds_read_b64_tr_b16 v[90:91], v22 offset:5120
v_mfma_f32_32x32x16_bf16 a[224:239], v[64:67], v[52:55], a[224:239]
buffer_store_dwordx4 v[104:107], v28, s[48:51], s66 offen offset:2048 sc1
ds_read_b64_tr_b16 v[92:93], v23 offset:4096
v_mfma_f32_32x32x16_bf16 a[176:191], v[68:71], v[48:51], a[176:191]
ds_read_b64_tr_b16 v[94:95], v23 offset:5120
buffer_load_dwordx4 v33, s[40:43], s71 offen offset:3072 lds
s_add_u32 s68, s68, 8192
s_and_b32 s68, s68, 32767
v_add_u32 v20, s68, v12
v_mfma_f32_32x32x16_bf16 a[240:255], v[68:71], v[52:55], a[240:255]
v_add_u32 v21, s68, v13
v_add_u32 v22, s68, v14
v_add_u32 v23, s68, v15
s_waitcnt lgkmcnt(0)
v_mfma_f32_32x32x16_bf16 a[128:143], v[80:83], v[72:75], a[128:143]
s_waitcnt vmcnt(18)
s_barrier
v_mfma_f32_32x32x16_bf16 a[192:207], v[80:83], v[76:79], a[192:207]
ds_read_b128 v[48:51], v18
ds_read_b128 v[52:55], v18 offset:4096
v_cvt_pk_bf16_f32 v108, v152, v153
s_add_u32 m0, s94, s97
v_mfma_f32_32x32x16_bf16 a[144:159], v[84:87], v[72:75], a[144:159]
ds_read_b64_tr_b16 v[56:57], v20
ds_read_b64_tr_b16 v[58:59], v20 offset:1024
v_cvt_pk_bf16_f32 v109, v154, v155
v_mfma_f32_32x32x16_bf16 a[208:223], v[84:87], v[76:79], a[208:223]
buffer_load_dwordx4 v34, s[44:47], s93 offen lds
ds_read_b64_tr_b16 v[60:61], v21
v_mfma_f32_32x32x16_bf16 a[160:175], v[88:91], v[72:75], a[160:175]
ds_read_b64_tr_b16 v[62:63], v21 offset:1024
ds_read_b64_tr_b16 v[64:65], v22
v_mfma_f32_32x32x16_bf16 a[224:239], v[88:91], v[76:79], a[224:239]
ds_read_b64_tr_b16 v[66:67], v22 offset:1024
ds_read_b64_tr_b16 v[68:69], v23
v_cvt_pk_bf16_f32 v110, v156, v157
v_mfma_f32_32x32x16_bf16 a[176:191], v[92:95], v[72:75], a[176:191]
ds_read_b64_tr_b16 v[70:71], v23 offset:1024
buffer_load_dwordx4 v35, s[44:47], s93 offen offset:1024 lds
s_add_u32 s93, s93, 262144
s_and_b32 s93, s93, 0x3fffff
s_add_u32 s94, s94, 8192
v_mfma_f32_32x32x16_bf16 a[240:255], v[92:95], v[76:79], a[240:255]
s_and_b32 s94, s94, 32767
s_add_u32 m0, s98, s95
s_add_u32 m0, m0, 4096
s_add_u32 s71, s70, s92
buffer_load_dwordx4 v30, s[40:43], s71 offen lds
s_waitcnt lgkmcnt(0)
v_mfma_f32_32x32x16_bf16 a[128:143], v[56:59], v[48:51], a[128:143]
ds_read_b128 v[72:75], v19
ds_read_b128 v[76:79], v19 offset:4096
v_cvt_pk_bf16_f32 v111, v158, v159
v_mfma_f32_32x32x16_bf16 a[192:207], v[56:59], v[52:55], a[192:207]
ds_read_b64_tr_b16 v[80:81], v20 offset:4096
buffer_load_dwordx4 v31, s[40:43], s71 offen offset:1024 lds
v_mfma_f32_32x32x16_bf16 a[144:159], v[60:63], v[48:51], a[144:159]
ds_read_b64_tr_b16 v[82:83], v20 offset:5120
ds_read_b64_tr_b16 v[84:85], v21 offset:4096
v_mfma_f32_32x32x16_bf16 a[208:223], v[60:63], v[52:55], a[208:223]
ds_read_b64_tr_b16 v[86:87], v21 offset:5120
ds_read_b64_tr_b16 v[88:89], v22 offset:4096
v_mfma_f32_32x32x16_bf16 a[160:175], v[64:67], v[48:51], a[160:175]
buffer_load_dwordx4 v32, s[40:43], s71 offen offset:2048 lds
ds_read_b64_tr_b16 v[90:91], v22 offset:5120
v_mfma_f32_32x32x16_bf16 a[224:239], v[64:67], v[52:55], a[224:239]
buffer_store_dwordx4 v[108:111], v28, s[48:51], s66 offen offset:3072 sc1
ds_read_b64_tr_b16 v[92:93], v23 offset:4096
v_mfma_f32_32x32x16_bf16 a[176:191], v[68:71], v[48:51], a[176:191]
ds_read_b64_tr_b16 v[94:95], v23 offset:5120
buffer_load_dwordx4 v33, s[40:43], s71 offen offset:3072 lds
s_add_u32 s68, s68, 8192
s_and_b32 s68, s68, 32767
v_add_u32 v20, s68, v12
v_mfma_f32_32x32x16_bf16 a[240:255], v[68:71], v[52:55], a[240:255]
v_add_u32 v21, s68, v13
v_add_u32 v22, s68, v14
v_add_u32 v23, s68, v15
s_add_u32 s69, s69, 8192
s_cmp_eq_u32 s69, 24576
s_cselect_b32 s69, 0, s69
v_add_u32 v16, s69, v8
v_add_u32 v17, s69, v9
v_add_u32 v18, s69, v10
v_add_u32 v19, s69, v11
s_add_u32 s92, s92, 128
s_and_b32 s92, s92, 1023
s_add_u32 s95, s95, 8192
s_cmp_eq_u32 s95, 24576
s_cselect_b32 s95, 0, s95
s_waitcnt lgkmcnt(0)
v_mfma_f32_32x32x16_bf16 a[128:143], v[80:83], v[72:75], a[128:143]
s_waitcnt vmcnt(14)
s_barrier
v_mfma_f32_32x32x16_bf16 a[192:207], v[80:83], v[76:79], a[192:207]
ds_read_b128 v[48:51], v16
ds_read_b128 v[52:55], v16 offset:4096
v_cvt_pk_bf16_f32 v112, v160, v161
s_add_u32 m0, s94, s97
v_cvt_pk_bf16_f32 v113, v162, v163
v_mfma_f32_32x32x16_bf16 a[144:159], v[84:87], v[72:75], a[144:159]
ds_read_b64_tr_b16 v[56:57], v20
ds_read_b64_tr_b16 v[58:59], v20 offset:1024
v_mfma_f32_32x32x16_bf16 a[208:223], v[84:87], v[76:79], a[208:223]
buffer_load_dwordx4 v34, s[44:47], s93 offen lds
ds_read_b64_tr_b16 v[60:61], v21
v_mfma_f32_32x32x16_bf16 a[160:175], v[88:91], v[72:75], a[160:175]
ds_read_b64_tr_b16 v[62:63], v21 offset:1024
ds_read_b64_tr_b16 v[64:65], v22
v_cvt_pk_bf16_f32 v114, v164, v165
v_mfma_f32_32x32x16_bf16 a[224:239], v[88:91], v[76:79], a[224:239]
ds_read_b64_tr_b16 v[66:67], v22 offset:1024
ds_read_b64_tr_b16 v[68:69], v23
v_mfma_f32_32x32x16_bf16 a[176:191], v[92:95], v[72:75], a[176:191]
ds_read_b64_tr_b16 v[70:71], v23 offset:1024
buffer_load_dwordx4 v35, s[44:47], s93 offen offset:1024 lds
s_add_u32 s93, s93, 262144
s_and_b32 s93, s93, 0x3fffff
s_add_u32 s94, s94, 8192
v_mfma_f32_32x32x16_bf16 a[240:255], v[92:95], v[76:79], a[240:255]
s_and_b32 s94, s94, 32767
s_add_u32 s71, s99, s92
s_add_u32 m0, s98, s95
s_nop 0
buffer_load_dwordx4 v30, s[40:43], s71 offen lds
s_waitcnt lgkmcnt(0)
v_mfma_f32_32x32x16_bf16 a[128:143], v[56:59], v[48:51], a[128:143]
ds_read_b128 v[72:75], v17
ds_read_b128 v[76:79], v17 offset:4096
v_cvt_pk_bf16_f32 v115, v166, v167
s_add_u32 s66, s66, 4096
v_mfma_f32_32x32x16_bf16 a[192:207], v[56:59], v[52:55], a[192:207]
ds_read_b64_tr_b16 v[80:81], v20 offset:4096
buffer_load_dwordx4 v31, s[40:43], s71 offen offset:1024 lds
v_mfma_f32_32x32x16_bf16 a[144:159], v[60:63], v[48:51], a[144:159]
ds_read_b64_tr_b16 v[82:83], v20 offset:5120
ds_read_b64_tr_b16 v[84:85], v21 offset:4096
v_mfma_f32_32x32x16_bf16 a[208:223], v[60:63], v[52:55], a[208:223]
ds_read_b64_tr_b16 v[86:87], v21 offset:5120
ds_read_b64_tr_b16 v[88:89], v22 offset:4096
v_mfma_f32_32x32x16_bf16 a[160:175], v[64:67], v[48:51], a[160:175]
buffer_load_dwordx4 v32, s[40:43], s71 offen offset:2048 lds
ds_read_b64_tr_b16 v[90:91], v22 offset:5120
v_mfma_f32_32x32x16_bf16 a[224:239], v[64:67], v[52:55], a[224:239]
ds_read_b64_tr_b16 v[92:93], v23 offset:4096
buffer_store_dwordx4 v[112:115], v28, s[48:51], s66 offen sc1
v_mfma_f32_32x32x16_bf16 a[176:191], v[68:71], v[48:51], a[176:191]
ds_read_b64_tr_b16 v[94:95], v23 offset:5120
buffer_load_dwordx4 v33, s[40:43], s71 offen offset:3072 lds
s_add_u32 s68, s68, 8192
s_and_b32 s68, s68, 32767
v_add_u32 v20, s68, v12
v_mfma_f32_32x32x16_bf16 a[240:255], v[68:71], v[52:55], a[240:255]
v_add_u32 v21, s68, v13
v_add_u32 v22, s68, v14
v_add_u32 v23, s68, v15
s_waitcnt lgkmcnt(0)
v_mfma_f32_32x32x16_bf16 a[128:143], v[80:83], v[72:75], a[128:143]
s_waitcnt vmcnt(18)
s_barrier
v_mfma_f32_32x32x16_bf16 a[192:207], v[80:83], v[76:79], a[192:207]
ds_read_b128 v[48:51], v18
ds_read_b128 v[52:55], v18 offset:4096
v_cvt_pk_bf16_f32 v116, v168, v169
s_add_u32 m0, s94, s97
v_mfma_f32_32x32x16_bf16 a[144:159], v[84:87], v[72:75], a[144:159]
ds_read_b64_tr_b16 v[56:57], v20
ds_read_b64_tr_b16 v[58:59], v20 offset:1024
v_cvt_pk_bf16_f32 v117, v170, v171
v_mfma_f32_32x32x16_bf16 a[208:223], v[84:87], v[76:79], a[208:223]
buffer_load_dwordx4 v34, s[44:47], s93 offen lds
ds_read_b64_tr_b16 v[60:61], v21
v_mfma_f32_32x32x16_bf16 a[160:175], v[88:91], v[72:75], a[160:175]
ds_read_b64_tr_b16 v[62:63], v21 offset:1024
ds_read_b64_tr_b16 v[64:65], v22
v_mfma_f32_32x32x16_bf16 a[224:239], v[88:91], v[76:79], a[224:239]
ds_read_b64_tr_b16 v[66:67], v22 offset:1024
ds_read_b64_tr_b16 v[68:69], v23
v_cvt_pk_bf16_f32 v118, v172, v173
v_mfma_f32_32x32x16_bf16 a[176:191], v[92:95], v[72:75], a[176:191]
ds_read_b64_tr_b16 v[70:71], v23 offset:1024
buffer_load_dwordx4 v35, s[44:47], s93 offen offset:1024 lds
s_add_u32 s93, s93, 262144
s_and_b32 s93, s93, 0x3fffff
s_add_u32 s94, s94, 8192
v_mfma_f32_32x32x16_bf16 a[240:255], v[92:95], v[76:79], a[240:255]
s_and_b32 s94, s94, 32767
s_add_u32 m0, s98, s95
s_add_u32 m0, m0, 4096
s_add_u32 s71, s70, s92
buffer_load_dwordx4 v30, s[40:43], s71 offen lds
s_waitcnt lgkmcnt(0)
v_mfma_f32_32x32x16_bf16 a[128:143], v[56:59], v[48:51], a[128:143]
ds_read_b128 v[72:75], v19
ds_read_b128 v[76:79], v19 offset:4096
v_cvt_pk_bf16_f32 v119, v174, v175
v_mfma_f32_32x32x16_bf16 a[192:207], v[56:59], v[52:55], a[192:207]
ds_read_b64_tr_b16 v[80:81], v20 offset:4096
buffer_load_dwordx4 v31, s[40:43], s71 offen offset:1024 lds
v_mfma_f32_32x32x16_bf16 a[144:159], v[60:63], v[48:51], a[144:159]
ds_read_b64_tr_b16 v[82:83], v20 offset:5120
ds_read_b64_tr_b16 v[84:85], v21 offset:4096
v_mfma_f32_32x32x16_bf16 a[208:223], v[60:63], v[52:55], a[208:223]
ds_read_b64_tr_b16 v[86:87], v21 offset:5120
ds_read_b64_tr_b16 v[88:89], v22 offset:4096
v_mfma_f32_32x32x16_bf16 a[160:175], v[64:67], v[48:51], a[160:175]
buffer_load_dwordx4 v32, s[40:43], s71 offen offset:2048 lds
ds_read_b64_tr_b16 v[90:91], v22 offset:5120
v_mfma_f32_32x32x16_bf16 a[224:239], v[64:67], v[52:55], a[224:239]
buffer_store_dwordx4 v[116:119], v28, s[48:51], s66 offen offset:1024 sc1
ds_read_b64_tr_b16 v[92:93], v23 offset:4096
v_mfma_f32_32x32x16_bf16 a[176:191], v[68:71], v[48:51], a[176:191]
ds_read_b64_tr_b16 v[94:95], v23 offset:5120
buffer_load_dwordx4 v33, s[40:43], s71 offen offset:3072 lds
s_add_u32 s68, s68, 8192
s_and_b32 s68, s68, 32767
v_add_u32 v20, s68, v12
v_mfma_f32_32x32x16_bf16 a[240:255], v[68:71], v[52:55], a[240:255]
v_add_u32 v21, s68, v13
v_add_u32 v22, s68, v14
v_add_u32 v23, s68, v15
s_add_u32 s69, s69, 8192
s_cmp_eq_u32 s69, 24576
s_cselect_b32 s69, 0, s69
v_add_u32 v16, s69, v8
v_add_u32 v17, s69, v9
v_add_u32 v18, s69, v10
v_add_u32 v19, s69, v11
s_add_u32 s92, s92, 128
s_and_b32 s92, s92, 1023
s_add_u32 s95, s95, 8192
s_cmp_eq_u32 s95, 24576
s_cselect_b32 s95, 0, s95
s_waitcnt lgkmcnt(0)
v_mfma_f32_32x32x16_bf16 a[128:143], v[80:83], v[72:75], a[128:143]
s_waitcnt vmcnt(14)
s_barrier
v_mfma_f32_32x32x16_bf16 a[192:207], v[80:83], v[76:79], a[192:207]
ds_read_b128 v[48:51], v16
ds_read_b128 v[52:55], v16 offset:4096
v_cvt_pk_bf16_f32 v120, v176, v177
s_add_u32 m0, s94, s97
v_mfma_f32_32x32x16_bf16 a[144:159], v[84:87], v[72:75], a[144:159]
ds_read_b64_tr_b16 v[56:57], v20
ds_read_b64_tr_b16 v[58:59], v20 offset:1024
v_cvt_pk_bf16_f32 v121, v178, v179
v_mfma_f32_32x32x16_bf16 a[208:223], v[84:87], v[76:79], a[208:223]
buffer_load_dwordx4 v34, s[44:47], s93 offen lds
ds_read_b64_tr_b16 v[60:61], v21
v_mfma_f32_32x32x16_bf16 a[160:175], v[88:91], v[72:75], a[160:175]
ds_read_b64_tr_b16 v[62:63], v21 offset:1024
ds_read_b64_tr_b16 v[64:65], v22
v_mfma_f32_32x32x16_bf16 a[224:239], v[88:91], v[76:79], a[224:239]
ds_read_b64_tr_b16 v[66:67], v22 offset:1024
ds_read_b64_tr_b16 v[68:69], v23
v_cvt_pk_bf16_f32 v122, v180, v181
v_mfma_f32_32x32x16_bf16 a[176:191], v[92:95], v[72:75], a[176:191]
ds_read_b64_tr_b16 v[70:71], v23 offset:1024
buffer_load_dwordx4 v35, s[44:47], s93 offen offset:1024 lds
s_add_u32 s93, s93, 262144
s_and_b32 s93, s93, 0x3fffff
s_add_u32 s94, s94, 8192
v_mfma_f32_32x32x16_bf16 a[240:255], v[92:95], v[76:79], a[240:255]
s_and_b32 s94, s94, 32767
s_add_u32 s71, s99, s92
s_add_u32 m0, s98, s95
s_nop 0
buffer_load_dwordx4 v30, s[40:43], s71 offen lds
s_waitcnt lgkmcnt(0)
v_mfma_f32_32x32x16_bf16 a[128:143], v[56:59], v[48:51], a[128:143]
ds_read_b128 v[72:75], v17
ds_read_b128 v[76:79], v17 offset:4096
v_cvt_pk_bf16_f32 v123, v182, v183
v_mfma_f32_32x32x16_bf16 a[192:207], v[56:59], v[52:55], a[192:207]
ds_read_b64_tr_b16 v[80:81], v20 offset:4096
buffer_load_dwordx4 v31, s[40:43], s71 offen offset:1024 lds
v_mfma_f32_32x32x16_bf16 a[144:159], v[60:63], v[48:51], a[144:159]
ds_read_b64_tr_b16 v[82:83], v20 offset:5120
ds_read_b64_tr_b16 v[84:85], v21 offset:4096
v_mfma_f32_32x32x16_bf16 a[208:223], v[60:63], v[52:55], a[208:223]
ds_read_b64_tr_b16 v[86:87], v21 offset:5120
ds_read_b64_tr_b16 v[88:89], v22 offset:4096
v_mfma_f32_32x32x16_bf16 a[160:175], v[64:67], v[48:51], a[160:175]
buffer_load_dwordx4 v32, s[40:43], s71 offen offset:2048 lds
ds_read_b64_tr_b16 v[90:91], v22 offset:5120
v_mfma_f32_32x32x16_bf16 a[224:239], v[64:67], v[52:55], a[224:239]
buffer_store_dwordx4 v[120:123], v28, s[48:51], s66 offen offset:2048 sc1
ds_read_b64_tr_b16 v[92:93], v23 offset:4096
v_mfma_f32_32x32x16_bf16 a[176:191], v[68:71], v[48:51], a[176:191]
ds_read_b64_tr_b16 v[94:95], v23 offset:5120
buffer_load_dwordx4 v33, s[40:43], s71 offen offset:3072 lds
s_add_u32 s68, s68, 8192
s_and_b32 s68, s68, 32767
v_add_u32 v20, s68, v12
v_mfma_f32_32x32x16_bf16 a[240:255], v[68:71], v[52:55], a[240:255]
v_add_u32 v21, s68, v13
v_add_u32 v22, s68, v14
v_add_u32 v23, s68, v15
s_waitcnt lgkmcnt(0)
v_mfma_f32_32x32x16_bf16 a[128:143], v[80:83], v[72:75], a[128:143]
s_waitcnt vmcnt(18)
s_barrier
v_mfma_f32_32x32x16_bf16 a[192:207], v[80:83], v[76:79], a[192:207]
ds_read_b128 v[48:51], v18
ds_read_b128 v[52:55], v18 offset:4096
v_cvt_pk_bf16_f32 v124, v184, v185
s_add_u32 m0, s94, s97
v_mfma_f32_32x32x16_bf16 a[144:159], v[84:87], v[72:75], a[144:159]
ds_read_b64_tr_b16 v[56:57], v20
ds_read_b64_tr_b16 v[58:59], v20 offset:1024
v_cvt_pk_bf16_f32 v125, v186, v187
v_mfma_f32_32x32x16_bf16 a[208:223], v[84:87], v[76:79], a[208:223]
buffer_load_dwordx4 v34, s[44:47], s93 offen lds
ds_read_b64_tr_b16 v[60:61], v21
v_mfma_f32_32x32x16_bf16 a[160:175], v[88:91], v[72:75], a[160:175]
ds_read_b64_tr_b16 v[62:63], v21 offset:1024
ds_read_b64_tr_b16 v[64:65], v22
v_mfma_f32_32x32x16_bf16 a[224:239], v[88:91], v[76:79], a[224:239]
ds_read_b64_tr_b16 v[66:67], v22 offset:1024
ds_read_b64_tr_b16 v[68:69], v23
v_cvt_pk_bf16_f32 v126, v188, v189
v_mfma_f32_32x32x16_bf16 a[176:191], v[92:95], v[72:75], a[176:191]
ds_read_b64_tr_b16 v[70:71], v23 offset:1024
buffer_load_dwordx4 v35, s[44:47], s93 offen offset:1024 lds
s_add_u32 s93, s93, 262144
s_and_b32 s93, s93, 0x3fffff
s_add_u32 s94, s94, 8192
v_mfma_f32_32x32x16_bf16 a[240:255], v[92:95], v[76:79], a[240:255]
s_and_b32 s94, s94, 32767
s_add_u32 m0, s98, s95
s_add_u32 m0, m0, 4096
s_add_u32 s71, s70, s92
buffer_load_dwordx4 v30, s[40:43], s71 offen lds
s_waitcnt lgkmcnt(0)
v_mfma_f32_32x32x16_bf16 a[128:143], v[56:59], v[48:51], a[128:143]
ds_read_b128 v[72:75], v19
ds_read_b128 v[76:79], v19 offset:4096
v_cvt_pk_bf16_f32 v127, v190, v191
v_mfma_f32_32x32x16_bf16 a[192:207], v[56:59], v[52:55], a[192:207]
ds_read_b64_tr_b16 v[80:81], v20 offset:4096
buffer_load_dwordx4 v31, s[40:43], s71 offen offset:1024 lds
v_mfma_f32_32x32x16_bf16 a[144:159], v[60:63], v[48:51], a[144:159]
ds_read_b64_tr_b16 v[82:83], v20 offset:5120
ds_read_b64_tr_b16 v[84:85], v21 offset:4096
v_mfma_f32_32x32x16_bf16 a[208:223], v[60:63], v[52:55], a[208:223]
ds_read_b64_tr_b16 v[86:87], v21 offset:5120
ds_read_b64_tr_b16 v[88:89], v22 offset:4096
v_mfma_f32_32x32x16_bf16 a[160:175], v[64:67], v[48:51], a[160:175]
buffer_load_dwordx4 v32, s[40:43], s71 offen offset:2048 lds
ds_read_b64_tr_b16 v[90:91], v22 offset:5120
v_mfma_f32_32x32x16_bf16 a[224:239], v[64:67], v[52:55], a[224:239]
buffer_store_dwordx4 v[124:127], v28, s[48:51], s66 offen offset:3072 sc1
ds_read_b64_tr_b16 v[92:93], v23 offset:4096
v_mfma_f32_32x32x16_bf16 a[176:191], v[68:71], v[48:51], a[176:191]
ds_read_b64_tr_b16 v[94:95], v23 offset:5120
buffer_load_dwordx4 v33, s[40:43], s71 offen offset:3072 lds
s_add_u32 s68, s68, 8192
s_and_b32 s68, s68, 32767
v_add_u32 v20, s68, v12
v_mfma_f32_32x32x16_bf16 a[240:255], v[68:71], v[52:55], a[240:255]
v_add_u32 v21, s68, v13
v_add_u32 v22, s68, v14
v_add_u32 v23, s68, v15
s_add_u32 s69, s69, 8192
s_cmp_eq_u32 s69, 24576
s_cselect_b32 s69, 0, s69
v_add_u32 v16, s69, v8
v_add_u32 v17, s69, v9
v_add_u32 v18, s69, v10
v_add_u32 v19, s69, v11
s_add_u32 s92, s92, 128
s_and_b32 s92, s92, 1023
s_add_u32 s95, s95, 8192
s_cmp_eq_u32 s95, 24576
s_cselect_b32 s95, 0, s95
s_waitcnt lgkmcnt(0)
v_mfma_f32_32x32x16_bf16 a[128:143], v[80:83], v[72:75], a[128:143]
s_waitcnt vmcnt(14)
s_barrier
v_mfma_f32_32x32x16_bf16 a[192:207], v[80:83], v[76:79], a[192:207]
ds_read_b128 v[48:51], v16
ds_read_b128 v[52:55], v16 offset:4096
v_cvt_pk_bf16_f32 v96, v192, v193
s_add_u32 m0, s94, s97
v_cvt_pk_bf16_f32 v97, v194, v195
v_mfma_f32_32x32x16_bf16 a[144:159], v[84:87], v[72:75], a[144:159]
ds_read_b64_tr_b16 v[56:57], v20
ds_read_b64_tr_b16 v[58:59], v20 offset:1024
v_mfma_f32_32x32x16_bf16 a[208:223], v[84:87], v[76:79], a[208:223]
buffer_load_dwordx4 v34, s[44:47], s93 offen lds
ds_read_b64_tr_b16 v[60:61], v21
v_mfma_f32_32x32x16_bf16 a[160:175], v[88:91], v[72:75], a[160:175]
ds_read_b64_tr_b16 v[62:63], v21 offset:1024
ds_read_b64_tr_b16 v[64:65], v22
v_cvt_pk_bf16_f32 v98, v196, v197
v_mfma_f32_32x32x16_bf16 a[224:239], v[88:91], v[76:79], a[224:239]
ds_read_b64_tr_b16 v[66:67], v22 offset:1024
ds_read_b64_tr_b16 v[68:69], v23
v_mfma_f32_32x32x16_bf16 a[176:191], v[92:95], v[72:75], a[176:191]
ds_read_b64_tr_b16 v[70:71], v23 offset:1024
buffer_load_dwordx4 v35, s[44:47], s93 offen offset:1024 lds
s_add_u32 s93, s93, 262144
s_and_b32 s93, s93, 0x3fffff
s_add_u32 s94, s94, 8192
v_mfma_f32_32x32x16_bf16 a[240:255], v[92:95], v[76:79], a[240:255]
s_and_b32 s94, s94, 32767
s_add_u32 s71, s99, s92
s_add_u32 m0, s98, s95
s_nop 0
buffer_load_dwordx4 v30, s[40:43], s71 offen lds
s_waitcnt lgkmcnt(0)
v_mfma_f32_32x32x16_bf16 a[128:143], v[56:59], v[48:51], a[128:143]
ds_read_b128 v[72:75], v17
ds_read_b128 v[76:79], v17 offset:4096
v_cvt_pk_bf16_f32 v99, v198, v199
s_add_u32 s66, s66, 4096
v_mfma_f32_32x32x16_bf16 a[192:207], v[56:59], v[52:55], a[192:207]
ds_read_b64_tr_b16 v[80:81], v20 offset:4096
buffer_load_dwordx4 v31, s[40:43], s71 offen offset:1024 lds
v_mfma_f32_32x32x16_bf16 a[144:159], v[60:63], v[48:51], a[144:159]
ds_read_b64_tr_b16 v[82:83], v20 offset:5120
ds_read_b64_tr_b16 v[84:85], v21 offset:4096
v_mfma_f32_32x32x16_bf16 a[208:223], v[60:63], v[52:55], a[208:223]
ds_read_b64_tr_b16 v[86:87], v21 offset:5120
ds_read_b64_tr_b16 v[88:89], v22 offset:4096
v_mfma_f32_32x32x16_bf16 a[160:175], v[64:67], v[48:51], a[160:175]
buffer_load_dwordx4 v32, s[40:43], s71 offen offset:2048 lds
ds_read_b64_tr_b16 v[90:91], v22 offset:5120
v_mfma_f32_32x32x16_bf16 a[224:239], v[64:67], v[52:55], a[224:239]
ds_read_b64_tr_b16 v[92:93], v23 offset:4096
buffer_store_dwordx4 v[96:99], v28, s[48:51], s66 offen sc1
v_mfma_f32_32x32x16_bf16 a[176:191], v[68:71], v[48:51], a[176:191]
ds_read_b64_tr_b16 v[94:95], v23 offset:5120
buffer_load_dwordx4 v33, s[40:43], s71 offen offset:3072 lds
s_add_u32 s68, s68, 8192
s_and_b32 s68, s68, 32767
v_add_u32 v20, s68, v12
v_mfma_f32_32x32x16_bf16 a[240:255], v[68:71], v[52:55], a[240:255]
v_add_u32 v21, s68, v13
v_add_u32 v22, s68, v14
v_add_u32 v23, s68, v15
s_waitcnt lgkmcnt(0)
v_mfma_f32_32x32x16_bf16 a[128:143], v[80:83], v[72:75], a[128:143]
s_waitcnt vmcnt(18)
s_barrier
v_mfma_f32_32x32x16_bf16 a[192:207], v[80:83], v[76:79], a[192:207]
ds_read_b128 v[48:51], v18
ds_read_b128 v[52:55], v18 offset:4096
v_cvt_pk_bf16_f32 v100, v200, v201
s_add_u32 m0, s94, s97
v_mfma_f32_32x32x16_bf16 a[144:159], v[84:87], v[72:75], a[144:159]
ds_read_b64_tr_b16 v[56:57], v20
ds_read_b64_tr_b16 v[58:59], v20 offset:1024
v_cvt_pk_bf16_f32 v101, v202, v203
v_mfma_f32_32x32x16_bf16 a[208:223], v[84:87], v[76:79], a[208:223]
buffer_load_dwordx4 v34, s[44:47], s93 offen lds
ds_read_b64_tr_b16 v[60:61], v21
v_mfma_f32_32x32x16_bf16 a[160:175], v[88:91], v[72:75], a[160:175]
ds_read_b64_tr_b16 v[62:63], v21 offset:1024
ds_read_b64_tr_b16 v[64:65], v22
v_mfma_f32_32x32x16_bf16 a[224:239], v[88:91], v[76:79], a[224:239]
ds_read_b64_tr_b16 v[66:67], v22 offset:1024
ds_read_b64_tr_b16 v[68:69], v23
v_cvt_pk_bf16_f32 v102, v204, v205
v_mfma_f32_32x32x16_bf16 a[176:191], v[92:95], v[72:75], a[176:191]
ds_read_b64_tr_b16 v[70:71], v23 offset:1024
buffer_load_dwordx4 v35, s[44:47], s93 offen offset:1024 lds
s_add_u32 s93, s93, 262144
s_and_b32 s93, s93, 0x3fffff
s_add_u32 s94, s94, 8192
v_mfma_f32_32x32x16_bf16 a[240:255], v[92:95], v[76:79], a[240:255]
s_and_b32 s94, s94, 32767
s_add_u32 m0, s98, s95
s_add_u32 m0, m0, 4096
s_add_u32 s71, s70, s92
buffer_load_dwordx4 v30, s[40:43], s71 offen lds
s_waitcnt lgkmcnt(0)
v_mfma_f32_32x32x16_bf16 a[128:143], v[56:59], v[48:51], a[128:143]
ds_read_b128 v[72:75], v19
ds_read_b128 v[76:79], v19 offset:4096
v_cvt_pk_bf16_f32 v103, v206, v207
v_mfma_f32_32x32x16_bf16 a[192:207], v[56:59], v[52:55], a[192:207]
ds_read_b64_tr_b16 v[80:81], v20 offset:4096
buffer_load_dwordx4 v31, s[40:43], s71 offen offset:1024 lds
v_mfma_f32_32x32x16_bf16 a[144:159], v[60:63], v[48:51], a[144:159]
ds_read_b64_tr_b16 v[82:83], v20 offset:5120
ds_read_b64_tr_b16 v[84:85], v21 offset:4096
v_mfma_f32_32x32x16_bf16 a[208:223], v[60:63], v[52:55], a[208:223]
ds_read_b64_tr_b16 v[86:87], v21 offset:5120
ds_read_b64_tr_b16 v[88:89], v22 offset:4096
v_mfma_f32_32x32x16_bf16 a[160:175], v[64:67], v[48:51], a[160:175]
buffer_load_dwordx4 v32, s[40:43], s71 offen offset:2048 lds
ds_read_b64_tr_b16 v[90:91], v22 offset:5120
v_mfma_f32_32x32x16_bf16 a[224:239], v[64:67], v[52:55], a[224:239]
buffer_store_dwordx4 v[100:103], v28, s[48:51], s66 offen offset:1024 sc1
ds_read_b64_tr_b16 v[92:93], v23 offset:4096
v_mfma_f32_32x32x16_bf16 a[176:191], v[68:71], v[48:51], a[176:191]
ds_read_b64_tr_b16 v[94:95], v23 offset:5120
buffer_load_dwordx4 v33, s[40:43], s71 offen offset:3072 lds
s_add_u32 s68, s68, 8192
s_and_b32 s68, s68, 32767
v_add_u32 v20, s68, v12
v_mfma_f32_32x32x16_bf16 a[240:255], v[68:71], v[52:55], a[240:255]
v_add_u32 v21, s68, v13
v_add_u32 v22, s68, v14
v_add_u32 v23, s68, v15
s_add_u32 s69, s69, 8192
s_cmp_eq_u32 s69, 24576
s_cselect_b32 s69, 0, s69
v_add_u32 v16, s69, v8
v_add_u32 v17, s69, v9
v_add_u32 v18, s69, v10
v_add_u32 v19, s69, v11
s_add_u32 s92, s92, 128
s_and_b32 s92, s92, 1023
s_add_u32 s95, s95, 8192
s_cmp_eq_u32 s95, 24576
s_cselect_b32 s95, 0, s95
s_waitcnt lgkmcnt(0)
v_mfma_f32_32x32x16_bf16 a[128:143], v[80:83], v[72:75], a[128:143]
s_waitcnt vmcnt(14)
s_barrier
v_mfma_f32_32x32x16_bf16 a[192:207], v[80:83], v[76:79], a[192:207]
ds_read_b128 v[48:51], v16
ds_read_b128 v[52:55], v16 offset:4096
v_cvt_pk_bf16_f32 v104, v208, v209
s_add_u32 m0, s94, s97
v_mfma_f32_32x32x16_bf16 a[144:159], v[84:87], v[72:75], a[144:159]
ds_read_b64_tr_b16 v[56:57], v20
ds_read_b64_tr_b16 v[58:59], v20 offset:1024
v_cvt_pk_bf16_f32 v105, v210, v211
v_mfma_f32_32x32x16_bf16 a[208:223], v[84:87], v[76:79], a[208:223]
buffer_load_dwordx4 v34, s[44:47], s93 offen lds
ds_read_b64_tr_b16 v[60:61], v21
v_mfma_f32_32x32x16_bf16 a[160:175], v[88:91], v[72:75], a[160:175]
ds_read_b64_tr_b16 v[62:63], v21 offset:1024
ds_read_b64_tr_b16 v[64:65], v22
v_mfma_f32_32x32x16_bf16 a[224:239], v[88:91], v[76:79], a[224:239]
ds_read_b64_tr_b16 v[66:67], v22 offset:1024
ds_read_b64_tr_b16 v[68:69], v23
v_cvt_pk_bf16_f32 v106, v212, v213
v_mfma_f32_32x32x16_bf16 a[176:191], v[92:95], v[72:75], a[176:191]
ds_read_b64_tr_b16 v[70:71], v23 offset:1024
buffer_load_dwordx4 v35, s[44:47], s93 offen offset:1024 lds
s_add_u32 s93, s93, 262144
s_and_b32 s93, s93, 0x3fffff
s_add_u32 s94, s94, 8192
v_mfma_f32_32x32x16_bf16 a[240:255], v[92:95], v[76:79], a[240:255]
s_and_b32 s94, s94, 32767
s_add_u32 s71, s99, s92
s_add_u32 m0, s98, s95
s_nop 0
buffer_load_dwordx4 v30, s[40:43], s71 offen lds
s_waitcnt lgkmcnt(0)
v_mfma_f32_32x32x16_bf16 a[128:143], v[56:59], v[48:51], a[128:143]
ds_read_b128 v[72:75], v17
ds_read_b128 v[76:79], v17 offset:4096
v_cvt_pk_bf16_f32 v107, v214, v215
v_mfma_f32_32x32x16_bf16 a[192:207], v[56:59], v[52:55], a[192:207]
ds_read_b64_tr_b16 v[80:81], v20 offset:4096
buffer_load_dwordx4 v31, s[40:43], s71 offen offset:1024 lds
v_mfma_f32_32x32x16_bf16 a[144:159], v[60:63], v[48:51], a[144:159]
ds_read_b64_tr_b16 v[82:83], v20 offset:5120
ds_read_b64_tr_b16 v[84:85], v21 offset:4096
v_mfma_f32_32x32x16_bf16 a[208:223], v[60:63], v[52:55], a[208:223]
ds_read_b64_tr_b16 v[86:87], v21 offset:5120
ds_read_b64_tr_b16 v[88:89], v22 offset:4096
v_mfma_f32_32x32x16_bf16 a[160:175], v[64:67], v[48:51], a[160:175]
buffer_load_dwordx4 v32, s[40:43], s71 offen offset:2048 lds
ds_read_b64_tr_b16 v[90:91], v22 offset:5120
v_mfma_f32_32x32x16_bf16 a[224:239], v[64:67], v[52:55], a[224:239]
buffer_store_dwordx4 v[104:107], v28, s[48:51], s66 offen offset:2048 sc1
ds_read_b64_tr_b16 v[92:93], v23 offset:4096
v_mfma_f32_32x32x16_bf16 a[176:191], v[68:71], v[48:51], a[176:191]
ds_read_b64_tr_b16 v[94:95], v23 offset:5120
buffer_load_dwordx4 v33, s[40:43], s71 offen offset:3072 lds
s_add_u32 s68, s68, 8192
s_and_b32 s68, s68, 32767
v_add_u32 v20, s68, v12
v_mfma_f32_32x32x16_bf16 a[240:255], v[68:71], v[52:55], a[240:255]
v_add_u32 v21, s68, v13
v_add_u32 v22, s68, v14
v_add_u32 v23, s68, v15
s_waitcnt lgkmcnt(0)
v_mfma_f32_32x32x16_bf16 a[128:143], v[80:83], v[72:75], a[128:143]
s_waitcnt vmcnt(18)
s_barrier
v_mfma_f32_32x32x16_bf16 a[192:207], v[80:83], v[76:79], a[192:207]
ds_read_b128 v[48:51], v18
ds_read_b128 v[52:55], v18 offset:4096
v_cvt_pk_bf16_f32 v108, v216, v217
s_add_u32 m0, s94, s97
v_mfma_f32_32x32x16_bf16 a[144:159], v[84:87], v[72:75], a[144:159]
ds_read_b64_tr_b16 v[56:57], v20
ds_read_b64_tr_b16 v[58:59], v20 offset:1024
v_cvt_pk_bf16_f32 v109, v218, v219
v_mfma_f32_32x32x16_bf16 a[208:223], v[84:87], v[76:79], a[208:223]
buffer_load_dwordx4 v34, s[44:47], s93 offen lds
ds_read_b64_tr_b16 v[60:61], v21
v_mfma_f32_32x32x16_bf16 a[160:175], v[88:91], v[72:75], a[160:175]
ds_read_b64_tr_b16 v[62:63], v21 offset:1024
ds_read_b64_tr_b16 v[64:65], v22
v_mfma_f32_32x32x16_bf16 a[224:239], v[88:91], v[76:79], a[224:239]
ds_read_b64_tr_b16 v[66:67], v22 offset:1024
ds_read_b64_tr_b16 v[68:69], v23
v_cvt_pk_bf16_f32 v110, v220, v221
v_mfma_f32_32x32x16_bf16 a[176:191], v[92:95], v[72:75], a[176:191]
ds_read_b64_tr_b16 v[70:71], v23 offset:1024
buffer_load_dwordx4 v35, s[44:47], s93 offen offset:1024 lds
s_add_u32 s93, s93, 262144
s_and_b32 s93, s93, 0x3fffff
s_add_u32 s94, s94, 8192
v_mfma_f32_32x32x16_bf16 a[240:255], v[92:95], v[76:79], a[240:255]
s_and_b32 s94, s94, 32767
s_add_u32 m0, s98, s95
s_add_u32 m0, m0, 4096
s_add_u32 s71, s70, s92
buffer_load_dwordx4 v30, s[40:43], s71 offen lds
s_waitcnt lgkmcnt(0)
v_mfma_f32_32x32x16_bf16 a[128:143], v[56:59], v[48:51], a[128:143]
ds_read_b128 v[72:75], v19
ds_read_b128 v[76:79], v19 offset:4096
v_cvt_pk_bf16_f32 v111, v222, v223
v_mfma_f32_32x32x16_bf16 a[192:207], v[56:59], v[52:55], a[192:207]
ds_read_b64_tr_b16 v[80:81], v20 offset:4096
buffer_load_dwordx4 v31, s[40:43], s71 offen offset:1024 lds
v_mfma_f32_32x32x16_bf16 a[144:159], v[60:63], v[48:51], a[144:159]
ds_read_b64_tr_b16 v[82:83], v20 offset:5120
ds_read_b64_tr_b16 v[84:85], v21 offset:4096
v_mfma_f32_32x32x16_bf16 a[208:223], v[60:63], v[52:55], a[208:223]
ds_read_b64_tr_b16 v[86:87], v21 offset:5120
ds_read_b64_tr_b16 v[88:89], v22 offset:4096
v_mfma_f32_32x32x16_bf16 a[160:175], v[64:67], v[48:51], a[160:175]
buffer_load_dwordx4 v32, s[40:43], s71 offen offset:2048 lds
ds_read_b64_tr_b16 v[90:91], v22 offset:5120
v_mfma_f32_32x32x16_bf16 a[224:239], v[64:67], v[52:55], a[224:239]
buffer_store_dwordx4 v[108:111], v28, s[48:51], s66 offen offset:3072 sc1
ds_read_b64_tr_b16 v[92:93], v23 offset:4096
v_mfma_f32_32x32x16_bf16 a[176:191], v[68:71], v[48:51], a[176:191]
ds_read_b64_tr_b16 v[94:95], v23 offset:5120
buffer_load_dwordx4 v33, s[40:43], s71 offen offset:3072 lds
s_add_u32 s68, s68, 8192
s_and_b32 s68, s68, 32767
v_add_u32 v20, s68, v12
v_mfma_f32_32x32x16_bf16 a[240:255], v[68:71], v[52:55], a[240:255]
v_add_u32 v21, s68, v13
v_add_u32 v22, s68, v14
v_add_u32 v23, s68, v15
s_add_u32 s69, s69, 8192
s_cmp_eq_u32 s69, 24576
s_cselect_b32 s69, 0, s69
v_add_u32 v16, s69, v8
v_add_u32 v17, s69, v9
v_add_u32 v18, s69, v10
v_add_u32 v19, s69, v11
s_add_u32 s92, s92, 128
s_and_b32 s92, s92, 1023
s_add_u32 s95, s95, 8192
s_cmp_eq_u32 s95, 24576
s_cselect_b32 s95, 0, s95
s_waitcnt lgkmcnt(0)
v_mfma_f32_32x32x16_bf16 a[128:143], v[80:83], v[72:75], a[128:143]
s_waitcnt vmcnt(14)
s_barrier
v_mfma_f32_32x32x16_bf16 a[192:207], v[80:83], v[76:79], a[192:207]
ds_read_b128 v[48:51], v16
ds_read_b128 v[52:55], v16 offset:4096
v_cvt_pk_bf16_f32 v112, v224, v225
s_add_u32 m0, s94, s97
v_cvt_pk_bf16_f32 v113, v226, v227
v_mfma_f32_32x32x16_bf16 a[144:159], v[84:87], v[72:75], a[144:159]
ds_read_b64_tr_b16 v[56:57], v20
ds_read_b64_tr_b16 v[58:59], v20 offset:1024
v_mfma_f32_32x32x16_bf16 a[208:223], v[84:87], v[76:79], a[208:223]
ds_read_b64_tr_b16 v[60:61], v21
ds_read_b64_tr_b16 v[62:63], v21 offset:1024
v_mfma_f32_32x32x16_bf16 a[160:175], v[88:91], v[72:75], a[160:175]
ds_read_b64_tr_b16 v[64:65], v22
buffer_load_dwordx4 v34, s[44:47], s93 offen lds
v_cvt_pk_bf16_f32 v114, v228, v229
v_mfma_f32_32x32x16_bf16 a[224:239], v[88:91], v[76:79], a[224:239]
ds_read_b64_tr_b16 v[66:67], v22 offset:1024
ds_read_b64_tr_b16 v[68:69], v23
v_mfma_f32_32x32x16_bf16 a[176:191], v[92:95], v[72:75], a[176:191]
ds_read_b64_tr_b16 v[70:71], v23 offset:1024
v_mfma_f32_32x32x16_bf16 a[240:255], v[92:95], v[76:79], a[240:255]
s_waitcnt lgkmcnt(0)
v_mfma_f32_32x32x16_bf16 a[128:143], v[56:59], v[48:51], a[128:143]
ds_read_b128 v[72:75], v17
ds_read_b128 v[76:79], v17 offset:4096
v_cvt_pk_bf16_f32 v115, v230, v231
s_add_u32 s66, s66, 4096
v_mfma_f32_32x32x16_bf16 a[192:207], v[56:59], v[52:55], a[192:207]
ds_read_b64_tr_b16 v[80:81], v20 offset:4096
ds_read_b64_tr_b16 v[82:83], v20 offset:5120
v_mfma_f32_32x32x16_bf16 a[144:159], v[60:63], v[48:51], a[144:159]
ds_read_b64_tr_b16 v[84:85], v21 offset:4096
buffer_load_dwordx4 v35, s[44:47], s93 offen offset:1024 lds
v_mfma_f32_32x32x16_bf16 a[208:223], v[60:63], v[52:55], a[208:223]
ds_read_b64_tr_b16 v[86:87], v21 offset:5120
ds_read_b64_tr_b16 v[88:89], v22 offset:4096
v_mfma_f32_32x32x16_bf16 a[160:175], v[64:67], v[48:51], a[160:175]
ds_read_b64_tr_b16 v[90:91], v22 offset:5120
ds_read_b64_tr_b16 v[92:93], v23 offset:4096
v_mfma_f32_32x32x16_bf16 a[224:239], v[64:67], v[52:55], a[224:239]
buffer_store_dwordx4 v[112:115], v28, s[48:51], s66 offen sc1
ds_read_b64_tr_b16 v[94:95], v23 offset:5120
s_add_u32 s68, s68, 8192
s_and_b32 s68, s68, 32767
v_add_u32 v20, s68, v12
v_mfma_f32_32x32x16_bf16 a[176:191], v[68:71], v[48:51], a[176:191]
v_add_u32 v21, s68, v13
v_add_u32 v22, s68, v14
v_add_u32 v23, s68, v15
v_mfma_f32_32x32x16_bf16 a[240:255], v[68:71], v[52:55], a[240:255]
s_add_u32 s93, s93, 262144
s_and_b32 s93, s93, 0x3fffff
s_add_u32 s94, s94, 8192
s_and_b32 s94, s94, 32767
s_waitcnt lgkmcnt(0)
v_mfma_f32_32x32x16_bf16 a[128:143], v[80:83], v[72:75], a[128:143]
s_waitcnt vmcnt(14)
s_barrier
v_mfma_f32_32x32x16_bf16 a[192:207], v[80:83], v[76:79], a[192:207]
ds_read_b128 v[48:51], v18
ds_read_b128 v[52:55], v18 offset:4096
v_cvt_pk_bf16_f32 v116, v232, v233
v_mfma_f32_32x32x16_bf16 a[144:159], v[84:87], v[72:75], a[144:159]
ds_read_b64_tr_b16 v[56:57], v20
ds_read_b64_tr_b16 v[58:59], v20 offset:1024
v_cvt_pk_bf16_f32 v117, v234, v235
v_mfma_f32_32x32x16_bf16 a[208:223], v[84:87], v[76:79], a[208:223]
ds_read_b64_tr_b16 v[60:61], v21
ds_read_b64_tr_b16 v[62:63], v21 offset:1024
v_mfma_f32_32x32x16_bf16 a[160:175], v[88:91], v[72:75], a[160:175]
ds_read_b64_tr_b16 v[64:65], v22
ds_read_b64_tr_b16 v[66:67], v22 offset:1024
v_mfma_f32_32x32x16_bf16 a[224:239], v[88:91], v[76:79], a[224:239]
ds_read_b64_tr_b16 v[68:69], v23
ds_read_b64_tr_b16 v[70:71], v23 offset:1024
v_cvt_pk_bf16_f32 v118, v236, v237
v_mfma_f32_32x32x16_bf16 a[176:191], v[92:95], v[72:75], a[176:191]
v_mfma_f32_32x32x16_bf16 a[240:255], v[92:95], v[76:79], a[240:255]
s_waitcnt lgkmcnt(0)
v_mfma_f32_32x32x16_bf16 a[128:143], v[56:59], v[48:51], a[128:143]
ds_read_b128 v[72:75], v19
ds_read_b128 v[76:79], v19 offset:4096
v_cvt_pk_bf16_f32 v119, v238, v239
v_mfma_f32_32x32x16_bf16 a[192:207], v[56:59], v[52:55], a[192:207]
ds_read_b64_tr_b16 v[80:81], v20 offset:4096
ds_read_b64_tr_b16 v[82:83], v20 offset:5120
v_mfma_f32_32x32x16_bf16 a[144:159], v[60:63], v[48:51], a[144:159]
ds_read_b64_tr_b16 v[84:85], v21 offset:4096
ds_read_b64_tr_b16 v[86:87], v21 offset:5120
v_mfma_f32_32x32x16_bf16 a[208:223], v[60:63], v[52:55], a[208:223]
ds_read_b64_tr_b16 v[88:89], v22 offset:4096
ds_read_b64_tr_b16 v[90:91], v22 offset:5120
v_mfma_f32_32x32x16_bf16 a[160:175], v[64:67], v[48:51], a[160:175]
buffer_store_dwordx4 v[116:119], v28, s[48:51], s66 offen offset:1024 sc1
ds_read_b64_tr_b16 v[92:93], v23 offset:4096
v_mfma_f32_32x32x16_bf16 a[224:239], v[64:67], v[52:55], a[224:239]
ds_read_b64_tr_b16 v[94:95], v23 offset:5120
s_add_u32 s68, s68, 8192
s_and_b32 s68, s68, 32767
v_add_u32 v20, s68, v12
v_add_u32 v21, s68, v13
v_add_u32 v22, s68, v14
v_mfma_f32_32x32x16_bf16 a[176:191], v[68:71], v[48:51], a[176:191]
v_add_u32 v23, s68, v15
s_add_u32 s69, s69, 8192
s_cmp_eq_u32 s69, 24576
s_cselect_b32 s69, 0, s69
v_add_u32 v16, s69, v8
v_add_u32 v17, s69, v9
v_mfma_f32_32x32x16_bf16 a[240:255], v[68:71], v[52:55], a[240:255]
v_add_u32 v18, s69, v10
v_add_u32 v19, s69, v11
s_waitcnt lgkmcnt(0)
v_mfma_f32_32x32x16_bf16 a[128:143], v[80:83], v[72:75], a[128:143]
s_waitcnt vmcnt(4)
s_barrier
v_mfma_f32_32x32x16_bf16 a[192:207], v[80:83], v[76:79], a[192:207]
ds_read_b128 v[48:51], v16
ds_read_b128 v[52:55], v16 offset:4096
v_cvt_pk_bf16_f32 v120, v240, v241
v_mfma_f32_32x32x16_bf16 a[144:159], v[84:87], v[72:75], a[144:159]
ds_read_b64_tr_b16 v[56:57], v20
ds_read_b64_tr_b16 v[58:59], v20 offset:1024
v_cvt_pk_bf16_f32 v121, v242, v243
v_mfma_f32_32x32x16_bf16 a[208:223], v[84:87], v[76:79], a[208:223]
ds_read_b64_tr_b16 v[60:61], v21
ds_read_b64_tr_b16 v[62:63], v21 offset:1024
v_mfma_f32_32x32x16_bf16 a[160:175], v[88:91], v[72:75], a[160:175]
ds_read_b64_tr_b16 v[64:65], v22
ds_read_b64_tr_b16 v[66:67], v22 offset:1024
v_mfma_f32_32x32x16_bf16 a[224:239], v[88:91], v[76:79], a[224:239]
ds_read_b64_tr_b16 v[68:69], v23
ds_read_b64_tr_b16 v[70:71], v23 offset:1024
v_cvt_pk_bf16_f32 v122, v244, v245
v_mfma_f32_32x32x16_bf16 a[176:191], v[92:95], v[72:75], a[176:191]
v_mfma_f32_32x32x16_bf16 a[240:255], v[92:95], v[76:79], a[240:255]
s_waitcnt lgkmcnt(0)
v_mfma_f32_32x32x16_bf16 a[128:143], v[56:59], v[48:51], a[128:143]
ds_read_b128 v[72:75], v17
ds_read_b128 v[76:79], v17 offset:4096
v_cvt_pk_bf16_f32 v123, v246, v247
v_mfma_f32_32x32x16_bf16 a[192:207], v[56:59], v[52:55], a[192:207]
ds_read_b64_tr_b16 v[80:81], v20 offset:4096
ds_read_b64_tr_b16 v[82:83], v20 offset:5120
v_mfma_f32_32x32x16_bf16 a[144:159], v[60:63], v[48:51], a[144:159]
ds_read_b64_tr_b16 v[84:85], v21 offset:4096
ds_read_b64_tr_b16 v[86:87], v21 offset:5120
v_mfma_f32_32x32x16_bf16 a[208:223], v[60:63], v[52:55], a[208:223]
ds_read_b64_tr_b16 v[88:89], v22 offset:4096
ds_read_b64_tr_b16 v[90:91], v22 offset:5120
v_mfma_f32_32x32x16_bf16 a[160:175], v[64:67], v[48:51], a[160:175]
buffer_store_dwordx4 v[120:123], v28, s[48:51], s66 offen offset:2048 sc1
ds_read_b64_tr_b16 v[92:93], v23 offset:4096
v_mfma_f32_32x32x16_bf16 a[224:239], v[64:67], v[52:55], a[224:239]
ds_read_b64_tr_b16 v[94:95], v23 offset:5120
s_add_u32 s68, s68, 8192
s_and_b32 s68, s68, 32767
v_add_u32 v20, s68, v12
v_add_u32 v21, s68, v13
v_add_u32 v22, s68, v14
v_mfma_f32_32x32x16_bf16 a[176:191], v[68:71], v[48:51], a[176:191]
v_add_u32 v23, s68, v15
v_mfma_f32_32x32x16_bf16 a[240:255], v[68:71], v[52:55], a[240:255]
s_waitcnt lgkmcnt(0)
v_mfma_f32_32x32x16_bf16 a[128:143], v[80:83], v[72:75], a[128:143]
s_waitcnt vmcnt(2)
s_barrier
v_mfma_f32_32x32x16_bf16 a[192:207], v[80:83], v[76:79], a[192:207]
ds_read_b128 v[48:51], v18
ds_read_b128 v[52:55], v18 offset:4096
v_cvt_pk_bf16_f32 v124, v248, v249
v_mfma_f32_32x32x16_bf16 a[144:159], v[84:87], v[72:75], a[144:159]
ds_read_b64_tr_b16 v[56:57], v20
ds_read_b64_tr_b16 v[58:59], v20 offset:1024
v_cvt_pk_bf16_f32 v125, v250, v251
v_mfma_f32_32x32x16_bf16 a[208:223], v[84:87], v[76:79], a[208:223]
ds_read_b64_tr_b16 v[60:61], v21
ds_read_b64_tr_b16 v[62:63], v21 offset:1024
v_mfma_f32_32x32x16_bf16 a[160:175], v[88:91], v[72:75], a[160:175]
ds_read_b64_tr_b16 v[64:65], v22
ds_read_b64_tr_b16 v[66:67], v22 offset:1024
v_mfma_f32_32x32x16_bf16 a[224:239], v[88:91], v[76:79], a[224:239]
ds_read_b64_tr_b16 v[68:69], v23
ds_read_b64_tr_b16 v[70:71], v23 offset:1024
v_cvt_pk_bf16_f32 v126, v252, v253
v_mfma_f32_32x32x16_bf16 a[176:191], v[92:95], v[72:75], a[176:191]
v_mfma_f32_32x32x16_bf16 a[240:255], v[92:95], v[76:79], a[240:255]
s_waitcnt lgkmcnt(0)
v_mfma_f32_32x32x16_bf16 a[128:143], v[56:59], v[48:51], a[128:143]
ds_read_b128 v[72:75], v19
ds_read_b128 v[76:79], v19 offset:4096
v_cvt_pk_bf16_f32 v127, v254, v255
v_mfma_f32_32x32x16_bf16 a[192:207], v[56:59], v[52:55], a[192:207]
ds_read_b64_tr_b16 v[80:81], v20 offset:4096
ds_read_b64_tr_b16 v[82:83], v20 offset:5120
v_mfma_f32_32x32x16_bf16 a[144:159], v[60:63], v[48:51], a[144:159]
ds_read_b64_tr_b16 v[84:85], v21 offset:4096
ds_read_b64_tr_b16 v[86:87], v21 offset:5120
v_mfma_f32_32x32x16_bf16 a[208:223], v[60:63], v[52:55], a[208:223]
ds_read_b64_tr_b16 v[88:89], v22 offset:4096
ds_read_b64_tr_b16 v[90:91], v22 offset:5120
v_mfma_f32_32x32x16_bf16 a[160:175], v[64:67], v[48:51], a[160:175]
buffer_store_dwordx4 v[124:127], v28, s[48:51], s66 offen offset:3072 sc1
ds_read_b64_tr_b16 v[92:93], v23 offset:4096
v_mfma_f32_32x32x16_bf16 a[224:239], v[64:67], v[52:55], a[224:239]
ds_read_b64_tr_b16 v[94:95], v23 offset:5120
v_mfma_f32_32x32x16_bf16 a[176:191], v[68:71], v[48:51], a[176:191]
v_mfma_f32_32x32x16_bf16 a[240:255], v[68:71], v[52:55], a[240:255]
s_waitcnt lgkmcnt(0)
s_barrier
s_lshr_b32 s60, s2, 3
s_cmp_ge_u32 s60, 28
s_cbranch_scc1 IDLE_g1
s_and_b32 s63, s60, 3
s_lshr_b32 s62, s60, 2
s_and_b32 s61, s2, 1
s_mul_i32 s61, s61, 7
s_add_u32 s62, s62, s61
s_lshl_b32 s60, s62, 2
s_add_u32 s60, s60, s63
s_bfe_u32 s61, s2, 0x20001
s_mov_b32 s36, s18
s_mov_b32 s37, s19
s_mov_b32 s38, 0x700000
s_mov_b32 s39, 0x20000
s_mov_b32 s40, s32
s_mov_b32 s41, s33
s_mov_b32 s42, 0x5000000
s_mov_b32 s43, 0x20000
v_lshrrev_b32 v24, 4, v0
v_lshlrev_b32 v25, 2, v24
v_and_b32 v26, 15, v0
v_xor_b32 v26, v26, v25
v_lshlrev_b32 v26, 4, v26
v_mul_u32_u24 v25, 3584, v24
v_add_u32 v25, v25, v26
s_mul_i32 s94, s34, 57344
v_add_u32 v2, s94, v25
v_lshl_add_u32 v25, v24, 10, v26
s_lshl_b32 s94, s34, 14
v_add_u32 v3, s94, v25
v_bfe_u32 v24, v0, 2, 2
v_lshrrev_b32 v25, 5, v0
v_lshl_add_u32 v25, v25, 2, v24
v_lshlrev_b32 v25, 8, v25
v_bfe_u32 v26, v0, 4, 1
v_lshlrev_b32 v26, 5, v26
v_and_b32 v27, 3, v0
v_lshl_add_u32 v26, v27, 3, v26
v_add_u32 v25, v25, v26
v_lshlrev_b32 v24, 6, v24
s_lshr_b32 s94, s34, 1
s_lshl_b32 s94, s94, 7
s_add_u32 s96, s94, 0
v_xor_b32 v26, s96, v24
v_add_u32 v26, v25, v26
v_add_u32 v4, 0, v26
v_add_u32 v6, 65536, v26
s_add_u32 s96, s94, 64
v_xor_b32 v26, s96, v24
v_add_u32 v26, v25, v26
v_add_u32 v5, 0, v26
v_add_u32 v7, 65536, v26
s_and_b32 s94, s34, 1
s_lshl_b32 s94, s94, 7
s_add_u32 s96, s94, 0
v_xor_b32 v26, s96, v24
v_add_u32 v26, v25, v26
v_add_u32 v8, 16384, v26
v_add_u32 v10, 81920, v26
s_add_u32 s96, s94, 64
v_xor_b32 v26, s96, v24
v_add_u32 v26, v25, v26
v_add_u32 v9, 16384, v26
v_add_u32 v11, 81920, v26
s_lshl_b32 s95, s34, 12
s_mul_i32 s92, s61, 1835008
s_lshl_b32 s94, s62, 8
s_add_u32 s92, s92, s94
s_lshl_b32 s93, s61, 19
s_lshl_b32 s94, s63, 8
s_add_u32 s93, s93, s94
s_add_u32 s93, s93, 65536
s_add_u32 m0, s95, 0
s_mov_b32 s94, s92
buffer_load_dwordx4 v2, s[36:39], s94 offen lds
s_add_u32 s94, s92, 13312
buffer_load_dwordx4 v2, s[36:39], s94 offen offset:1024 lds
s_add_u32 s94, s92, 26624
buffer_load_dwordx4 v2, s[36:39], s94 offen offset:2048 lds
s_add_u32 s94, s92, 39936
buffer_load_dwordx4 v2, s[36:39], s94 offen offset:3072 lds
s_add_u32 m0, s95, 16384
s_mov_b32 s94, s93
buffer_load_dwordx4 v3, s[40:43], s94 offen lds
s_add_u32 s94, s93, 3072
buffer_load_dwordx4 v3, s[40:43], s94 offen offset:1024 lds
s_add_u32 s94, s93, 6144
buffer_load_dwordx4 v3, s[40:43], s94 offen offset:2048 lds
s_add_u32 s94, s93, 9216
buffer_load_dwordx4 v3, s[40:43], s94 offen offset:3072 lds
s_add_u32 s92, s92, 229376
s_add_u32 s93, s93, 65536
s_add_u32 m0, s95, 32768
s_mov_b32 s94, s92
buffer_load_dwordx4 v2, s[36:39], s94 offen lds
s_add_u32 s94, s92, 13312
buffer_load_dwordx4 v2, s[36:39], s94 offen offset:1024 lds
s_add_u32 s94, s92, 26624
buffer_load_dwordx4 v2, s[36:39], s94 offen offset:2048 lds
s_add_u32 s94, s92, 39936
buffer_load_dwordx4 v2, s[36:39], s94 offen offset:3072 lds
s_add_u32 m0, s95, 49152
s_mov_b32 s94, s93
buffer_load_dwordx4 v3, s[40:43], s94 offen lds
s_add_u32 s94, s93, 3072
buffer_load_dwordx4 v3, s[40:43], s94 offen offset:1024 lds
s_add_u32 s94, s93, 6144
buffer_load_dwordx4 v3, s[40:43], s94 offen offset:2048 lds
s_add_u32 s94, s93, 9216
buffer_load_dwordx4 v3, s[40:43], s94 offen offset:3072 lds
s_add_u32 s92, s92, 229376
s_add_u32 s93, s93, 65536
s_add_u32 m0, s95, 65536
s_mov_b32 s94, s92
buffer_load_dwordx4 v2, s[36:39], s94 offen lds
s_add_u32 s94, s92, 13312
buffer_load_dwordx4 v2, s[36:39], s94 offen offset:1024 lds
s_add_u32 s94, s92, 26624
buffer_load_dwordx4 v2, s[36:39], s94 offen offset:2048 lds
s_add_u32 s94, s92, 39936
buffer_load_dwordx4 v2, s[36:39], s94 offen offset:3072 lds
s_add_u32 m0, s95, 81920
s_mov_b32 s94, s93
buffer_load_dwordx4 v3, s[40:43], s94 offen lds
s_add_u32 s94, s93, 3072
buffer_load_dwordx4 v3, s[40:43], s94 offen offset:1024 lds
s_add_u32 s94, s93, 6144
buffer_load_dwordx4 v3, s[40:43], s94 offen offset:2048 lds
s_add_u32 s94, s93, 9216
buffer_load_dwordx4 v3, s[40:43], s94 offen offset:3072 lds
s_add_u32 s92, s92, 229376
s_add_u32 s93, s93, 65536
v_mfma_f32_32x32x16_bf16 a[128:143], v[80:83], v[72:75], a[128:143]
v_mfma_f32_32x32x16_bf16 a[192:207], v[80:83], v[76:79], a[192:207]
v_mfma_f32_32x32x16_bf16 a[144:159], v[84:87], v[72:75], a[144:159]
v_mfma_f32_32x32x16_bf16 a[208:223], v[84:87], v[76:79], a[208:223]
v_mfma_f32_32x32x16_bf16 a[160:175], v[88:91], v[72:75], a[160:175]
v_mfma_f32_32x32x16_bf16 a[224:239], v[88:91], v[76:79], a[224:239]
v_mfma_f32_32x32x16_bf16 a[176:191], v[92:95], v[72:75], a[176:191]
v_mfma_f32_32x32x16_bf16 a[240:255], v[92:95], v[76:79], a[240:255]
v_mov_b32 v26, 0x3e0293ee
s_waitcnt vmcnt(16)
s_barrier
ds_read_b64_tr_b16 v[64:65], v4
ds_read_b64_tr_b16 v[66:67], v4 offset:2048
ds_read_b64_tr_b16 v[68:69], v5
ds_read_b64_tr_b16 v[70:71], v5 offset:2048
ds_read_b64_tr_b16 v[72:73], v8
ds_read_b64_tr_b16 v[74:75], v8 offset:2048
ds_read_b64_tr_b16 v[76:77], v9
ds_read_b64_tr_b16 v[78:79], v9 offset:2048
s_waitcnt lgkmcnt(0)
v_mfma_f32_32x32x16_bf16 v[128:143], v[64:67], v[72:75], 0
ds_read_b64_tr_b16 v[80:81], v4 offset:4096
ds_read_b64_tr_b16 v[82:83], v4 offset:6144
s_add_u32 m0, s95, 98304
s_mov_b32 s94, s92
v_accvgpr_read_b32 v30, a0
v_accvgpr_read_b32 v31, a1
v_accvgpr_read_b32 v32, a2
v_accvgpr_read_b32 v33, a3
v_mfma_f32_32x32x16_bf16 v[144:159], v[64:67], v[76:79], 0
ds_read_b64_tr_b16 v[84:85], v5 offset:4096
buffer_load_dwordx4 v2, s[36:39], s94 offen lds
ds_read_b64_tr_b16 v[86:87], v5 offset:6144
v_accvgpr_read_b32 v34, a4
v_accvgpr_read_b32 v35, a5
v_accvgpr_read_b32 v36, a6
v_accvgpr_read_b32 v37, a7
v_mfma_f32_32x32x16_bf16 v[160:175], v[68:71], v[72:75], 0
ds_read_b64_tr_b16 v[88:89], v8 offset:4096
ds_read_b64_tr_b16 v[90:91], v8 offset:6144
ds_read_b64_tr_b16 v[92:93], v9 offset:4096
ds_read_b64_tr_b16 v[94:95], v9 offset:6144
v_cvt_pk_bf16_f32 v112, v30, v31
v_cvt_pk_bf16_f32 v113, v32, v33
v_cvt_pk_bf16_f32 v114, v34, v35
s_add_u32 s94, s92, 13312
v_mfma_f32_32x32x16_bf16 v[176:191], v[68:71], v[76:79], 0
buffer_load_dwordx4 v2, s[36:39], s94 offen offset:1024 lds
v_cvt_pk_bf16_f32 v115, v36, v37
s_add_u32 s66, s66, 4096
s_add_u32 s94, s92, 26624
s_waitcnt lgkmcnt(0)
v_mfma_f32_32x32x16_bf16 v[128:143], v[80:83], v[88:91], v[128:143]
buffer_store_dwordx4 v[112:115], v28, s[48:51], s66 offen sc1
v_accvgpr_read_b32 v30, a16
v_accvgpr_read_b32 v31, a17
v_accvgpr_read_b32 v32, a18
v_accvgpr_read_b32 v33, a19
v_accvgpr_read_b32 v34, a20
v_accvgpr_read_b32 v35, a21
v_mfma_f32_32x32x16_bf16 v[144:159], v[80:83], v[92:95], v[144:159]
ds_read_b64_tr_b16 v[64:65], v4 offset:8192
ds_read_b64_tr_b16 v[66:67], v4 offset:10240
v_accvgpr_read_b32 v36, a22
v_accvgpr_read_b32 v37, a23
v_cvt_pk_bf16_f32 v116, v30, v31
v_cvt_pk_bf16_f32 v117, v32, v33
v_cvt_pk_bf16_f32 v118, v34, v35
v_cvt_pk_bf16_f32 v119, v36, v37
v_mfma_f32_32x32x16_bf16 v[160:175], v[84:87], v[88:91], v[160:175]
ds_read_b64_tr_b16 v[68:69], v5 offset:8192
ds_read_b64_tr_b16 v[70:71], v5 offset:10240
ds_read_b64_tr_b16 v[72:73], v8 offset:8192
ds_read_b64_tr_b16 v[74:75], v8 offset:10240
ds_read_b64_tr_b16 v[76:77], v9 offset:8192
ds_read_b64_tr_b16 v[78:79], v9 offset:10240
v_mfma_f32_32x32x16_bf16 v[176:191], v[84:87], v[92:95], v[176:191]
buffer_store_dwordx4 v[116:119], v28, s[48:51], s66 offen offset:1024 sc1
buffer_load_dwordx4 v2, s[36:39], s94 offen offset:2048 lds
v_accvgpr_read_b32 v30, a32
v_accvgpr_read_b32 v31, a33
v_accvgpr_read_b32 v32, a34
s_waitcnt lgkmcnt(0)
v_mfma_f32_32x32x16_bf16 v[128:143], v[64:67], v[72:75], v[128:143]
v_accvgpr_read_b32 v33, a35
v_accvgpr_read_b32 v34, a36
s_add_u32 s94, s92, 39936
v_accvgpr_read_b32 v35, a37
v_accvgpr_read_b32 v36, a38
v_accvgpr_read_b32 v37, a39
v_cvt_pk_bf16_f32 v120, v30, v31
v_cvt_pk_bf16_f32 v121, v32, v33
v_mfma_f32_32x32x16_bf16 v[144:159], v[64:67], v[76:79], v[144:159]
buffer_load_dwordx4 v2, s[36:39], s94 offen offset:3072 lds
ds_read_b64_tr_b16 v[80:81], v4 offset:12288
ds_read_b64_tr_b16 v[82:83], v4 offset:14336
v_cvt_pk_bf16_f32 v122, v34, v35
v_cvt_pk_bf16_f32 v123, v36, v37
s_add_u32 m0, s95, 114688
s_mov_b32 s94, s93
v_mfma_f32_32x32x16_bf16 v[160:175], v[68:71], v[72:75], v[160:175]
ds_read_b64_tr_b16 v[84:85], v5 offset:12288
ds_read_b64_tr_b16 v[86:87], v5 offset:14336
ds_read_b64_tr_b16 v[88:89], v8 offset:12288
ds_read_b64_tr_b16 v[90:91], v8 offset:14336
ds_read_b64_tr_b16 v[92:93], v9 offset:12288
ds_read_b64_tr_b16 v[94:95], v9 offset:14336
v_mfma_f32_32x32x16_bf16 v[176:191], v[68:71], v[76:79], v[176:191]
buffer_store_dwordx4 v[120:123], v28, s[48:51], s66 offen offset:2048 sc1
buffer_load_dwordx4 v3, s[40:43], s94 offen lds
v_accvgpr_read_b32 v96, a128
v_accvgpr_read_b32 v97, a129
v_accvgpr_read_b32 v98, a130
v_accvgpr_read_b32 v99, a131
v_accvgpr_read_b32 v100, a132
v_accvgpr_read_b32 v101, a133
v_accvgpr_read_b32 v102, a134
v_accvgpr_read_b32 v103, a135
v_mul_f32 v96, v96, v26
v_mul_f32 v97, v97, v26
v_mul_f32 v98, v98, v26
v_mul_f32 v99, v99, v26
v_mul_f32 v100, v100, v26
s_add_u32 s94, s93, 3072
v_mul_f32 v101, v101, v26
v_mul_f32 v102, v102, v26
v_mul_f32 v103, v103, v26
v_cvt_pk_bf16_f32 v192, v96, v97
v_cvt_pk_bf16_f32 v193, v98, v99
v_cvt_pk_bf16_f32 v194, v100, v101
v_cvt_pk_bf16_f32 v195, v102, v103
buffer_load_dwordx4 v3, s[40:43], s94 offen offset:1024 lds
v_accvgpr_read_b32 v104, a136
v_accvgpr_read_b32 v105, a137
v_accvgpr_read_b32 v106, a138
s_add_u32 s94, s93, 6144
v_accvgpr_read_b32 v107, a139
v_accvgpr_read_b32 v108, a140
v_accvgpr_read_b32 v109, a141
v_accvgpr_read_b32 v110, a142
v_accvgpr_read_b32 v111, a143
v_mul_f32 v104, v104, v26
v_mul_f32 v105, v105, v26
buffer_load_dwordx4 v3, s[40:43], s94 offen offset:2048 lds
v_mul_f32 v106, v106, v26
v_mul_f32 v107, v107, v26
v_mul_f32 v108, v108, v26
v_mul_f32 v109, v109, v26
s_add_u32 s94, s93, 9216
v_mul_f32 v110, v110, v26
v_mul_f32 v111, v111, v26
v_cvt_pk_bf16_f32 v196, v104, v105
v_cvt_pk_bf16_f32 v197, v106, v107
v_cvt_pk_bf16_f32 v198, v108, v109
v_cvt_pk_bf16_f32 v199, v110, v111
buffer_load_dwordx4 v3, s[40:43], s94 offen offset:3072 lds
s_add_u32 s92, s92, 229376
s_add_u32 s93, s93, 65536
s_waitcnt lgkmcnt(0)
v_mfma_f32_32x32x16_bf16 v[128:143], v[80:83], v[88:91], v[128:143]
s_waitcnt vmcnt(19)
s_barrier
v_mfma_f32_32x32x16_bf16 v[144:159], v[80:83], v[92:95], v[144:159]
ds_read_b64_tr_b16 v[64:65], v4 offset:32768
ds_read_b64_tr_b16 v[66:67], v4 offset:34816
ds_read_b64_tr_b16 v[68:69], v5 offset:32768
v_accvgpr_read_b32 v30, a48
s_add_u32 m0, s95, 0
s_mov_b32 s94, s92
v_accvgpr_read_b32 v31, a49
v_accvgpr_read_b32 v32, a50
v_mfma_f32_32x32x16_bf16 v[160:175], v[84:87], v[88:91], v[160:175]
ds_read_b64_tr_b16 v[70:71], v5 offset:34816
ds_read_b64_tr_b16 v[72:73], v8 offset:32768
ds_read_b64_tr_b16 v[74:75], v8 offset:34816
ds_read_b64_tr_b16 v[76:77], v9 offset:32768
ds_read_b64_tr_b16 v[78:79], v9 offset:34816
v_accvgpr_read_b32 v33, a51
v_accvgpr_read_b32 v34, a52
v_accvgpr_read_b32 v35, a53
v_mfma_f32_32x32x16_bf16 v[176:191], v[84:87], v[92:95], v[176:191]
buffer_load_dwordx4 v2, s[36:39], s94 offen lds
v_accvgpr_read_b32 v36, a54
v_accvgpr_read_b32 v37, a55
v_cvt_pk_bf16_f32 v124, v30, v31
v_cvt_pk_bf16_f32 v125, v32, v33
v_cvt_pk_bf16_f32 v126, v34, v35
s_waitcnt lgkmcnt(0)
v_mfma_f32_32x32x16_bf16 v[128:143], v[64:67], v[72:75], v[128:143]
ds_read_b64_tr_b16 v[80:81], v4 offset:36864
ds_read_b64_tr_b16 v[82:83], v4 offset:38912
ds_read_b64_tr_b16 v[84:85], v5 offset:36864
s_add_u32 s94, s92, 13312
v_cvt_pk_bf16_f32 v127, v36, v37
v_mfma_f32_32x32x16_bf16 v[144:159], v[64:67], v[76:79], v[144:159]
buffer_store_dwordx4 v[124:127], v28, s[48:51], s66 offen offset:3072 sc1
v_accvgpr_read_b32 v30, a8
v_accvgpr_read_b32 v31, a9
v_accvgpr_read_b32 v32, a10
v_accvgpr_read_b32 v33, a11
v_accvgpr_read_b32 v34, a12
v_accvgpr_read_b32 v35, a13
v_mfma_f32_32x32x16_bf16 v[160:175], v[68:71], v[72:75], v[160:175]
ds_read_b64_tr_b16 v[86:87], v5 offset:38912
ds_read_b64_tr_b16 v[88:89], v8 offset:36864
ds_read_b64_tr_b16 v[90:91], v8 offset:38912
ds_read_b64_tr_b16 v[92:93], v9 offset:36864
ds_read_b64_tr_b16 v[94:95], v9 offset:38912
v_accvgpr_read_b32 v36, a14
v_accvgpr_read_b32 v37, a15
v_cvt_pk_bf16_f32 v112, v30, v31
v_mfma_f32_32x32x16_bf16 v[176:191], v[68:71], v[76:79], v[176:191]
buffer_load_dwordx4 v2, s[36:39], s94 offen offset:1024 lds
s_add_u32 s94, s92, 26624
v_cvt_pk_bf16_f32 v113, v32, v33
v_cvt_pk_bf16_f32 v114, v34, v35
v_cvt_pk_bf16_f32 v115, v36, v37
s_add_u32 s66, s66, 4096
s_waitcnt lgkmcnt(0)
v_mfma_f32_32x32x16_bf16 v[128:143], v[80:83], v[88:91], v[128:143]
buffer_store_dwordx4 v[112:115], v28, s[48:51], s66 offen sc1
buffer_load_dwordx4 v2, s[36:39], s94 offen offset:2048 lds
v_accvgpr_read_b32 v30, a24
v_accvgpr_read_b32 v31, a25
v_accvgpr_read_b32 v32, a26
v_accvgpr_read_b32 v33, a27
v_mfma_f32_32x32x16_bf16 v[144:159], v[80:83], v[92:95], v[144:159]
v_accvgpr_read_b32 v34, a28
s_add_u32 s94, s92, 39936
v_accvgpr_read_b32 v35, a29
v_accvgpr_read_b32 v36, a30
v_accvgpr_read_b32 v37, a31
v_cvt_pk_bf16_f32 v116, v30, v31
v_cvt_pk_bf16_f32 v117, v32, v33
v_cvt_pk_bf16_f32 v118, v34, v35
v_mfma_f32_32x32x16_bf16 v[160:175], v[84:87], v[88:91], v[160:175]
ds_read_b64_tr_b16 v[64:65], v4 offset:40960
ds_read_b64_tr_b16 v[66:67], v4 offset:43008
ds_read_b64_tr_b16 v[68:69], v5 offset:40960
ds_read_b64_tr_b16 v[70:71], v5 offset:43008
ds_read_b64_tr_b16 v[72:73], v8 offset:40960
ds_read_b64_tr_b16 v[74:75], v8 offset:43008
ds_read_b64_tr_b16 v[76:77], v9 offset:40960
ds_read_b64_tr_b16 v[78:79], v9 offset:43008
v_mfma_f32_32x32x16_bf16 v[176:191], v[84:87], v[92:95], v[176:191]
buffer_load_dwordx4 v2, s[36:39], s94 offen offset:3072 lds
v_cvt_pk_bf16_f32 v119, v36, v37
s_add_u32 m0, s95, 16384
s_mov_b32 s94, s93
s_waitcnt lgkmcnt(0)
v_mfma_f32_32x32x16_bf16 v[128:143], v[64:67], v[72:75], v[128:143]
buffer_store_dwordx4 v[116:119], v28, s[48:51], s66 offen offset:1024 sc1
v_accvgpr_read_b32 v96, a144
v_accvgpr_read_b32 v97, a145
v_accvgpr_read_b32 v98, a146
v_accvgpr_read_b32 v99, a147
v_accvgpr_read_b32 v100, a148
v_accvgpr_read_b32 v101, a149
v_mfma_f32_32x32x16_bf16 v[144:159], v[64:67], v[76:79], v[144:159]
buffer_load_dwordx4 v3, s[40:43], s94 offen lds
v_accvgpr_read_b32 v102, a150
v_accvgpr_read_b32 v103, a151
v_mul_f32 v96, v96, v26
v_mul_f32 v97, v97, v26
v_mul_f32 v98, v98, v26
v_mul_f32 v99, v99, v26
v_mfma_f32_32x32x16_bf16 v[160:175], v[68:71], v[72:75], v[160:175]
ds_read_b64_tr_b16 v[80:81], v4 offset:45056
ds_read_b64_tr_b16 v[82:83], v4 offset:47104
ds_read_b64_tr_b16 v[84:85], v5 offset:45056
ds_read_b64_tr_b16 v[86:87], v5 offset:47104
ds_read_b64_tr_b16 v[88:89], v8 offset:45056
ds_read_b64_tr_b16 v[90:91], v8 offset:47104
ds_read_b64_tr_b16 v[92:93], v9 offset:45056
ds_read_b64_tr_b16 v[94:95], v9 offset:47104
v_mfma_f32_32x32x16_bf16 v[176:191], v[68:71], v[76:79], v[176:191]
v_mul_f32 v100, v100, v26
s_add_u32 s94, s93, 3072
v_mul_f32 v101, v101, v26
v_mul_f32 v102, v102, v26
v_mul_f32 v103, v103, v26
v_cvt_pk_bf16_f32 v200, v96, v97
v_cvt_pk_bf16_f32 v201, v98, v99
v_cvt_pk_bf16_f32 v202, v100, v101
v_cvt_pk_bf16_f32 v203, v102, v103
buffer_load_dwordx4 v3, s[40:43], s94 offen offset:1024 lds
v_accvgpr_read_b32 v104, a152
v_accvgpr_read_b32 v105, a153
v_accvgpr_read_b32 v106, a154
s_add_u32 s94, s93, 6144
v_accvgpr_read_b32 v107, a155
v_accvgpr_read_b32 v108, a156
v_accvgpr_read_b32 v109, a157
v_accvgpr_read_b32 v110, a158
v_accvgpr_read_b32 v111, a159
v_mul_f32 v104, v104, v26
v_mul_f32 v105, v105, v26
buffer_load_dwordx4 v3, s[40:43], s94 offen offset:2048 lds
v_mul_f32 v106, v106, v26
v_mul_f32 v107, v107, v26
v_mul_f32 v108, v108, v26
s_add_u32 s94, s93, 9216
v_mul_f32 v109, v109, v26
v_mul_f32 v110, v110, v26
v_mul_f32 v111, v111, v26
v_cvt_pk_bf16_f32 v204, v104, v105
v_cvt_pk_bf16_f32 v205, v106, v107
v_cvt_pk_bf16_f32 v206, v108, v109
v_cvt_pk_bf16_f32 v207, v110, v111
buffer_load_dwordx4 v3, s[40:43], s94 offen offset:3072 lds
s_add_u32 s92, s92, 229376
s_add_u32 s93, s93, 65536
s_waitcnt lgkmcnt(0)
v_mfma_f32_32x32x16_bf16 v[128:143], v[80:83], v[88:91], v[128:143]
s_waitcnt vmcnt(22)
s_barrier
v_mfma_f32_32x32x16_bf16 v[144:159], v[80:83], v[92:95], v[144:159]
ds_read_b64_tr_b16 v[64:65], v6
ds_read_b64_tr_b16 v[66:67], v6 offset:2048
ds_read_b64_tr_b16 v[68:69], v7
v_accvgpr_read_b32 v30, a40
s_add_u32 m0, s95, 32768
s_mov_b32 s94, s92
v_accvgpr_read_b32 v31, a41
v_accvgpr_read_b32 v32, a42
v_mfma_f32_32x32x16_bf16 v[160:175], v[84:87], v[88:91], v[160:175]
ds_read_b64_tr_b16 v[70:71], v7 offset:2048
ds_read_b64_tr_b16 v[72:73], v10
ds_read_b64_tr_b16 v[74:75], v10 offset:2048
ds_read_b64_tr_b16 v[76:77], v11
ds_read_b64_tr_b16 v[78:79], v11 offset:2048
v_accvgpr_read_b32 v33, a43
v_accvgpr_read_b32 v34, a44
v_accvgpr_read_b32 v35, a45
v_mfma_f32_32x32x16_bf16 v[176:191], v[84:87], v[92:95], v[176:191]
buffer_load_dwordx4 v2, s[36:39], s94 offen lds
v_accvgpr_read_b32 v36, a46
v_accvgpr_read_b32 v37, a47
v_cvt_pk_bf16_f32 v120, v30, v31
v_cvt_pk_bf16_f32 v121, v32, v33
v_cvt_pk_bf16_f32 v122, v34, v35
s_waitcnt lgkmcnt(0)
v_mfma_f32_32x32x16_bf16 v[128:143], v[64:67], v[72:75], v[128:143]
ds_read_b64_tr_b16 v[80:81], v6 offset:4096
ds_read_b64_tr_b16 v[82:83], v6 offset:6144
ds_read_b64_tr_b16 v[84:85], v7 offset:4096
s_add_u32 s94, s92, 13312
v_cvt_pk_bf16_f32 v123, v36, v37
v_mfma_f32_32x32x16_bf16 v[144:159], v[64:67], v[76:79], v[144:159]
buffer_store_dwordx4 v[120:123], v28, s[48:51], s66 offen offset:2048 sc1
v_accvgpr_read_b32 v30, a56
v_accvgpr_read_b32 v31, a57
v_accvgpr_read_b32 v32, a58
v_accvgpr_read_b32 v33, a59
v_accvgpr_read_b32 v34, a60
v_accvgpr_read_b32 v35, a61
v_mfma_f32_32x32x16_bf16 v[160:175], v[68:71], v[72:75], v[160:175]
ds_read_b64_tr_b16 v[86:87], v7 offset:6144
ds_read_b64_tr_b16 v[88:89], v10 offset:4096
ds_read_b64_tr_b16 v[90:91], v10 offset:6144
ds_read_b64_tr_b16 v[92:93], v11 offset:4096
ds_read_b64_tr_b16 v[94:95], v11 offset:6144
v_accvgpr_read_b32 v36, a62
v_accvgpr_read_b32 v37, a63
v_cvt_pk_bf16_f32 v124, v30, v31
v_mfma_f32_32x32x16_bf16 v[176:191], v[68:71], v[76:79], v[176:191]
buffer_load_dwordx4 v2, s[36:39], s94 offen offset:1024 lds
s_add_u32 s94, s92, 26624
v_cvt_pk_bf16_f32 v125, v32, v33
v_cvt_pk_bf16_f32 v126, v34, v35
v_cvt_pk_bf16_f32 v127, v36, v37
s_waitcnt lgkmcnt(0)
v_mfma_f32_32x32x16_bf16 v[128:143], v[80:83], v[88:91], v[128:143]
buffer_store_dwordx4 v[124:127], v28, s[48:51], s66 offen offset:3072 sc1
buffer_load_dwordx4 v2, s[36:39], s94 offen offset:2048 lds
v_accvgpr_read_b32 v30, a64
v_accvgpr_read_b32 v31, a65
v_accvgpr_read_b32 v32, a66
v_accvgpr_read_b32 v33, a67
v_mfma_f32_32x32x16_bf16 v[144:159], v[80:83], v[92:95], v[144:159]
v_accvgpr_read_b32 v34, a68
v_accvgpr_read_b32 v35, a69
s_add_u32 s94, s92, 39936
v_accvgpr_read_b32 v36, a70
v_accvgpr_read_b32 v37, a71
v_cvt_pk_bf16_f32 v112, v30, v31
v_cvt_pk_bf16_f32 v113, v32, v33
v_cvt_pk_bf16_f32 v114, v34, v35
v_mfma_f32_32x32x16_bf16 v[160:175], v[84:87], v[88:91], v[160:175]
ds_read_b64_tr_b16 v[64:65], v6 offset:8192
ds_read_b64_tr_b16 v[66:67], v6 offset:10240
ds_read_b64_tr_b16 v[68:69], v7 offset:8192
ds_read_b64_tr_b16 v[70:71], v7 offset:10240
ds_read_b64_tr_b16 v[72:73], v10 offset:8192
ds_read_b64_tr_b16 v[74:75], v10 offset:10240
ds_read_b64_tr_b16 v[76:77], v11 offset:8192
ds_read_b64_tr_b16 v[78:79], v11 offset:10240
v_mfma_f32_32x32x16_bf16 v[176:191], v[84:87], v[92:95], v[176:191]
buffer_load_dwordx4 v2, s[36:39], s94 offen offset:3072 lds
v_cvt_pk_bf16_f32 v115, v36, v37
s_add_u32 s66, s66, 4096
s_add_u32 m0, s95, 49152
s_mov_b32 s94, s93
s_waitcnt lgkmcnt(0)
v_mfma_f32_32x32x16_bf16 v[128:143], v[64:67], v[72:75], v[128:143]
buffer_store_dwordx4 v[112:115], v28, s[48:51], s66 offen sc1
v_accvgpr_read_b32 v96, a160
v_accvgpr_read_b32 v97, a161
v_accvgpr_read_b32 v98, a162
v_accvgpr_read_b32 v99, a163
v_accvgpr_read_b32 v100, a164
v_accvgpr_read_b32 v101, a165
v_mfma_f32_32x32x16_bf16 v[144:159], v[64:67], v[76:79], v[144:159]
buffer_load_dwordx4 v3, s[40:43], s94 offen lds
v_accvgpr_read_b32 v102, a166
v_accvgpr_read_b32 v103, a167
v_mul_f32 v96, v96, v26
v_mul_f32 v97, v97, v26
v_mul_f32 v98, v98, v26
v_mul_f32 v99, v99, v26
v_mfma_f32_32x32x16_bf16 v[160:175], v[68:71], v[72:75], v[160:175]
ds_read_b64_tr_b16 v[80:81], v6 offset:12288
ds_read_b64_tr_b16 v[82:83], v6 offset:14336
ds_read_b64_tr_b16 v[84:85], v7 offset:12288
ds_read_b64_tr_b16 v[86:87], v7 offset:14336
ds_read_b64_tr_b16 v[88:89], v10 offset:12288
ds_read_b64_tr_b16 v[90:91], v10 offset:14336
ds_read_b64_tr_b16 v[92:93], v11 offset:12288
ds_read_b64_tr_b16 v[94:95], v11 offset:14336
v_mfma_f32_32x32x16_bf16 v[176:191], v[68:71], v[76:79], v[176:191]
v_mul_f32 v100, v100, v26
s_add_u32 s94, s93, 3072
v_mul_f32 v101, v101, v26
v_mul_f32 v102, v102, v26
v_mul_f32 v103, v103, v26
v_cvt_pk_bf16_f32 v208, v96, v97
v_cvt_pk_bf16_f32 v209, v98, v99
v_cvt_pk_bf16_f32 v210, v100, v101
v_cvt_pk_bf16_f32 v211, v102, v103
buffer_load_dwordx4 v3, s[40:43], s94 offen offset:1024 lds
v_accvgpr_read_b32 v104, a168
v_accvgpr_read_b32 v105, a169
v_accvgpr_read_b32 v106, a170
s_add_u32 s94, s93, 6144
v_accvgpr_read_b32 v107, a171
v_accvgpr_read_b32 v108, a172
v_accvgpr_read_b32 v109, a173
v_accvgpr_read_b32 v110, a174
v_accvgpr_read_b32 v111, a175
v_mul_f32 v104, v104, v26
v_mul_f32 v105, v105, v26
buffer_load_dwordx4 v3, s[40:43], s94 offen offset:2048 lds
v_mul_f32 v106, v106, v26
v_mul_f32 v107, v107, v26
v_mul_f32 v108, v108, v26
s_add_u32 s94, s93, 9216
v_mul_f32 v109, v109, v26
v_mul_f32 v110, v110, v26
v_mul_f32 v111, v111, v26
v_cvt_pk_bf16_f32 v212, v104, v105
v_cvt_pk_bf16_f32 v213, v106, v107
v_cvt_pk_bf16_f32 v214, v108, v109
v_cvt_pk_bf16_f32 v215, v110, v111
buffer_load_dwordx4 v3, s[40:43], s94 offen offset:3072 lds
s_add_u32 s92, s92, 229376
s_add_u32 s93, s93, 65536
s_waitcnt lgkmcnt(0)
v_mfma_f32_32x32x16_bf16 v[128:143], v[80:83], v[88:91], v[128:143]
s_waitcnt vmcnt(22)
s_barrier
v_mfma_f32_32x32x16_bf16 v[144:159], v[80:83], v[92:95], v[144:159]
ds_read_b64_tr_b16 v[64:65], v6 offset:32768
ds_read_b64_tr_b16 v[66:67], v6 offset:34816
ds_read_b64_tr_b16 v[68:69], v7 offset:32768
v_accvgpr_read_b32 v30, a80
s_add_u32 m0, s95, 65536
s_mov_b32 s94, s92
v_accvgpr_read_b32 v31, a81
v_accvgpr_read_b32 v32, a82
v_mfma_f32_32x32x16_bf16 v[160:175], v[84:87], v[88:91], v[160:175]
ds_read_b64_tr_b16 v[70:71], v7 offset:34816
ds_read_b64_tr_b16 v[72:73], v10 offset:32768
ds_read_b64_tr_b16 v[74:75], v10 offset:34816
ds_read_b64_tr_b16 v[76:77], v11 offset:32768
ds_read_b64_tr_b16 v[78:79], v11 offset:34816
v_accvgpr_read_b32 v33, a83
v_accvgpr_read_b32 v34, a84
v_accvgpr_read_b32 v35, a85
v_mfma_f32_32x32x16_bf16 v[176:191], v[84:87], v[92:95], v[176:191]
buffer_load_dwordx4 v2, s[36:39], s94 offen lds
v_accvgpr_read_b32 v36, a86
v_accvgpr_read_b32 v37, a87
v_cvt_pk_bf16_f32 v116, v30, v31
v_cvt_pk_bf16_f32 v117, v32, v33
v_cvt_pk_bf16_f32 v118, v34, v35
s_waitcnt lgkmcnt(0)
v_mfma_f32_32x32x16_bf16 v[128:143], v[64:67], v[72:75], v[128:143]
ds_read_b64_tr_b16 v[80:81], v6 offset:36864
ds_read_b64_tr_b16 v[82:83], v6 offset:38912
ds_read_b64_tr_b16 v[84:85], v7 offset:36864
s_add_u32 s94, s92, 13312
v_cvt_pk_bf16_f32 v119, v36, v37
v_mfma_f32_32x32x16_bf16 v[144:159], v[64:67], v[76:79], v[144:159]
buffer_store_dwordx4 v[116:119], v28, s[48:51], s66 offen offset:1024 sc1
v_accvgpr_read_b32 v30, a96
v_accvgpr_read_b32 v31, a97
v_accvgpr_read_b32 v32, a98
v_accvgpr_read_b32 v33, a99
v_accvgpr_read_b32 v34, a100
v_accvgpr_read_b32 v35, a101
v_mfma_f32_32x32x16_bf16 v[160:175], v[68:71], v[72:75], v[160:175]
ds_read_b64_tr_b16 v[86:87], v7 offset:38912
ds_read_b64_tr_b16 v[88:89], v10 offset:36864
ds_read_b64_tr_b16 v[90:91], v10 offset:38912
ds_read_b64_tr_b16 v[92:93], v11 offset:36864
ds_read_b64_tr_b16 v[94:95], v11 offset:38912
v_accvgpr_read_b32 v36, a102
v_accvgpr_read_b32 v37, a103
v_cvt_pk_bf16_f32 v120, v30, v31
v_mfma_f32_32x32x16_bf16 v[176:191], v[68:71], v[76:79], v[176:191]
buffer_load_dwordx4 v2, s[36:39], s94 offen offset:1024 lds
s_add_u32 s94, s92, 26624
v_cvt_pk_bf16_f32 v121, v32, v33
v_cvt_pk_bf16_f32 v122, v34, v35
v_cvt_pk_bf16_f32 v123, v36, v37
s_waitcnt lgkmcnt(0)
v_mfma_f32_32x32x16_bf16 v[128:143], v[80:83], v[88:91], v[128:143]
buffer_store_dwordx4 v[120:123], v28, s[48:51], s66 offen offset:2048 sc1
buffer_load_dwordx4 v2, s[36:39], s94 offen offset:2048 lds
v_accvgpr_read_b32 v30, a112
v_accvgpr_read_b32 v31, a113
v_accvgpr_read_b32 v32, a114
v_accvgpr_read_b32 v33, a115
v_mfma_f32_32x32x16_bf16 v[144:159], v[80:83], v[92:95], v[144:159]
v_accvgpr_read_b32 v34, a116
v_accvgpr_read_b32 v35, a117
s_add_u32 s94, s92, 39936
v_accvgpr_read_b32 v36, a118
v_accvgpr_read_b32 v37, a119
v_cvt_pk_bf16_f32 v124, v30, v31
v_cvt_pk_bf16_f32 v125, v32, v33
v_cvt_pk_bf16_f32 v126, v34, v35
v_mfma_f32_32x32x16_bf16 v[160:175], v[84:87], v[88:91], v[160:175]
ds_read_b64_tr_b16 v[64:65], v6 offset:40960
ds_read_b64_tr_b16 v[66:67], v6 offset:43008
ds_read_b64_tr_b16 v[68:69], v7 offset:40960
ds_read_b64_tr_b16 v[70:71], v7 offset:43008
ds_read_b64_tr_b16 v[72:73], v10 offset:40960
ds_read_b64_tr_b16 v[74:75], v10 offset:43008
ds_read_b64_tr_b16 v[76:77], v11 offset:40960
ds_read_b64_tr_b16 v[78:79], v11 offset:43008
v_mfma_f32_32x32x16_bf16 v[176:191], v[84:87], v[92:95], v[176:191]
buffer_load_dwordx4 v2, s[36:39], s94 offen offset:3072 lds
v_cvt_pk_bf16_f32 v127, v36, v37
s_add_u32 m0, s95, 81920
s_mov_b32 s94, s93
s_waitcnt lgkmcnt(0)
v_mfma_f32_32x32x16_bf16 v[128:143], v[64:67], v[72:75], v[128:143]
buffer_store_dwordx4 v[124:127], v28, s[48:51], s66 offen offset:3072 sc1
v_accvgpr_read_b32 v96, a176
v_accvgpr_read_b32 v97, a177
v_accvgpr_read_b32 v98, a178
v_accvgpr_read_b32 v99, a179
v_accvgpr_read_b32 v100, a180
v_accvgpr_read_b32 v101, a181
v_mfma_f32_32x32x16_bf16 v[144:159], v[64:67], v[76:79], v[144:159]
buffer_load_dwordx4 v3, s[40:43], s94 offen lds
v_accvgpr_read_b32 v102, a182
v_accvgpr_read_b32 v103, a183
v_mul_f32 v96, v96, v26
v_mul_f32 v97, v97, v26
v_mul_f32 v98, v98, v26
v_mul_f32 v99, v99, v26
v_mfma_f32_32x32x16_bf16 v[160:175], v[68:71], v[72:75], v[160:175]
ds_read_b64_tr_b16 v[80:81], v6 offset:45056
ds_read_b64_tr_b16 v[82:83], v6 offset:47104
ds_read_b64_tr_b16 v[84:85], v7 offset:45056
ds_read_b64_tr_b16 v[86:87], v7 offset:47104
ds_read_b64_tr_b16 v[88:89], v10 offset:45056
ds_read_b64_tr_b16 v[90:91], v10 offset:47104
ds_read_b64_tr_b16 v[92:93], v11 offset:45056
ds_read_b64_tr_b16 v[94:95], v11 offset:47104
v_mfma_f32_32x32x16_bf16 v[176:191], v[68:71], v[76:79], v[176:191]
v_mul_f32 v100, v100, v26
s_add_u32 s94, s93, 3072
v_mul_f32 v101, v101, v26
v_mul_f32 v102, v102, v26
v_mul_f32 v103, v103, v26
v_cvt_pk_bf16_f32 v216, v96, v97
v_cvt_pk_bf16_f32 v217, v98, v99
v_cvt_pk_bf16_f32 v218, v100, v101
v_cvt_pk_bf16_f32 v219, v102, v103
buffer_load_dwordx4 v3, s[40:43], s94 offen offset:1024 lds
v_accvgpr_read_b32 v104, a184
v_accvgpr_read_b32 v105, a185
v_accvgpr_read_b32 v106, a186
s_add_u32 s94, s93, 6144
v_accvgpr_read_b32 v107, a187
v_accvgpr_read_b32 v108, a188
v_accvgpr_read_b32 v109, a189
v_accvgpr_read_b32 v110, a190
v_accvgpr_read_b32 v111, a191
v_mul_f32 v104, v104, v26
v_mul_f32 v105, v105, v26
buffer_load_dwordx4 v3, s[40:43], s94 offen offset:2048 lds
v_mul_f32 v106, v106, v26
v_mul_f32 v107, v107, v26
v_mul_f32 v108, v108, v26
s_add_u32 s94, s93, 9216
v_mul_f32 v109, v109, v26
v_mul_f32 v110, v110, v26
v_mul_f32 v111, v111, v26
v_cvt_pk_bf16_f32 v220, v104, v105
v_cvt_pk_bf16_f32 v221, v106, v107
v_cvt_pk_bf16_f32 v222, v108, v109
v_cvt_pk_bf16_f32 v223, v110, v111
buffer_load_dwordx4 v3, s[40:43], s94 offen offset:3072 lds
s_add_u32 s92, s92, 229376
s_add_u32 s93, s93, 65536
s_waitcnt lgkmcnt(0)
v_mfma_f32_32x32x16_bf16 v[128:143], v[80:83], v[88:91], v[128:143]
s_waitcnt vmcnt(22)
s_barrier
v_mfma_f32_32x32x16_bf16 v[144:159], v[80:83], v[92:95], v[144:159]
ds_read_b64_tr_b16 v[64:65], v4
ds_read_b64_tr_b16 v[66:67], v4 offset:2048
v_accvgpr_read_b32 v30, a72
s_add_u32 m0, s95, 98304
s_mov_b32 s94, s92
v_accvgpr_read_b32 v31, a73
v_accvgpr_read_b32 v32, a74
v_accvgpr_read_b32 v33, a75
v_mfma_f32_32x32x16_bf16 v[160:175], v[84:87], v[88:91], v[160:175]
ds_read_b64_tr_b16 v[68:69], v5
ds_read_b64_tr_b16 v[70:71], v5 offset:2048
ds_read_b64_tr_b16 v[72:73], v8
ds_read_b64_tr_b16 v[74:75], v8 offset:2048
ds_read_b64_tr_b16 v[76:77], v9
ds_read_b64_tr_b16 v[78:79], v9 offset:2048
v_accvgpr_read_b32 v34, a76
v_accvgpr_read_b32 v35, a77
v_mfma_f32_32x32x16_bf16 v[176:191], v[84:87], v[92:95], v[176:191]
buffer_load_dwordx4 v2, s[36:39], s94 offen lds
v_accvgpr_read_b32 v36, a78
v_accvgpr_read_b32 v37, a79
v_cvt_pk_bf16_f32 v112, v30, v31
v_cvt_pk_bf16_f32 v113, v32, v33
v_cvt_pk_bf16_f32 v114, v34, v35
s_waitcnt lgkmcnt(0)
v_mfma_f32_32x32x16_bf16 v[128:143], v[64:67], v[72:75], v[128:143]
ds_read_b64_tr_b16 v[80:81], v4 offset:4096
ds_read_b64_tr_b16 v[82:83], v4 offset:6144
ds_read_b64_tr_b16 v[84:85], v5 offset:4096
v_cvt_pk_bf16_f32 v115, v36, v37
s_add_u32 s66, s66, 4096
s_add_u32 s94, s92, 13312
v_mfma_f32_32x32x16_bf16 v[144:159], v[64:67], v[76:79], v[144:159]
buffer_store_dwordx4 v[112:115], v28, s[48:51], s66 offen sc1
v_accvgpr_read_b32 v30, a88
v_accvgpr_read_b32 v31, a89
v_accvgpr_read_b32 v32, a90
v_accvgpr_read_b32 v33, a91
v_accvgpr_read_b32 v34, a92
v_accvgpr_read_b32 v35, a93
v_mfma_f32_32x32x16_bf16 v[160:175], v[68:71], v[72:75], v[160:175]
ds_read_b64_tr_b16 v[86:87], v5 offset:6144
ds_read_b64_tr_b16 v[88:89], v8 offset:4096
ds_read_b64_tr_b16 v[90:91], v8 offset:6144
ds_read_b64_tr_b16 v[92:93], v9 offset:4096
ds_read_b64_tr_b16 v[94:95], v9 offset:6144
v_accvgpr_read_b32 v36, a94
v_accvgpr_read_b32 v37, a95
v_cvt_pk_bf16_f32 v116, v30, v31
v_mfma_f32_32x32x16_bf16 v[176:191], v[68:71], v[76:79], v[176:191]
buffer_load_dwordx4 v2, s[36:39], s94 offen offset:1024 lds
v_cvt_pk_bf16_f32 v117, v32, v33
v_cvt_pk_bf16_f32 v118, v34, v35
s_add_u32 s94, s92, 26624
v_cvt_pk_bf16_f32 v119, v36, v37
s_waitcnt lgkmcnt(0)
v_mfma_f32_32x32x16_bf16 v[128:143], v[80:83], v[88:91], v[128:143]
buffer_store_dwordx4 v[116:119], v28, s[48:51], s66 offen offset:1024 sc1
v_accvgpr_read_b32 v30, a104
v_accvgpr_read_b32 v31, a105
v_accvgpr_read_b32 v32, a106
v_accvgpr_read_b32 v33, a107
v_accvgpr_read_b32 v34, a108
v_accvgpr_read_b32 v35, a109
v_mfma_f32_32x32x16_bf16 v[144:159], v[80:83], v[92:95], v[144:159]
buffer_load_dwordx4 v2, s[36:39], s94 offen offset:2048 lds
v_accvgpr_read_b32 v36, a110
v_accvgpr_read_b32 v37, a111
v_cvt_pk_bf16_f32 v120, v30, v31
v_cvt_pk_bf16_f32 v121, v32, v33
s_add_u32 s94, s92, 39936
v_cvt_pk_bf16_f32 v122, v34, v35
v_mfma_f32_32x32x16_bf16 v[160:175], v[84:87], v[88:91], v[160:175]
ds_read_b64_tr_b16 v[64:65], v4 offset:8192
ds_read_b64_tr_b16 v[66:67], v4 offset:10240
ds_read_b64_tr_b16 v[68:69], v5 offset:8192
ds_read_b64_tr_b16 v[70:71], v5 offset:10240
ds_read_b64_tr_b16 v[72:73], v8 offset:8192
ds_read_b64_tr_b16 v[74:75], v8 offset:10240
ds_read_b64_tr_b16 v[76:77], v9 offset:8192
ds_read_b64_tr_b16 v[78:79], v9 offset:10240
v_mfma_f32_32x32x16_bf16 v[176:191], v[84:87], v[92:95], v[176:191]
buffer_load_dwordx4 v2, s[36:39], s94 offen offset:3072 lds
v_cvt_pk_bf16_f32 v123, v36, v37
s_add_u32 m0, s95, 114688
s_mov_b32 s94, s93
s_waitcnt lgkmcnt(0)
v_mfma_f32_32x32x16_bf16 v[128:143], v[64:67], v[72:75], v[128:143]
buffer_store_dwordx4 v[120:123], v28, s[48:51], s66 offen offset:2048 sc1
v_accvgpr_read_b32 v30, a120
v_accvgpr_read_b32 v31, a121
v_accvgpr_read_b32 v32, a122
v_accvgpr_read_b32 v33, a123
v_accvgpr_read_b32 v34, a124
v_accvgpr_read_b32 v35, a125
v_mfma_f32_32x32x16_bf16 v[144:159], v[64:67], v[76:79], v[144:159]
buffer_load_dwordx4 v3, s[40:43], s94 offen lds
v_accvgpr_read_b32 v36, a126
v_accvgpr_read_b32 v37, a127
v_cvt_pk_bf16_f32 v124, v30, v31
v_cvt_pk_bf16_f32 v125, v32, v33
v_cvt_pk_bf16_f32 v126, v34, v35
v_cvt_pk_bf16_f32 v127, v36, v37
v_mfma_f32_32x32x16_bf16 v[160:175], v[68:71], v[72:75], v[160:175]
ds_read_b64_tr_b16 v[80:81], v4 offset:12288
ds_read_b64_tr_b16 v[82:83], v4 offset:14336
ds_read_b64_tr_b16 v[84:85], v5 offset:12288
ds_read_b64_tr_b16 v[86:87], v5 offset:14336
ds_read_b64_tr_b16 v[88:89], v8 offset:12288
ds_read_b64_tr_b16 v[90:91], v8 offset:14336
ds_read_b64_tr_b16 v[92:93], v9 offset:12288
ds_read_b64_tr_b16 v[94:95], v9 offset:14336
v_mfma_f32_32x32x16_bf16 v[176:191], v[68:71], v[76:79], v[176:191]
buffer_store_dwordx4 v[124:127], v28, s[48:51], s66 offen offset:3072 sc1
v_accvgpr_read_b32 v96, a192
v_accvgpr_read_b32 v97, a193
v_accvgpr_read_b32 v98, a194
v_accvgpr_read_b32 v99, a195
v_accvgpr_read_b32 v100, a196
v_accvgpr_read_b32 v101, a197
v_accvgpr_read_b32 v102, a198
v_accvgpr_read_b32 v103, a199
s_add_u32 s94, s93, 3072
v_mul_f32 v96, v96, v26
v_mul_f32 v97, v97, v26
v_mul_f32 v98, v98, v26
v_mul_f32 v99, v99, v26
v_mul_f32 v100, v100, v26
v_mul_f32 v101, v101, v26
v_mul_f32 v102, v102, v26
v_mul_f32 v103, v103, v26
v_cvt_pk_bf16_f32 v224, v96, v97
buffer_load_dwordx4 v3, s[40:43], s94 offen offset:1024 lds
v_cvt_pk_bf16_f32 v225, v98, v99
v_cvt_pk_bf16_f32 v226, v100, v101
v_cvt_pk_bf16_f32 v227, v102, v103
s_add_u32 s94, s93, 6144
v_accvgpr_read_b32 v104, a200
v_accvgpr_read_b32 v105, a201
v_accvgpr_read_b32 v106, a202
v_accvgpr_read_b32 v107, a203
v_accvgpr_read_b32 v108, a204
v_accvgpr_read_b32 v109, a205
v_accvgpr_read_b32 v110, a206
v_accvgpr_read_b32 v111, a207
v_mul_f32 v104, v104, v26
buffer_load_dwordx4 v3, s[40:43], s94 offen offset:2048 lds
v_mul_f32 v105, v105, v26
v_mul_f32 v106, v106, v26
v_mul_f32 v107, v107, v26
s_add_u32 s94, s93, 9216
v_mul_f32 v108, v108, v26
v_mul_f32 v109, v109, v26
v_mul_f32 v110, v110, v26
v_mul_f32 v111, v111, v26
v_cvt_pk_bf16_f32 v228, v104, v105
v_cvt_pk_bf16_f32 v229, v106, v107
v_cvt_pk_bf16_f32 v230, v108, v109
v_cvt_pk_bf16_f32 v231, v110, v111
buffer_load_dwordx4 v3, s[40:43], s94 offen offset:3072 lds
s_add_u32 s92, s92, 229376
s_add_u32 s93, s93, 65536
s_waitcnt lgkmcnt(0)
v_mfma_f32_32x32x16_bf16 v[128:143], v[80:83], v[88:91], v[128:143]
s_waitcnt vmcnt(23)
s_barrier
v_mfma_f32_32x32x16_bf16 v[144:159], v[80:83], v[92:95], v[144:159]
ds_read_b64_tr_b16 v[64:65], v4 offset:32768
ds_read_b64_tr_b16 v[66:67], v4 offset:34816
ds_read_b64_tr_b16 v[68:69], v5 offset:32768
v_accvgpr_read_b32 v96, a208
v_accvgpr_read_b32 v97, a209
v_accvgpr_read_b32 v98, a210
v_accvgpr_read_b32 v99, a211
v_accvgpr_read_b32 v100, a212
v_mfma_f32_32x32x16_bf16 v[160:175], v[84:87], v[88:91], v[160:175]
ds_read_b64_tr_b16 v[70:71], v5 offset:34816
ds_read_b64_tr_b16 v[72:73], v8 offset:32768
ds_read_b64_tr_b16 v[74:75], v8 offset:34816
ds_read_b64_tr_b16 v[76:77], v9 offset:32768
ds_read_b64_tr_b16 v[78:79], v9 offset:34816
v_accvgpr_read_b32 v101, a213
v_accvgpr_read_b32 v102, a214
v_accvgpr_read_b32 v103, a215
v_mfma_f32_32x32x16_bf16 v[176:191], v[84:87], v[92:95], v[176:191]
v_mul_f32 v96, v96, v26
v_mul_f32 v97, v97, v26
v_mul_f32 v98, v98, v26
v_mul_f32 v99, v99, v26
v_mul_f32 v100, v100, v26
v_mul_f32 v101, v101, v26
v_mul_f32 v102, v102, v26
s_waitcnt lgkmcnt(0)
v_mfma_f32_32x32x16_bf16 v[128:143], v[64:67], v[72:75], v[128:143]
ds_read_b64_tr_b16 v[80:81], v4 offset:36864
ds_read_b64_tr_b16 v[82:83], v4 offset:38912
v_mul_f32 v103, v103, v26
v_cvt_pk_bf16_f32 v232, v96, v97
v_cvt_pk_bf16_f32 v233, v98, v99
v_cvt_pk_bf16_f32 v234, v100, v101
v_cvt_pk_bf16_f32 v235, v102, v103
v_accvgpr_read_b32 v104, a216
v_mfma_f32_32x32x16_bf16 v[144:159], v[64:67], v[76:79], v[144:159]
ds_read_b64_tr_b16 v[84:85], v5 offset:36864
ds_read_b64_tr_b16 v[86:87], v5 offset:38912
v_accvgpr_read_b32 v105, a217
v_accvgpr_read_b32 v106, a218
v_accvgpr_read_b32 v107, a219
v_accvgpr_read_b32 v108, a220
v_accvgpr_read_b32 v109, a221
v_accvgpr_read_b32 v110, a222
v_mfma_f32_32x32x16_bf16 v[160:175], v[68:71], v[72:75], v[160:175]
ds_read_b64_tr_b16 v[88:89], v8 offset:36864
ds_read_b64_tr_b16 v[90:91], v8 offset:38912
ds_read_b64_tr_b16 v[92:93], v9 offset:36864
ds_read_b64_tr_b16 v[94:95], v9 offset:38912
v_accvgpr_read_b32 v111, a223
v_mul_f32 v104, v104, v26
v_mul_f32 v105, v105, v26
v_mul_f32 v106, v106, v26
v_mfma_f32_32x32x16_bf16 v[176:191], v[68:71], v[76:79], v[176:191]
v_mul_f32 v107, v107, v26
v_mul_f32 v108, v108, v26
v_mul_f32 v109, v109, v26
v_mul_f32 v110, v110, v26
v_mul_f32 v111, v111, v26
v_cvt_pk_bf16_f32 v236, v104, v105
v_cvt_pk_bf16_f32 v237, v106, v107
s_waitcnt lgkmcnt(0)
v_mfma_f32_32x32x16_bf16 v[128:143], v[80:83], v[88:91], v[128:143]
ds_read_b64_tr_b16 v[64:65], v4 offset:40960
v_cvt_pk_bf16_f32 v238, v108, v109
v_cvt_pk_bf16_f32 v239, v110, v111
v_accvgpr_write_b32 a0, 0
v_accvgpr_write_b32 a1, 0
v_accvgpr_write_b32 a2, 0
v_accvgpr_write_b32 a3, 0
v_accvgpr_write_b32 a4, 0
v_mfma_f32_32x32x16_bf16 v[144:159], v[80:83], v[92:95], v[144:159]
ds_read_b64_tr_b16 v[66:67], v4 offset:43008
ds_read_b64_tr_b16 v[68:69], v5 offset:40960
ds_read_b64_tr_b16 v[70:71], v5 offset:43008
v_accvgpr_write_b32 a5, 0
v_accvgpr_write_b32 a6, 0
v_accvgpr_write_b32 a7, 0
v_accvgpr_write_b32 a8, 0
v_accvgpr_write_b32 a9, 0
v_mfma_f32_32x32x16_bf16 v[160:175], v[84:87], v[88:91], v[160:175]
ds_read_b64_tr_b16 v[72:73], v8 offset:40960
ds_read_b64_tr_b16 v[74:75], v8 offset:43008
ds_read_b64_tr_b16 v[76:77], v9 offset:40960
ds_read_b64_tr_b16 v[78:79], v9 offset:43008
v_accvgpr_write_b32 a10, 0
v_accvgpr_write_b32 a11, 0
v_accvgpr_write_b32 a12, 0
v_accvgpr_write_b32 a13, 0
v_mfma_f32_32x32x16_bf16 v[176:191], v[84:87], v[92:95], v[176:191]
v_accvgpr_write_b32 a14, 0
v_accvgpr_write_b32 a15, 0
v_accvgpr_write_b32 a16, 0
v_accvgpr_write_b32 a17, 0
v_accvgpr_write_b32 a18, 0
v_accvgpr_write_b32 a19, 0
v_accvgpr_write_b32 a20, 0
s_waitcnt lgkmcnt(0)
v_mfma_f32_32x32x16_bf16 v[128:143], v[64:67], v[72:75], v[128:143]
ds_read_b64_tr_b16 v[80:81], v4 offset:45056
v_accvgpr_write_b32 a21, 0
v_accvgpr_write_b32 a22, 0
v_accvgpr_write_b32 a23, 0
v_accvgpr_write_b32 a24, 0
v_accvgpr_write_b32 a25, 0
v_accvgpr_write_b32 a26, 0
v_accvgpr_write_b32 a27, 0
v_mfma_f32_32x32x16_bf16 v[144:159], v[64:67], v[76:79], v[144:159]
ds_read_b64_tr_b16 v[82:83], v4 offset:47104
ds_read_b64_tr_b16 v[84:85], v5 offset:45056
v_accvgpr_write_b32 a28, 0
v_accvgpr_write_b32 a29, 0
v_accvgpr_write_b32 a30, 0
v_accvgpr_write_b32 a31, 0
v_accvgpr_write_b32 a32, 0
v_accvgpr_write_b32 a33, 0
v_mfma_f32_32x32x16_bf16 v[160:175], v[68:71], v[72:75], v[160:175]
ds_read_b64_tr_b16 v[86:87], v5 offset:47104
ds_read_b64_tr_b16 v[88:89], v8 offset:45056
ds_read_b64_tr_b16 v[90:91], v8 offset:47104
ds_read_b64_tr_b16 v[92:93], v9 offset:45056
ds_read_b64_tr_b16 v[94:95], v9 offset:47104
v_accvgpr_write_b32 a34, 0
v_accvgpr_write_b32 a35, 0
v_accvgpr_write_b32 a36, 0
v_mfma_f32_32x32x16_bf16 v[176:191], v[68:71], v[76:79], v[176:191]
v_accvgpr_write_b32 a37, 0
v_accvgpr_write_b32 a38, 0
v_accvgpr_write_b32 a39, 0
v_accvgpr_write_b32 a40, 0
v_accvgpr_write_b32 a41, 0
v_accvgpr_write_b32 a42, 0
v_accvgpr_write_b32 a43, 0
v_accvgpr_write_b32 a44, 0
v_accvgpr_write_b32 a45, 0
v_accvgpr_write_b32 a46, 0
v_accvgpr_write_b32 a47, 0
s_waitcnt vmcnt(3)
s_barrier
s_cmp_lg_u32 s34, 0
s_cbranch_scc1 W8
v_mov_b32 v24, 1
v_mov_b32 v25, 0
s_mov_b64 exec, 1
buffer_store_dword v24, v25, s[48:51], s100 offen sc1
s_mov_b64 exec, -1
W8:
s_waitcnt lgkmcnt(0)
v_mfma_f32_32x32x16_bf16 v[128:143], v[80:83], v[88:91], v[128:143]
s_waitcnt vmcnt(12)
s_barrier
v_mfma_f32_32x32x16_bf16 v[144:159], v[80:83], v[92:95], v[144:159]
ds_read_b64_tr_b16 v[64:65], v6
ds_read_b64_tr_b16 v[66:67], v6 offset:2048
ds_read_b64_tr_b16 v[68:69], v7
v_accvgpr_read_b32 v96, a224
v_accvgpr_read_b32 v97, a225
v_accvgpr_read_b32 v98, a226
v_accvgpr_read_b32 v99, a227
v_accvgpr_read_b32 v100, a228
v_mfma_f32_32x32x16_bf16 v[160:175], v[84:87], v[88:91], v[160:175]
ds_read_b64_tr_b16 v[70:71], v7 offset:2048
ds_read_b64_tr_b16 v[72:73], v10
ds_read_b64_tr_b16 v[74:75], v10 offset:2048
ds_read_b64_tr_b16 v[76:77], v11
ds_read_b64_tr_b16 v[78:79], v11 offset:2048
v_accvgpr_read_b32 v101, a229
v_accvgpr_read_b32 v102, a230
v_accvgpr_read_b32 v103, a231
v_mfma_f32_32x32x16_bf16 v[176:191], v[84:87], v[92:95], v[176:191]
v_mul_f32 v96, v96, v26
v_mul_f32 v97, v97, v26
v_mul_f32 v98, v98, v26
v_mul_f32 v99, v99, v26
v_mul_f32 v100, v100, v26
v_mul_f32 v101, v101, v26
v_mul_f32 v102, v102, v26
s_waitcnt lgkmcnt(0)
v_mfma_f32_32x32x16_bf16 v[128:143], v[64:67], v[72:75], v[128:143]
ds_read_b64_tr_b16 v[80:81], v6 offset:4096
ds_read_b64_tr_b16 v[82:83], v6 offset:6144
v_mul_f32 v103, v103, v26
v_cvt_pk_bf16_f32 v240, v96, v97
v_cvt_pk_bf16_f32 v241, v98, v99
v_cvt_pk_bf16_f32 v242, v100, v101
v_cvt_pk_bf16_f32 v243, v102, v103
v_accvgpr_read_b32 v104, a232
v_mfma_f32_32x32x16_bf16 v[144:159], v[64:67], v[76:79], v[144:159]
ds_read_b64_tr_b16 v[84:85], v7 offset:4096
ds_read_b64_tr_b16 v[86:87], v7 offset:6144
v_accvgpr_read_b32 v105, a233
v_accvgpr_read_b32 v106, a234
v_accvgpr_read_b32 v107, a235
v_accvgpr_read_b32 v108, a236
v_accvgpr_read_b32 v109, a237
v_accvgpr_read_b32 v110, a238
v_mfma_f32_32x32x16_bf16 v[160:175], v[68:71], v[72:75], v[160:175]
ds_read_b64_tr_b16 v[88:89], v10 offset:4096
ds_read_b64_tr_b16 v[90:91], v10 offset:6144
ds_read_b64_tr_b16 v[92:93], v11 offset:4096
ds_read_b64_tr_b16 v[94:95], v11 offset:6144
v_accvgpr_read_b32 v111, a239
v_mul_f32 v104, v104, v26
v_mul_f32 v105, v105, v26
v_mul_f32 v106, v106, v26
v_mfma_f32_32x32x16_bf16 v[176:191], v[68:71], v[76:79], v[176:191]
v_mul_f32 v107, v107, v26
v_mul_f32 v108, v108, v26
v_mul_f32 v109, v109, v26
v_mul_f32 v110, v110, v26
v_mul_f32 v111, v111, v26
v_cvt_pk_bf16_f32 v244, v104, v105
v_cvt_pk_bf16_f32 v245, v106, v107
s_waitcnt lgkmcnt(0)
v_mfma_f32_32x32x16_bf16 v[128:143], v[80:83], v[88:91], v[128:143]
ds_read_b64_tr_b16 v[64:65], v6 offset:8192
v_cvt_pk_bf16_f32 v246, v108, v109
v_cvt_pk_bf16_f32 v247, v110, v111
v_accvgpr_write_b32 a48, 0
v_accvgpr_write_b32 a49, 0
v_accvgpr_write_b32 a50, 0
v_accvgpr_write_b32 a51, 0
v_accvgpr_write_b32 a52, 0
v_mfma_f32_32x32x16_bf16 v[144:159], v[80:83], v[92:95], v[144:159]
ds_read_b64_tr_b16 v[66:67], v6 offset:10240
ds_read_b64_tr_b16 v[68:69], v7 offset:8192
ds_read_b64_tr_b16 v[70:71], v7 offset:10240
v_accvgpr_write_b32 a53, 0
v_accvgpr_write_b32 a54, 0
v_accvgpr_write_b32 a55, 0
v_accvgpr_write_b32 a56, 0
v_accvgpr_write_b32 a57, 0
v_mfma_f32_32x32x16_bf16 v[160:175], v[84:87], v[88:91], v[160:175]
ds_read_b64_tr_b16 v[72:73], v10 offset:8192
ds_read_b64_tr_b16 v[74:75], v10 offset:10240
ds_read_b64_tr_b16 v[76:77], v11 offset:8192
ds_read_b64_tr_b16 v[78:79], v11 offset:10240
v_accvgpr_write_b32 a58, 0
v_accvgpr_write_b32 a59, 0
v_accvgpr_write_b32 a60, 0
v_accvgpr_write_b32 a61, 0
v_mfma_f32_32x32x16_bf16 v[176:191], v[84:87], v[92:95], v[176:191]
v_accvgpr_write_b32 a62, 0
v_accvgpr_write_b32 a63, 0
v_accvgpr_write_b32 a64, 0
v_accvgpr_write_b32 a65, 0
v_accvgpr_write_b32 a66, 0
v_accvgpr_write_b32 a67, 0
v_accvgpr_write_b32 a68, 0
s_waitcnt lgkmcnt(0)
v_mfma_f32_32x32x16_bf16 v[128:143], v[64:67], v[72:75], v[128:143]
ds_read_b64_tr_b16 v[80:81], v6 offset:12288
v_accvgpr_write_b32 a69, 0
v_accvgpr_write_b32 a70, 0
v_accvgpr_write_b32 a71, 0
v_accvgpr_write_b32 a72, 0
v_accvgpr_write_b32 a73, 0
v_accvgpr_write_b32 a74, 0
v_accvgpr_write_b32 a75, 0
v_mfma_f32_32x32x16_bf16 v[144:159], v[64:67], v[76:79], v[144:159]
ds_read_b64_tr_b16 v[82:83], v6 offset:14336
ds_read_b64_tr_b16 v[84:85], v7 offset:12288
v_accvgpr_write_b32 a76, 0
v_accvgpr_write_b32 a77, 0
v_accvgpr_write_b32 a78, 0
v_accvgpr_write_b32 a79, 0
v_accvgpr_write_b32 a80, 0
v_accvgpr_write_b32 a81, 0
v_mfma_f32_32x32x16_bf16 v[160:175], v[68:71], v[72:75], v[160:175]
ds_read_b64_tr_b16 v[86:87], v7 offset:14336
ds_read_b64_tr_b16 v[88:89], v10 offset:12288
ds_read_b64_tr_b16 v[90:91], v10 offset:14336
ds_read_b64_tr_b16 v[92:93], v11 offset:12288
ds_read_b64_tr_b16 v[94:95], v11 offset:14336
v_accvgpr_write_b32 a82, 0
v_accvgpr_write_b32 a83, 0
v_accvgpr_write_b32 a84, 0
v_mfma_f32_32x32x16_bf16 v[176:191], v[68:71], v[76:79], v[176:191]
v_accvgpr_write_b32 a85, 0
v_accvgpr_write_b32 a86, 0
v_accvgpr_write_b32 a87, 0
v_accvgpr_write_b32 a88, 0
v_accvgpr_write_b32 a89, 0
v_accvgpr_write_b32 a90, 0
v_accvgpr_write_b32 a91, 0
v_accvgpr_write_b32 a92, 0
v_accvgpr_write_b32 a93, 0
v_accvgpr_write_b32 a94, 0
v_accvgpr_write_b32 a95, 0
s_cmp_lg_u32 s34, 0
s_cbranch_scc1 W9
s_lshl_b32 s91, s65, 5
s_add_u32 s91, s91, 2293760
v_lshlrev_b32 v25, 2, v0
s_mov_b32 exec_lo, 0xff
s_mov_b32 exec_hi, 0
buffer_load_dword v27, v25, s[48:51], s91 offen sc1
s_mov_b64 exec, -1
W9:
s_waitcnt lgkmcnt(0)
v_mfma_f32_32x32x16_bf16 v[128:143], v[80:83], v[88:91], v[128:143]
s_waitcnt vmcnt(0)
s_barrier
v_mfma_f32_32x32x16_bf16 v[144:159], v[80:83], v[92:95], v[144:159]
ds_read_b64_tr_b16 v[64:65], v6 offset:32768
ds_read_b64_tr_b16 v[66:67], v6 offset:34816
ds_read_b64_tr_b16 v[68:69], v7 offset:32768
v_accvgpr_read_b32 v96, a240
v_accvgpr_read_b32 v97, a241
v_accvgpr_read_b32 v98, a242
v_accvgpr_read_b32 v99, a243
v_accvgpr_read_b32 v100, a244
v_mfma_f32_32x32x16_bf16 v[160:175], v[84:87], v[88:91], v[160:175]
ds_read_b64_tr_b16 v[70:71], v7 offset:34816
ds_read_b64_tr_b16 v[72:73], v10 offset:32768
ds_read_b64_tr_b16 v[74:75], v10 offset:34816
ds_read_b64_tr_b16 v[76:77], v11 offset:32768
ds_read_b64_tr_b16 v[78:79], v11 offset:34816
v_accvgpr_read_b32 v101, a245
v_accvgpr_read_b32 v102, a246
v_accvgpr_read_b32 v103, a247
v_mfma_f32_32x32x16_bf16 v[176:191], v[84:87], v[92:95], v[176:191]
v_mul_f32 v96, v96, v26
v_mul_f32 v97, v97, v26
v_mul_f32 v98, v98, v26
v_mul_f32 v99, v99, v26
v_mul_f32 v100, v100, v26
v_mul_f32 v101, v101, v26
v_mul_f32 v102, v102, v26
s_waitcnt lgkmcnt(0)
v_mfma_f32_32x32x16_bf16 v[128:143], v[64:67], v[72:75], v[128:143]
ds_read_b64_tr_b16 v[80:81], v6 offset:36864
ds_read_b64_tr_b16 v[82:83], v6 offset:38912
ds_read_b64_tr_b16 v[84:85], v7 offset:36864
v_mul_f32 v103, v103, v26
v_cvt_pk_bf16_f32 v248, v96, v97
v_cvt_pk_bf16_f32 v249, v98, v99
v_cvt_pk_bf16_f32 v250, v100, v101
v_cvt_pk_bf16_f32 v251, v102, v103
v_mfma_f32_32x32x16_bf16 v[144:159], v[64:67], v[76:79], v[144:159]
ds_read_b64_tr_b16 v[86:87], v7 offset:38912
ds_read_b64_tr_b16 v[88:89], v10 offset:36864
ds_read_b64_tr_b16 v[90:91], v10 offset:38912
v_accvgpr_read_b32 v104, a248
v_accvgpr_read_b32 v105, a249
v_accvgpr_read_b32 v106, a250
v_accvgpr_read_b32 v107, a251
v_accvgpr_read_b32 v108, a252
v_mfma_f32_32x32x16_bf16 v[160:175], v[68:71], v[72:75], v[160:175]
ds_read_b64_tr_b16 v[92:93], v11 offset:36864
ds_read_b64_tr_b16 v[94:95], v11 offset:38912
v_accvgpr_read_b32 v109, a253
v_accvgpr_read_b32 v110, a254
v_accvgpr_read_b32 v111, a255
v_mul_f32 v104, v104, v26
v_mul_f32 v105, v105, v26
v_mul_f32 v106, v106, v26
v_mfma_f32_32x32x16_bf16 v[176:191], v[68:71], v[76:79], v[176:191]
v_mul_f32 v107, v107, v26
v_mul_f32 v108, v108, v26
v_mul_f32 v109, v109, v26
v_mul_f32 v110, v110, v26
v_mul_f32 v111, v111, v26
v_cvt_pk_bf16_f32 v252, v104, v105
v_cvt_pk_bf16_f32 v253, v106, v107
s_waitcnt lgkmcnt(0)
v_mfma_f32_32x32x16_bf16 v[128:143], v[80:83], v[88:91], v[128:143]
ds_read_b64_tr_b16 v[64:65], v6 offset:40960
ds_read_b64_tr_b16 v[66:67], v6 offset:43008
ds_read_b64_tr_b16 v[68:69], v7 offset:40960
v_cvt_pk_bf16_f32 v254, v108, v109
v_cvt_pk_bf16_f32 v255, v110, v111
v_accvgpr_write_b32 a96, 0
v_accvgpr_write_b32 a97, 0
v_accvgpr_write_b32 a98, 0
v_mfma_f32_32x32x16_bf16 v[144:159], v[80:83], v[92:95], v[144:159]
ds_read_b64_tr_b16 v[70:71], v7 offset:43008
ds_read_b64_tr_b16 v[72:73], v10 offset:40960
ds_read_b64_tr_b16 v[74:75], v10 offset:43008
v_accvgpr_write_b32 a99, 0
v_accvgpr_write_b32 a100, 0
v_accvgpr_write_b32 a101, 0
v_accvgpr_write_b32 a102, 0
v_accvgpr_write_b32 a103, 0
v_mfma_f32_32x32x16_bf16 v[160:175], v[84:87], v[88:91], v[160:175]
ds_read_b64_tr_b16 v[76:77], v11 offset:40960
ds_read_b64_tr_b16 v[78:79], v11 offset:43008
v_accvgpr_write_b32 a104, 0
v_accvgpr_write_b32 a105, 0
v_accvgpr_write_b32 a106, 0
v_accvgpr_write_b32 a107, 0
v_accvgpr_write_b32 a108, 0
v_accvgpr_write_b32 a109, 0
v_mfma_f32_32x32x16_bf16 v[176:191], v[84:87], v[92:95], v[176:191]
v_accvgpr_write_b32 a110, 0
v_accvgpr_write_b32 a111, 0
v_accvgpr_write_b32 a112, 0
v_accvgpr_write_b32 a113, 0
v_accvgpr_write_b32 a114, 0
v_accvgpr_write_b32 a115, 0
v_accvgpr_write_b32 a116, 0
s_waitcnt lgkmcnt(0)
v_mfma_f32_32x32x16_bf16 v[128:143], v[64:67], v[72:75], v[128:143]
ds_read_b64_tr_b16 v[80:81], v6 offset:45056
ds_read_b64_tr_b16 v[82:83], v6 offset:47104
ds_read_b64_tr_b16 v[84:85], v7 offset:45056
v_accvgpr_write_b32 a117, 0
v_accvgpr_write_b32 a118, 0
v_accvgpr_write_b32 a119, 0
v_accvgpr_write_b32 a120, 0
v_accvgpr_write_b32 a121, 0
v_mfma_f32_32x32x16_bf16 v[144:159], v[64:67], v[76:79], v[144:159]
ds_read_b64_tr_b16 v[86:87], v7 offset:47104
ds_read_b64_tr_b16 v[88:89], v10 offset:45056
ds_read_b64_tr_b16 v[90:91], v10 offset:47104
v_accvgpr_write_b32 a122, 0
v_accvgpr_write_b32 a123, 0
v_accvgpr_write_b32 a124, 0
v_accvgpr_write_b32 a125, 0
v_accvgpr_write_b32 a126, 0
v_mfma_f32_32x32x16_bf16 v[160:175], v[68:71], v[72:75], v[160:175]
ds_read_b64_tr_b16 v[92:93], v11 offset:45056
ds_read_b64_tr_b16 v[94:95], v11 offset:47104
v_accvgpr_write_b32 a127, 0
v_mfma_f32_32x32x16_bf16 v[176:191], v[68:71], v[76:79], v[176:191]
s_waitcnt lgkmcnt(0)
v_mfma_f32_32x32x16_bf16 v[128:143], v[80:83], v[88:91], v[128:143]
v_mfma_f32_32x32x16_bf16 v[144:159], v[80:83], v[92:95], v[144:159]
v_mfma_f32_32x32x16_bf16 v[160:175], v[84:87], v[88:91], v[160:175]
v_mfma_f32_32x32x16_bf16 v[176:191], v[84:87], v[92:95], v[176:191]
s_cmp_lg_u32 s34, 0
s_cbranch_scc1 W10
s_waitcnt vmcnt(0)
s_mov_b32 exec_lo, 0xff
s_mov_b32 exec_hi, 0
v_cmp_gt_u32 vcc, 1, v27
s_mov_b64 exec, -1
s_cbranch_vccz KK11
s_lshl_b32 s91, s65, 5
s_add_u32 s91, s91, 2293760
v_lshlrev_b32 v25, 2, v0
s_mov_b32 s90, 200000
s_mov_b32 exec_lo, 0xff
s_mov_b32 exec_hi, 0
PL12:
buffer_load_dword v24, v25, s[48:51], s91 offen sc1
s_waitcnt vmcnt(0)
v_cmp_gt_u32 vcc, 1, v24
s_cbranch_vccz PD13
s_sub_u32 s90, s90, 1
s_cbranch_scc1 PD13
s_sleep 1
s_branch PL12
PD13:
s_mov_b64 exec, -1
KK11:
W10:
s_barrier
s_lshl_b32 s90, s65, 20
s_add_u32 s90, s90, 8388608
s_add_u32 s44, s32, s90
s_addc_u32 s45, s33, 0
s_sub_u32 s91, 16, s64
s_lshl_b32 s46, s91, 16
s_mov_b32 s47, 0x20000
v_lshlrev_b32 v34, 4, v0
s_lshl_b32 s91, s34, 13
v_add_u32 v35, s91, v34
s_mov_b32 s57, s91
s_mov_b32 s54, 0
s_mov_b32 s53, 0
s_add_u32 m0, s53, s57
s_nop 0
buffer_load_dwordx4 v35, s[44:47], s54 offen lds
buffer_load_dwordx4 v35, s[44:47], s54 offen offset:1024 lds
buffer_load_dwordx4 v35, s[44:47], s54 offen offset:2048 lds
buffer_load_dwordx4 v35, s[44:47], s54 offen offset:3072 lds
s_add_u32 s54, s54, 4096
s_add_u32 m0, m0, 4096
s_nop 0
buffer_load_dwordx4 v35, s[44:47], s54 offen lds
buffer_load_dwordx4 v35, s[44:47], s54 offen offset:1024 lds
buffer_load_dwordx4 v35, s[44:47], s54 offen offset:2048 lds
buffer_load_dwordx4 v35, s[44:47], s54 offen offset:3072 lds
s_add_u32 s54, s54, 28672
s_mov_b32 s53, 32768
s_add_u32 m0, s53, s57
s_nop 0
buffer_load_dwordx4 v35, s[44:47], s54 offen lds
buffer_load_dwordx4 v35, s[44:47], s54 offen offset:1024 lds
buffer_load_dwordx4 v35, s[44:47], s54 offen offset:2048 lds
buffer_load_dwordx4 v35, s[44:47], s54 offen offset:3072 lds
s_add_u32 s54, s54, 4096
s_add_u32 m0, m0, 4096
s_nop 0
buffer_load_dwordx4 v35, s[44:47], s54 offen lds
buffer_load_dwordx4 v35, s[44:47], s54 offen offset:1024 lds
buffer_load_dwordx4 v35, s[44:47], s54 offen offset:2048 lds
buffer_load_dwordx4 v35, s[44:47], s54 offen offset:3072 lds
s_add_u32 s54, s54, 28672
s_mov_b32 s53, 65536
s_add_u32 m0, s53, s57
s_nop 0
buffer_load_dwordx4 v35, s[44:47], s54 offen lds
buffer_load_dwordx4 v35, s[44:47], s54 offen offset:1024 lds
buffer_load_dwordx4 v35, s[44:47], s54 offen offset:2048 lds
buffer_load_dwordx4 v35, s[44:47], s54 offen offset:3072 lds
s_add_u32 s54, s54, 4096
s_add_u32 m0, m0, 4096
s_nop 0
buffer_load_dwordx4 v35, s[44:47], s54 offen lds
buffer_load_dwordx4 v35, s[44:47], s54 offen offset:1024 lds
buffer_load_dwordx4 v35, s[44:47], s54 offen offset:2048 lds
buffer_load_dwordx4 v35, s[44:47], s54 offen offset:3072 lds
s_add_u32 s54, s54, 28672
s_lshl_b32 s66, s60, 2
s_add_u32 s66, s66, s34
s_lshl_b32 s66, s66, 2
s_add_u32 s66, s66, s61
s_lshl_b32 s66, s66, 13
s_add_u32 s66, s66, 75497472
v_lshlrev_b32 v24, 4, v0
s_nop 7
v_cvt_pk_bf16_f32 v64, v128, v129
v_cvt_pk_bf16_f32 v65, v130, v131
v_cvt_pk_bf16_f32 v66, v132, v133
v_cvt_pk_bf16_f32 v67, v134, v135
v_cvt_pk_bf16_f32 v68, v136, v137
v_cvt_pk_bf16_f32 v69, v138, v139
v_cvt_pk_bf16_f32 v70, v140, v141
v_cvt_pk_bf16_f32 v71, v142, v143
buffer_store_dwordx4 v[64:67], v24, s[48:51], s66 offen sc1
buffer_store_dwordx4 v[68:71], v24, s[48:51], s66 offen offset:1024 sc1
v_cvt_pk_bf16_f32 v72, v144, v145
v_cvt_pk_bf16_f32 v73, v146, v147
v_cvt_pk_bf16_f32 v74, v148, v149
v_cvt_pk_bf16_f32 v75, v150, v151
v_cvt_pk_bf16_f32 v76, v152, v153
v_cvt_pk_bf16_f32 v77, v154, v155
v_cvt_pk_bf16_f32 v78, v156, v157
v_cvt_pk_bf16_f32 v79, v158, v159
buffer_store_dwordx4 v[72:75], v24, s[48:51], s66 offen offset:2048 sc1
buffer_store_dwordx4 v[76:79], v24, s[48:51], s66 offen offset:3072 sc1
v_cvt_pk_bf16_f32 v80, v160, v161
v_cvt_pk_bf16_f32 v81, v162, v163
v_cvt_pk_bf16_f32 v82, v164, v165
v_cvt_pk_bf16_f32 v83, v166, v167
v_cvt_pk_bf16_f32 v84, v168, v169
v_cvt_pk_bf16_f32 v85, v170, v171
v_cvt_pk_bf16_f32 v86, v172, v173
v_cvt_pk_bf16_f32 v87, v174, v175
s_add_u32 s66, s66, 4096
buffer_store_dwordx4 v[80:83], v24, s[48:51], s66 offen sc1
buffer_store_dwordx4 v[84:87], v24, s[48:51], s66 offen offset:1024 sc1
v_cvt_pk_bf16_f32 v88, v176, v177
v_cvt_pk_bf16_f32 v89, v178, v179
v_cvt_pk_bf16_f32 v90, v180, v181
v_cvt_pk_bf16_f32 v91, v182, v183
v_cvt_pk_bf16_f32 v92, v184, v185
v_cvt_pk_bf16_f32 v93, v186, v187
v_cvt_pk_bf16_f32 v94, v188, v189
v_cvt_pk_bf16_f32 v95, v190, v191
buffer_store_dwordx4 v[88:91], v24, s[48:51], s66 offen offset:2048 sc1
buffer_store_dwordx4 v[92:95], v24, s[48:51], s66 offen offset:3072 sc1
s_mov_b32 s89, 1
s_waitcnt vmcnt(24)
s_branch JOIN_q
IDLE_g1:
v_mfma_f32_32x32x16_bf16 a[128:143], v[80:83], v[72:75], a[128:143]
v_mfma_f32_32x32x16_bf16 a[192:207], v[80:83], v[76:79], a[192:207]
v_mfma_f32_32x32x16_bf16 a[144:159], v[84:87], v[72:75], a[144:159]
v_mfma_f32_32x32x16_bf16 a[208:223], v[84:87], v[76:79], a[208:223]
v_mfma_f32_32x32x16_bf16 a[160:175], v[88:91], v[72:75], a[160:175]
v_mfma_f32_32x32x16_bf16 a[224:239], v[88:91], v[76:79], a[224:239]
v_mfma_f32_32x32x16_bf16 a[176:191], v[92:95], v[72:75], a[176:191]
v_mfma_f32_32x32x16_bf16 a[240:255], v[92:95], v[76:79], a[240:255]
v_accvgpr_read_b32 v30, a0
v_accvgpr_read_b32 v31, a1
v_accvgpr_read_b32 v32, a2
v_accvgpr_read_b32 v33, a3
v_accvgpr_read_b32 v34, a4
v_accvgpr_read_b32 v35, a5
v_accvgpr_read_b32 v36, a6
v_accvgpr_read_b32 v37, a7
v_cvt_pk_bf16_f32 v112, v30, v31
v_cvt_pk_bf16_f32 v113, v32, v33
v_cvt_pk_bf16_f32 v114, v34, v35
v_cvt_pk_bf16_f32 v115, v36, v37
s_add_u32 s66, s66, 4096
buffer_store_dwordx4 v[112:115], v28, s[48:51], s66 offen sc1
v_accvgpr_read_b32 v30, a16
v_accvgpr_read_b32 v31, a17
v_accvgpr_read_b32 v32, a18
v_accvgpr_read_b32 v33, a19
v_accvgpr_read_b32 v34, a20
v_accvgpr_read_b32 v35, a21
v_accvgpr_read_b32 v36, a22
v_accvgpr_read_b32 v37, a23
v_cvt_pk_bf16_f32 v116, v30, v31
v_cvt_pk_bf16_f32 v117, v32, v33
v_cvt_pk_bf16_f32 v118, v34, v35
v_cvt_pk_bf16_f32 v119, v36, v37
buffer_store_dwordx4 v[116:119], v28, s[48:51], s66 offen offset:1024 sc1
v_accvgpr_read_b32 v30, a32
v_accvgpr_read_b32 v31, a33
v_accvgpr_read_b32 v32, a34
v_accvgpr_read_b32 v33, a35
v_accvgpr_read_b32 v34, a36
v_accvgpr_read_b32 v35, a37
v_accvgpr_read_b32 v36, a38
v_accvgpr_read_b32 v37, a39
v_cvt_pk_bf16_f32 v120, v30, v31
v_cvt_pk_bf16_f32 v121, v32, v33
v_cvt_pk_bf16_f32 v122, v34, v35
v_cvt_pk_bf16_f32 v123, v36, v37
buffer_store_dwordx4 v[120:123], v28, s[48:51], s66 offen offset:2048 sc1
v_accvgpr_read_b32 v30, a48
v_accvgpr_read_b32 v31, a49
v_accvgpr_read_b32 v32, a50
v_accvgpr_read_b32 v33, a51
v_accvgpr_read_b32 v34, a52
v_accvgpr_read_b32 v35, a53
v_accvgpr_read_b32 v36, a54
v_accvgpr_read_b32 v37, a55
v_cvt_pk_bf16_f32 v124, v30, v31
v_cvt_pk_bf16_f32 v125, v32, v33
v_cvt_pk_bf16_f32 v126, v34, v35
v_cvt_pk_bf16_f32 v127, v36, v37
buffer_store_dwordx4 v[124:127], v28, s[48:51], s66 offen offset:3072 sc1
v_accvgpr_read_b32 v30, a8
v_accvgpr_read_b32 v31, a9
v_accvgpr_read_b32 v32, a10
v_accvgpr_read_b32 v33, a11
v_accvgpr_read_b32 v34, a12
v_accvgpr_read_b32 v35, a13
v_accvgpr_read_b32 v36, a14
v_accvgpr_read_b32 v37, a15
v_cvt_pk_bf16_f32 v112, v30, v31
v_cvt_pk_bf16_f32 v113, v32, v33
v_cvt_pk_bf16_f32 v114, v34, v35
v_cvt_pk_bf16_f32 v115, v36, v37
s_add_u32 s66, s66, 4096
buffer_store_dwordx4 v[112:115], v28, s[48:51], s66 offen sc1
v_accvgpr_read_b32 v30, a24
v_accvgpr_read_b32 v31, a25
v_accvgpr_read_b32 v32, a26
v_accvgpr_read_b32 v33, a27
v_accvgpr_read_b32 v34, a28
v_accvgpr_read_b32 v35, a29
v_accvgpr_read_b32 v36, a30
v_accvgpr_read_b32 v37, a31
v_cvt_pk_bf16_f32 v116, v30, v31
v_cvt_pk_bf16_f32 v117, v32, v33
v_cvt_pk_bf16_f32 v118, v34, v35
v_cvt_pk_bf16_f32 v119, v36, v37
buffer_store_dwordx4 v[116:119], v28, s[48:51], s66 offen offset:1024 sc1
v_accvgpr_read_b32 v30, a40
v_accvgpr_read_b32 v31, a41
v_accvgpr_read_b32 v32, a42
v_accvgpr_read_b32 v33, a43
v_accvgpr_read_b32 v34, a44
v_accvgpr_read_b32 v35, a45
v_accvgpr_read_b32 v36, a46
v_accvgpr_read_b32 v37, a47
v_cvt_pk_bf16_f32 v120, v30, v31
v_cvt_pk_bf16_f32 v121, v32, v33
v_cvt_pk_bf16_f32 v122, v34, v35
v_cvt_pk_bf16_f32 v123, v36, v37
buffer_store_dwordx4 v[120:123], v28, s[48:51], s66 offen offset:2048 sc1
v_accvgpr_read_b32 v30, a56
v_accvgpr_read_b32 v31, a57
v_accvgpr_read_b32 v32, a58
v_accvgpr_read_b32 v33, a59
v_accvgpr_read_b32 v34, a60
v_accvgpr_read_b32 v35, a61
v_accvgpr_read_b32 v36, a62
v_accvgpr_read_b32 v37, a63
v_cvt_pk_bf16_f32 v124, v30, v31
v_cvt_pk_bf16_f32 v125, v32, v33
v_cvt_pk_bf16_f32 v126, v34, v35
v_cvt_pk_bf16_f32 v127, v36, v37
buffer_store_dwordx4 v[124:127], v28, s[48:51], s66 offen offset:3072 sc1
v_accvgpr_read_b32 v30, a64
v_accvgpr_read_b32 v31, a65
v_accvgpr_read_b32 v32, a66
v_accvgpr_read_b32 v33, a67
v_accvgpr_read_b32 v34, a68
v_accvgpr_read_b32 v35, a69
v_accvgpr_read_b32 v36, a70
v_accvgpr_read_b32 v37, a71
v_cvt_pk_bf16_f32 v112, v30, v31
v_cvt_pk_bf16_f32 v113, v32, v33
v_cvt_pk_bf16_f32 v114, v34, v35
v_cvt_pk_bf16_f32 v115, v36, v37
s_add_u32 s66, s66, 4096
buffer_store_dwordx4 v[112:115], v28, s[48:51], s66 offen sc1
v_accvgpr_read_b32 v30, a80
v_accvgpr_read_b32 v31, a81
v_accvgpr_read_b32 v32, a82
v_accvgpr_read_b32 v33, a83
v_accvgpr_read_b32 v34, a84
v_accvgpr_read_b32 v35, a85
v_accvgpr_read_b32 v36, a86
v_accvgpr_read_b32 v37, a87
v_cvt_pk_bf16_f32 v116, v30, v31
v_cvt_pk_bf16_f32 v117, v32, v33
v_cvt_pk_bf16_f32 v118, v34, v35
v_cvt_pk_bf16_f32 v119, v36, v37
buffer_store_dwordx4 v[116:119], v28, s[48:51], s66 offen offset:1024 sc1
v_accvgpr_read_b32 v30, a96
v_accvgpr_read_b32 v31, a97
v_accvgpr_read_b32 v32, a98
v_accvgpr_read_b32 v33, a99
v_accvgpr_read_b32 v34, a100
v_accvgpr_read_b32 v35, a101
v_accvgpr_read_b32 v36, a102
v_accvgpr_read_b32 v37, a103
v_cvt_pk_bf16_f32 v120, v30, v31
v_cvt_pk_bf16_f32 v121, v32, v33
v_cvt_pk_bf16_f32 v122, v34, v35
v_cvt_pk_bf16_f32 v123, v36, v37
buffer_store_dwordx4 v[120:123], v28, s[48:51], s66 offen offset:2048 sc1
v_accvgpr_read_b32 v30, a112
v_accvgpr_read_b32 v31, a113
v_accvgpr_read_b32 v32, a114
v_accvgpr_read_b32 v33, a115
v_accvgpr_read_b32 v34, a116
v_accvgpr_read_b32 v35, a117
v_accvgpr_read_b32 v36, a118
v_accvgpr_read_b32 v37, a119
v_cvt_pk_bf16_f32 v124, v30, v31
v_cvt_pk_bf16_f32 v125, v32, v33
v_cvt_pk_bf16_f32 v126, v34, v35
v_cvt_pk_bf16_f32 v127, v36, v37
buffer_store_dwordx4 v[124:127], v28, s[48:51], s66 offen offset:3072 sc1
v_accvgpr_read_b32 v30, a72
v_accvgpr_read_b32 v31, a73
v_accvgpr_read_b32 v32, a74
v_accvgpr_read_b32 v33, a75
v_accvgpr_read_b32 v34, a76
v_accvgpr_read_b32 v35, a77
v_accvgpr_read_b32 v36, a78
v_accvgpr_read_b32 v37, a79
v_cvt_pk_bf16_f32 v112, v30, v31
v_cvt_pk_bf16_f32 v113, v32, v33
v_cvt_pk_bf16_f32 v114, v34, v35
v_cvt_pk_bf16_f32 v115, v36, v37
s_add_u32 s66, s66, 4096
buffer_store_dwordx4 v[112:115], v28, s[48:51], s66 offen sc1
v_accvgpr_read_b32 v30, a88
v_accvgpr_read_b32 v31, a89
v_accvgpr_read_b32 v32, a90
v_accvgpr_read_b32 v33, a91
v_accvgpr_read_b32 v34, a92
v_accvgpr_read_b32 v35, a93
v_accvgpr_read_b32 v36, a94
v_accvgpr_read_b32 v37, a95
v_cvt_pk_bf16_f32 v116, v30, v31
v_cvt_pk_bf16_f32 v117, v32, v33
v_cvt_pk_bf16_f32 v118, v34, v35
v_cvt_pk_bf16_f32 v119, v36, v37
buffer_store_dwordx4 v[116:119], v28, s[48:51], s66 offen offset:1024 sc1
v_accvgpr_read_b32 v30, a104
v_accvgpr_read_b32 v31, a105
v_accvgpr_read_b32 v32, a106
v_accvgpr_read_b32 v33, a107
v_accvgpr_read_b32 v34, a108
v_accvgpr_read_b32 v35, a109
v_accvgpr_read_b32 v36, a110
v_accvgpr_read_b32 v37, a111
v_cvt_pk_bf16_f32 v120, v30, v31
v_cvt_pk_bf16_f32 v121, v32, v33
v_cvt_pk_bf16_f32 v122, v34, v35
v_cvt_pk_bf16_f32 v123, v36, v37
buffer_store_dwordx4 v[120:123], v28, s[48:51], s66 offen offset:2048 sc1
v_accvgpr_read_b32 v30, a120
v_accvgpr_read_b32 v31, a121
v_accvgpr_read_b32 v32, a122
v_accvgpr_read_b32 v33, a123
v_accvgpr_read_b32 v34, a124
v_accvgpr_read_b32 v35, a125
v_accvgpr_read_b32 v36, a126
v_accvgpr_read_b32 v37, a127
v_cvt_pk_bf16_f32 v124, v30, v31
v_cvt_pk_bf16_f32 v125, v32, v33
v_cvt_pk_bf16_f32 v126, v34, v35
v_cvt_pk_bf16_f32 v127, v36, v37
buffer_store_dwordx4 v[124:127], v28, s[48:51], s66 offen offset:3072 sc1
v_mov_b32 v26, 0x3e0293ee
s_waitcnt vmcnt(0)
s_barrier
s_cmp_lg_u32 s34, 0
s_cbranch_scc1 W14
v_mov_b32 v24, 1
v_mov_b32 v25, 0
s_mov_b64 exec, 1
buffer_store_dword v24, v25, s[48:51], s100 offen sc1
s_mov_b64 exec, -1
W14:
s_and_b32 s90, s2, 7
s_lshl_b32 s90, s90, 2
s_lshr_b32 s91, s2, 3
s_add_u32 s90, s90, s91
s_sub_u32 s90, s90, 28
s_lshl_b32 s90, s90, 2
s_add_u32 s90, s90, s34
v_lshlrev_b32 v24, 7, v0
s_mov_b32 s68, s22
s_mov_b32 s69, s23
s_mov_b32 s70, 7340032
s_mov_b32 s71, 0x20000
s_mul_i32 s91, s90, 57344
buffer_load_dword v27, v24, s[68:71], s91 offen
s_add_u32 s91, s91, 8192
buffer_load_dword v27, v24, s[68:71], s91 offen
s_add_u32 s91, s91, 8192
buffer_load_dword v27, v24, s[68:71], s91 offen
s_add_u32 s91, s91, 8192
buffer_load_dword v27, v24, s[68:71], s91 offen
s_add_u32 s91, s91, 8192
buffer_load_dword v27, v24, s[68:71], s91 offen
s_add_u32 s91, s91, 8192
buffer_load_dword v27, v24, s[68:71], s91 offen
s_add_u32 s91, s91, 8192
buffer_load_dword v27, v24, s[68:71], s91 offen
s_add_u32 s91, s91, 8192
s_mov_b32 s68, s14
s_mov_b32 s69, s15
s_mov_b32 s70, 4194304
s_mov_b32 s71, 0x20000
s_mul_i32 s91, s90, 32768
buffer_load_dword v27, v24, s[68:71], s91 offen
s_add_u32 s91, s91, 8192
buffer_load_dword v27, v24, s[68:71], s91 offen
s_add_u32 s91, s91, 8192
buffer_load_dword v27, v24, s[68:71], s91 offen
s_add_u32 s91, s91, 8192
buffer_load_dword v27, v24, s[68:71], s91 offen
s_add_u32 s91, s91, 8192
s_nop 7
v_accvgpr_read_b32 v96, a128
v_accvgpr_read_b32 v97, a129
v_accvgpr_read_b32 v98, a130
v_accvgpr_read_b32 v99, a131
v_accvgpr_read_b32 v100, a132
v_accvgpr_read_b32 v101, a133
v_accvgpr_read_b32 v102, a134
v_accvgpr_read_b32 v103, a135
v_mul_f32 v96, v96, v26
v_mul_f32 v97, v97, v26
v_mul_f32 v98, v98, v26
v_mul_f32 v99, v99, v26
v_mul_f32 v100, v100, v26
v_mul_f32 v101, v101, v26
v_mul_f32 v102, v102, v26
v_mul_f32 v103, v103, v26
v_cvt_pk_bf16_f32 v192, v96, v97
v_cvt_pk_bf16_f32 v193, v98, v99
v_cvt_pk_bf16_f32 v194, v100, v101
v_cvt_pk_bf16_f32 v195, v102, v103
v_accvgpr_read_b32 v104, a136
v_accvgpr_read_b32 v105, a137
v_accvgpr_read_b32 v106, a138
v_accvgpr_read_b32 v107, a139
v_accvgpr_read_b32 v108, a140
v_accvgpr_read_b32 v109, a141
v_accvgpr_read_b32 v110, a142
v_accvgpr_read_b32 v111, a143
v_mul_f32 v104, v104, v26
v_mul_f32 v105, v105, v26
v_mul_f32 v106, v106, v26
v_mul_f32 v107, v107, v26
v_mul_f32 v108, v108, v26
v_mul_f32 v109, v109, v26
v_mul_f32 v110, v110, v26
v_mul_f32 v111, v111, v26
v_cvt_pk_bf16_f32 v196, v104, v105
v_cvt_pk_bf16_f32 v197, v106, v107
v_cvt_pk_bf16_f32 v198, v108, v109
v_cvt_pk_bf16_f32 v199, v110, v111
v_accvgpr_read_b32 v96, a144
v_accvgpr_read_b32 v97, a145
v_accvgpr_read_b32 v98, a146
v_accvgpr_read_b32 v99, a147
v_accvgpr_read_b32 v100, a148
v_accvgpr_read_b32 v101, a149
v_accvgpr_read_b32 v102, a150
v_accvgpr_read_b32 v103, a151
v_mul_f32 v96, v96, v26
v_mul_f32 v97, v97, v26
v_mul_f32 v98, v98, v26
v_mul_f32 v99, v99, v26
v_mul_f32 v100, v100, v26
v_mul_f32 v101, v101, v26
v_mul_f32 v102, v102, v26
v_mul_f32 v103, v103, v26
v_cvt_pk_bf16_f32 v200, v96, v97
v_cvt_pk_bf16_f32 v201, v98, v99
v_cvt_pk_bf16_f32 v202, v100, v101
v_cvt_pk_bf16_f32 v203, v102, v103
v_accvgpr_read_b32 v104, a152
v_accvgpr_read_b32 v105, a153
v_accvgpr_read_b32 v106, a154
v_accvgpr_read_b32 v107, a155
v_accvgpr_read_b32 v108, a156
v_accvgpr_read_b32 v109, a157
v_accvgpr_read_b32 v110, a158
v_accvgpr_read_b32 v111, a159
v_mul_f32 v104, v104, v26
v_mul_f32 v105, v105, v26
v_mul_f32 v106, v106, v26
v_mul_f32 v107, v107, v26
v_mul_f32 v108, v108, v26
v_mul_f32 v109, v109, v26
v_mul_f32 v110, v110, v26
v_mul_f32 v111, v111, v26
v_cvt_pk_bf16_f32 v204, v104, v105
v_cvt_pk_bf16_f32 v205, v106, v107
v_cvt_pk_bf16_f32 v206, v108, v109
v_cvt_pk_bf16_f32 v207, v110, v111
v_accvgpr_read_b32 v96, a160
v_accvgpr_read_b32 v97, a161
v_accvgpr_read_b32 v98, a162
v_accvgpr_read_b32 v99, a163
v_accvgpr_read_b32 v100, a164
v_accvgpr_read_b32 v101, a165
v_accvgpr_read_b32 v102, a166
v_accvgpr_read_b32 v103, a167
v_mul_f32 v96, v96, v26
v_mul_f32 v97, v97, v26
v_mul_f32 v98, v98, v26
v_mul_f32 v99, v99, v26
v_mul_f32 v100, v100, v26
v_mul_f32 v101, v101, v26
v_mul_f32 v102, v102, v26
v_mul_f32 v103, v103, v26
v_cvt_pk_bf16_f32 v208, v96, v97
v_cvt_pk_bf16_f32 v209, v98, v99
v_cvt_pk_bf16_f32 v210, v100, v101
v_cvt_pk_bf16_f32 v211, v102, v103
v_accvgpr_read_b32 v104, a168
v_accvgpr_read_b32 v105, a169
v_accvgpr_read_b32 v106, a170
v_accvgpr_read_b32 v107, a171
v_accvgpr_read_b32 v108, a172
v_accvgpr_read_b32 v109, a173
v_accvgpr_read_b32 v110, a174
v_accvgpr_read_b32 v111, a175
v_mul_f32 v104, v104, v26
v_mul_f32 v105, v105, v26
v_mul_f32 v106, v106, v26
v_mul_f32 v107, v107, v26
v_mul_f32 v108, v108, v26
v_mul_f32 v109, v109, v26
v_mul_f32 v110, v110, v26
v_mul_f32 v111, v111, v26
v_cvt_pk_bf16_f32 v212, v104, v105
v_cvt_pk_bf16_f32 v213, v106, v107
v_cvt_pk_bf16_f32 v214, v108, v109
v_cvt_pk_bf16_f32 v215, v110, v111
v_accvgpr_read_b32 v96, a176
v_accvgpr_read_b32 v97, a177
v_accvgpr_read_b32 v98, a178
v_accvgpr_read_b32 v99, a179
v_accvgpr_read_b32 v100, a180
v_accvgpr_read_b32 v101, a181
v_accvgpr_read_b32 v102, a182
v_accvgpr_read_b32 v103, a183
v_mul_f32 v96, v96, v26
v_mul_f32 v97, v97, v26
v_mul_f32 v98, v98, v26
v_mul_f32 v99, v99, v26
v_mul_f32 v100, v100, v26
v_mul_f32 v101, v101, v26
v_mul_f32 v102, v102, v26
v_mul_f32 v103, v103, v26
v_cvt_pk_bf16_f32 v216, v96, v97
v_cvt_pk_bf16_f32 v217, v98, v99
v_cvt_pk_bf16_f32 v218, v100, v101
v_cvt_pk_bf16_f32 v219, v102, v103
v_accvgpr_read_b32 v104, a184
v_accvgpr_read_b32 v105, a185
v_accvgpr_read_b32 v106, a186
v_accvgpr_read_b32 v107, a187
v_accvgpr_read_b32 v108, a188
v_accvgpr_read_b32 v109, a189
v_accvgpr_read_b32 v110, a190
v_accvgpr_read_b32 v111, a191
v_mul_f32 v104, v104, v26
v_mul_f32 v105, v105, v26
v_mul_f32 v106, v106, v26
v_mul_f32 v107, v107, v26
v_mul_f32 v108, v108, v26
v_mul_f32 v109, v109, v26
v_mul_f32 v110, v110, v26
v_mul_f32 v111, v111, v26
v_cvt_pk_bf16_f32 v220, v104, v105
v_cvt_pk_bf16_f32 v221, v106, v107
v_cvt_pk_bf16_f32 v222, v108, v109
v_cvt_pk_bf16_f32 v223, v110, v111
v_accvgpr_read_b32 v96, a192
v_accvgpr_read_b32 v97, a193
v_accvgpr_read_b32 v98, a194
v_accvgpr_read_b32 v99, a195
v_accvgpr_read_b32 v100, a196
v_accvgpr_read_b32 v101, a197
v_accvgpr_read_b32 v102, a198
v_accvgpr_read_b32 v103, a199
v_mul_f32 v96, v96, v26
v_mul_f32 v97, v97, v26
v_mul_f32 v98, v98, v26
v_mul_f32 v99, v99, v26
v_mul_f32 v100, v100, v26
v_mul_f32 v101, v101, v26
v_mul_f32 v102, v102, v26
v_mul_f32 v103, v103, v26
v_cvt_pk_bf16_f32 v224, v96, v97
v_cvt_pk_bf16_f32 v225, v98, v99
v_cvt_pk_bf16_f32 v226, v100, v101
v_cvt_pk_bf16_f32 v227, v102, v103
v_accvgpr_read_b32 v104, a200
v_accvgpr_read_b32 v105, a201
v_accvgpr_read_b32 v106, a202
v_accvgpr_read_b32 v107, a203
v_accvgpr_read_b32 v108, a204
v_accvgpr_read_b32 v109, a205
v_accvgpr_read_b32 v110, a206
v_accvgpr_read_b32 v111, a207
v_mul_f32 v104, v104, v26
v_mul_f32 v105, v105, v26
v_mul_f32 v106, v106, v26
v_mul_f32 v107, v107, v26
v_mul_f32 v108, v108, v26
v_mul_f32 v109, v109, v26
v_mul_f32 v110, v110, v26
v_mul_f32 v111, v111, v26
v_cvt_pk_bf16_f32 v228, v104, v105
v_cvt_pk_bf16_f32 v229, v106, v107
v_cvt_pk_bf16_f32 v230, v108, v109
v_cvt_pk_bf16_f32 v231, v110, v111
v_accvgpr_read_b32 v96, a208
v_accvgpr_read_b32 v97, a209
v_accvgpr_read_b32 v98, a210
v_accvgpr_read_b32 v99, a211
v_accvgpr_read_b32 v100, a212
v_accvgpr_read_b32 v101, a213
v_accvgpr_read_b32 v102, a214
v_accvgpr_read_b32 v103, a215
v_mul_f32 v96, v96, v26
v_mul_f32 v97, v97, v26
v_mul_f32 v98, v98, v26
v_mul_f32 v99, v99, v26
v_mul_f32 v100, v100, v26
v_mul_f32 v101, v101, v26
v_mul_f32 v102, v102, v26
v_mul_f32 v103, v103, v26
v_cvt_pk_bf16_f32 v232, v96, v97
v_cvt_pk_bf16_f32 v233, v98, v99
v_cvt_pk_bf16_f32 v234, v100, v101
v_cvt_pk_bf16_f32 v235, v102, v103
v_accvgpr_read_b32 v104, a216
v_accvgpr_read_b32 v105, a217
v_accvgpr_read_b32 v106, a218
v_accvgpr_read_b32 v107, a219
v_accvgpr_read_b32 v108, a220
v_accvgpr_read_b32 v109, a221
v_accvgpr_read_b32 v110, a222
v_accvgpr_read_b32 v111, a223
v_mul_f32 v104, v104, v26
v_mul_f32 v105, v105, v26
v_mul_f32 v106, v106, v26
v_mul_f32 v107, v107, v26
v_mul_f32 v108, v108, v26
v_mul_f32 v109, v109, v26
v_mul_f32 v110, v110, v26
v_mul_f32 v111, v111, v26
v_cvt_pk_bf16_f32 v236, v104, v105
v_cvt_pk_bf16_f32 v237, v106, v107
v_cvt_pk_bf16_f32 v238, v108, v109
v_cvt_pk_bf16_f32 v239, v110, v111
v_accvgpr_read_b32 v96, a224
v_accvgpr_read_b32 v97, a225
v_accvgpr_read_b32 v98, a226
v_accvgpr_read_b32 v99, a227
v_accvgpr_read_b32 v100, a228
v_accvgpr_read_b32 v101, a229
v_accvgpr_read_b32 v102, a230
v_accvgpr_read_b32 v103, a231
v_mul_f32 v96, v96, v26
v_mul_f32 v97, v97, v26
v_mul_f32 v98, v98, v26
v_mul_f32 v99, v99, v26
v_mul_f32 v100, v100, v26
v_mul_f32 v101, v101, v26
v_mul_f32 v102, v102, v26
v_mul_f32 v103, v103, v26
v_cvt_pk_bf16_f32 v240, v96, v97
v_cvt_pk_bf16_f32 v241, v98, v99
v_cvt_pk_bf16_f32 v242, v100, v101
v_cvt_pk_bf16_f32 v243, v102, v103
v_accvgpr_read_b32 v104, a232
v_accvgpr_read_b32 v105, a233
v_accvgpr_read_b32 v106, a234
v_accvgpr_read_b32 v107, a235
v_accvgpr_read_b32 v108, a236
v_accvgpr_read_b32 v109, a237
v_accvgpr_read_b32 v110, a238
v_accvgpr_read_b32 v111, a239
v_mul_f32 v104, v104, v26
v_mul_f32 v105, v105, v26
v_mul_f32 v106, v106, v26
v_mul_f32 v107, v107, v26
v_mul_f32 v108, v108, v26
v_mul_f32 v109, v109, v26
v_mul_f32 v110, v110, v26
v_mul_f32 v111, v111, v26
v_cvt_pk_bf16_f32 v244, v104, v105
v_cvt_pk_bf16_f32 v245, v106, v107
v_cvt_pk_bf16_f32 v246, v108, v109
v_cvt_pk_bf16_f32 v247, v110, v111
v_accvgpr_read_b32 v96, a240
v_accvgpr_read_b32 v97, a241
v_accvgpr_read_b32 v98, a242
v_accvgpr_read_b32 v99, a243
v_accvgpr_read_b32 v100, a244
v_accvgpr_read_b32 v101, a245
v_accvgpr_read_b32 v102, a246
v_accvgpr_read_b32 v103, a247
v_mul_f32 v96, v96, v26
v_mul_f32 v97, v97, v26
v_mul_f32 v98, v98, v26
v_mul_f32 v99, v99, v26
v_mul_f32 v100, v100, v26
v_mul_f32 v101, v101, v26
v_mul_f32 v102, v102, v26
v_mul_f32 v103, v103, v26
v_cvt_pk_bf16_f32 v248, v96, v97
v_cvt_pk_bf16_f32 v249, v98, v99
v_cvt_pk_bf16_f32 v250, v100, v101
v_cvt_pk_bf16_f32 v251, v102, v103
v_accvgpr_read_b32 v104, a248
v_accvgpr_read_b32 v105, a249
v_accvgpr_read_b32 v106, a250
v_accvgpr_read_b32 v107, a251
v_accvgpr_read_b32 v108, a252
v_accvgpr_read_b32 v109, a253
v_accvgpr_read_b32 v110, a254
v_accvgpr_read_b32 v111, a255
v_mul_f32 v104, v104, v26
v_mul_f32 v105, v105, v26
v_mul_f32 v106, v106, v26
v_mul_f32 v107, v107, v26
v_mul_f32 v108, v108, v26
v_mul_f32 v109, v109, v26
v_mul_f32 v110, v110, v26
v_mul_f32 v111, v111, v26
v_cvt_pk_bf16_f32 v252, v104, v105
v_cvt_pk_bf16_f32 v253, v106, v107
v_cvt_pk_bf16_f32 v254, v108, v109
v_cvt_pk_bf16_f32 v255, v110, v111
v_accvgpr_write_b32 a0, 0
v_accvgpr_write_b32 a1, 0
v_accvgpr_write_b32 a2, 0
v_accvgpr_write_b32 a3, 0
v_accvgpr_write_b32 a4, 0
v_accvgpr_write_b32 a5, 0
v_accvgpr_write_b32 a6, 0
v_accvgpr_write_b32 a7, 0
v_accvgpr_write_b32 a8, 0
v_accvgpr_write_b32 a9, 0
v_accvgpr_write_b32 a10, 0
v_accvgpr_write_b32 a11, 0
v_accvgpr_write_b32 a12, 0
v_accvgpr_write_b32 a13, 0
v_accvgpr_write_b32 a14, 0
v_accvgpr_write_b32 a15, 0
v_accvgpr_write_b32 a16, 0
v_accvgpr_write_b32 a17, 0
v_accvgpr_write_b32 a18, 0
v_accvgpr_write_b32 a19, 0
v_accvgpr_write_b32 a20, 0
v_accvgpr_write_b32 a21, 0
v_accvgpr_write_b32 a22, 0
v_accvgpr_write_b32 a23, 0
v_accvgpr_write_b32 a24, 0
v_accvgpr_write_b32 a25, 0
v_accvgpr_write_b32 a26, 0
v_accvgpr_write_b32 a27, 0
v_accvgpr_write_b32 a28, 0
v_accvgpr_write_b32 a29, 0
v_accvgpr_write_b32 a30, 0
v_accvgpr_write_b32 a31, 0
v_accvgpr_write_b32 a32, 0
v_accvgpr_write_b32 a33, 0
v_accvgpr_write_b32 a34, 0
v_accvgpr_write_b32 a35, 0
v_accvgpr_write_b32 a36, 0
v_accvgpr_write_b32 a37, 0
v_accvgpr_write_b32 a38, 0
v_accvgpr_write_b32 a39, 0
v_accvgpr_write_b32 a40, 0
v_accvgpr_write_b32 a41, 0
v_accvgpr_write_b32 a42, 0
v_accvgpr_write_b32 a43, 0
v_accvgpr_write_b32 a44, 0
v_accvgpr_write_b32 a45, 0
v_accvgpr_write_b32 a46, 0
v_accvgpr_write_b32 a47, 0
v_accvgpr_write_b32 a48, 0
v_accvgpr_write_b32 a49, 0
v_accvgpr_write_b32 a50, 0
v_accvgpr_write_b32 a51, 0
v_accvgpr_write_b32 a52, 0
v_accvgpr_write_b32 a53, 0
v_accvgpr_write_b32 a54, 0
v_accvgpr_write_b32 a55, 0
v_accvgpr_write_b32 a56, 0
v_accvgpr_write_b32 a57, 0
v_accvgpr_write_b32 a58, 0
v_accvgpr_write_b32 a59, 0
v_accvgpr_write_b32 a60, 0
v_accvgpr_write_b32 a61, 0
v_accvgpr_write_b32 a62, 0
v_accvgpr_write_b32 a63, 0
v_accvgpr_write_b32 a64, 0
v_accvgpr_write_b32 a65, 0
v_accvgpr_write_b32 a66, 0
v_accvgpr_write_b32 a67, 0
v_accvgpr_write_b32 a68, 0
v_accvgpr_write_b32 a69, 0
v_accvgpr_write_b32 a70, 0
v_accvgpr_write_b32 a71, 0
v_accvgpr_write_b32 a72, 0
v_accvgpr_write_b32 a73, 0
v_accvgpr_write_b32 a74, 0
v_accvgpr_write_b32 a75, 0
v_accvgpr_write_b32 a76, 0
v_accvgpr_write_b32 a77, 0
v_accvgpr_write_b32 a78, 0
v_accvgpr_write_b32 a79, 0
v_accvgpr_write_b32 a80, 0
v_accvgpr_write_b32 a81, 0
v_accvgpr_write_b32 a82, 0
v_accvgpr_write_b32 a83, 0
v_accvgpr_write_b32 a84, 0
v_accvgpr_write_b32 a85, 0
v_accvgpr_write_b32 a86, 0
v_accvgpr_write_b32 a87, 0
v_accvgpr_write_b32 a88, 0
v_accvgpr_write_b32 a89, 0
v_accvgpr_write_b32 a90, 0
v_accvgpr_write_b32 a91, 0
v_accvgpr_write_b32 a92, 0
v_accvgpr_write_b32 a93, 0
v_accvgpr_write_b32 a94, 0
v_accvgpr_write_b32 a95, 0
v_accvgpr_write_b32 a96, 0
v_accvgpr_write_b32 a97, 0
v_accvgpr_write_b32 a98, 0
v_accvgpr_write_b32 a99, 0
v_accvgpr_write_b32 a100, 0
v_accvgpr_write_b32 a101, 0
v_accvgpr_write_b32 a102, 0
v_accvgpr_write_b32 a103, 0
v_accvgpr_write_b32 a104, 0
v_accvgpr_write_b32 a105, 0
v_accvgpr_write_b32 a106, 0
v_accvgpr_write_b32 a107, 0
v_accvgpr_write_b32 a108, 0
v_accvgpr_write_b32 a109, 0
v_accvgpr_write_b32 a110, 0
v_accvgpr_write_b32 a111, 0
v_accvgpr_write_b32 a112, 0
v_accvgpr_write_b32 a113, 0
v_accvgpr_write_b32 a114, 0
v_accvgpr_write_b32 a115, 0
v_accvgpr_write_b32 a116, 0
v_accvgpr_write_b32 a117, 0
v_accvgpr_write_b32 a118, 0
v_accvgpr_write_b32 a119, 0
v_accvgpr_write_b32 a120, 0
v_accvgpr_write_b32 a121, 0
v_accvgpr_write_b32 a122, 0
v_accvgpr_write_b32 a123, 0
v_accvgpr_write_b32 a124, 0
v_accvgpr_write_b32 a125, 0
v_accvgpr_write_b32 a126, 0
v_accvgpr_write_b32 a127, 0
s_cmp_lg_u32 s34, 0
s_cbranch_scc1 W15
s_lshl_b32 s91, s65, 5
s_add_u32 s91, s91, 2293760
v_lshlrev_b32 v25, 2, v0
s_mov_b32 s90, 200000
s_mov_b32 exec_lo, 0xff
s_mov_b32 exec_hi, 0
PL16:
buffer_load_dword v24, v25, s[48:51], s91 offen sc1
s_waitcnt vmcnt(0)
v_cmp_gt_u32 vcc, 1, v24
s_cbranch_vccz PD17
s_sub_u32 s90, s90, 1
s_cbranch_scc1 PD17
s_sleep 1
s_branch PL16
PD17:
s_mov_b64 exec, -1
W15:
s_barrier
s_lshl_b32 s90, s65, 20
s_add_u32 s90, s90, 8388608
s_add_u32 s44, s32, s90
s_addc_u32 s45, s33, 0
s_sub_u32 s91, 16, s64
s_lshl_b32 s46, s91, 16
s_mov_b32 s47, 0x20000
v_lshlrev_b32 v34, 4, v0
s_lshl_b32 s91, s34, 13
v_add_u32 v35, s91, v34
s_mov_b32 s57, s91
s_mov_b32 s54, 0
s_mov_b32 s53, 0
s_add_u32 m0, s53, s57
s_nop 0
buffer_load_dwordx4 v35, s[44:47], s54 offen lds
buffer_load_dwordx4 v35, s[44:47], s54 offen offset:1024 lds
buffer_load_dwordx4 v35, s[44:47], s54 offen offset:2048 lds
buffer_load_dwordx4 v35, s[44:47], s54 offen offset:3072 lds
s_add_u32 s54, s54, 4096
s_add_u32 m0, m0, 4096
s_nop 0
buffer_load_dwordx4 v35, s[44:47], s54 offen lds
buffer_load_dwordx4 v35, s[44:47], s54 offen offset:1024 lds
buffer_load_dwordx4 v35, s[44:47], s54 offen offset:2048 lds
buffer_load_dwordx4 v35, s[44:47], s54 offen offset:3072 lds
s_add_u32 s54, s54, 28672
s_mov_b32 s53, 32768
s_add_u32 m0, s53, s57
s_nop 0
buffer_load_dwordx4 v35, s[44:47], s54 offen lds
buffer_load_dwordx4 v35, s[44:47], s54 offen offset:1024 lds
buffer_load_dwordx4 v35, s[44:47], s54 offen offset:2048 lds
buffer_load_dwordx4 v35, s[44:47], s54 offen offset:3072 lds
s_add_u32 s54, s54, 4096
s_add_u32 m0, m0, 4096
s_nop 0
buffer_load_dwordx4 v35, s[44:47], s54 offen lds
buffer_load_dwordx4 v35, s[44:47], s54 offen offset:1024 lds
buffer_load_dwordx4 v35, s[44:47], s54 offen offset:2048 lds
buffer_load_dwordx4 v35, s[44:47], s54 offen offset:3072 lds
s_add_u32 s54, s54, 28672
s_mov_b32 s53, 65536
s_add_u32 m0, s53, s57
s_nop 0
buffer_load_dwordx4 v35, s[44:47], s54 offen lds
buffer_load_dwordx4 v35, s[44:47], s54 offen offset:1024 lds
buffer_load_dwordx4 v35, s[44:47], s54 offen offset:2048 lds
buffer_load_dwordx4 v35, s[44:47], s54 offen offset:3072 lds
s_add_u32 s54, s54, 4096
s_add_u32 m0, m0, 4096
s_nop 0
buffer_load_dwordx4 v35, s[44:47], s54 offen lds
buffer_load_dwordx4 v35, s[44:47], s54 offen offset:1024 lds
buffer_load_dwordx4 v35, s[44:47], s54 offen offset:2048 lds
buffer_load_dwordx4 v35, s[44:47], s54 offen offset:3072 lds
s_add_u32 s54, s54, 28672
s_mov_b32 s89, 0
s_waitcnt vmcnt(16)
JOIN_q:
s_mov_b32 s53, 65536
s_mov_b32 s52, 0
v_mov_b32 v32, v34
v_mov_b32 v33, v34
v_mov_b32 v47, 0xff800000
v_mov_b32 v37, 0x44800000
s_mov_b32 s56, 0
v_mov_b32 v40, 0
v_mov_b32 v42, 0
v_mov_b32 v41, 0
v_mov_b32 v43, 0
s_waitcnt vmcnt(63)
s_barrier
ds_read_b128 a[128:131], v32
ds_read_b128 a[132:135], v32 offset:1024
ds_read_b128 a[136:139], v32 offset:2048
ds_read_b128 a[140:143], v32 offset:3072
ds_read_b128 a[144:147], v32 offset:4096
ds_read_b128 a[148:151], v32 offset:5120
ds_read_b128 a[152:155], v32 offset:6144
ds_read_b128 a[156:159], v32 offset:7168
s_cmp_lg_u32 s64, 0
s_cbranch_scc1 QM18
v_mov_b32 v64, 0
v_subrev_u32 v46, s56, v44
v_cmp_le_i32 s[92:93], 0, v46
v_cmp_le_i32 s[94:95], 1, v46
v_cmp_le_i32 s[96:97], 2, v46
v_cmp_le_i32 s[98:99], 3, v46
v_cndmask_b32 v128, v47, v64, s[92:93]
v_cndmask_b32 v129, v47, v64, s[94:95]
v_cndmask_b32 v130, v47, v64, s[96:97]
v_cndmask_b32 v131, v47, v64, s[98:99]
v_cmp_le_i32 s[92:93], 8, v46
v_cmp_le_i32 s[94:95], 9, v46
v_cmp_le_i32 s[96:97], 10, v46
v_cmp_le_i32 s[98:99], 11, v46
v_cndmask_b32 v132, v47, v64, s[92:93]
v_cndmask_b32 v133, v47, v64, s[94:95]
v_cndmask_b32 v134, v47, v64, s[96:97]
v_cndmask_b32 v135, v47, v64, s[98:99]
v_cmp_le_i32 s[92:93], 16, v46
v_cmp_le_i32 s[94:95], 17, v46
v_cmp_le_i32 s[96:97], 18, v46
v_cmp_le_i32 s[98:99], 19, v46
v_cndmask_b32 v136, v47, v64, s[92:93]
v_cndmask_b32 v137, v47, v64, s[94:95]
v_cndmask_b32 v138, v47, v64, s[96:97]
v_cndmask_b32 v139, v47, v64, s[98:99]
v_cmp_le_i32 s[92:93], 24, v46
v_cmp_le_i32 s[94:95], 25, v46
v_cmp_le_i32 s[96:97], 26, v46
v_cmp_le_i32 s[98:99], 27, v46
v_cndmask_b32 v140, v47, v64, s[92:93]
v_cndmask_b32 v141, v47, v64, s[94:95]
v_cndmask_b32 v142, v47, v64, s[96:97]
v_cndmask_b32 v143, v47, v64, s[98:99]
s_nop 0
s_waitcnt lgkmcnt(0)
v_mfma_f32_32x32x16_bf16 v[128:143], a[128:131], v[192:195], v[128:143]
v_mfma_f32_32x32x16_bf16 v[160:175], a[128:131], v[224:227], 0
v_mfma_f32_32x32x16_bf16 v[128:143], a[132:135], v[196:199], v[128:143]
v_mfma_f32_32x32x16_bf16 v[160:175], a[132:135], v[228:231], v[160:175]
v_mfma_f32_32x32x16_bf16 v[128:143], a[136:139], v[200:203], v[128:143]
v_mfma_f32_32x32x16_bf16 v[160:175], a[136:139], v[232:235], v[160:175]
v_mfma_f32_32x32x16_bf16 v[128:143], a[140:143], v[204:207], v[128:143]
v_mfma_f32_32x32x16_bf16 v[160:175], a[140:143], v[236:239], v[160:175]
v_mfma_f32_32x32x16_bf16 v[128:143], a[144:147], v[208:211], v[128:143]
v_mfma_f32_32x32x16_bf16 v[160:175], a[144:147], v[240:243], v[160:175]
v_mfma_f32_32x32x16_bf16 v[128:143], a[148:151], v[212:215], v[128:143]
v_mfma_f32_32x32x16_bf16 v[160:175], a[148:151], v[244:247], v[160:175]
v_mfma_f32_32x32x16_bf16 v[128:143], a[152:155], v[216:219], v[128:143]
v_mfma_f32_32x32x16_bf16 v[160:175], a[152:155], v[248:251], v[160:175]
v_mfma_f32_32x32x16_bf16 v[128:143], a[156:159], v[220:223], v[128:143]
v_mfma_f32_32x32x16_bf16 v[160:175], a[156:159], v[252:255], v[160:175]
s_branch QJ19
QM18:
s_waitcnt lgkmcnt(0)
v_mfma_f32_32x32x16_bf16 v[128:143], a[128:131], v[192:195], 0
v_mfma_f32_32x32x16_bf16 v[160:175], a[128:131], v[224:227], 0
v_mfma_f32_32x32x16_bf16 v[128:143], a[132:135], v[196:199], v[128:143]
v_mfma_f32_32x32x16_bf16 v[160:175], a[132:135], v[228:231], v[160:175]
v_mfma_f32_32x32x16_bf16 v[128:143], a[136:139], v[200:203], v[128:143]
v_mfma_f32_32x32x16_bf16 v[160:175], a[136:139], v[232:235], v[160:175]
v_mfma_f32_32x32x16_bf16 v[128:143], a[140:143], v[204:207], v[128:143]
v_mfma_f32_32x32x16_bf16 v[160:175], a[140:143], v[236:239], v[160:175]
v_mfma_f32_32x32x16_bf16 v[128:143], a[144:147], v[208:211], v[128:143]
v_mfma_f32_32x32x16_bf16 v[160:175], a[144:147], v[240:243], v[160:175]
v_mfma_f32_32x32x16_bf16 v[128:143], a[148:151], v[212:215], v[128:143]
v_mfma_f32_32x32x16_bf16 v[160:175], a[148:151], v[244:247], v[160:175]
v_mfma_f32_32x32x16_bf16 v[128:143], a[152:155], v[216:219], v[128:143]
v_mfma_f32_32x32x16_bf16 v[160:175], a[152:155], v[248:251], v[160:175]
v_mfma_f32_32x32x16_bf16 v[128:143], a[156:159], v[220:223], v[128:143]
v_mfma_f32_32x32x16_bf16 v[160:175], a[156:159], v[252:255], v[160:175]
QJ19:
s_nop 15
v_max3_f32 v48, v128, v129, v130
v_max3_f32 v50, v160, v161, v162
v_max3_f32 v48, v48, v131, v132
v_max3_f32 v50, v50, v163, v164
v_max3_f32 v48, v48, v133, v134
v_max3_f32 v50, v50, v165, v166
v_max3_f32 v48, v48, v135, v136
v_max3_f32 v50, v50, v167, v168
v_max3_f32 v48, v48, v137, v138
v_max3_f32 v50, v50, v169, v170
v_max3_f32 v48, v48, v139, v140
v_max3_f32 v50, v50, v171, v172
v_max3_f32 v48, v48, v141, v142
v_max3_f32 v50, v50, v173, v174
v_max_f32 v48, v48, v143
v_max_f32 v50, v50, v175
v_mov_b32 v49, v48
v_mov_b32 v51, v50
s_nop 0
v_permlane32_swap_b32 v48, v49
v_permlane32_swap_b32 v50, v51
s_nop 0
v_max_f32 v48, v48, v49
v_max_f32 v50, v50, v51
v_ceil_f32 v48, v48
v_ceil_f32 v50, v50
v_sub_f32 v48, 0, v48
v_sub_f32 v50, 0, v50
v_pk_add_f32 v[128:129], v[128:129], v[48:49] op_sel_hi:[1,0]
v_pk_mov_b32 v[64:65], v[48:49], v[48:49] op_sel:[0,0]
v_pk_add_f32 v[130:131], v[130:131], v[48:49] op_sel_hi:[1,0]
v_pk_mov_b32 v[66:67], v[48:49], v[48:49] op_sel:[0,0]
v_pk_add_f32 v[132:133], v[132:133], v[48:49] op_sel_hi:[1,0]
v_pk_mov_b32 v[68:69], v[48:49], v[48:49] op_sel:[0,0]
v_pk_add_f32 v[134:135], v[134:135], v[48:49] op_sel_hi:[1,0]
v_pk_mov_b32 v[70:71], v[48:49], v[48:49] op_sel:[0,0]
v_pk_add_f32 v[136:137], v[136:137], v[48:49] op_sel_hi:[1,0]
v_pk_mov_b32 v[72:73], v[48:49], v[48:49] op_sel:[0,0]
v_pk_add_f32 v[138:139], v[138:139], v[48:49] op_sel_hi:[1,0]
v_pk_mov_b32 v[74:75], v[48:49], v[48:49] op_sel:[0,0]
v_pk_add_f32 v[140:141], v[140:141], v[48:49] op_sel_hi:[1,0]
v_pk_mov_b32 v[76:77], v[48:49], v[48:49] op_sel:[0,0]
v_pk_add_f32 v[142:143], v[142:143], v[48:49] op_sel_hi:[1,0]
v_pk_mov_b32 v[78:79], v[48:49], v[48:49] op_sel:[0,0]
v_pk_add_f32 v[160:161], v[160:161], v[50:51] op_sel_hi:[1,0]
v_pk_mov_b32 v[80:81], v[50:51], v[50:51] op_sel:[0,0]
v_pk_add_f32 v[162:163], v[162:163], v[50:51] op_sel_hi:[1,0]
v_pk_mov_b32 v[82:83], v[50:51], v[50:51] op_sel:[0,0]
v_pk_add_f32 v[164:165], v[164:165], v[50:51] op_sel_hi:[1,0]
v_pk_mov_b32 v[84:85], v[50:51], v[50:51] op_sel:[0,0]
v_pk_add_f32 v[166:167], v[166:167], v[50:51] op_sel_hi:[1,0]
v_pk_mov_b32 v[86:87], v[50:51], v[50:51] op_sel:[0,0]
v_pk_add_f32 v[168:169], v[168:169], v[50:51] op_sel_hi:[1,0]
v_pk_mov_b32 v[88:89], v[50:51], v[50:51] op_sel:[0,0]
v_pk_add_f32 v[170:171], v[170:171], v[50:51] op_sel_hi:[1,0]
v_pk_mov_b32 v[90:91], v[50:51], v[50:51] op_sel:[0,0]
v_pk_add_f32 v[172:173], v[172:173], v[50:51] op_sel_hi:[1,0]
v_pk_mov_b32 v[92:93], v[50:51], v[50:51] op_sel:[0,0]
v_pk_add_f32 v[174:175], v[174:175], v[50:51] op_sel_hi:[1,0]
v_pk_mov_b32 v[94:95], v[50:51], v[50:51] op_sel:[0,0]
s_add_u32 s56, s56, 32
ds_read_b128 a[128:131], v32 offset:8192
ds_read_b128 a[132:135], v32 offset:9216
ds_read_b128 a[136:139], v32 offset:10240
ds_read_b128 a[140:143], v32 offset:11264
ds_read_b128 a[144:147], v32 offset:12288
ds_read_b128 a[148:151], v32 offset:13312
ds_read_b128 a[152:155], v32 offset:14336
ds_read_b128 a[156:159], v32 offset:15360
v_subrev_u32 v46, s56, v44
v_cmp_le_i32 s[92:93], 0, v46
v_cmp_le_i32 s[94:95], 1, v46
v_cmp_le_i32 s[96:97], 2, v46
v_cmp_le_i32 s[98:99], 3, v46
v_cndmask_b32 v144, v47, v64, s[92:93]
v_cndmask_b32 v145, v47, v64, s[94:95]
v_cndmask_b32 v146, v47, v64, s[96:97]
v_cndmask_b32 v147, v47, v64, s[98:99]
v_cmp_le_i32 s[92:93], 8, v46
v_cmp_le_i32 s[94:95], 9, v46
v_cmp_le_i32 s[96:97], 10, v46
v_cmp_le_i32 s[98:99], 11, v46
v_cndmask_b32 v148, v47, v64, s[92:93]
v_cndmask_b32 v149, v47, v64, s[94:95]
v_cndmask_b32 v150, v47, v64, s[96:97]
v_cndmask_b32 v151, v47, v64, s[98:99]
v_cmp_le_i32 s[92:93], 16, v46
v_cmp_le_i32 s[94:95], 17, v46
v_cmp_le_i32 s[96:97], 18, v46
v_cmp_le_i32 s[98:99], 19, v46
v_cndmask_b32 v152, v47, v64, s[92:93]
v_cndmask_b32 v153, v47, v64, s[94:95]
v_cndmask_b32 v154, v47, v64, s[96:97]
v_cndmask_b32 v155, v47, v64, s[98:99]
v_cmp_le_i32 s[92:93], 24, v46
v_cmp_le_i32 s[94:95], 25, v46
v_cmp_le_i32 s[96:97], 26, v46
v_cmp_le_i32 s[98:99], 27, v46
v_cndmask_b32 v156, v47, v64, s[92:93]
v_cndmask_b32 v157, v47, v64, s[94:95]
v_cndmask_b32 v158, v47, v64, s[96:97]
v_cndmask_b32 v159, v47, v64, s[98:99]
s_nop 0
s_waitcnt lgkmcnt(0)
v_mfma_f32_32x32x16_bf16 v[144:159], a[128:131], v[192:195], v[144:159]
ds_read_b128 a[160:163], v32 offset:16384
ds_read_b128 a[164:167], v32 offset:17408
v_exp_f32 v2, v128
v_exp_f32 v48, v160
v_mfma_f32_32x32x16_bf16 v[176:191], a[128:131], v[224:227], v[80:95]
ds_read_b128 a[168:171], v32 offset:18432
ds_read_b128 a[172:175], v32 offset:19456
v_exp_f32 v3, v129
v_exp_f32 v49, v161
v_mfma_f32_32x32x16_bf16 v[144:159], a[132:135], v[196:199], v[144:159]
ds_read_b128 a[176:179], v32 offset:20480
ds_read_b128 a[180:183], v32 offset:21504
v_exp_f32 v4, v130
v_exp_f32 v50, v162
v_mfma_f32_32x32x16_bf16 v[176:191], a[132:135], v[228:231], v[176:191]
ds_read_b128 a[184:187], v32 offset:22528
v_exp_f32 v5, v131
v_add_f32 v42, v2, v3
v_exp_f32 v51, v163
v_mfma_f32_32x32x16_bf16 v[144:159], a[136:139], v[200:203], v[144:159]
ds_read_b128 a[188:191], v32 offset:23552
v_exp_f32 v6, v132
v_add_f32 v43, v48, v49
v_add_f32 v42, v42, v4
v_mfma_f32_32x32x16_bf16 v[176:191], a[136:139], v[232:235], v[176:191]
v_exp_f32 v52, v164
v_exp_f32 v7, v133
v_add_f32 v43, v43, v50
v_add_f32 v42, v42, v5
v_mfma_f32_32x32x16_bf16 v[144:159], a[140:143], v[204:207], v[144:159]
v_exp_f32 v53, v165
v_exp_f32 v8, v134
v_add_f32 v43, v43, v51
v_add_f32 v42, v42, v6
v_mfma_f32_32x32x16_bf16 v[176:191], a[140:143], v[236:239], v[176:191]
v_exp_f32 v54, v166
v_exp_f32 v9, v135
v_add_f32 v43, v43, v52
v_add_f32 v42, v42, v7
v_mfma_f32_32x32x16_bf16 v[144:159], a[144:147], v[208:211], v[144:159]
v_exp_f32 v55, v167
v_exp_f32 v10, v136
v_add_f32 v43, v43, v53
v_add_f32 v42, v42, v8
v_mfma_f32_32x32x16_bf16 v[176:191], a[144:147], v[240:243], v[176:191]
v_exp_f32 v56, v168
v_exp_f32 v11, v137
v_add_f32 v43, v43, v54
v_add_f32 v42, v42, v9
v_mfma_f32_32x32x16_bf16 v[144:159], a[148:151], v[212:215], v[144:159]
v_exp_f32 v57, v169
v_exp_f32 v12, v138
v_add_f32 v43, v43, v55
v_add_f32 v42, v42, v10
v_mfma_f32_32x32x16_bf16 v[176:191], a[148:151], v[244:247], v[176:191]
v_exp_f32 v58, v170
v_exp_f32 v13, v139
v_add_f32 v43, v43, v56
v_cvt_pk_bf16_f32 v96, v2, v3
v_mfma_f32_32x32x16_bf16 v[144:159], a[152:155], v[216:219], v[144:159]
v_cvt_pk_bf16_f32 v112, v48, v49
v_add_f32 v42, v42, v11
v_exp_f32 v59, v171
v_exp_f32 v14, v140
v_mfma_f32_32x32x16_bf16 v[176:191], a[152:155], v[248:251], v[176:191]
v_add_f32 v43, v43, v57
v_cvt_pk_bf16_f32 v97, v4, v5
v_cvt_pk_bf16_f32 v113, v50, v51
v_add_f32 v42, v42, v12
v_exp_f32 v60, v172
v_mfma_f32_32x32x16_bf16 v[144:159], a[156:159], v[220:223], v[144:159]
v_exp_f32 v15, v141
v_add_f32 v43, v43, v58
v_add_f32 v42, v42, v13
v_exp_f32 v61, v173
v_exp_f32 v16, v142
v_add_f32 v43, v43, v59
v_add_f32 v42, v42, v14
v_exp_f32 v62, v174
v_exp_f32 v17, v143
v_add_f32 v43, v43, v60
v_add_f32 v42, v42, v15
v_exp_f32 v63, v175
v_add_f32 v42, v42, v16
v_add_f32 v43, v43, v61
v_add_f32 v42, v42, v17
v_add_f32 v43, v43, v62
v_add_f32 v43, v43, v63
v_max_f32 v36, v42, v43
v_cmp_nle_f32 vcc, v36, v37
v_mfma_f32_32x32x16_bf16 v[176:191], a[156:159], v[252:255], v[176:191]
v_cvt_pk_bf16_f32 v98, v6, v7
v_cvt_pk_bf16_f32 v114, v52, v53
v_cvt_pk_bf16_f32 v99, v8, v9
v_cvt_pk_bf16_f32 v115, v54, v55
v_cvt_pk_bf16_f32 v100, v10, v11
v_cvt_pk_bf16_f32 v116, v56, v57
v_cvt_pk_bf16_f32 v101, v12, v13
v_cvt_pk_bf16_f32 v117, v58, v59
s_add_u32 s52, s52, 32768
s_and_b32 s52, s52, 131071
s_xor_b32 s53, s52, 65536
v_mov_b32 v33, v32
v_add_u32 v32, s52, v34
v_cvt_pk_bf16_f32 v102, v14, v15
v_cvt_pk_bf16_f32 v118, v60, v61
v_cvt_pk_bf16_f32 v103, v16, v17
v_cvt_pk_bf16_f32 v119, v62, v63
s_cbranch_vccnz RS20
RR21:
s_cmp_eq_u32 s89, 0
s_cbranch_scc1 NY22
s_waitcnt vmcnt(0)
s_lshl_b32 s90, s34, 4
s_add_u32 s90, s90, s88
v_mov_b32 v24, 1
v_mov_b32 v25, 0
s_mov_b64 exec, 1
buffer_store_dword v24, v25, s[48:51], s90 offen sc1
s_mov_b64 exec, -1
NY22:
s_lshl_b32 s55, s64, 1
s_sub_u32 s55, s55, 1
s_cmp_le_i32 s55, 0
s_cbranch_scc1 AS24
s_sub_u32 s55, s55, 1
AL23:
s_waitcnt lgkmcnt(0)
v_mfma_f32_32x32x16_bf16 a[0:15], a[160:163], v[96:99], a[0:15]
s_waitcnt vmcnt(8)
s_barrier
v_mfma_f32_32x32x16_bf16 a[64:79], a[160:163], v[112:115], a[64:79]
ds_read_b128 a[128:131], v32
ds_read_b128 a[132:135], v32 offset:1024
v_add_f32 v40, v40, v42
v_add_f32 v41, v41, v43
v_mfma_f32_32x32x16_bf16 a[16:31], a[164:167], v[96:99], a[16:31]
ds_read_b128 a[136:139], v32 offset:2048
ds_read_b128 a[140:143], v32 offset:3072
v_exp_f32 v2, v144
v_exp_f32 v48, v176
v_mfma_f32_32x32x16_bf16 a[80:95], a[164:167], v[112:115], a[80:95]
ds_read_b128 a[144:147], v32 offset:4096
v_exp_f32 v3, v145
v_exp_f32 v49, v177
s_add_u32 m0, s53, s57
v_mfma_f32_32x32x16_bf16 a[32:47], a[168:171], v[96:99], a[32:47]
buffer_load_dwordx4 v35, s[44:47], s54 offen lds
ds_read_b128 a[148:151], v32 offset:5120
v_exp_f32 v4, v146
v_mfma_f32_32x32x16_bf16 a[96:111], a[168:171], v[112:115], a[96:111]
ds_read_b128 a[152:155], v32 offset:6144
v_exp_f32 v50, v178
v_exp_f32 v5, v147
v_mfma_f32_32x32x16_bf16 a[48:63], a[172:175], v[96:99], a[48:63]
ds_read_b128 a[156:159], v32 offset:7168
v_add_f32 v42, v2, v3
v_exp_f32 v51, v179
v_exp_f32 v6, v148
v_mfma_f32_32x32x16_bf16 a[112:127], a[172:175], v[112:115], a[112:127]
v_add_f32 v43, v48, v49
v_add_f32 v42, v42, v4
v_exp_f32 v52, v180
v_mfma_f32_32x32x16_bf16 a[0:15], a[176:179], v[100:103], a[0:15]
v_exp_f32 v7, v149
v_add_f32 v43, v43, v50
v_mfma_f32_32x32x16_bf16 a[64:79], a[176:179], v[116:119], a[64:79]
v_add_f32 v42, v42, v5
v_exp_f32 v53, v181
v_mfma_f32_32x32x16_bf16 a[16:31], a[180:183], v[100:103], a[16:31]
v_exp_f32 v8, v150
v_add_f32 v43, v43, v51
v_add_f32 v42, v42, v6
v_exp_f32 v54, v182
v_mfma_f32_32x32x16_bf16 a[80:95], a[180:183], v[116:119], a[80:95]
v_exp_f32 v9, v151
v_add_f32 v43, v43, v52
v_mfma_f32_32x32x16_bf16 a[32:47], a[184:187], v[100:103], a[32:47]
buffer_load_dwordx4 v35, s[44:47], s54 offen offset:1024 lds
v_add_f32 v42, v42, v7
v_exp_f32 v55, v183
v_mfma_f32_32x32x16_bf16 a[96:111], a[184:187], v[116:119], a[96:111]
v_exp_f32 v10, v152
v_add_f32 v43, v43, v53
v_mfma_f32_32x32x16_bf16 a[48:63], a[188:191], v[100:103], a[48:63]
v_add_f32 v42, v42, v8
v_exp_f32 v56, v184
v_mfma_f32_32x32x16_bf16 a[112:127], a[188:191], v[116:119], a[112:127]
v_exp_f32 v11, v153
v_add_f32 v43, v43, v54
v_add_f32 v42, v42, v9
s_waitcnt lgkmcnt(0)
v_mfma_f32_32x32x16_bf16 v[128:143], a[128:131], v[192:195], v[64:79]
ds_read_b128 a[160:163], v33 offset:24576
ds_read_b128 a[164:167], v33 offset:25600
v_exp_f32 v57, v185
v_add_f32 v43, v43, v55
v_mfma_f32_32x32x16_bf16 v[160:175], a[128:131], v[224:227], v[80:95]
ds_read_b128 a[168:171], v33 offset:26624
v_exp_f32 v12, v154
v_add_f32 v42, v42, v10
v_exp_f32 v58, v186
v_mfma_f32_32x32x16_bf16 v[128:143], a[132:135], v[196:199], v[128:143]
ds_read_b128 a[172:175], v33 offset:27648
ds_read_b128 a[176:179], v33 offset:28672
v_exp_f32 v13, v155
v_add_f32 v43, v43, v56
v_mfma_f32_32x32x16_bf16 v[160:175], a[132:135], v[228:231], v[160:175]
ds_read_b128 a[180:183], v33 offset:29696
buffer_load_dwordx4 v35, s[44:47], s54 offen offset:2048 lds
v_add_f32 v42, v42, v11
v_exp_f32 v59, v187
v_mfma_f32_32x32x16_bf16 v[128:143], a[136:139], v[200:203], v[128:143]
ds_read_b128 a[184:187], v33 offset:30720
v_add_f32 v43, v43, v57
v_exp_f32 v14, v156
v_add_f32 v42, v42, v12
v_mfma_f32_32x32x16_bf16 v[160:175], a[136:139], v[232:235], v[160:175]
ds_read_b128 a[188:191], v33 offset:31744
v_exp_f32 v60, v188
v_exp_f32 v15, v157
v_add_f32 v43, v43, v58
v_mfma_f32_32x32x16_bf16 v[128:143], a[140:143], v[204:207], v[128:143]
v_add_f32 v42, v42, v13
v_exp_f32 v61, v189
v_mfma_f32_32x32x16_bf16 v[160:175], a[140:143], v[236:239], v[160:175]
v_add_f32 v43, v43, v59
v_exp_f32 v16, v158
v_cvt_pk_bf16_f32 v104, v2, v3
v_cvt_pk_bf16_f32 v120, v48, v49
v_add_f32 v42, v42, v14
v_mfma_f32_32x32x16_bf16 v[128:143], a[144:147], v[208:211], v[128:143]
v_exp_f32 v62, v190
v_cvt_pk_bf16_f32 v105, v4, v5
v_cvt_pk_bf16_f32 v121, v50, v51
v_exp_f32 v17, v159
v_mfma_f32_32x32x16_bf16 v[160:175], a[144:147], v[240:243], v[160:175]
v_add_f32 v43, v43, v60
v_cvt_pk_bf16_f32 v106, v6, v7
v_cvt_pk_bf16_f32 v122, v52, v53
v_add_f32 v42, v42, v15
v_exp_f32 v63, v191
v_mfma_f32_32x32x16_bf16 v[128:143], a[148:151], v[212:215], v[128:143]
v_cvt_pk_bf16_f32 v107, v8, v9
v_cvt_pk_bf16_f32 v123, v54, v55
v_add_f32 v43, v43, v61
v_add_f32 v42, v42, v16
v_cvt_pk_bf16_f32 v108, v10, v11
v_cvt_pk_bf16_f32 v124, v56, v57
v_mfma_f32_32x32x16_bf16 v[160:175], a[148:151], v[244:247], v[160:175]
buffer_load_dwordx4 v35, s[44:47], s54 offen offset:3072 lds
v_add_f32 v42, v42, v17
v_add_f32 v43, v43, v62
v_cvt_pk_bf16_f32 v109, v12, v13
v_cvt_pk_bf16_f32 v125, v58, v59
v_mfma_f32_32x32x16_bf16 v[128:143], a[152:155], v[216:219], v[128:143]
v_add_f32 v43, v43, v63
v_max_f32 v36, v42, v43
v_cmp_nle_f32 vcc, v36, v37
v_cvt_pk_bf16_f32 v110, v14, v15
v_cvt_pk_bf16_f32 v126, v60, v61
v_mfma_f32_32x32x16_bf16 v[160:175], a[152:155], v[248:251], v[160:175]
v_mfma_f32_32x32x16_bf16 v[128:143], a[156:159], v[220:223], v[128:143]
v_cvt_pk_bf16_f32 v111, v16, v17
v_mfma_f32_32x32x16_bf16 v[160:175], a[156:159], v[252:255], v[160:175]
v_cvt_pk_bf16_f32 v127, v62, v63
s_add_u32 s54, s54, 4096
s_cbranch_vccnz RS25
RR26:
s_waitcnt lgkmcnt(0)
v_mfma_f32_32x32x16_bf16 a[0:15], a[160:163], v[104:107], a[0:15]
ds_read_b128 a[128:131], v32 offset:8192
v_add_f32 v40, v40, v42
v_add_f32 v41, v41, v43
s_add_u32 s52, s52, 32768
s_and_b32 s52, s52, 131071
s_xor_b32 s53, s52, 65536
v_mfma_f32_32x32x16_bf16 a[64:79], a[160:163], v[120:123], a[64:79]
ds_read_b128 a[132:135], v32 offset:9216
ds_read_b128 a[136:139], v32 offset:10240
v_mov_b32 v33, v32
v_mfma_f32_32x32x16_bf16 a[16:31], a[164:167], v[104:107], a[16:31]
ds_read_b128 a[140:143], v32 offset:11264
ds_read_b128 a[144:147], v32 offset:12288
v_exp_f32 v2, v128
v_exp_f32 v48, v160
v_mfma_f32_32x32x16_bf16 a[80:95], a[164:167], v[120:123], a[80:95]
ds_read_b128 a[148:151], v32 offset:13312
v_exp_f32 v3, v129
v_exp_f32 v49, v161
s_add_u32 m0, m0, 4096
v_mfma_f32_32x32x16_bf16 a[32:47], a[168:171], v[104:107], a[32:47]
buffer_load_dwordx4 v35, s[44:47], s54 offen lds
ds_read_b128 a[152:155], v32 offset:14336
v_exp_f32 v4, v130
v_mfma_f32_32x32x16_bf16 a[96:111], a[168:171], v[120:123], a[96:111]
ds_read_b128 a[156:159], v32 offset:15360
v_exp_f32 v50, v162
v_exp_f32 v5, v131
v_mfma_f32_32x32x16_bf16 a[48:63], a[172:175], v[104:107], a[48:63]
v_add_f32 v42, v2, v3
v_exp_f32 v51, v163
v_exp_f32 v6, v132
v_add_f32 v43, v48, v49
v_mfma_f32_32x32x16_bf16 a[112:127], a[172:175], v[120:123], a[112:127]
v_add_f32 v42, v42, v4
v_exp_f32 v52, v164
v_mfma_f32_32x32x16_bf16 a[0:15], a[176:179], v[108:111], a[0:15]
v_exp_f32 v7, v133
v_add_f32 v43, v43, v50
v_mfma_f32_32x32x16_bf16 a[64:79], a[176:179], v[124:127], a[64:79]
v_add_f32 v42, v42, v5
v_exp_f32 v53, v165
v_mfma_f32_32x32x16_bf16 a[16:31], a[180:183], v[108:111], a[16:31]
v_exp_f32 v8, v134
v_add_f32 v43, v43, v51
v_add_f32 v42, v42, v6
v_exp_f32 v54, v166
v_mfma_f32_32x32x16_bf16 a[80:95], a[180:183], v[124:127], a[80:95]
v_exp_f32 v9, v135
v_add_f32 v43, v43, v52
v_mfma_f32_32x32x16_bf16 a[32:47], a[184:187], v[108:111], a[32:47]
buffer_load_dwordx4 v35, s[44:47], s54 offen offset:1024 lds
v_add_f32 v42, v42, v7
v_exp_f32 v55, v167
v_mfma_f32_32x32x16_bf16 a[96:111], a[184:187], v[124:127], a[96:111]
v_exp_f32 v10, v136
v_add_f32 v43, v43, v53
v_mfma_f32_32x32x16_bf16 a[48:63], a[188:191], v[108:111], a[48:63]
v_add_f32 v42, v42, v8
v_exp_f32 v56, v168
v_mfma_f32_32x32x16_bf16 a[112:127], a[188:191], v[124:127], a[112:127]
v_exp_f32 v11, v137
v_add_f32 v43, v43, v54
v_add_f32 v42, v42, v9
s_waitcnt lgkmcnt(0)
v_mfma_f32_32x32x16_bf16 v[144:159], a[128:131], v[192:195], v[64:79]
ds_read_b128 a[160:163], v32 offset:16384
ds_read_b128 a[164:167], v32 offset:17408
v_exp_f32 v57, v169
v_add_f32 v43, v43, v55
v_mfma_f32_32x32x16_bf16 v[176:191], a[128:131], v[224:227], v[80:95]
ds_read_b128 a[168:171], v32 offset:18432
v_exp_f32 v12, v138
v_add_f32 v42, v42, v10
v_exp_f32 v58, v170
v_mfma_f32_32x32x16_bf16 v[144:159], a[132:135], v[196:199], v[144:159]
ds_read_b128 a[172:175], v32 offset:19456
ds_read_b128 a[176:179], v32 offset:20480
v_exp_f32 v13, v139
v_add_f32 v43, v43, v56
v_mfma_f32_32x32x16_bf16 v[176:191], a[132:135], v[228:231], v[176:191]
ds_read_b128 a[180:183], v32 offset:21504
buffer_load_dwordx4 v35, s[44:47], s54 offen offset:2048 lds
v_add_f32 v42, v42, v11
v_exp_f32 v59, v171
v_mfma_f32_32x32x16_bf16 v[144:159], a[136:139], v[200:203], v[144:159]
ds_read_b128 a[184:187], v32 offset:22528
v_add_f32 v43, v43, v57
v_exp_f32 v14, v140
v_add_f32 v42, v42, v12
v_mfma_f32_32x32x16_bf16 v[176:191], a[136:139], v[232:235], v[176:191]
ds_read_b128 a[188:191], v32 offset:23552
v_exp_f32 v60, v172
v_exp_f32 v15, v141
v_add_f32 v43, v43, v58
v_mfma_f32_32x32x16_bf16 v[144:159], a[140:143], v[204:207], v[144:159]
v_add_f32 v42, v42, v13
v_exp_f32 v61, v173
v_mfma_f32_32x32x16_bf16 v[176:191], a[140:143], v[236:239], v[176:191]
v_add_f32 v43, v43, v59
v_exp_f32 v16, v142
v_cvt_pk_bf16_f32 v96, v2, v3
v_cvt_pk_bf16_f32 v112, v48, v49
v_add_f32 v42, v42, v14
v_mfma_f32_32x32x16_bf16 v[144:159], a[144:147], v[208:211], v[144:159]
v_exp_f32 v62, v174
v_cvt_pk_bf16_f32 v97, v4, v5
v_cvt_pk_bf16_f32 v113, v50, v51
v_exp_f32 v17, v143
v_mfma_f32_32x32x16_bf16 v[176:191], a[144:147], v[240:243], v[176:191]
v_add_f32 v43, v43, v60
v_cvt_pk_bf16_f32 v98, v6, v7
v_cvt_pk_bf16_f32 v114, v52, v53
v_add_f32 v42, v42, v15
v_exp_f32 v63, v175
v_mfma_f32_32x32x16_bf16 v[144:159], a[148:151], v[212:215], v[144:159]
v_cvt_pk_bf16_f32 v99, v8, v9
v_cvt_pk_bf16_f32 v115, v54, v55
v_add_f32 v43, v43, v61
v_add_f32 v42, v42, v16
v_cvt_pk_bf16_f32 v100, v10, v11
v_cvt_pk_bf16_f32 v116, v56, v57
v_mfma_f32_32x32x16_bf16 v[176:191], a[148:151], v[244:247], v[176:191]
buffer_load_dwordx4 v35, s[44:47], s54 offen offset:3072 lds
v_add_f32 v42, v42, v17
v_add_f32 v43, v43, v62
v_cvt_pk_bf16_f32 v101, v12, v13
v_cvt_pk_bf16_f32 v117, v58, v59
v_mfma_f32_32x32x16_bf16 v[144:159], a[152:155], v[216:219], v[144:159]
v_add_u32 v32, s52, v34
v_add_f32 v43, v43, v63
v_max_f32 v36, v42, v43
v_cmp_nle_f32 vcc, v36, v37
v_cvt_pk_bf16_f32 v102, v14, v15
v_cvt_pk_bf16_f32 v118, v60, v61
v_mfma_f32_32x32x16_bf16 v[176:191], a[152:155], v[248:251], v[176:191]
v_mfma_f32_32x32x16_bf16 v[144:159], a[156:159], v[220:223], v[144:159]
v_cvt_pk_bf16_f32 v103, v16, v17
v_mfma_f32_32x32x16_bf16 v[176:191], a[156:159], v[252:255], v[176:191]
v_cvt_pk_bf16_f32 v119, v62, v63
s_add_u32 s54, s54, 28672
s_cbranch_vccnz RS27
RR28:
s_sub_u32 s55, s55, 1
s_cbranch_scc0 AL23
AS24:
s_lshl_b32 s56, s64, 7
s_sub_u32 s56, s56, 32
s_cmp_eq_u32 s64, 0
s_cselect_b32 s56, 32, s56
s_cmp_eq_u32 s64, 0
s_cselect_b32 s55, 1, 2
s_cmp_le_i32 s55, 0
s_cbranch_scc1 AS30
s_sub_u32 s55, s55, 1
AL29:
s_add_u32 s56, s56, 32
s_waitcnt lgkmcnt(0)
v_mfma_f32_32x32x16_bf16 a[0:15], a[160:163], v[96:99], a[0:15]
s_waitcnt vmcnt(8)
s_barrier
v_mfma_f32_32x32x16_bf16 a[64:79], a[160:163], v[112:115], a[64:79]
ds_read_b128 a[128:131], v32
v_add_f32 v40, v40, v42
v_add_f32 v41, v41, v43
v_subrev_u32 v46, s56, v44
v_cmp_le_i32 s[92:93], 0, v46
v_cmp_le_i32 s[94:95], 1, v46
v_mfma_f32_32x32x16_bf16 a[16:31], a[164:167], v[96:99], a[16:31]
ds_read_b128 a[132:135], v32 offset:1024
v_exp_f32 v2, v144
v_cmp_le_i32 s[96:97], 2, v46
v_cmp_le_i32 s[98:99], 3, v46
v_cndmask_b32 v128, v47, v64, s[92:93]
v_mfma_f32_32x32x16_bf16 a[80:95], a[164:167], v[112:115], a[80:95]
ds_read_b128 a[136:139], v32 offset:2048
v_exp_f32 v48, v176
v_cndmask_b32 v129, v47, v64, s[94:95]
v_exp_f32 v3, v145
v_mfma_f32_32x32x16_bf16 a[32:47], a[168:171], v[96:99], a[32:47]
ds_read_b128 a[140:143], v32 offset:3072
v_cndmask_b32 v130, v47, v64, s[96:97]
v_cndmask_b32 v131, v47, v64, s[98:99]
v_exp_f32 v49, v177
v_cmp_le_i32 s[92:93], 8, v46
v_mfma_f32_32x32x16_bf16 a[96:111], a[168:171], v[112:115], a[96:111]
ds_read_b128 a[144:147], v32 offset:4096
s_add_u32 m0, s53, s57
v_cmp_le_i32 s[94:95], 9, v46
v_exp_f32 v4, v146
v_cmp_le_i32 s[96:97], 10, v46
v_mfma_f32_32x32x16_bf16 a[48:63], a[172:175], v[96:99], a[48:63]
buffer_load_dwordx4 v35, s[44:47], s54 offen lds
ds_read_b128 a[148:151], v32 offset:5120
v_cmp_le_i32 s[98:99], 11, v46
v_exp_f32 v50, v178
v_mfma_f32_32x32x16_bf16 a[112:127], a[172:175], v[112:115], a[112:127]
ds_read_b128 a[152:155], v32 offset:6144
v_cndmask_b32 v132, v47, v64, s[92:93]
v_cndmask_b32 v133, v47, v64, s[94:95]
v_exp_f32 v5, v147
v_cndmask_b32 v134, v47, v64, s[96:97]
v_mfma_f32_32x32x16_bf16 a[0:15], a[176:179], v[100:103], a[0:15]
ds_read_b128 a[156:159], v32 offset:7168
v_cndmask_b32 v135, v47, v64, s[98:99]
v_add_f32 v42, v2, v3
v_exp_f32 v51, v179
v_cmp_le_i32 s[92:93], 16, v46
v_mfma_f32_32x32x16_bf16 a[64:79], a[176:179], v[116:119], a[64:79]
v_cmp_le_i32 s[94:95], 17, v46
v_exp_f32 v6, v148
v_add_f32 v43, v48, v49
v_cmp_le_i32 s[96:97], 18, v46
v_cmp_le_i32 s[98:99], 19, v46
v_mfma_f32_32x32x16_bf16 a[16:31], a[180:183], v[100:103], a[16:31]
v_add_f32 v42, v42, v4
v_exp_f32 v52, v180
v_cndmask_b32 v136, v47, v64, s[92:93]
v_cndmask_b32 v137, v47, v64, s[94:95]
v_cndmask_b32 v138, v47, v64, s[96:97]
v_mfma_f32_32x32x16_bf16 a[80:95], a[180:183], v[116:119], a[80:95]
v_exp_f32 v7, v149
v_add_f32 v43, v43, v50
v_cndmask_b32 v139, v47, v64, s[98:99]
v_cmp_le_i32 s[92:93], 24, v46
v_add_f32 v42, v42, v5
v_mfma_f32_32x32x16_bf16 a[32:47], a[184:187], v[100:103], a[32:47]
v_exp_f32 v53, v181
v_cmp_le_i32 s[94:95], 25, v46
v_cmp_le_i32 s[96:97], 26, v46
v_exp_f32 v8, v150
v_mfma_f32_32x32x16_bf16 a[96:111], a[184:187], v[116:119], a[96:111]
v_add_f32 v43, v43, v51
v_cmp_le_i32 s[98:99], 27, v46
v_cndmask_b32 v140, v47, v64, s[92:93]
v_add_f32 v42, v42, v6
v_exp_f32 v54, v182
v_mfma_f32_32x32x16_bf16 a[48:63], a[188:191], v[100:103], a[48:63]
v_cndmask_b32 v141, v47, v64, s[94:95]
v_cndmask_b32 v142, v47, v64, s[96:97]
v_cndmask_b32 v143, v47, v64, s[98:99]
v_exp_f32 v9, v151
v_add_f32 v43, v43, v52
v_mfma_f32_32x32x16_bf16 a[112:127], a[188:191], v[116:119], a[112:127]
buffer_load_dwordx4 v35, s[44:47], s54 offen offset:1024 lds
v_add_f32 v42, v42, v7
v_exp_f32 v55, v183
s_waitcnt lgkmcnt(0)
v_mfma_f32_32x32x16_bf16 v[128:143], a[128:131], v[192:195], v[128:143]
v_exp_f32 v10, v152
v_add_f32 v43, v43, v53
v_add_f32 v42, v42, v8
v_exp_f32 v56, v184
v_mfma_f32_32x32x16_bf16 v[160:175], a[128:131], v[224:227], v[80:95]
ds_read_b128 a[160:163], v33 offset:24576
ds_read_b128 a[164:167], v33 offset:25600
v_exp_f32 v11, v153
v_add_f32 v43, v43, v54
v_add_f32 v42, v42, v9
v_mfma_f32_32x32x16_bf16 v[128:143], a[132:135], v[196:199], v[128:143]
ds_read_b128 a[168:171], v33 offset:26624
v_exp_f32 v57, v185
v_add_f32 v43, v43, v55
v_exp_f32 v12, v154
v_mfma_f32_32x32x16_bf16 v[160:175], a[132:135], v[228:231], v[160:175]
ds_read_b128 a[172:175], v33 offset:27648
v_add_f32 v42, v42, v10
v_exp_f32 v58, v186
v_exp_f32 v13, v155
v_mfma_f32_32x32x16_bf16 v[128:143], a[136:139], v[200:203], v[128:143]
ds_read_b128 a[176:179], v33 offset:28672
ds_read_b128 a[180:183], v33 offset:29696
v_add_f32 v43, v43, v56
v_add_f32 v42, v42, v11
v_exp_f32 v59, v187
v_mfma_f32_32x32x16_bf16 v[160:175], a[136:139], v[232:235], v[160:175]
buffer_load_dwordx4 v35, s[44:47], s54 offen offset:2048 lds
ds_read_b128 a[184:187], v33 offset:30720
v_add_f32 v43, v43, v57
v_exp_f32 v14, v156
v_mfma_f32_32x32x16_bf16 v[128:143], a[140:143], v[204:207], v[128:143]
v_add_f32 v42, v42, v12
v_exp_f32 v60, v188
v_exp_f32 v15, v157
v_add_f32 v43, v43, v58
v_mfma_f32_32x32x16_bf16 v[160:175], a[140:143], v[236:239], v[160:175]
ds_read_b128 a[188:191], v33 offset:31744
v_add_f32 v42, v42, v13
v_exp_f32 v61, v189
v_add_f32 v43, v43, v59
v_cvt_pk_bf16_f32 v104, v2, v3
v_mfma_f32_32x32x16_bf16 v[128:143], a[144:147], v[208:211], v[128:143]
v_exp_f32 v16, v158
v_cvt_pk_bf16_f32 v120, v48, v49
v_add_f32 v42, v42, v14
v_exp_f32 v62, v190
v_mfma_f32_32x32x16_bf16 v[160:175], a[144:147], v[240:243], v[160:175]
v_cvt_pk_bf16_f32 v105, v4, v5
v_cvt_pk_bf16_f32 v121, v50, v51
v_exp_f32 v17, v159
v_add_f32 v43, v43, v60
v_cvt_pk_bf16_f32 v106, v6, v7
v_mfma_f32_32x32x16_bf16 v[128:143], a[148:151], v[212:215], v[128:143]
v_cvt_pk_bf16_f32 v122, v52, v53
v_add_f32 v42, v42, v15
v_exp_f32 v63, v191
v_cvt_pk_bf16_f32 v107, v8, v9
v_cvt_pk_bf16_f32 v123, v54, v55
v_mfma_f32_32x32x16_bf16 v[160:175], a[148:151], v[244:247], v[160:175]
v_add_f32 v43, v43, v61
v_add_f32 v42, v42, v16
v_cvt_pk_bf16_f32 v108, v10, v11
v_cvt_pk_bf16_f32 v124, v56, v57
v_add_f32 v42, v42, v17
v_add_f32 v43, v43, v62
v_mfma_f32_32x32x16_bf16 v[128:143], a[152:155], v[216:219], v[128:143]
buffer_load_dwordx4 v35, s[44:47], s54 offen offset:3072 lds
v_cvt_pk_bf16_f32 v109, v12, v13
v_cvt_pk_bf16_f32 v125, v58, v59
v_add_f32 v43, v43, v63
v_max_f32 v36, v42, v43
v_mfma_f32_32x32x16_bf16 v[160:175], a[152:155], v[248:251], v[160:175]
v_cmp_nle_f32 vcc, v36, v37
v_cvt_pk_bf16_f32 v110, v14, v15
v_cvt_pk_bf16_f32 v126, v60, v61
v_mfma_f32_32x32x16_bf16 v[128:143], a[156:159], v[220:223], v[128:143]
v_cvt_pk_bf16_f32 v111, v16, v17
v_mfma_f32_32x32x16_bf16 v[160:175], a[156:159], v[252:255], v[160:175]
v_cvt_pk_bf16_f32 v127, v62, v63
s_add_u32 s54, s54, 4096
s_cbranch_vccnz RS31
RR32:
s_add_u32 s56, s56, 32
s_waitcnt lgkmcnt(0)
v_mfma_f32_32x32x16_bf16 a[0:15], a[160:163], v[104:107], a[0:15]
ds_read_b128 a[128:131], v32 offset:8192
v_add_f32 v40, v40, v42
v_add_f32 v41, v41, v43
v_subrev_u32 v46, s56, v44
s_add_u32 s52, s52, 32768
s_and_b32 s52, s52, 131071
v_mfma_f32_32x32x16_bf16 a[64:79], a[160:163], v[120:123], a[64:79]
ds_read_b128 a[132:135], v32 offset:9216
s_xor_b32 s53, s52, 65536
v_mov_b32 v33, v32
v_cmp_le_i32 s[92:93], 0, v46
v_cmp_le_i32 s[94:95], 1, v46
v_cmp_le_i32 s[96:97], 2, v46
v_mfma_f32_32x32x16_bf16 a[16:31], a[164:167], v[104:107], a[16:31]
ds_read_b128 a[136:139], v32 offset:10240
v_cmp_le_i32 s[98:99], 3, v46
v_exp_f32 v2, v128
v_cndmask_b32 v144, v47, v64, s[92:93]
v_cndmask_b32 v145, v47, v64, s[94:95]
v_mfma_f32_32x32x16_bf16 a[80:95], a[164:167], v[120:123], a[80:95]
ds_read_b128 a[140:143], v32 offset:11264
v_exp_f32 v48, v160
v_cndmask_b32 v146, v47, v64, s[96:97]
v_cndmask_b32 v147, v47, v64, s[98:99]
v_cmp_le_i32 s[92:93], 8, v46
v_mfma_f32_32x32x16_bf16 a[32:47], a[168:171], v[104:107], a[32:47]
ds_read_b128 a[144:147], v32 offset:12288
v_exp_f32 v3, v129
v_cmp_le_i32 s[94:95], 9, v46
v_exp_f32 v49, v161
v_mfma_f32_32x32x16_bf16 a[96:111], a[168:171], v[120:123], a[96:111]
ds_read_b128 a[148:151], v32 offset:13312
s_add_u32 m0, m0, 4096
v_cmp_le_i32 s[96:97], 10, v46
v_cmp_le_i32 s[98:99], 11, v46
v_exp_f32 v4, v130
v_mfma_f32_32x32x16_bf16 a[48:63], a[172:175], v[104:107], a[48:63]
buffer_load_dwordx4 v35, s[44:47], s54 offen lds
ds_read_b128 a[152:155], v32 offset:14336
v_cndmask_b32 v148, v47, v64, s[92:93]
v_cndmask_b32 v149, v47, v64, s[94:95]
v_cndmask_b32 v150, v47, v64, s[96:97]
v_mfma_f32_32x32x16_bf16 a[112:127], a[172:175], v[120:123], a[112:127]
ds_read_b128 a[156:159], v32 offset:15360
v_exp_f32 v50, v162
v_cndmask_b32 v151, v47, v64, s[98:99]
v_exp_f32 v5, v131
v_mfma_f32_32x32x16_bf16 a[0:15], a[176:179], v[108:111], a[0:15]
v_cmp_le_i32 s[92:93], 16, v46
v_cmp_le_i32 s[94:95], 17, v46
v_add_f32 v42, v2, v3
v_exp_f32 v51, v163
v_cmp_le_i32 s[96:97], 18, v46
v_mfma_f32_32x32x16_bf16 a[64:79], a[176:179], v[124:127], a[64:79]
v_exp_f32 v6, v132
v_add_f32 v43, v48, v49
v_cmp_le_i32 s[98:99], 19, v46
v_cndmask_b32 v152, v47, v64, s[92:93]
v_add_f32 v42, v42, v4
v_mfma_f32_32x32x16_bf16 a[16:31], a[180:183], v[108:111], a[16:31]
v_exp_f32 v52, v164
v_cndmask_b32 v153, v47, v64, s[94:95]
v_cndmask_b32 v154, v47, v64, s[96:97]
v_exp_f32 v7, v133
v_mfma_f32_32x32x16_bf16 a[80:95], a[180:183], v[124:127], a[80:95]
v_add_f32 v43, v43, v50
v_cndmask_b32 v155, v47, v64, s[98:99]
v_cmp_le_i32 s[92:93], 24, v46
v_add_f32 v42, v42, v5
v_exp_f32 v53, v165
v_mfma_f32_32x32x16_bf16 a[32:47], a[184:187], v[108:111], a[32:47]
v_cmp_le_i32 s[94:95], 25, v46
v_cmp_le_i32 s[96:97], 26, v46
v_exp_f32 v8, v134
v_add_f32 v43, v43, v51
v_cmp_le_i32 s[98:99], 27, v46
v_mfma_f32_32x32x16_bf16 a[96:111], a[184:187], v[124:127], a[96:111]
v_cndmask_b32 v156, v47, v64, s[92:93]
v_add_f32 v42, v42, v6
v_exp_f32 v54, v166
v_cndmask_b32 v157, v47, v64, s[94:95]
v_cndmask_b32 v158, v47, v64, s[96:97]
v_mfma_f32_32x32x16_bf16 a[48:63], a[188:191], v[108:111], a[48:63]
buffer_load_dwordx4 v35, s[44:47], s54 offen offset:1024 lds
v_cndmask_b32 v159, v47, v64, s[98:99]
v_exp_f32 v9, v135
v_add_f32 v43, v43, v52
v_mfma_f32_32x32x16_bf16 a[112:127], a[188:191], v[124:127], a[112:127]
v_add_f32 v42, v42, v7
v_exp_f32 v55, v167
v_exp_f32 v10, v136
s_waitcnt lgkmcnt(0)
v_mfma_f32_32x32x16_bf16 v[144:159], a[128:131], v[192:195], v[144:159]
ds_read_b128 a[160:163], v32 offset:16384
ds_read_b128 a[164:167], v32 offset:17408
v_add_f32 v43, v43, v53
v_add_f32 v42, v42, v8
v_exp_f32 v56, v168
v_mfma_f32_32x32x16_bf16 v[176:191], a[128:131], v[224:227], v[80:95]
v_exp_f32 v11, v137
v_add_f32 v43, v43, v54
v_add_f32 v42, v42, v9
v_exp_f32 v57, v169
v_mfma_f32_32x32x16_bf16 v[144:159], a[132:135], v[196:199], v[144:159]
ds_read_b128 a[168:171], v32 offset:18432
ds_read_b128 a[172:175], v32 offset:19456
v_add_f32 v43, v43, v55
v_exp_f32 v12, v138
v_add_f32 v42, v42, v10
v_mfma_f32_32x32x16_bf16 v[176:191], a[132:135], v[228:231], v[176:191]
ds_read_b128 a[176:179], v32 offset:20480
v_exp_f32 v58, v170
v_exp_f32 v13, v139
v_add_f32 v43, v43, v56
v_mfma_f32_32x32x16_bf16 v[144:159], a[136:139], v[200:203], v[144:159]
ds_read_b128 a[180:183], v32 offset:21504
buffer_load_dwordx4 v35, s[44:47], s54 offen offset:2048 lds
v_add_f32 v42, v42, v11
v_exp_f32 v59, v171
v_mfma_f32_32x32x16_bf16 v[176:191], a[136:139], v[232:235], v[176:191]
ds_read_b128 a[184:187], v32 offset:22528
ds_read_b128 a[188:191], v32 offset:23552
v_add_f32 v43, v43, v57
v_exp_f32 v14, v140
v_add_f32 v42, v42, v12
v_mfma_f32_32x32x16_bf16 v[144:159], a[140:143], v[204:207], v[144:159]
v_exp_f32 v60, v172
v_exp_f32 v15, v141
v_add_f32 v43, v43, v58
v_add_f32 v42, v42, v13
v_mfma_f32_32x32x16_bf16 v[176:191], a[140:143], v[236:239], v[176:191]
v_exp_f32 v61, v173
v_add_f32 v43, v43, v59
v_exp_f32 v16, v142
v_cvt_pk_bf16_f32 v96, v2, v3
v_mfma_f32_32x32x16_bf16 v[144:159], a[144:147], v[208:211], v[144:159]
v_cvt_pk_bf16_f32 v112, v48, v49
v_add_f32 v42, v42, v14
v_exp_f32 v62, v174
v_cvt_pk_bf16_f32 v97, v4, v5
v_cvt_pk_bf16_f32 v113, v50, v51
v_mfma_f32_32x32x16_bf16 v[176:191], a[144:147], v[240:243], v[176:191]
v_exp_f32 v17, v143
v_add_f32 v43, v43, v60
v_cvt_pk_bf16_f32 v98, v6, v7
v_cvt_pk_bf16_f32 v114, v52, v53
v_add_f32 v42, v42, v15
v_mfma_f32_32x32x16_bf16 v[144:159], a[148:151], v[212:215], v[144:159]
v_exp_f32 v63, v175
v_cvt_pk_bf16_f32 v99, v8, v9
v_cvt_pk_bf16_f32 v115, v54, v55
v_add_f32 v43, v43, v61
v_add_f32 v42, v42, v16
v_mfma_f32_32x32x16_bf16 v[176:191], a[148:151], v[244:247], v[176:191]
v_cvt_pk_bf16_f32 v100, v10, v11
v_cvt_pk_bf16_f32 v116, v56, v57
v_add_f32 v42, v42, v17
v_add_f32 v43, v43, v62
v_cvt_pk_bf16_f32 v101, v12, v13
v_cvt_pk_bf16_f32 v117, v58, v59
v_mfma_f32_32x32x16_bf16 v[144:159], a[152:155], v[216:219], v[144:159]
buffer_load_dwordx4 v35, s[44:47], s54 offen offset:3072 lds
v_add_u32 v32, s52, v34
v_add_f32 v43, v43, v63
v_max_f32 v36, v42, v43
v_cmp_nle_f32 vcc, v36, v37
v_mfma_f32_32x32x16_bf16 v[176:191], a[152:155], v[248:251], v[176:191]
v_cvt_pk_bf16_f32 v102, v14, v15
v_cvt_pk_bf16_f32 v118, v60, v61
v_mfma_f32_32x32x16_bf16 v[144:159], a[156:159], v[220:223], v[144:159]
v_cvt_pk_bf16_f32 v103, v16, v17
v_mfma_f32_32x32x16_bf16 v[176:191], a[156:159], v[252:255], v[176:191]
v_cvt_pk_bf16_f32 v119, v62, v63
s_add_u32 s54, s54, 28672
s_cbranch_vccnz RS33
RR34:
s_sub_u32 s55, s55, 1
s_cbranch_scc0 AL29
AS30:
s_cmp_eq_u32 s89, 0
s_cbranch_scc1 NP35
s_lshl_b32 s91, s60, 2
s_add_u32 s91, s91, s61
s_lshl_b32 s91, s91, 4
s_add_u32 s91, s91, 2310144
v_lshlrev_b32 v27, 2, v0
s_mov_b32 exec_lo, 15
s_mov_b32 exec_hi, 0
buffer_load_dword v26, v27, s[48:51], s91 offen sc1
s_mov_b64 exec, -1
NP35:
s_add_u32 s56, s56, 32
s_waitcnt lgkmcnt(0)
v_mfma_f32_32x32x16_bf16 a[0:15], a[160:163], v[96:99], a[0:15]
s_waitcnt vmcnt(8)
s_barrier
v_mfma_f32_32x32x16_bf16 a[64:79], a[160:163], v[112:115], a[64:79]
ds_read_b128 a[128:131], v32
v_add_f32 v40, v40, v42
v_add_f32 v41, v41, v43
v_subrev_u32 v46, s56, v45
v_cmp_le_i32 s[92:93], 0, v46
v_cmp_le_i32 s[94:95], 1, v46
v_mfma_f32_32x32x16_bf16 a[16:31], a[164:167], v[96:99], a[16:31]
ds_read_b128 a[132:135], v32 offset:1024
v_exp_f32 v2, v144
v_cmp_le_i32 s[96:97], 2, v46
v_exp_f32 v48, v176
v_mfma_f32_32x32x16_bf16 a[80:95], a[164:167], v[112:115], a[80:95]
ds_read_b128 a[136:139], v32 offset:2048
v_cmp_le_i32 s[98:99], 3, v46
v_cndmask_b32 v160, v47, v80, s[92:93]
s_add_u32 m0, s53, s57
v_exp_f32 v3, v145
v_mfma_f32_32x32x16_bf16 a[32:47], a[168:171], v[96:99], a[32:47]
ds_read_b128 a[140:143], v32 offset:3072
v_cndmask_b32 v161, v47, v80, s[94:95]
v_exp_f32 v49, v177
v_cndmask_b32 v162, v47, v80, s[96:97]
v_cndmask_b32 v163, v47, v80, s[98:99]
v_mfma_f32_32x32x16_bf16 a[96:111], a[168:171], v[112:115], a[96:111]
buffer_load_dwordx4 v35, s[44:47], s54 offen lds
v_exp_f32 v4, v146
v_cmp_le_i32 s[92:93], 8, v46
v_cmp_le_i32 s[94:95], 9, v46
v_mfma_f32_32x32x16_bf16 a[48:63], a[172:175], v[96:99], a[48:63]
ds_read_b128 a[144:147], v32 offset:4096
v_exp_f32 v50, v178
v_cmp_le_i32 s[96:97], 10, v46
v_exp_f32 v5, v147
v_mfma_f32_32x32x16_bf16 a[112:127], a[172:175], v[112:115], a[112:127]
ds_read_b128 a[148:151], v32 offset:5120
v_cmp_le_i32 s[98:99], 11, v46
v_add_f32 v42, v2, v3
v_exp_f32 v51, v179
v_cndmask_b32 v164, v47, v80, s[92:93]
v_mfma_f32_32x32x16_bf16 a[0:15], a[176:179], v[100:103], a[0:15]
ds_read_b128 a[152:155], v32 offset:6144
v_cndmask_b32 v165, v47, v80, s[94:95]
v_exp_f32 v6, v148
v_add_f32 v43, v48, v49
v_cndmask_b32 v166, v47, v80, s[96:97]
v_mfma_f32_32x32x16_bf16 a[64:79], a[176:179], v[116:119], a[64:79]
ds_read_b128 a[156:159], v32 offset:7168
v_add_f32 v42, v42, v4
v_exp_f32 v52, v180
v_cndmask_b32 v167, v47, v80, s[98:99]
v_cmp_le_i32 s[92:93], 16, v46
v_mfma_f32_32x32x16_bf16 a[16:31], a[180:183], v[100:103], a[16:31]
v_exp_f32 v7, v149
v_add_f32 v43, v43, v50
v_cmp_le_i32 s[94:95], 17, v46
v_add_f32 v42, v42, v5
v_cmp_le_i32 s[96:97], 18, v46
v_mfma_f32_32x32x16_bf16 a[80:95], a[180:183], v[116:119], a[80:95]
v_exp_f32 v53, v181
v_add_f32 v43, v43, v51
v_exp_f32 v8, v150
v_cmp_le_i32 s[98:99], 19, v46
v_mfma_f32_32x32x16_bf16 a[32:47], a[184:187], v[100:103], a[32:47]
v_cndmask_b32 v168, v47, v80, s[92:93]
v_add_f32 v42, v42, v6
v_exp_f32 v54, v182
v_cndmask_b32 v169, v47, v80, s[94:95]
v_cndmask_b32 v170, v47, v80, s[96:97]
v_mfma_f32_32x32x16_bf16 a[96:111], a[184:187], v[116:119], a[96:111]
buffer_load_dwordx4 v35, s[44:47], s54 offen offset:1024 lds
v_exp_f32 v9, v151
v_add_f32 v43, v43, v52
v_cndmask_b32 v171, v47, v80, s[98:99]
v_mfma_f32_32x32x16_bf16 a[48:63], a[188:191], v[100:103], a[48:63]
v_cmp_le_i32 s[92:93], 24, v46
v_cmp_le_i32 s[94:95], 25, v46
v_cmp_le_i32 s[96:97], 26, v46
v_cmp_le_i32 s[98:99], 27, v46
v_cndmask_b32 v172, v47, v80, s[92:93]
v_cndmask_b32 v173, v47, v80, s[94:95]
v_cndmask_b32 v174, v47, v80, s[96:97]
v_cndmask_b32 v175, v47, v80, s[98:99]
v_mfma_f32_32x32x16_bf16 a[112:127], a[188:191], v[116:119], a[112:127]
v_add_f32 v42, v42, v7
v_exp_f32 v55, v183
v_exp_f32 v10, v152
s_waitcnt lgkmcnt(0)
v_mfma_f32_32x32x16_bf16 v[160:175], a[128:131], v[224:227], v[160:175]
v_add_f32 v43, v43, v53
v_add_f32 v42, v42, v8
v_exp_f32 v56, v184
v_exp_f32 v11, v153
v_mfma_f32_32x32x16_bf16 v[160:175], a[132:135], v[228:231], v[160:175]
v_add_f32 v43, v43, v54
v_add_f32 v42, v42, v9
v_exp_f32 v57, v185
v_exp_f32 v12, v154
v_mfma_f32_32x32x16_bf16 v[160:175], a[136:139], v[232:235], v[160:175]
ds_read_b128 a[160:163], v33 offset:24576
v_add_f32 v43, v43, v55
v_add_f32 v42, v42, v10
v_exp_f32 v58, v186
v_add_f32 v43, v43, v56
v_mfma_f32_32x32x16_bf16 v[160:175], a[140:143], v[236:239], v[160:175]
v_exp_f32 v13, v155
v_add_f32 v42, v42, v11
v_exp_f32 v59, v187
v_cvt_pk_bf16_f32 v104, v2, v3
v_mfma_f32_32x32x16_bf16 v[160:175], a[144:147], v[240:243], v[160:175]
buffer_load_dwordx4 v35, s[44:47], s54 offen offset:2048 lds
v_exp_f32 v14, v156
v_add_f32 v43, v43, v57
v_add_f32 v42, v42, v12
v_mfma_f32_32x32x16_bf16 v[160:175], a[148:151], v[244:247], v[160:175]
v_exp_f32 v60, v188
v_exp_f32 v15, v157
v_add_f32 v43, v43, v58
v_cvt_pk_bf16_f32 v120, v48, v49
v_mfma_f32_32x32x16_bf16 v[160:175], a[152:155], v[248:251], v[160:175]
ds_read_b128 a[164:167], v33 offset:25600
ds_read_b128 a[168:171], v33 offset:26624
ds_read_b128 a[172:175], v33 offset:27648
ds_read_b128 a[176:179], v33 offset:28672
ds_read_b128 a[180:183], v33 offset:29696
ds_read_b128 a[184:187], v33 offset:30720
ds_read_b128 a[188:191], v33 offset:31744
v_add_f32 v42, v42, v13
v_exp_f32 v61, v189
v_exp_f32 v16, v158
v_add_f32 v43, v43, v59
v_add_f32 v42, v42, v14
v_exp_f32 v62, v190
v_exp_f32 v17, v159
v_add_f32 v43, v43, v60
v_add_f32 v42, v42, v15
v_exp_f32 v63, v191
v_add_f32 v42, v42, v16
v_add_f32 v43, v43, v61
v_add_f32 v42, v42, v17
v_add_f32 v43, v43, v62
v_add_f32 v43, v43, v63
v_max_f32 v36, v42, v43
v_cmp_nle_f32 vcc, v36, v37
v_mfma_f32_32x32x16_bf16 v[160:175], a[156:159], v[252:255], v[160:175]
buffer_load_dwordx4 v35, s[44:47], s54 offen offset:3072 lds
v_cvt_pk_bf16_f32 v105, v4, v5
v_cvt_pk_bf16_f32 v121, v50, v51
v_cvt_pk_bf16_f32 v106, v6, v7
v_cvt_pk_bf16_f32 v122, v52, v53
v_cvt_pk_bf16_f32 v107, v8, v9
v_cvt_pk_bf16_f32 v123, v54, v55
v_cvt_pk_bf16_f32 v108, v10, v11
v_cvt_pk_bf16_f32 v124, v56, v57
v_cvt_pk_bf16_f32 v109, v12, v13
v_cvt_pk_bf16_f32 v125, v58, v59
v_cvt_pk_bf16_f32 v110, v14, v15
v_cvt_pk_bf16_f32 v126, v60, v61
v_cvt_pk_bf16_f32 v111, v16, v17
v_cvt_pk_bf16_f32 v127, v62, v63
s_add_u32 s54, s54, 4096
s_cbranch_vccnz RS36
RR37:
s_add_u32 s56, s56, 32
s_waitcnt lgkmcnt(0)
v_mfma_f32_32x32x16_bf16 a[0:15], a[160:163], v[104:107], a[0:15]
ds_read_b128 a[128:131], v32 offset:8192
v_add_f32 v40, v40, v42
v_add_f32 v41, v41, v43
v_subrev_u32 v46, s56, v45
s_add_u32 s52, s52, 32768
s_and_b32 s52, s52, 131071
v_mfma_f32_32x32x16_bf16 a[64:79], a[160:163], v[120:123], a[64:79]
ds_read_b128 a[132:135], v32 offset:9216
s_xor_b32 s53, s52, 65536
v_mov_b32 v33, v32
v_cmp_le_i32 s[92:93], 0, v46
v_cmp_le_i32 s[94:95], 1, v46
v_cmp_le_i32 s[96:97], 2, v46
v_mfma_f32_32x32x16_bf16 a[16:31], a[164:167], v[104:107], a[16:31]
ds_read_b128 a[136:139], v32 offset:10240
v_cmp_le_i32 s[98:99], 3, v46
v_exp_f32 v48, v160
v_cndmask_b32 v176, v47, v80, s[92:93]
v_cndmask_b32 v177, v47, v80, s[94:95]
v_mfma_f32_32x32x16_bf16 a[80:95], a[164:167], v[120:123], a[80:95]
ds_read_b128 a[140:143], v32 offset:11264
v_cndmask_b32 v178, v47, v80, s[96:97]
s_add_u32 m0, m0, 4096
v_exp_f32 v49, v161
v_cndmask_b32 v179, v47, v80, s[98:99]
v_mfma_f32_32x32x16_bf16 a[32:47], a[168:171], v[104:107], a[32:47]
ds_read_b128 a[144:147], v32 offset:12288
v_cmp_le_i32 s[92:93], 8, v46
v_cmp_le_i32 s[94:95], 9, v46
v_exp_f32 v50, v162
v_cmp_le_i32 s[96:97], 10, v46
v_mfma_f32_32x32x16_bf16 a[96:111], a[168:171], v[120:123], a[96:111]
buffer_load_dwordx4 v35, s[44:47], s54 offen lds
ds_read_b128 a[148:151], v32 offset:13312
v_cmp_le_i32 s[98:99], 11, v46
v_exp_f32 v51, v163
v_mfma_f32_32x32x16_bf16 a[48:63], a[172:175], v[104:107], a[48:63]
ds_read_b128 a[152:155], v32 offset:14336
v_cndmask_b32 v180, v47, v80, s[92:93]
v_cndmask_b32 v181, v47, v80, s[94:95]
v_add_f32 v43, v48, v49
v_cndmask_b32 v182, v47, v80, s[96:97]
v_cndmask_b32 v183, v47, v80, s[98:99]
v_mfma_f32_32x32x16_bf16 a[112:127], a[172:175], v[120:123], a[112:127]
ds_read_b128 a[156:159], v32 offset:15360
v_exp_f32 v52, v164
v_add_f32 v43, v43, v50
v_cmp_le_i32 s[92:93], 16, v46
v_cmp_le_i32 s[94:95], 17, v46
v_mfma_f32_32x32x16_bf16 a[0:15], a[176:179], v[108:111], a[0:15]
v_exp_f32 v53, v165
v_cmp_le_i32 s[96:97], 18, v46
v_add_f32 v43, v43, v51
v_cmp_le_i32 s[98:99], 19, v46
v_cndmask_b32 v184, v47, v80, s[92:93]
v_mfma_f32_32x32x16_bf16 a[64:79], a[176:179], v[124:127], a[64:79]
v_exp_f32 v54, v166
v_cndmask_b32 v185, v47, v80, s[94:95]
v_add_f32 v43, v43, v52
v_cndmask_b32 v186, v47, v80, s[96:97]
v_cndmask_b32 v187, v47, v80, s[98:99]
v_mfma_f32_32x32x16_bf16 a[16:31], a[180:183], v[108:111], a[16:31]
buffer_load_dwordx4 v35, s[44:47], s54 offen offset:1024 lds
v_exp_f32 v55, v167
v_add_f32 v43, v43, v53
v_cmp_le_i32 s[92:93], 24, v46
v_mfma_f32_32x32x16_bf16 a[80:95], a[180:183], v[124:127], a[80:95]
v_cmp_le_i32 s[94:95], 25, v46
v_exp_f32 v56, v168
v_cmp_le_i32 s[96:97], 26, v46
v_add_f32 v43, v43, v54
v_cmp_le_i32 s[98:99], 27, v46
v_mfma_f32_32x32x16_bf16 a[32:47], a[184:187], v[108:111], a[32:47]
v_exp_f32 v57, v169
v_cndmask_b32 v188, v47, v80, s[92:93]
v_cndmask_b32 v189, v47, v80, s[94:95]
v_add_f32 v43, v43, v55
v_cndmask_b32 v190, v47, v80, s[96:97]
v_mfma_f32_32x32x16_bf16 a[96:111], a[184:187], v[124:127], a[96:111]
v_exp_f32 v58, v170
v_cndmask_b32 v191, v47, v80, s[98:99]
v_add_f32 v43, v43, v56
v_exp_f32 v59, v171
v_mfma_f32_32x32x16_bf16 a[48:63], a[188:191], v[108:111], a[48:63]
buffer_load_dwordx4 v35, s[44:47], s54 offen offset:2048 lds
v_add_f32 v43, v43, v57
v_exp_f32 v60, v172
v_add_f32 v43, v43, v58
v_mfma_f32_32x32x16_bf16 a[112:127], a[188:191], v[124:127], a[112:127]
v_exp_f32 v61, v173
v_cvt_pk_bf16_f32 v112, v48, v49
v_add_f32 v43, v43, v59
s_waitcnt lgkmcnt(0)
v_mfma_f32_32x32x16_bf16 v[176:191], a[128:131], v[224:227], v[176:191]
ds_read_b128 a[160:163], v32 offset:16384
ds_read_b128 a[164:167], v32 offset:17408
v_cvt_pk_bf16_f32 v113, v50, v51
v_exp_f32 v62, v174
v_mfma_f32_32x32x16_bf16 v[176:191], a[132:135], v[228:231], v[176:191]
ds_read_b128 a[168:171], v32 offset:18432
ds_read_b128 a[172:175], v32 offset:19456
v_cvt_pk_bf16_f32 v114, v52, v53
v_add_f32 v43, v43, v60
v_exp_f32 v63, v175
v_mfma_f32_32x32x16_bf16 v[176:191], a[136:139], v[232:235], v[176:191]
ds_read_b128 a[176:179], v32 offset:20480
v_cvt_pk_bf16_f32 v115, v54, v55
v_add_f32 v43, v43, v61
v_cvt_pk_bf16_f32 v116, v56, v57
v_add_f32 v43, v43, v62
v_mfma_f32_32x32x16_bf16 v[176:191], a[140:143], v[236:239], v[176:191]
ds_read_b128 a[180:183], v32 offset:21504
v_cvt_pk_bf16_f32 v117, v58, v59
v_add_f32 v43, v43, v63
v_mfma_f32_32x32x16_bf16 v[176:191], a[144:147], v[240:243], v[176:191]
buffer_load_dwordx4 v35, s[44:47], s54 offen offset:3072 lds
ds_read_b128 a[184:187], v32 offset:22528
v_cmp_nle_f32 vcc, v43, v37
v_cvt_pk_bf16_f32 v118, v60, v61
v_mfma_f32_32x32x16_bf16 v[176:191], a[148:151], v[244:247], v[176:191]
ds_read_b128 a[188:191], v32 offset:23552
v_add_u32 v32, s52, v34
v_mfma_f32_32x32x16_bf16 v[176:191], a[152:155], v[248:251], v[176:191]
v_cvt_pk_bf16_f32 v119, v62, v63
v_mfma_f32_32x32x16_bf16 v[176:191], a[156:159], v[252:255], v[176:191]
s_add_u32 s54, s54, 28672
s_cbranch_vccnz RS38
RR39:
s_cmp_eq_u32 s89, 0
s_cbranch_scc1 NF40
s_waitcnt vmcnt(8)
s_mov_b32 exec_lo, 15
s_mov_b32 exec_hi, 0
v_cmp_gt_u32 vcc, 1, v26
s_mov_b64 exec, -1
s_cbranch_vccz YK42
s_lshl_b32 s91, s60, 2
s_add_u32 s91, s91, s61
s_lshl_b32 s91, s91, 4
s_add_u32 s91, s91, 2310144
v_lshlrev_b32 v105, 2, v0
s_mov_b32 s90, 200000
s_mov_b32 exec_lo, 0xf
s_mov_b32 exec_hi, 0
PL43:
buffer_load_dword v104, v105, s[48:51], s91 offen sc1
s_waitcnt vmcnt(0)
v_cmp_gt_u32 vcc, 1, v104
s_cbranch_vccz PD44
s_sub_u32 s90, s90, 1
s_cbranch_scc1 PD44
s_sleep 1
s_branch PL43
PD44:
s_mov_b64 exec, -1
YK42:
s_lshl_b32 s90, s60, 2
s_add_u32 s90, s90, s61
s_lshl_b32 s90, s90, 15
s_lshl_b32 s91, s34, 11
s_add_u32 s90, s90, s91
s_add_u32 s90, s90, 75497472
v_lshlrev_b32 v104, 4, v0
buffer_load_dwordx4 v[192:195], v104, s[48:51], s90 offen
buffer_load_dwordx4 v[196:199], v104, s[48:51], s90 offen offset:1024
s_add_u32 s90, s90, 8192
buffer_load_dwordx4 v[200:203], v104, s[48:51], s90 offen
buffer_load_dwordx4 v[204:207], v104, s[48:51], s90 offen offset:1024
s_add_u32 s90, s90, 8192
buffer_load_dwordx4 v[208:211], v104, s[48:51], s90 offen
buffer_load_dwordx4 v[212:215], v104, s[48:51], s90 offen offset:1024
s_add_u32 s90, s90, 8192
buffer_load_dwordx4 v[216:219], v104, s[48:51], s90 offen
buffer_load_dwordx4 v[220:223], v104, s[48:51], s90 offen offset:1024
s_mov_b32 s68, s20
s_mov_b32 s69, s21
s_mov_b32 s70, 3584
s_mov_b32 s71, 0x20000
s_lshl_b32 s90, s62, 8
s_lshr_b32 s91, s61, 1
s_lshl_b32 s91, s91, 7
s_add_u32 s90, s90, s91
s_lshr_b32 s91, s34, 1
s_lshl_b32 s91, s91, 6
s_add_u32 s90, s90, s91
v_lshrrev_b32 v105, 5, v0
v_lshlrev_b32 v105, 3, v105
buffer_load_dwordx2 v[64:65], v105, s[68:71], s90 offen
buffer_load_dwordx2 v[66:67], v105, s[68:71], s90 offen offset:16
buffer_load_dwordx2 v[68:69], v105, s[68:71], s90 offen offset:32
buffer_load_dwordx2 v[70:71], v105, s[68:71], s90 offen offset:48
s_lshl_b32 s90, s63, 2
s_and_b32 s91, s61, 1
s_lshl_b32 s91, s91, 1
s_add_u32 s90, s90, s91
s_and_b32 s91, s34, 1
s_add_u32 s90, s90, s91
s_mul_i32 s90, s90, 112
s_lshl_b32 s91, s62, 3
s_add_u32 s90, s90, s91
s_lshr_b32 s91, s61, 1
s_lshl_b32 s91, s91, 2
s_add_u32 s90, s90, s91
s_lshr_b32 s91, s34, 1
s_lshl_b32 s91, s91, 1
s_add_u32 s90, s90, s91
s_lshl_b32 s90, s90, 10
s_add_u32 s90, s90, 4194304
v_mov_b32 v106, 0xc0135761
v_mov_b32 v107, 0xbdd2d3e8
s_mov_b32 s87, s90
s_lshl_b32 s66, s64, 2
s_add_u32 s66, s66, s34
s_lshl_b32 s66, s66, 18
s_lshl_b32 s68, s65, 13
s_add_u32 s66, s66, s68
s_add_u32 s66, s66, 41943040
s_sub_u32 s67, 15, s64
s_lshl_b32 s67, s67, 2
s_add_u32 s67, s67, s34
s_lshl_b32 s67, s67, 18
s_add_u32 s67, s67, s68
s_add_u32 s67, s67, 41943040
v_mov_b32 v20, v40
v_mov_b32 v21, v40
s_nop 1
v_permlane32_swap_b32 v20, v21
s_nop 1
v_add_f32 v20, v20, v21
v_rcp_f32 v20, v20
s_nop 0
v_mul_f32 v18, v20, v38
v_accvgpr_read_b32 v128, a0
v_accvgpr_read_b32 v129, a1
v_accvgpr_read_b32 v130, a2
v_accvgpr_read_b32 v131, a3
v_accvgpr_read_b32 v132, a4
v_accvgpr_read_b32 v133, a5
v_accvgpr_read_b32 v134, a6
v_accvgpr_read_b32 v135, a7
v_mul_f32 v128, v128, v18
v_mul_f32 v129, v129, v18
v_mul_f32 v130, v130, v18
v_mul_f32 v131, v131, v18
v_mul_f32 v132, v132, v18
v_mul_f32 v133, v133, v18
v_mul_f32 v134, v134, v18
v_mul_f32 v135, v135, v18
v_cvt_pk_bf16_f32 v144, v128, v129
v_cvt_pk_bf16_f32 v145, v130, v131
v_cvt_pk_bf16_f32 v146, v132, v133
v_cvt_pk_bf16_f32 v147, v134, v135
buffer_store_dwordx4 v[144:147], v34, s[48:51], s66 offen sc1
v_accvgpr_read_b32 v136, a8
v_accvgpr_read_b32 v137, a9
v_accvgpr_read_b32 v138, a10
v_accvgpr_read_b32 v139, a11
v_accvgpr_read_b32 v140, a12
v_accvgpr_read_b32 v141, a13
v_accvgpr_read_b32 v142, a14
v_accvgpr_read_b32 v143, a15
v_mul_f32 v136, v136, v18
v_mul_f32 v137, v137, v18
v_mul_f32 v138, v138, v18
v_mul_f32 v139, v139, v18
v_mul_f32 v140, v140, v18
v_mul_f32 v141, v141, v18
v_mul_f32 v142, v142, v18
v_mul_f32 v143, v143, v18
v_cvt_pk_bf16_f32 v148, v136, v137
v_cvt_pk_bf16_f32 v149, v138, v139
v_cvt_pk_bf16_f32 v150, v140, v141
v_cvt_pk_bf16_f32 v151, v142, v143
buffer_store_dwordx4 v[148:151], v34, s[48:51], s66 offen offset:1024 sc1
v_accvgpr_read_b32 v128, a16
v_accvgpr_read_b32 v129, a17
v_accvgpr_read_b32 v130, a18
v_accvgpr_read_b32 v131, a19
v_accvgpr_read_b32 v132, a20
v_accvgpr_read_b32 v133, a21
v_accvgpr_read_b32 v134, a22
v_accvgpr_read_b32 v135, a23
v_mul_f32 v128, v128, v18
v_mul_f32 v129, v129, v18
v_mul_f32 v130, v130, v18
v_mul_f32 v131, v131, v18
v_mul_f32 v132, v132, v18
v_mul_f32 v133, v133, v18
v_mul_f32 v134, v134, v18
v_mul_f32 v135, v135, v18
v_cvt_pk_bf16_f32 v152, v128, v129
v_cvt_pk_bf16_f32 v153, v130, v131
v_cvt_pk_bf16_f32 v154, v132, v133
v_cvt_pk_bf16_f32 v155, v134, v135
buffer_store_dwordx4 v[152:155], v34, s[48:51], s66 offen offset:2048 sc1
v_accvgpr_read_b32 v136, a24
v_accvgpr_read_b32 v137, a25
v_accvgpr_read_b32 v138, a26
v_accvgpr_read_b32 v139, a27
v_accvgpr_read_b32 v140, a28
v_accvgpr_read_b32 v141, a29
v_accvgpr_read_b32 v142, a30
v_accvgpr_read_b32 v143, a31
v_mul_f32 v136, v136, v18
v_mul_f32 v137, v137, v18
v_mul_f32 v138, v138, v18
v_mul_f32 v139, v139, v18
v_mul_f32 v140, v140, v18
v_mul_f32 v141, v141, v18
v_mul_f32 v142, v142, v18
v_mul_f32 v143, v143, v18
v_cvt_pk_bf16_f32 v156, v136, v137
v_cvt_pk_bf16_f32 v157, v138, v139
v_cvt_pk_bf16_f32 v158, v140, v141
v_cvt_pk_bf16_f32 v159, v142, v143
buffer_store_dwordx4 v[156:159], v34, s[48:51], s66 offen offset:3072 sc1
v_accvgpr_read_b32 v128, a32
v_accvgpr_read_b32 v129, a33
v_accvgpr_read_b32 v130, a34
v_accvgpr_read_b32 v131, a35
v_accvgpr_read_b32 v132, a36
v_accvgpr_read_b32 v133, a37
v_accvgpr_read_b32 v134, a38
v_accvgpr_read_b32 v135, a39
v_mul_f32 v128, v128, v18
v_mul_f32 v129, v129, v18
v_mul_f32 v130, v130, v18
v_mul_f32 v131, v131, v18
v_mul_f32 v132, v132, v18
v_mul_f32 v133, v133, v18
v_mul_f32 v134, v134, v18
v_mul_f32 v135, v135, v18
v_cvt_pk_bf16_f32 v144, v128, v129
v_cvt_pk_bf16_f32 v145, v130, v131
v_cvt_pk_bf16_f32 v146, v132, v133
v_cvt_pk_bf16_f32 v147, v134, v135
s_add_u32 s66, s66, 4096
buffer_store_dwordx4 v[144:147], v34, s[48:51], s66 offen sc1
v_accvgpr_read_b32 v136, a40
v_accvgpr_read_b32 v137, a41
v_accvgpr_read_b32 v138, a42
v_accvgpr_read_b32 v139, a43
v_accvgpr_read_b32 v140, a44
v_accvgpr_read_b32 v141, a45
v_accvgpr_read_b32 v142, a46
v_accvgpr_read_b32 v143, a47
v_mul_f32 v136, v136, v18
v_mul_f32 v137, v137, v18
v_mul_f32 v138, v138, v18
v_mul_f32 v139, v139, v18
v_mul_f32 v140, v140, v18
v_mul_f32 v141, v141, v18
v_mul_f32 v142, v142, v18
v_mul_f32 v143, v143, v18
v_cvt_pk_bf16_f32 v148, v136, v137
v_cvt_pk_bf16_f32 v149, v138, v139
v_cvt_pk_bf16_f32 v150, v140, v141
v_cvt_pk_bf16_f32 v151, v142, v143
buffer_store_dwordx4 v[148:151], v34, s[48:51], s66 offen offset:1024 sc1
v_accvgpr_read_b32 v128, a48
v_accvgpr_read_b32 v129, a49
v_accvgpr_read_b32 v130, a50
v_accvgpr_read_b32 v131, a51
v_accvgpr_read_b32 v132, a52
v_accvgpr_read_b32 v133, a53
v_accvgpr_read_b32 v134, a54
v_accvgpr_read_b32 v135, a55
v_mul_f32 v128, v128, v18
v_mul_f32 v129, v129, v18
v_mul_f32 v130, v130, v18
v_mul_f32 v131, v131, v18
v_mul_f32 v132, v132, v18
v_mul_f32 v133, v133, v18
v_mul_f32 v134, v134, v18
v_mul_f32 v135, v135, v18
v_cvt_pk_bf16_f32 v152, v128, v129
v_cvt_pk_bf16_f32 v153, v130, v131
v_cvt_pk_bf16_f32 v154, v132, v133
v_cvt_pk_bf16_f32 v155, v134, v135
buffer_store_dwordx4 v[152:155], v34, s[48:51], s66 offen offset:2048 sc1
v_accvgpr_read_b32 v136, a56
v_accvgpr_read_b32 v137, a57
v_accvgpr_read_b32 v138, a58
v_accvgpr_read_b32 v139, a59
v_accvgpr_read_b32 v140, a60
v_accvgpr_read_b32 v141, a61
v_accvgpr_read_b32 v142, a62
v_accvgpr_read_b32 v143, a63
v_mul_f32 v136, v136, v18
v_mul_f32 v137, v137, v18
v_mul_f32 v138, v138, v18
v_mul_f32 v139, v139, v18
v_mul_f32 v140, v140, v18
v_mul_f32 v141, v141, v18
v_mul_f32 v142, v142, v18
v_mul_f32 v143, v143, v18
v_cvt_pk_bf16_f32 v156, v136, v137
v_cvt_pk_bf16_f32 v157, v138, v139
v_cvt_pk_bf16_f32 v158, v140, v141
v_cvt_pk_bf16_f32 v159, v142, v143
buffer_store_dwordx4 v[156:159], v34, s[48:51], s66 offen offset:3072 sc1
s_waitcnt vmcnt(18)
v_lshlrev_b32 v128, 16, v192
v_and_b32 v129, 0xffff0000, v192
v_lshlrev_b32 v130, 16, v193
v_and_b32 v131, 0xffff0000, v193
v_lshlrev_b32 v132, 16, v194
v_and_b32 v133, 0xffff0000, v194
v_lshlrev_b32 v134, 16, v195
v_and_b32 v135, 0xffff0000, v195
v_lshlrev_b32 v136, 16, v196
v_and_b32 v137, 0xffff0000, v196
v_lshlrev_b32 v138, 16, v197
v_and_b32 v139, 0xffff0000, v197
v_lshlrev_b32 v140, 16, v198
v_and_b32 v141, 0xffff0000, v198
v_lshlrev_b32 v142, 16, v199
v_and_b32 v143, 0xffff0000, v199
s_waitcnt vmcnt(16)
v_lshlrev_b32 v144, 16, v200
v_and_b32 v145, 0xffff0000, v200
v_lshlrev_b32 v146, 16, v201
v_and_b32 v147, 0xffff0000, v201
v_lshlrev_b32 v148, 16, v202
v_and_b32 v149, 0xffff0000, v202
v_lshlrev_b32 v150, 16, v203
v_and_b32 v151, 0xffff0000, v203
v_lshlrev_b32 v152, 16, v204
v_and_b32 v153, 0xffff0000, v204
v_lshlrev_b32 v154, 16, v205
v_and_b32 v155, 0xffff0000, v205
v_lshlrev_b32 v156, 16, v206
v_and_b32 v157, 0xffff0000, v206
v_lshlrev_b32 v158, 16, v207
v_and_b32 v159, 0xffff0000, v207
v_pk_add_f32 v[128:129], v[128:129], v[144:145]
v_pk_add_f32 v[130:131], v[130:131], v[146:147]
v_pk_add_f32 v[132:133], v[132:133], v[148:149]
v_pk_add_f32 v[134:135], v[134:135], v[150:151]
v_pk_add_f32 v[136:137], v[136:137], v[152:153]
v_pk_add_f32 v[138:139], v[138:139], v[154:155]
v_pk_add_f32 v[140:141], v[140:141], v[156:157]
v_pk_add_f32 v[142:143], v[142:143], v[158:159]
s_waitcnt vmcnt(14)
v_lshlrev_b32 v144, 16, v208
v_and_b32 v145, 0xffff0000, v208
v_lshlrev_b32 v146, 16, v209
v_and_b32 v147, 0xffff0000, v209
v_lshlrev_b32 v148, 16, v210
v_and_b32 v149, 0xffff0000, v210
v_lshlrev_b32 v150, 16, v211
v_and_b32 v151, 0xffff0000, v211
v_lshlrev_b32 v152, 16, v212
v_and_b32 v153, 0xffff0000, v212
v_lshlrev_b32 v154, 16, v213
v_and_b32 v155, 0xffff0000, v213
v_lshlrev_b32 v156, 16, v214
v_and_b32 v157, 0xffff0000, v214
v_lshlrev_b32 v158, 16, v215
v_and_b32 v159, 0xffff0000, v215
v_pk_add_f32 v[128:129], v[128:129], v[144:145]
v_pk_add_f32 v[130:131], v[130:131], v[146:147]
v_pk_add_f32 v[132:133], v[132:133], v[148:149]
v_pk_add_f32 v[134:135], v[134:135], v[150:151]
v_pk_add_f32 v[136:137], v[136:137], v[152:153]
v_pk_add_f32 v[138:139], v[138:139], v[154:155]
v_pk_add_f32 v[140:141], v[140:141], v[156:157]
v_pk_add_f32 v[142:143], v[142:143], v[158:159]
s_waitcnt vmcnt(12)
v_lshlrev_b32 v144, 16, v216
v_and_b32 v145, 0xffff0000, v216
v_lshlrev_b32 v146, 16, v217
v_and_b32 v147, 0xffff0000, v217
v_lshlrev_b32 v148, 16, v218
v_and_b32 v149, 0xffff0000, v218
v_lshlrev_b32 v150, 16, v219
v_and_b32 v151, 0xffff0000, v219
v_lshlrev_b32 v152, 16, v220
v_and_b32 v153, 0xffff0000, v220
v_lshlrev_b32 v154, 16, v221
v_and_b32 v155, 0xffff0000, v221
v_lshlrev_b32 v156, 16, v222
v_and_b32 v157, 0xffff0000, v222
v_lshlrev_b32 v158, 16, v223
v_and_b32 v159, 0xffff0000, v223
v_pk_add_f32 v[128:129], v[128:129], v[144:145]
v_pk_add_f32 v[130:131], v[130:131], v[146:147]
v_pk_add_f32 v[132:133], v[132:133], v[148:149]
v_pk_add_f32 v[134:135], v[134:135], v[150:151]
v_pk_add_f32 v[136:137], v[136:137], v[152:153]
v_pk_add_f32 v[138:139], v[138:139], v[154:155]
v_pk_add_f32 v[140:141], v[140:141], v[156:157]
v_pk_add_f32 v[142:143], v[142:143], v[158:159]
s_waitcnt vmcnt(8)
v_lshlrev_b32 v2, 16, v64
v_and_b32 v3, 0xffff0000, v64
v_lshlrev_b32 v4, 16, v65
v_and_b32 v5, 0xffff0000, v65
v_lshlrev_b32 v6, 16, v66
v_and_b32 v7, 0xffff0000, v66
v_lshlrev_b32 v8, 16, v67
v_and_b32 v9, 0xffff0000, v67
v_lshlrev_b32 v10, 16, v68
v_and_b32 v11, 0xffff0000, v68
v_lshlrev_b32 v12, 16, v69
v_and_b32 v13, 0xffff0000, v69
v_lshlrev_b32 v14, 16, v70
v_and_b32 v15, 0xffff0000, v70
v_lshlrev_b32 v16, 16, v71
v_and_b32 v17, 0xffff0000, v71
v_pk_add_f32 v[128:129], v[128:129], v[2:3]
v_pk_add_f32 v[130:131], v[130:131], v[4:5]
v_pk_add_f32 v[132:133], v[132:133], v[6:7]
v_pk_add_f32 v[134:135], v[134:135], v[8:9]
v_pk_add_f32 v[136:137], v[136:137], v[10:11]
v_pk_add_f32 v[138:139], v[138:139], v[12:13]
v_pk_add_f32 v[140:141], v[140:141], v[14:15]
v_pk_add_f32 v[142:143], v[142:143], v[16:17]
v_pk_mul_f32 v[144:145], v[128:129], v[128:129]
v_pk_mul_f32 v[146:147], v[130:131], v[130:131]
v_pk_mul_f32 v[148:149], v[132:133], v[132:133]
v_pk_mul_f32 v[150:151], v[134:135], v[134:135]
v_pk_mul_f32 v[152:153], v[136:137], v[136:137]
v_pk_mul_f32 v[154:155], v[138:139], v[138:139]
v_pk_mul_f32 v[156:157], v[140:141], v[140:141]
v_pk_mul_f32 v[158:159], v[142:143], v[142:143]
v_pk_fma_f32 v[144:145], v[144:145], v[106:107], v[106:107] op_sel:[0,1,0] op_sel_hi:[1,1,0]
v_pk_fma_f32 v[146:147], v[146:147], v[106:107], v[106:107] op_sel:[0,1,0] op_sel_hi:[1,1,0]
v_pk_fma_f32 v[148:149], v[148:149], v[106:107], v[106:107] op_sel:[0,1,0] op_sel_hi:[1,1,0]
v_pk_fma_f32 v[150:151], v[150:151], v[106:107], v[106:107] op_sel:[0,1,0] op_sel_hi:[1,1,0]
v_pk_fma_f32 v[152:153], v[152:153], v[106:107], v[106:107] op_sel:[0,1,0] op_sel_hi:[1,1,0]
v_pk_fma_f32 v[154:155], v[154:155], v[106:107], v[106:107] op_sel:[0,1,0] op_sel_hi:[1,1,0]
v_pk_fma_f32 v[156:157], v[156:157], v[106:107], v[106:107] op_sel:[0,1,0] op_sel_hi:[1,1,0]
v_pk_fma_f32 v[158:159], v[158:159], v[106:107], v[106:107] op_sel:[0,1,0] op_sel_hi:[1,1,0]
v_pk_mul_f32 v[144:145], v[144:145], v[128:129]
v_pk_mul_f32 v[146:147], v[146:147], v[130:131]
v_pk_mul_f32 v[148:149], v[148:149], v[132:133]
v_pk_mul_f32 v[150:151], v[150:151], v[134:135]
v_pk_mul_f32 v[152:153], v[152:153], v[136:137]
v_pk_mul_f32 v[154:155], v[154:155], v[138:139]
v_pk_mul_f32 v[156:157], v[156:157], v[140:141]
v_pk_mul_f32 v[158:159], v[158:159], v[142:143]
v_exp_f32 v144, v144
v_exp_f32 v145, v145
v_exp_f32 v146, v146
v_exp_f32 v147, v147
v_exp_f32 v148, v148
v_exp_f32 v149, v149
v_exp_f32 v150, v150
v_exp_f32 v151, v151
v_exp_f32 v152, v152
v_exp_f32 v153, v153
v_exp_f32 v154, v154
v_exp_f32 v155, v155
v_exp_f32 v156, v156
v_exp_f32 v157, v157
v_exp_f32 v158, v158
v_exp_f32 v159, v159
v_add_f32 v144, 1.0, v144
v_add_f32 v145, 1.0, v145
v_add_f32 v146, 1.0, v146
v_add_f32 v147, 1.0, v147
v_add_f32 v148, 1.0, v148
v_add_f32 v149, 1.0, v149
v_add_f32 v150, 1.0, v150
v_add_f32 v151, 1.0, v151
v_add_f32 v152, 1.0, v152
v_add_f32 v153, 1.0, v153
v_add_f32 v154, 1.0, v154
v_add_f32 v155, 1.0, v155
v_add_f32 v156, 1.0, v156
v_add_f32 v157, 1.0, v157
v_add_f32 v158, 1.0, v158
v_add_f32 v159, 1.0, v159
v_rcp_f32 v144, v144
v_rcp_f32 v145, v145
v_rcp_f32 v146, v146
v_rcp_f32 v147, v147
v_rcp_f32 v148, v148
v_rcp_f32 v149, v149
v_rcp_f32 v150, v150
v_rcp_f32 v151, v151
v_rcp_f32 v152, v152
v_rcp_f32 v153, v153
v_rcp_f32 v154, v154
v_rcp_f32 v155, v155
v_rcp_f32 v156, v156
v_rcp_f32 v157, v157
v_rcp_f32 v158, v158
v_rcp_f32 v159, v159
v_pk_mul_f32 v[128:129], v[128:129], v[144:145]
v_pk_mul_f32 v[130:131], v[130:131], v[146:147]
v_pk_mul_f32 v[132:133], v[132:133], v[148:149]
v_pk_mul_f32 v[134:135], v[134:135], v[150:151]
v_pk_mul_f32 v[136:137], v[136:137], v[152:153]
v_pk_mul_f32 v[138:139], v[138:139], v[154:155]
v_pk_mul_f32 v[140:141], v[140:141], v[156:157]
v_pk_mul_f32 v[142:143], v[142:143], v[158:159]
v_cvt_pk_bf16_f32 v96, v128, v129
v_cvt_pk_bf16_f32 v97, v130, v131
v_cvt_pk_bf16_f32 v98, v132, v133
v_cvt_pk_bf16_f32 v99, v134, v135
v_cvt_pk_bf16_f32 v100, v136, v137
v_cvt_pk_bf16_f32 v101, v138, v139
v_cvt_pk_bf16_f32 v102, v140, v141
v_cvt_pk_bf16_f32 v103, v142, v143
buffer_store_dwordx4 v[96:99], v104, s[48:51], s87 offen sc1
buffer_store_dwordx4 v[100:103], v104, s[48:51], s87 offen offset:1024 sc1
s_branch FD41
NF40:
s_lshl_b32 s66, s64, 2
s_add_u32 s66, s66, s34
s_lshl_b32 s66, s66, 18
s_lshl_b32 s68, s65, 13
s_add_u32 s66, s66, s68
s_add_u32 s66, s66, 41943040
s_sub_u32 s67, 15, s64
s_lshl_b32 s67, s67, 2
s_add_u32 s67, s67, s34
s_lshl_b32 s67, s67, 18
s_add_u32 s67, s67, s68
s_add_u32 s67, s67, 41943040
v_mov_b32 v20, v40
v_mov_b32 v21, v40
s_nop 1
v_permlane32_swap_b32 v20, v21
s_nop 1
v_add_f32 v20, v20, v21
v_rcp_f32 v20, v20
s_nop 0
v_mul_f32 v18, v20, v38
v_accvgpr_read_b32 v192, a0
v_accvgpr_read_b32 v193, a1
v_accvgpr_read_b32 v194, a2
v_accvgpr_read_b32 v195, a3
v_accvgpr_read_b32 v196, a4
v_accvgpr_read_b32 v197, a5
v_accvgpr_read_b32 v198, a6
v_accvgpr_read_b32 v199, a7
v_mul_f32 v192, v192, v18
v_mul_f32 v193, v193, v18
v_mul_f32 v194, v194, v18
v_mul_f32 v195, v195, v18
v_mul_f32 v196, v196, v18
v_mul_f32 v197, v197, v18
v_mul_f32 v198, v198, v18
v_mul_f32 v199, v199, v18
v_cvt_pk_bf16_f32 v128, v192, v193
v_cvt_pk_bf16_f32 v129, v194, v195
v_cvt_pk_bf16_f32 v130, v196, v197
v_cvt_pk_bf16_f32 v131, v198, v199
buffer_store_dwordx4 v[128:131], v34, s[48:51], s66 offen sc1
v_accvgpr_read_b32 v200, a8
v_accvgpr_read_b32 v201, a9
v_accvgpr_read_b32 v202, a10
v_accvgpr_read_b32 v203, a11
v_accvgpr_read_b32 v204, a12
v_accvgpr_read_b32 v205, a13
v_accvgpr_read_b32 v206, a14
v_accvgpr_read_b32 v207, a15
v_mul_f32 v200, v200, v18
v_mul_f32 v201, v201, v18
v_mul_f32 v202, v202, v18
v_mul_f32 v203, v203, v18
v_mul_f32 v204, v204, v18
v_mul_f32 v205, v205, v18
v_mul_f32 v206, v206, v18
v_mul_f32 v207, v207, v18
v_cvt_pk_bf16_f32 v132, v200, v201
v_cvt_pk_bf16_f32 v133, v202, v203
v_cvt_pk_bf16_f32 v134, v204, v205
v_cvt_pk_bf16_f32 v135, v206, v207
buffer_store_dwordx4 v[132:135], v34, s[48:51], s66 offen offset:1024 sc1
v_accvgpr_read_b32 v192, a16
v_accvgpr_read_b32 v193, a17
v_accvgpr_read_b32 v194, a18
v_accvgpr_read_b32 v195, a19
v_accvgpr_read_b32 v196, a20
v_accvgpr_read_b32 v197, a21
v_accvgpr_read_b32 v198, a22
v_accvgpr_read_b32 v199, a23
v_mul_f32 v192, v192, v18
v_mul_f32 v193, v193, v18
v_mul_f32 v194, v194, v18
v_mul_f32 v195, v195, v18
v_mul_f32 v196, v196, v18
v_mul_f32 v197, v197, v18
v_mul_f32 v198, v198, v18
v_mul_f32 v199, v199, v18
v_cvt_pk_bf16_f32 v136, v192, v193
v_cvt_pk_bf16_f32 v137, v194, v195
v_cvt_pk_bf16_f32 v138, v196, v197
v_cvt_pk_bf16_f32 v139, v198, v199
buffer_store_dwordx4 v[136:139], v34, s[48:51], s66 offen offset:2048 sc1
v_accvgpr_read_b32 v200, a24
v_accvgpr_read_b32 v201, a25
v_accvgpr_read_b32 v202, a26
v_accvgpr_read_b32 v203, a27
v_accvgpr_read_b32 v204, a28
v_accvgpr_read_b32 v205, a29
v_accvgpr_read_b32 v206, a30
v_accvgpr_read_b32 v207, a31
v_mul_f32 v200, v200, v18
v_mul_f32 v201, v201, v18
v_mul_f32 v202, v202, v18
v_mul_f32 v203, v203, v18
v_mul_f32 v204, v204, v18
v_mul_f32 v205, v205, v18
v_mul_f32 v206, v206, v18
v_mul_f32 v207, v207, v18
v_cvt_pk_bf16_f32 v140, v200, v201
v_cvt_pk_bf16_f32 v141, v202, v203
v_cvt_pk_bf16_f32 v142, v204, v205
v_cvt_pk_bf16_f32 v143, v206, v207
buffer_store_dwordx4 v[140:143], v34, s[48:51], s66 offen offset:3072 sc1
v_accvgpr_read_b32 v192, a32
v_accvgpr_read_b32 v193, a33
v_accvgpr_read_b32 v194, a34
v_accvgpr_read_b32 v195, a35
v_accvgpr_read_b32 v196, a36
v_accvgpr_read_b32 v197, a37
v_accvgpr_read_b32 v198, a38
v_accvgpr_read_b32 v199, a39
v_mul_f32 v192, v192, v18
v_mul_f32 v193, v193, v18
v_mul_f32 v194, v194, v18
v_mul_f32 v195, v195, v18
v_mul_f32 v196, v196, v18
v_mul_f32 v197, v197, v18
v_mul_f32 v198, v198, v18
v_mul_f32 v199, v199, v18
v_cvt_pk_bf16_f32 v144, v192, v193
v_cvt_pk_bf16_f32 v145, v194, v195
v_cvt_pk_bf16_f32 v146, v196, v197
v_cvt_pk_bf16_f32 v147, v198, v199
s_add_u32 s66, s66, 4096
buffer_store_dwordx4 v[144:147], v34, s[48:51], s66 offen sc1
v_accvgpr_read_b32 v200, a40
v_accvgpr_read_b32 v201, a41
v_accvgpr_read_b32 v202, a42
v_accvgpr_read_b32 v203, a43
v_accvgpr_read_b32 v204, a44
v_accvgpr_read_b32 v205, a45
v_accvgpr_read_b32 v206, a46
v_accvgpr_read_b32 v207, a47
v_mul_f32 v200, v200, v18
v_mul_f32 v201, v201, v18
v_mul_f32 v202, v202, v18
v_mul_f32 v203, v203, v18
v_mul_f32 v204, v204, v18
v_mul_f32 v205, v205, v18
v_mul_f32 v206, v206, v18
v_mul_f32 v207, v207, v18
v_cvt_pk_bf16_f32 v148, v200, v201
v_cvt_pk_bf16_f32 v149, v202, v203
v_cvt_pk_bf16_f32 v150, v204, v205
v_cvt_pk_bf16_f32 v151, v206, v207
buffer_store_dwordx4 v[148:151], v34, s[48:51], s66 offen offset:1024 sc1
v_accvgpr_read_b32 v192, a48
v_accvgpr_read_b32 v193, a49
v_accvgpr_read_b32 v194, a50
v_accvgpr_read_b32 v195, a51
v_accvgpr_read_b32 v196, a52
v_accvgpr_read_b32 v197, a53
v_accvgpr_read_b32 v198, a54
v_accvgpr_read_b32 v199, a55
v_mul_f32 v192, v192, v18
v_mul_f32 v193, v193, v18
v_mul_f32 v194, v194, v18
v_mul_f32 v195, v195, v18
v_mul_f32 v196, v196, v18
v_mul_f32 v197, v197, v18
v_mul_f32 v198, v198, v18
v_mul_f32 v199, v199, v18
v_cvt_pk_bf16_f32 v152, v192, v193
v_cvt_pk_bf16_f32 v153, v194, v195
v_cvt_pk_bf16_f32 v154, v196, v197
v_cvt_pk_bf16_f32 v155, v198, v199
buffer_store_dwordx4 v[152:155], v34, s[48:51], s66 offen offset:2048 sc1
v_accvgpr_read_b32 v200, a56
v_accvgpr_read_b32 v201, a57
v_accvgpr_read_b32 v202, a58
v_accvgpr_read_b32 v203, a59
v_accvgpr_read_b32 v204, a60
v_accvgpr_read_b32 v205, a61
v_accvgpr_read_b32 v206, a62
v_accvgpr_read_b32 v207, a63
v_mul_f32 v200, v200, v18
v_mul_f32 v201, v201, v18
v_mul_f32 v202, v202, v18
v_mul_f32 v203, v203, v18
v_mul_f32 v204, v204, v18
v_mul_f32 v205, v205, v18
v_mul_f32 v206, v206, v18
v_mul_f32 v207, v207, v18
v_cvt_pk_bf16_f32 v156, v200, v201
v_cvt_pk_bf16_f32 v157, v202, v203
v_cvt_pk_bf16_f32 v158, v204, v205
v_cvt_pk_bf16_f32 v159, v206, v207
buffer_store_dwordx4 v[156:159], v34, s[48:51], s66 offen offset:3072 sc1
FD41:
s_lshl_b32 s55, s64, 2
s_sub_u32 s55, 27, s55
s_cmp_le_i32 s55, 0
s_cbranch_scc1 AS46
s_sub_u32 s55, s55, 1
AL45:
s_waitcnt lgkmcnt(0)
v_mfma_f32_32x32x16_bf16 a[64:79], a[160:163], v[112:115], a[64:79]
s_waitcnt vmcnt(8)
s_barrier
v_mfma_f32_32x32x16_bf16 a[80:95], a[164:167], v[112:115], a[80:95]
ds_read_b128 a[128:131], v32
ds_read_b128 a[132:135], v32 offset:1024
v_add_f32 v41, v41, v43
s_add_u32 m0, s53, s57
v_mfma_f32_32x32x16_bf16 a[96:111], a[168:171], v[112:115], a[96:111]
ds_read_b128 a[136:139], v32 offset:2048
ds_read_b128 a[140:143], v32 offset:3072
v_exp_f32 v48, v176
v_exp_f32 v49, v177
v_mfma_f32_32x32x16_bf16 a[112:127], a[172:175], v[112:115], a[112:127]
buffer_load_dwordx4 v35, s[44:47], s54 offen lds
ds_read_b128 a[144:147], v32 offset:4096
v_exp_f32 v50, v178
v_mfma_f32_32x32x16_bf16 a[64:79], a[176:179], v[116:119], a[64:79]
ds_read_b128 a[148:151], v32 offset:5120
ds_read_b128 a[152:155], v32 offset:6144
v_exp_f32 v51, v179
v_add_f32 v43, v48, v49
v_mfma_f32_32x32x16_bf16 a[80:95], a[180:183], v[116:119], a[80:95]
ds_read_b128 a[156:159], v32 offset:7168
v_exp_f32 v52, v180
v_add_f32 v43, v43, v50
v_exp_f32 v53, v181
v_mfma_f32_32x32x16_bf16 a[96:111], a[184:187], v[116:119], a[96:111]
buffer_load_dwordx4 v35, s[44:47], s54 offen offset:1024 lds
v_add_f32 v43, v43, v51
v_exp_f32 v54, v182
v_add_f32 v43, v43, v52
v_mfma_f32_32x32x16_bf16 a[112:127], a[188:191], v[116:119], a[112:127]
v_exp_f32 v55, v183
v_add_f32 v43, v43, v53
v_exp_f32 v56, v184
s_waitcnt lgkmcnt(0)
v_mfma_f32_32x32x16_bf16 v[160:175], a[128:131], v[224:227], v[80:95]
ds_read_b128 a[160:163], v33 offset:24576
ds_read_b128 a[164:167], v33 offset:25600
v_add_f32 v43, v43, v54
v_exp_f32 v57, v185
v_add_f32 v43, v43, v55
v_mfma_f32_32x32x16_bf16 v[160:175], a[132:135], v[228:231], v[160:175]
ds_read_b128 a[168:171], v33 offset:26624
ds_read_b128 a[172:175], v33 offset:27648
v_exp_f32 v58, v186
v_cvt_pk_bf16_f32 v120, v48, v49
v_add_f32 v43, v43, v56
v_mfma_f32_32x32x16_bf16 v[160:175], a[136:139], v[232:235], v[160:175]
ds_read_b128 a[176:179], v33 offset:28672
v_exp_f32 v59, v187
v_add_f32 v43, v43, v57
v_cvt_pk_bf16_f32 v121, v50, v51
v_cvt_pk_bf16_f32 v122, v52, v53
v_mfma_f32_32x32x16_bf16 v[160:175], a[140:143], v[236:239], v[160:175]
buffer_load_dwordx4 v35, s[44:47], s54 offen offset:2048 lds
ds_read_b128 a[180:183], v33 offset:29696
v_exp_f32 v60, v188
v_add_f32 v43, v43, v58
v_mfma_f32_32x32x16_bf16 v[160:175], a[144:147], v[240:243], v[160:175]
ds_read_b128 a[184:187], v33 offset:30720
ds_read_b128 a[188:191], v33 offset:31744
v_exp_f32 v61, v189
v_add_f32 v43, v43, v59
v_cvt_pk_bf16_f32 v123, v54, v55
v_mfma_f32_32x32x16_bf16 v[160:175], a[148:151], v[244:247], v[160:175]
v_exp_f32 v62, v190
v_add_f32 v43, v43, v60
v_cvt_pk_bf16_f32 v124, v56, v57
v_exp_f32 v63, v191
v_mfma_f32_32x32x16_bf16 v[160:175], a[152:155], v[248:251], v[160:175]
v_add_f32 v43, v43, v61
v_add_f32 v43, v43, v62
v_add_f32 v43, v43, v63
v_cmp_nle_f32 vcc, v43, v37
v_cvt_pk_bf16_f32 v125, v58, v59
v_cvt_pk_bf16_f32 v126, v60, v61
v_mfma_f32_32x32x16_bf16 v[160:175], a[156:159], v[252:255], v[160:175]
buffer_load_dwordx4 v35, s[44:47], s54 offen offset:3072 lds
v_cvt_pk_bf16_f32 v127, v62, v63
s_add_u32 s54, s54, 4096
s_cbranch_vccnz RS47
RR48:
s_waitcnt lgkmcnt(0)
v_mfma_f32_32x32x16_bf16 a[64:79], a[160:163], v[120:123], a[64:79]
ds_read_b128 a[128:131], v32 offset:8192
v_add_f32 v41, v41, v43
s_add_u32 s52, s52, 32768
s_and_b32 s52, s52, 131071
s_xor_b32 s53, s52, 65536
v_mov_b32 v33, v32
v_mfma_f32_32x32x16_bf16 a[80:95], a[164:167], v[120:123], a[80:95]
ds_read_b128 a[132:135], v32 offset:9216
ds_read_b128 a[136:139], v32 offset:10240
s_add_u32 m0, m0, 4096
v_mfma_f32_32x32x16_bf16 a[96:111], a[168:171], v[120:123], a[96:111]
ds_read_b128 a[140:143], v32 offset:11264
ds_read_b128 a[144:147], v32 offset:12288
v_exp_f32 v48, v160
v_exp_f32 v49, v161
v_mfma_f32_32x32x16_bf16 a[112:127], a[172:175], v[120:123], a[112:127]
ds_read_b128 a[148:151], v32 offset:13312
buffer_load_dwordx4 v35, s[44:47], s54 offen lds
v_exp_f32 v50, v162
v_mfma_f32_32x32x16_bf16 a[64:79], a[176:179], v[124:127], a[64:79]
ds_read_b128 a[152:155], v32 offset:14336
ds_read_b128 a[156:159], v32 offset:15360
v_exp_f32 v51, v163
v_add_f32 v43, v48, v49
v_mfma_f32_32x32x16_bf16 a[80:95], a[180:183], v[124:127], a[80:95]
v_exp_f32 v52, v164
v_add_f32 v43, v43, v50
v_exp_f32 v53, v165
v_add_f32 v43, v43, v51
v_mfma_f32_32x32x16_bf16 a[96:111], a[184:187], v[124:127], a[96:111]
buffer_load_dwordx4 v35, s[44:47], s54 offen offset:1024 lds
v_exp_f32 v54, v166
v_add_f32 v43, v43, v52
v_mfma_f32_32x32x16_bf16 a[112:127], a[188:191], v[124:127], a[112:127]
v_exp_f32 v55, v167
v_add_f32 v43, v43, v53
v_exp_f32 v56, v168
s_waitcnt lgkmcnt(0)
v_mfma_f32_32x32x16_bf16 v[176:191], a[128:131], v[224:227], v[80:95]
ds_read_b128 a[160:163], v32 offset:16384
ds_read_b128 a[164:167], v32 offset:17408
v_add_f32 v43, v43, v54
v_exp_f32 v57, v169
v_add_f32 v43, v43, v55
v_mfma_f32_32x32x16_bf16 v[176:191], a[132:135], v[228:231], v[176:191]
ds_read_b128 a[168:171], v32 offset:18432
ds_read_b128 a[172:175], v32 offset:19456
v_exp_f32 v58, v170
v_cvt_pk_bf16_f32 v112, v48, v49
v_add_f32 v43, v43, v56
v_mfma_f32_32x32x16_bf16 v[176:191], a[136:139], v[232:235], v[176:191]
ds_read_b128 a[176:179], v32 offset:20480
v_exp_f32 v59, v171
v_add_f32 v43, v43, v57
v_cvt_pk_bf16_f32 v113, v50, v51
v_cvt_pk_bf16_f32 v114, v52, v53
v_mfma_f32_32x32x16_bf16 v[176:191], a[140:143], v[236:239], v[176:191]
buffer_load_dwordx4 v35, s[44:47], s54 offen offset:2048 lds
ds_read_b128 a[180:183], v32 offset:21504
v_exp_f32 v60, v172
v_add_f32 v43, v43, v58
v_mfma_f32_32x32x16_bf16 v[176:191], a[144:147], v[240:243], v[176:191]
ds_read_b128 a[184:187], v32 offset:22528
ds_read_b128 a[188:191], v32 offset:23552
v_exp_f32 v61, v173
v_add_f32 v43, v43, v59
v_cvt_pk_bf16_f32 v115, v54, v55
v_mfma_f32_32x32x16_bf16 v[176:191], a[148:151], v[244:247], v[176:191]
v_exp_f32 v62, v174
v_add_f32 v43, v43, v60
v_cvt_pk_bf16_f32 v116, v56, v57
v_exp_f32 v63, v175
v_mfma_f32_32x32x16_bf16 v[176:191], a[152:155], v[248:251], v[176:191]
v_add_f32 v43, v43, v61
v_add_f32 v43, v43, v62
v_add_f32 v43, v43, v63
v_cmp_nle_f32 vcc, v43, v37
v_cvt_pk_bf16_f32 v117, v58, v59
v_add_u32 v32, s52, v34
v_mfma_f32_32x32x16_bf16 v[176:191], a[156:159], v[252:255], v[176:191]
buffer_load_dwordx4 v35, s[44:47], s54 offen offset:3072 lds
v_cvt_pk_bf16_f32 v118, v60, v61
v_cvt_pk_bf16_f32 v119, v62, v63
s_add_u32 s54, s54, 28672
s_cbranch_vccnz RS49
RR50:
s_sub_u32 s55, s55, 1
s_cbranch_scc0 AL45
AS46:
s_cmp_lg_u32 s34, 0
s_cbranch_scc1 W51
s_cmp_eq_u32 s89, 0
s_cbranch_scc1 NU52
v_mov_b32 v24, 1
v_mov_b32 v25, 0
s_mov_b64 exec, 1
buffer_store_dword v24, v25, s[48:51], s35 offen sc1
s_mov_b64 exec, -1
NU52:
W51:
s_mov_b32 s68, s22
s_mov_b32 s69, s23
s_mov_b32 s70, 7340032
s_mov_b32 s71, 0x20000
s_lshr_b32 s90, s2, 3
s_lshl_b32 s90, s90, 2
s_add_u32 s90, s90, s34
s_mul_i32 s90, s90, 56
v_add_u32 v28, s90, v0
v_lshrrev_b32 v29, 4, v28
v_and_b32 v28, 15, v28
v_lshlrev_b32 v28, 7, v28
v_lshl_add_u32 v28, v29, 12, v28
s_bfe_u32 s90, s2, 0x20001
s_mul_i32 s90, s90, 1835008
s_and_b32 s91, s2, 1
s_lshl_b32 s91, s91, 11
s_add_u32 s90, s90, s91
s_mov_b32 exec_lo, -1
s_mov_b32 exec_hi, 0xffffff
buffer_load_dword v29, v28, s[68:71], s90 offen
s_mov_b64 exec, -1
s_cmp_eq_u32 s64, 7
s_cselect_b32 s55, 1, 2
s_lshl_b32 s56, s64, 1
s_sub_u32 s56, 32, s56
s_sub_u32 s56, s56, s55
s_lshl_b32 s56, s56, 6
s_sub_u32 s56, s56, 32
s_cmp_le_i32 s55, 0
s_cbranch_scc1 AS54
s_sub_u32 s55, s55, 1
AL53:
s_add_u32 s56, s56, 32
s_waitcnt lgkmcnt(0)
v_mfma_f32_32x32x16_bf16 a[64:79], a[160:163], v[112:115], a[64:79]
s_waitcnt vmcnt(8)
s_barrier
v_mfma_f32_32x32x16_bf16 a[80:95], a[164:167], v[112:115], a[80:95]
ds_read_b128 a[128:131], v32
v_add_f32 v41, v41, v43
v_subrev_u32 v46, s56, v45
v_cmp_le_i32 s[92:93], 0, v46
v_cmp_le_i32 s[94:95], 1, v46
v_cmp_le_i32 s[96:97], 2, v46
v_mfma_f32_32x32x16_bf16 a[96:111], a[168:171], v[112:115], a[96:111]
ds_read_b128 a[132:135], v32 offset:1024
ds_read_b128 a[136:139], v32 offset:2048
v_cmp_le_i32 s[98:99], 3, v46
s_add_u32 m0, s53, s57
v_cndmask_b32 v160, v47, v80, s[92:93]
v_cndmask_b32 v161, v47, v80, s[94:95]
v_mfma_f32_32x32x16_bf16 a[112:127], a[172:175], v[112:115], a[112:127]
ds_read_b128 a[140:143], v32 offset:3072
v_exp_f32 v48, v176
v_cndmask_b32 v162, v47, v80, s[96:97]
v_cndmask_b32 v163, v47, v80, s[98:99]
v_cmp_le_i32 s[92:93], 8, v46
v_mfma_f32_32x32x16_bf16 a[64:79], a[176:179], v[116:119], a[64:79]
buffer_load_dwordx4 v35, s[44:47], s54 offen lds
v_cmp_le_i32 s[94:95], 9, v46
v_cmp_le_i32 s[96:97], 10, v46
v_exp_f32 v49, v177
v_mfma_f32_32x32x16_bf16 a[80:95], a[180:183], v[116:119], a[80:95]
ds_read_b128 a[144:147], v32 offset:4096
v_cmp_le_i32 s[98:99], 11, v46
v_cndmask_b32 v164, v47, v80, s[92:93]
v_cndmask_b32 v165, v47, v80, s[94:95]
v_cndmask_b32 v166, v47, v80, s[96:97]
v_cndmask_b32 v167, v47, v80, s[98:99]
v_mfma_f32_32x32x16_bf16 a[96:111], a[184:187], v[116:119], a[96:111]
ds_read_b128 a[148:151], v32 offset:5120
ds_read_b128 a[152:155], v32 offset:6144
ds_read_b128 a[156:159], v32 offset:7168
v_cmp_le_i32 s[92:93], 16, v46
v_cmp_le_i32 s[94:95], 17, v46
v_cmp_le_i32 s[96:97], 18, v46
v_cmp_le_i32 s[98:99], 19, v46
v_cndmask_b32 v168, v47, v80, s[92:93]
v_cndmask_b32 v169, v47, v80, s[94:95]
v_cndmask_b32 v170, v47, v80, s[96:97]
v_cndmask_b32 v171, v47, v80, s[98:99]
v_cmp_le_i32 s[92:93], 24, v46
v_cmp_le_i32 s[94:95], 25, v46
v_cmp_le_i32 s[96:97], 26, v46
v_cmp_le_i32 s[98:99], 27, v46
v_cndmask_b32 v172, v47, v80, s[92:93]
v_cndmask_b32 v173, v47, v80, s[94:95]
v_cndmask_b32 v174, v47, v80, s[96:97]
v_cndmask_b32 v175, v47, v80, s[98:99]
v_mfma_f32_32x32x16_bf16 a[112:127], a[188:191], v[116:119], a[112:127]
v_exp_f32 v50, v178
v_exp_f32 v51, v179
v_add_f32 v43, v48, v49
s_waitcnt lgkmcnt(0)
v_mfma_f32_32x32x16_bf16 v[160:175], a[128:131], v[224:227], v[160:175]
v_exp_f32 v52, v180
v_add_f32 v43, v43, v50
v_exp_f32 v53, v181
v_add_f32 v43, v43, v51
v_mfma_f32_32x32x16_bf16 v[160:175], a[132:135], v[228:231], v[160:175]
buffer_load_dwordx4 v35, s[44:47], s54 offen offset:1024 lds
ds_read_b128 a[160:163], v33 offset:24576
v_exp_f32 v54, v182
v_add_f32 v43, v43, v52
v_mfma_f32_32x32x16_bf16 v[160:175], a[136:139], v[232:235], v[160:175]
v_exp_f32 v55, v183
v_add_f32 v43, v43, v53
v_exp_f32 v56, v184
v_add_f32 v43, v43, v54
v_mfma_f32_32x32x16_bf16 v[160:175], a[140:143], v[236:239], v[160:175]
ds_read_b128 a[164:167], v33 offset:25600
v_exp_f32 v57, v185
v_add_f32 v43, v43, v55
v_exp_f32 v58, v186
v_mfma_f32_32x32x16_bf16 v[160:175], a[144:147], v[240:243], v[160:175]
ds_read_b128 a[168:171], v33 offset:26624
ds_read_b128 a[172:175], v33 offset:27648
v_cvt_pk_bf16_f32 v120, v48, v49
v_add_f32 v43, v43, v56
v_exp_f32 v59, v187
v_mfma_f32_32x32x16_bf16 v[160:175], a[148:151], v[244:247], v[160:175]
ds_read_b128 a[176:179], v33 offset:28672
v_add_f32 v43, v43, v57
v_cvt_pk_bf16_f32 v121, v50, v51
v_exp_f32 v60, v188
v_add_f32 v43, v43, v58
v_mfma_f32_32x32x16_bf16 v[160:175], a[152:155], v[248:251], v[160:175]
ds_read_b128 a[180:183], v33 offset:29696
ds_read_b128 a[184:187], v33 offset:30720
ds_read_b128 a[188:191], v33 offset:31744
v_exp_f32 v61, v189
v_add_f32 v43, v43, v59
v_exp_f32 v62, v190
v_add_f32 v43, v43, v60
v_exp_f32 v63, v191
v_add_f32 v43, v43, v61
v_add_f32 v43, v43, v62
v_add_f32 v43, v43, v63
v_cmp_nle_f32 vcc, v43, v37
v_mfma_f32_32x32x16_bf16 v[160:175], a[156:159], v[252:255], v[160:175]
buffer_load_dwordx4 v35, s[44:47], s54 offen offset:2048 lds
buffer_load_dwordx4 v35, s[44:47], s54 offen offset:3072 lds
v_cvt_pk_bf16_f32 v122, v52, v53
v_cvt_pk_bf16_f32 v123, v54, v55
v_cvt_pk_bf16_f32 v124, v56, v57
v_cvt_pk_bf16_f32 v125, v58, v59
v_cvt_pk_bf16_f32 v126, v60, v61
v_cvt_pk_bf16_f32 v127, v62, v63
s_add_u32 s54, s54, 4096
s_cbranch_vccnz RS55
RR56:
s_add_u32 s56, s56, 32
s_waitcnt lgkmcnt(0)
v_mfma_f32_32x32x16_bf16 a[64:79], a[160:163], v[120:123], a[64:79]
ds_read_b128 a[128:131], v32 offset:8192
v_add_f32 v41, v41, v43
v_subrev_u32 v46, s56, v45
s_add_u32 s52, s52, 32768
s_and_b32 s52, s52, 131071
s_xor_b32 s53, s52, 65536
v_mfma_f32_32x32x16_bf16 a[80:95], a[164:167], v[120:123], a[80:95]
ds_read_b128 a[132:135], v32 offset:9216
v_mov_b32 v33, v32
v_cmp_le_i32 s[92:93], 0, v46
v_cmp_le_i32 s[94:95], 1, v46
v_cmp_le_i32 s[96:97], 2, v46
v_cmp_le_i32 s[98:99], 3, v46
v_mfma_f32_32x32x16_bf16 a[96:111], a[168:171], v[120:123], a[96:111]
ds_read_b128 a[136:139], v32 offset:10240
ds_read_b128 a[140:143], v32 offset:11264
v_cndmask_b32 v176, v47, v80, s[92:93]
v_cndmask_b32 v177, v47, v80, s[94:95]
v_cndmask_b32 v178, v47, v80, s[96:97]
v_cndmask_b32 v179, v47, v80, s[98:99]
v_mfma_f32_32x32x16_bf16 a[112:127], a[172:175], v[120:123], a[112:127]
ds_read_b128 a[144:147], v32 offset:12288
s_add_u32 m0, m0, 4096
v_cmp_le_i32 s[92:93], 8, v46
v_cmp_le_i32 s[94:95], 9, v46
v_cmp_le_i32 s[96:97], 10, v46
v_cmp_le_i32 s[98:99], 11, v46
v_mfma_f32_32x32x16_bf16 a[64:79], a[176:179], v[124:127], a[64:79]
ds_read_b128 a[148:151], v32 offset:13312
v_exp_f32 v48, v160
v_cndmask_b32 v180, v47, v80, s[92:93]
v_cndmask_b32 v181, v47, v80, s[94:95]
v_cndmask_b32 v182, v47, v80, s[96:97]
v_mfma_f32_32x32x16_bf16 a[80:95], a[180:183], v[124:127], a[80:95]
buffer_load_dwordx4 v35, s[44:47], s54 offen lds
ds_read_b128 a[152:155], v32 offset:14336
v_exp_f32 v49, v161
v_cndmask_b32 v183, v47, v80, s[98:99]
v_mfma_f32_32x32x16_bf16 a[96:111], a[184:187], v[124:127], a[96:111]
ds_read_b128 a[156:159], v32 offset:15360
v_cmp_le_i32 s[92:93], 16, v46
v_cmp_le_i32 s[94:95], 17, v46
v_cmp_le_i32 s[96:97], 18, v46
v_cmp_le_i32 s[98:99], 19, v46
v_cndmask_b32 v184, v47, v80, s[92:93]
v_cndmask_b32 v185, v47, v80, s[94:95]
v_cndmask_b32 v186, v47, v80, s[96:97]
v_cndmask_b32 v187, v47, v80, s[98:99]
v_cmp_le_i32 s[92:93], 24, v46
v_cmp_le_i32 s[94:95], 25, v46
v_cmp_le_i32 s[96:97], 26, v46
v_cmp_le_i32 s[98:99], 27, v46
v_cndmask_b32 v188, v47, v80, s[92:93]
v_cndmask_b32 v189, v47, v80, s[94:95]
v_cndmask_b32 v190, v47, v80, s[96:97]
v_cndmask_b32 v191, v47, v80, s[98:99]
v_mfma_f32_32x32x16_bf16 a[112:127], a[188:191], v[124:127], a[112:127]
v_exp_f32 v50, v162
v_exp_f32 v51, v163
v_add_f32 v43, v48, v49
s_waitcnt lgkmcnt(0)
v_mfma_f32_32x32x16_bf16 v[176:191], a[128:131], v[224:227], v[176:191]
v_exp_f32 v52, v164
v_add_f32 v43, v43, v50
v_exp_f32 v53, v165
v_add_f32 v43, v43, v51
v_mfma_f32_32x32x16_bf16 v[176:191], a[132:135], v[228:231], v[176:191]
buffer_load_dwordx4 v35, s[44:47], s54 offen offset:1024 lds
ds_read_b128 a[160:163], v32 offset:16384
v_exp_f32 v54, v166
v_add_f32 v43, v43, v52
v_mfma_f32_32x32x16_bf16 v[176:191], a[136:139], v[232:235], v[176:191]
v_exp_f32 v55, v167
v_add_f32 v43, v43, v53
v_exp_f32 v56, v168
v_add_f32 v43, v43, v54
v_mfma_f32_32x32x16_bf16 v[176:191], a[140:143], v[236:239], v[176:191]
ds_read_b128 a[164:167], v32 offset:17408
v_exp_f32 v57, v169
v_add_f32 v43, v43, v55
v_exp_f32 v58, v170
v_mfma_f32_32x32x16_bf16 v[176:191], a[144:147], v[240:243], v[176:191]
ds_read_b128 a[168:171], v32 offset:18432
ds_read_b128 a[172:175], v32 offset:19456
v_cvt_pk_bf16_f32 v112, v48, v49
v_add_f32 v43, v43, v56
v_exp_f32 v59, v171
v_mfma_f32_32x32x16_bf16 v[176:191], a[148:151], v[244:247], v[176:191]
ds_read_b128 a[176:179], v32 offset:20480
v_add_f32 v43, v43, v57
v_cvt_pk_bf16_f32 v113, v50, v51
v_exp_f32 v60, v172
v_add_f32 v43, v43, v58
v_mfma_f32_32x32x16_bf16 v[176:191], a[152:155], v[248:251], v[176:191]
ds_read_b128 a[180:183], v32 offset:21504
ds_read_b128 a[184:187], v32 offset:22528
ds_read_b128 a[188:191], v32 offset:23552
v_exp_f32 v61, v173
v_add_f32 v43, v43, v59
v_exp_f32 v62, v174
v_add_f32 v43, v43, v60
v_exp_f32 v63, v175
v_add_f32 v43, v43, v61
v_add_f32 v43, v43, v62
v_add_f32 v43, v43, v63
v_cmp_nle_f32 vcc, v43, v37
v_mfma_f32_32x32x16_bf16 v[176:191], a[156:159], v[252:255], v[176:191]
buffer_load_dwordx4 v35, s[44:47], s54 offen offset:2048 lds
buffer_load_dwordx4 v35, s[44:47], s54 offen offset:3072 lds
v_cvt_pk_bf16_f32 v114, v52, v53
v_cvt_pk_bf16_f32 v115, v54, v55
v_cvt_pk_bf16_f32 v116, v56, v57
v_cvt_pk_bf16_f32 v117, v58, v59
v_add_u32 v32, s52, v34
v_cvt_pk_bf16_f32 v118, v60, v61
v_cvt_pk_bf16_f32 v119, v62, v63
s_add_u32 s54, s54, 28672
s_cbranch_vccnz RS57
RR58:
s_sub_u32 s55, s55, 1
s_cbranch_scc0 AL53
AS54:
s_waitcnt lgkmcnt(0)
v_mfma_f32_32x32x16_bf16 a[64:79], a[160:163], v[112:115], a[64:79]
ds_read_b128 a[160:163], v33 offset:24576
v_add_f32 v41, v41, v43
v_mfma_f32_32x32x16_bf16 a[80:95], a[164:167], v[112:115], a[80:95]
ds_read_b128 a[164:167], v33 offset:25600
v_mfma_f32_32x32x16_bf16 a[96:111], a[168:171], v[112:115], a[96:111]
ds_read_b128 a[168:171], v33 offset:26624
v_exp_f32 v48, v176
v_exp_f32 v49, v177
v_mfma_f32_32x32x16_bf16 a[112:127], a[172:175], v[112:115], a[112:127]
v_exp_f32 v50, v178
v_exp_f32 v51, v179
v_add_f32 v43, v48, v49
v_cvt_pk_bf16_f32 v120, v48, v49
v_mfma_f32_32x32x16_bf16 a[64:79], a[176:179], v[116:119], a[64:79]
v_exp_f32 v52, v180
v_add_f32 v43, v43, v50
v_exp_f32 v53, v181
v_cvt_pk_bf16_f32 v121, v50, v51
v_mfma_f32_32x32x16_bf16 a[80:95], a[180:183], v[116:119], a[80:95]
ds_read_b128 a[172:175], v33 offset:27648
v_add_f32 v43, v43, v51
v_exp_f32 v54, v182
v_add_f32 v43, v43, v52
v_cvt_pk_bf16_f32 v122, v52, v53
v_mfma_f32_32x32x16_bf16 a[96:111], a[184:187], v[116:119], a[96:111]
v_exp_f32 v55, v183
v_add_f32 v43, v43, v53
v_exp_f32 v56, v184
v_add_f32 v43, v43, v54
v_mfma_f32_32x32x16_bf16 a[112:127], a[188:191], v[116:119], a[112:127]
ds_read_b128 a[176:179], v33 offset:28672
ds_read_b128 a[180:183], v33 offset:29696
ds_read_b128 a[184:187], v33 offset:30720
ds_read_b128 a[188:191], v33 offset:31744
v_exp_f32 v57, v185
v_add_f32 v43, v43, v55
v_exp_f32 v58, v186
v_cvt_pk_bf16_f32 v123, v54, v55
v_add_f32 v43, v43, v56
v_exp_f32 v59, v187
v_add_f32 v43, v43, v57
v_exp_f32 v60, v188
v_add_f32 v43, v43, v58
v_exp_f32 v61, v189
v_add_f32 v43, v43, v59
v_exp_f32 v62, v190
v_add_f32 v43, v43, v60
v_exp_f32 v63, v191
v_cvt_pk_bf16_f32 v124, v56, v57
v_cvt_pk_bf16_f32 v125, v58, v59
v_add_f32 v43, v43, v61
v_add_f32 v43, v43, v62
v_add_f32 v43, v43, v63
v_cvt_pk_bf16_f32 v126, v60, v61
v_cvt_pk_bf16_f32 v127, v62, v63
v_cmp_nle_f32 vcc, v43, v37
s_cbranch_vccnz RS59
RR60:
v_add_f32 v41, v41, v43
s_waitcnt lgkmcnt(0)
s_bfe_u32 s62, s2, 0x20001
s_and_b32 s60, s2, 1
s_lshl_b32 s60, s60, 3
s_lshr_b32 s63, s2, 5
s_add_u32 s60, s60, s63
s_bfe_u32 s61, s2, 0x20003
s_waitcnt vmcnt(0)
s_cmp_lg_u32 s34, 0
s_cbranch_scc1 W61
s_lshl_b32 s91, s61, 8
s_mul_i32 s90, s62, 28
s_add_u32 s91, s91, s90
s_add_u32 s91, s91, 2301952
v_lshlrev_b32 v25, 2, v0
s_mov_b32 s90, 200000
s_mov_b32 exec_lo, 0x7f
s_mov_b32 exec_hi, 0x7f
PL62:
buffer_load_dword v24, v25, s[48:51], s91 offen sc1
s_waitcnt vmcnt(0)
v_cmp_gt_u32 vcc, 1, v24
s_cbranch_vccz PD63
s_sub_u32 s90, s90, 1
s_cbranch_scc1 PD63
s_sleep 1
s_branch PL62
PD63:
s_mov_b64 exec, -1
W61:
s_barrier
s_mov_b32 s36, s22
s_mov_b32 s37, s23
s_mov_b32 s38, 0x700000
s_mov_b32 s39, 0x20000
s_mov_b32 s40, s32
s_mov_b32 s41, s33
s_mov_b32 s42, 0x5000000
s_mov_b32 s43, 0x20000
v_lshlrev_b32 v2, 4, v0
v_lshrrev_b32 v24, 4, v0
v_lshlrev_b32 v25, 2, v24
v_and_b32 v26, 15, v0
v_xor_b32 v26, v26, v25
v_lshlrev_b32 v26, 4, v26
v_mul_u32_u24 v24, 4096, v24
v_add_u32 v26, v26, v24
s_mul_i32 s56, s34, 65536
v_add_u32 v3, s56, v26
s_lshr_b32 s56, s34, 1
s_lshl_b32 s56, s56, 11
s_add_u32 s56, s56, 0
v_lshlrev_b32 v24, 4, v0
v_add_u32 v10, s56, v24
v_bfe_u32 v24, v0, 2, 2
v_lshrrev_b32 v25, 5, v0
v_lshl_add_u32 v25, v25, 2, v24
v_lshlrev_b32 v25, 8, v25
v_bfe_u32 v26, v0, 4, 1
v_lshlrev_b32 v26, 5, v26
v_and_b32 v27, 3, v0
v_lshl_add_u32 v26, v27, 3, v26
v_add_u32 v25, v25, v26
v_add_u32 v25, 16384, v25
v_lshlrev_b32 v24, 6, v24
s_and_b32 s56, s34, 1
s_lshl_b32 s56, s56, 7
s_add_u32 s55, s56, 0
v_xor_b32 v26, s55, v24
v_add_u32 v11, v25, v26
s_add_u32 s55, s56, 64
v_xor_b32 v26, s55, v24
v_add_u32 v12, v25, v26
s_lshl_b32 s57, s34, 12
s_add_u32 s57, s57, 0
s_add_u32 s54, s57, 16384
v_mov_b32 v4, v10
v_add_u32 v5, 0x10000, v10
v_mov_b32 v6, v11
v_mov_b32 v7, v12
v_add_u32 v8, 0x10000, v11
v_add_u32 v9, 0x10000, v12
v_and_b32 v24, 31, v0
v_lshlrev_b32 v24, 2, v24
s_and_b32 s56, s34, 1
s_lshl_b32 s56, s56, 8
s_lshl_b32 s63, s60, 9
s_add_u32 s56, s56, s63
s_add_u32 s56, s56, 2228224
buffer_load_dword v28, v24, s[48:51], s56 offen
buffer_load_dword v29, v24, s[48:51], s56 offen offset:128
s_mul_i32 s52, s61, 458752
s_mul_i32 s63, s62, 28672
s_add_u32 s52, s52, s63
s_lshl_b32 s63, s34, 10
s_add_u32 s52, s52, s63
s_add_u32 s52, s52, 4194304
s_mul_i32 s53, s62, 1835008
s_lshl_b32 s63, s60, 8
s_add_u32 s53, s53, s63
s_add_u32 m0, s57, 0
s_mov_b32 s56, s52
buffer_load_dwordx4 v2, s[40:43], s56 offen lds
s_add_u32 s56, s52, 113664
buffer_load_dwordx4 v2, s[40:43], s56 offen offset:1024 lds
s_add_u32 s56, s52, 227328
buffer_load_dwordx4 v2, s[40:43], s56 offen offset:2048 lds
s_add_u32 s56, s52, 340992
buffer_load_dwordx4 v2, s[40:43], s56 offen offset:3072 lds
s_add_u32 m0, s54, 0
s_mov_b32 s56, s53
buffer_load_dwordx4 v3, s[36:39], s56 offen lds
s_add_u32 s56, s53, 15360
buffer_load_dwordx4 v3, s[36:39], s56 offen offset:1024 lds
s_add_u32 s56, s53, 30720
buffer_load_dwordx4 v3, s[36:39], s56 offen offset:2048 lds
s_add_u32 s56, s53, 46080
buffer_load_dwordx4 v3, s[36:39], s56 offen offset:3072 lds
s_add_u32 s52, s52, 4096
s_add_u32 s53, s53, 262144
s_add_u32 m0, s57, 32768
s_mov_b32 s56, s52
buffer_load_dwordx4 v2, s[40:43], s56 offen lds
s_add_u32 s56, s52, 113664
buffer_load_dwordx4 v2, s[40:43], s56 offen offset:1024 lds
s_add_u32 s56, s52, 227328
buffer_load_dwordx4 v2, s[40:43], s56 offen offset:2048 lds
s_add_u32 s56, s52, 340992
buffer_load_dwordx4 v2, s[40:43], s56 offen offset:3072 lds
s_add_u32 m0, s54, 32768
s_mov_b32 s56, s53
buffer_load_dwordx4 v3, s[36:39], s56 offen lds
s_add_u32 s56, s53, 15360
buffer_load_dwordx4 v3, s[36:39], s56 offen offset:1024 lds
s_add_u32 s56, s53, 30720
buffer_load_dwordx4 v3, s[36:39], s56 offen offset:2048 lds
s_add_u32 s56, s53, 46080
buffer_load_dwordx4 v3, s[36:39], s56 offen offset:3072 lds
s_add_u32 s52, s52, 4096
s_add_u32 s53, s53, 262144
s_add_u32 m0, s57, 65536
s_mov_b32 s56, s52
buffer_load_dwordx4 v2, s[40:43], s56 offen lds
s_add_u32 s56, s52, 113664
buffer_load_dwordx4 v2, s[40:43], s56 offen offset:1024 lds
s_add_u32 s56, s52, 227328
buffer_load_dwordx4 v2, s[40:43], s56 offen offset:2048 lds
s_add_u32 s56, s52, 340992
buffer_load_dwordx4 v2, s[40:43], s56 offen offset:3072 lds
s_add_u32 m0, s54, 65536
s_mov_b32 s56, s53
buffer_load_dwordx4 v3, s[36:39], s56 offen lds
s_add_u32 s56, s53, 15360
buffer_load_dwordx4 v3, s[36:39], s56 offen offset:1024 lds
s_add_u32 s56, s53, 30720
buffer_load_dwordx4 v3, s[36:39], s56 offen offset:2048 lds
s_add_u32 s56, s53, 46080
buffer_load_dwordx4 v3, s[36:39], s56 offen offset:3072 lds
s_add_u32 s52, s52, 4096
s_add_u32 s53, s53, 262144
v_mfma_f32_32x32x16_bf16 a[64:79], a[160:163], v[120:123], a[64:79]
v_mfma_f32_32x32x16_bf16 a[80:95], a[164:167], v[120:123], a[80:95]
v_mfma_f32_32x32x16_bf16 a[96:111], a[168:171], v[120:123], a[96:111]
v_mfma_f32_32x32x16_bf16 a[112:127], a[172:175], v[120:123], a[112:127]
v_mfma_f32_32x32x16_bf16 a[64:79], a[176:179], v[124:127], a[64:79]
v_mfma_f32_32x32x16_bf16 a[80:95], a[180:183], v[124:127], a[80:95]
v_mfma_f32_32x32x16_bf16 a[96:111], a[184:187], v[124:127], a[96:111]
v_mfma_f32_32x32x16_bf16 a[112:127], a[188:191], v[124:127], a[112:127]
v_mov_b32 v20, v41
v_mov_b32 v21, v41
s_nop 1
v_permlane32_swap_b32 v20, v21
s_nop 1
v_add_f32 v20, v20, v21
v_rcp_f32 v20, v20
s_nop 0
v_mul_f32 v19, v20, v39
s_mov_b32 s44, s14
s_mov_b32 s45, s15
s_mov_b32 s46, 0x400000
s_mov_b32 s47, 0x20000
s_lshr_b32 s69, s2, 3
s_lshl_b32 s69, s69, 2
s_add_u32 s69, s69, s34
s_lshl_b32 s69, s69, 13
s_lshl_b32 s70, s62, 20
s_add_u32 s69, s69, s70
v_lshlrev_b32 v14, 7, v0
s_waitcnt vmcnt(16)
s_barrier
ds_read_b128 v[64:67], v4
ds_read_b128 v[68:71], v4 offset:1024
ds_read_b64_tr_b16 v[72:73], v6
ds_read_b64_tr_b16 v[74:75], v6 offset:2048
ds_read_b64_tr_b16 v[76:77], v7
ds_read_b64_tr_b16 v[78:79], v7 offset:2048
s_waitcnt lgkmcnt(0)
v_mfma_f32_32x32x16_bf16 v[128:143], v[64:67], v[72:75], 0
ds_read_b128 v[80:83], v4 offset:4096
ds_read_b128 v[84:87], v4 offset:5120
s_add_u32 m0, s57, 98304
s_mov_b32 s56, s52
v_accvgpr_read_b32 v192, a64
v_accvgpr_read_b32 v193, a65
v_accvgpr_read_b32 v194, a66
v_accvgpr_read_b32 v195, a67
v_mfma_f32_32x32x16_bf16 v[144:159], v[64:67], v[76:79], 0
ds_read_b64_tr_b16 v[88:89], v6 offset:4096
v_accvgpr_read_b32 v196, a68
v_accvgpr_read_b32 v197, a69
v_accvgpr_read_b32 v198, a70
v_accvgpr_read_b32 v199, a71
v_mul_f32 v192, v192, v19
v_mul_f32 v193, v193, v19
v_mul_f32 v194, v194, v19
v_mfma_f32_32x32x16_bf16 v[160:175], v[68:71], v[72:75], 0
ds_read_b64_tr_b16 v[90:91], v6 offset:6144
ds_read_b64_tr_b16 v[92:93], v7 offset:4096
ds_read_b64_tr_b16 v[94:95], v7 offset:6144
v_mul_f32 v195, v195, v19
v_mul_f32 v196, v196, v19
v_mul_f32 v197, v197, v19
v_mul_f32 v198, v198, v19
v_mul_f32 v199, v199, v19
v_mfma_f32_32x32x16_bf16 v[176:191], v[68:71], v[76:79], 0
buffer_load_dwordx4 v2, s[40:43], s56 offen lds
v_cvt_pk_bf16_f32 v208, v192, v193
v_cvt_pk_bf16_f32 v209, v194, v195
v_cvt_pk_bf16_f32 v210, v196, v197
v_cvt_pk_bf16_f32 v211, v198, v199
s_add_u32 s56, s52, 113664
s_waitcnt lgkmcnt(0)
v_mfma_f32_32x32x16_bf16 v[128:143], v[80:83], v[88:91], v[128:143]
buffer_store_dwordx4 v[208:211], v34, s[48:51], s67 offen sc1
v_accvgpr_read_b32 v200, a72
v_accvgpr_read_b32 v201, a73
v_accvgpr_read_b32 v202, a74
v_accvgpr_read_b32 v203, a75
v_accvgpr_read_b32 v204, a76
v_accvgpr_read_b32 v205, a77
v_mfma_f32_32x32x16_bf16 v[144:159], v[80:83], v[92:95], v[144:159]
v_accvgpr_read_b32 v206, a78
v_accvgpr_read_b32 v207, a79
v_mul_f32 v200, v200, v19
v_mul_f32 v201, v201, v19
v_mul_f32 v202, v202, v19
v_mul_f32 v203, v203, v19
v_mul_f32 v204, v204, v19
v_mul_f32 v205, v205, v19
v_mfma_f32_32x32x16_bf16 v[160:175], v[84:87], v[88:91], v[160:175]
ds_read_b128 v[64:67], v4 offset:8192
ds_read_b128 v[68:71], v4 offset:9216
ds_read_b64_tr_b16 v[72:73], v6 offset:8192
ds_read_b64_tr_b16 v[74:75], v6 offset:10240
ds_read_b64_tr_b16 v[76:77], v7 offset:8192
ds_read_b64_tr_b16 v[78:79], v7 offset:10240
v_mul_f32 v206, v206, v19
v_mul_f32 v207, v207, v19
v_mfma_f32_32x32x16_bf16 v[176:191], v[84:87], v[92:95], v[176:191]
buffer_load_dwordx4 v2, s[40:43], s56 offen offset:1024 lds
v_cvt_pk_bf16_f32 v212, v200, v201
v_cvt_pk_bf16_f32 v213, v202, v203
v_cvt_pk_bf16_f32 v214, v204, v205
v_cvt_pk_bf16_f32 v215, v206, v207
s_add_u32 s56, s52, 227328
s_waitcnt lgkmcnt(0)
v_mfma_f32_32x32x16_bf16 v[128:143], v[64:67], v[72:75], v[128:143]
buffer_store_dwordx4 v[212:215], v34, s[48:51], s67 offen offset:1024 sc1
v_accvgpr_read_b32 v192, a80
v_accvgpr_read_b32 v193, a81
v_accvgpr_read_b32 v194, a82
v_accvgpr_read_b32 v195, a83
v_accvgpr_read_b32 v196, a84
v_accvgpr_read_b32 v197, a85
v_mfma_f32_32x32x16_bf16 v[144:159], v[64:67], v[76:79], v[144:159]
v_accvgpr_read_b32 v198, a86
v_accvgpr_read_b32 v199, a87
v_mul_f32 v192, v192, v19
v_mul_f32 v193, v193, v19
v_mul_f32 v194, v194, v19
v_mul_f32 v195, v195, v19
v_mul_f32 v196, v196, v19
v_mul_f32 v197, v197, v19
v_mfma_f32_32x32x16_bf16 v[160:175], v[68:71], v[72:75], v[160:175]
ds_read_b128 v[80:83], v4 offset:12288
ds_read_b128 v[84:87], v4 offset:13312
ds_read_b64_tr_b16 v[88:89], v6 offset:12288
ds_read_b64_tr_b16 v[90:91], v6 offset:14336
ds_read_b64_tr_b16 v[92:93], v7 offset:12288
ds_read_b64_tr_b16 v[94:95], v7 offset:14336
v_mul_f32 v198, v198, v19
v_mul_f32 v199, v199, v19
v_mfma_f32_32x32x16_bf16 v[176:191], v[68:71], v[76:79], v[176:191]
buffer_load_dwordx4 v2, s[40:43], s56 offen offset:2048 lds
v_cvt_pk_bf16_f32 v216, v192, v193
v_cvt_pk_bf16_f32 v217, v194, v195
v_cvt_pk_bf16_f32 v218, v196, v197
v_cvt_pk_bf16_f32 v219, v198, v199
buffer_store_dwordx4 v[216:219], v34, s[48:51], s67 offen offset:2048 sc1
v_accvgpr_read_b32 v200, a88
v_accvgpr_read_b32 v201, a89
v_accvgpr_read_b32 v202, a90
v_accvgpr_read_b32 v203, a91
s_add_u32 s56, s52, 340992
v_accvgpr_read_b32 v204, a92
v_accvgpr_read_b32 v205, a93
v_accvgpr_read_b32 v206, a94
v_accvgpr_read_b32 v207, a95
v_mul_f32 v200, v200, v19
v_mul_f32 v201, v201, v19
v_mul_f32 v202, v202, v19
v_mul_f32 v203, v203, v19
v_mul_f32 v204, v204, v19
v_mul_f32 v205, v205, v19
v_mul_f32 v206, v206, v19
v_mul_f32 v207, v207, v19
v_cvt_pk_bf16_f32 v220, v200, v201
v_cvt_pk_bf16_f32 v221, v202, v203
v_cvt_pk_bf16_f32 v222, v204, v205
buffer_load_dwordx4 v2, s[40:43], s56 offen offset:3072 lds
v_cvt_pk_bf16_f32 v223, v206, v207
buffer_store_dwordx4 v[220:223], v34, s[48:51], s67 offen offset:3072 sc1
v_accvgpr_read_b32 v192, a96
v_accvgpr_read_b32 v193, a97
v_accvgpr_read_b32 v194, a98
v_accvgpr_read_b32 v195, a99
v_accvgpr_read_b32 v196, a100
s_add_u32 m0, s54, 98304
s_mov_b32 s56, s53
v_accvgpr_read_b32 v197, a101
v_accvgpr_read_b32 v198, a102
v_accvgpr_read_b32 v199, a103
v_mul_f32 v192, v192, v19
v_mul_f32 v193, v193, v19
v_mul_f32 v194, v194, v19
v_mul_f32 v195, v195, v19
v_mul_f32 v196, v196, v19
v_mul_f32 v197, v197, v19
v_mul_f32 v198, v198, v19
v_mul_f32 v199, v199, v19
v_cvt_pk_bf16_f32 v224, v192, v193
v_cvt_pk_bf16_f32 v225, v194, v195
v_cvt_pk_bf16_f32 v226, v196, v197
v_cvt_pk_bf16_f32 v227, v198, v199
buffer_load_dwordx4 v3, s[36:39], s56 offen lds
s_add_u32 s67, s67, 4096
buffer_store_dwordx4 v[224:227], v34, s[48:51], s67 offen sc1
v_accvgpr_read_b32 v200, a104
v_accvgpr_read_b32 v201, a105
v_accvgpr_read_b32 v202, a106
v_accvgpr_read_b32 v203, a107
v_accvgpr_read_b32 v204, a108
s_add_u32 s56, s53, 15360
v_accvgpr_read_b32 v205, a109
v_accvgpr_read_b32 v206, a110
v_accvgpr_read_b32 v207, a111
v_mul_f32 v200, v200, v19
v_mul_f32 v201, v201, v19
v_mul_f32 v202, v202, v19
v_mul_f32 v203, v203, v19
v_mul_f32 v204, v204, v19
v_mul_f32 v205, v205, v19
v_mul_f32 v206, v206, v19
v_mul_f32 v207, v207, v19
v_cvt_pk_bf16_f32 v228, v200, v201
v_cvt_pk_bf16_f32 v229, v202, v203
v_cvt_pk_bf16_f32 v230, v204, v205
v_cvt_pk_bf16_f32 v231, v206, v207
buffer_load_dwordx4 v3, s[36:39], s56 offen offset:1024 lds
buffer_store_dwordx4 v[228:231], v34, s[48:51], s67 offen offset:1024 sc1
v_accvgpr_read_b32 v192, a112
v_accvgpr_read_b32 v193, a113
v_accvgpr_read_b32 v194, a114
v_accvgpr_read_b32 v195, a115
v_accvgpr_read_b32 v196, a116
v_accvgpr_read_b32 v197, a117
s_add_u32 s56, s53, 30720
v_accvgpr_read_b32 v198, a118
v_accvgpr_read_b32 v199, a119
v_mul_f32 v192, v192, v19
v_mul_f32 v193, v193, v19
v_mul_f32 v194, v194, v19
v_mul_f32 v195, v195, v19
v_mul_f32 v196, v196, v19
v_mul_f32 v197, v197, v19
v_mul_f32 v198, v198, v19
v_mul_f32 v199, v199, v19
v_cvt_pk_bf16_f32 v232, v192, v193
v_cvt_pk_bf16_f32 v233, v194, v195
v_cvt_pk_bf16_f32 v234, v196, v197
v_cvt_pk_bf16_f32 v235, v198, v199
buffer_store_dwordx4 v[232:235], v34, s[48:51], s67 offen offset:2048 sc1
buffer_load_dwordx4 v3, s[36:39], s56 offen offset:2048 lds
v_accvgpr_read_b32 v200, a120
v_accvgpr_read_b32 v201, a121
v_accvgpr_read_b32 v202, a122
v_accvgpr_read_b32 v203, a123
v_accvgpr_read_b32 v204, a124
v_accvgpr_read_b32 v205, a125
v_accvgpr_read_b32 v206, a126
s_add_u32 s56, s53, 46080
v_accvgpr_read_b32 v207, a127
v_mul_f32 v200, v200, v19
v_mul_f32 v201, v201, v19
v_mul_f32 v202, v202, v19
v_mul_f32 v203, v203, v19
v_mul_f32 v204, v204, v19
v_mul_f32 v205, v205, v19
v_mul_f32 v206, v206, v19
v_mul_f32 v207, v207, v19
v_cvt_pk_bf16_f32 v236, v200, v201
v_cvt_pk_bf16_f32 v237, v202, v203
v_cvt_pk_bf16_f32 v238, v204, v205
v_cvt_pk_bf16_f32 v239, v206, v207
buffer_store_dwordx4 v[236:239], v34, s[48:51], s67 offen offset:3072 sc1
buffer_load_dwordx4 v3, s[36:39], s56 offen offset:3072 lds
s_add_u32 s52, s52, 4096
s_add_u32 s53, s53, 262144
s_waitcnt lgkmcnt(0)
v_mfma_f32_32x32x16_bf16 v[128:143], v[80:83], v[88:91], v[128:143]
s_waitcnt vmcnt(24)
s_barrier
v_mfma_f32_32x32x16_bf16 v[144:159], v[80:83], v[92:95], v[144:159]
ds_read_b128 v[64:67], v4 offset:32768
ds_read_b128 v[68:71], v4 offset:33792
ds_read_b64_tr_b16 v[72:73], v6 offset:32768
s_add_u32 m0, s57, 0
s_mov_b32 s56, s52
v_mfma_f32_32x32x16_bf16 v[160:175], v[84:87], v[88:91], v[160:175]
ds_read_b64_tr_b16 v[74:75], v6 offset:34816
ds_read_b64_tr_b16 v[76:77], v7 offset:32768
ds_read_b64_tr_b16 v[78:79], v7 offset:34816
v_mfma_f32_32x32x16_bf16 v[176:191], v[84:87], v[92:95], v[176:191]
buffer_load_dwordx4 v2, s[40:43], s56 offen lds
s_add_u32 s56, s52, 113664
s_waitcnt lgkmcnt(0)
v_mfma_f32_32x32x16_bf16 v[128:143], v[64:67], v[72:75], v[128:143]
ds_read_b128 v[80:83], v4 offset:36864
ds_read_b128 v[84:87], v4 offset:37888
buffer_load_dwordx4 v2, s[40:43], s56 offen offset:1024 lds
s_add_u32 s56, s52, 227328
v_mfma_f32_32x32x16_bf16 v[144:159], v[64:67], v[76:79], v[144:159]
ds_read_b64_tr_b16 v[88:89], v6 offset:36864
ds_read_b64_tr_b16 v[90:91], v6 offset:38912
ds_read_b64_tr_b16 v[92:93], v7 offset:36864
v_mfma_f32_32x32x16_bf16 v[160:175], v[68:71], v[72:75], v[160:175]
ds_read_b64_tr_b16 v[94:95], v7 offset:38912
buffer_load_dwordx4 v2, s[40:43], s56 offen offset:2048 lds
s_add_u32 s56, s52, 340992
v_mfma_f32_32x32x16_bf16 v[176:191], v[68:71], v[76:79], v[176:191]
buffer_load_dwordx4 v2, s[40:43], s56 offen offset:3072 lds
s_add_u32 m0, s54, 0
s_mov_b32 s56, s53
s_waitcnt lgkmcnt(0)
v_mfma_f32_32x32x16_bf16 v[128:143], v[80:83], v[88:91], v[128:143]
ds_read_b128 v[64:67], v4 offset:40960
ds_read_b128 v[68:71], v4 offset:41984
ds_read_b64_tr_b16 v[72:73], v6 offset:40960
v_mfma_f32_32x32x16_bf16 v[144:159], v[80:83], v[92:95], v[144:159]
ds_read_b64_tr_b16 v[74:75], v6 offset:43008
ds_read_b64_tr_b16 v[76:77], v7 offset:40960
buffer_load_dwordx4 v3, s[36:39], s56 offen lds
s_add_u32 s56, s53, 15360
v_mfma_f32_32x32x16_bf16 v[160:175], v[84:87], v[88:91], v[160:175]
ds_read_b64_tr_b16 v[78:79], v7 offset:43008
buffer_load_dwordx4 v3, s[36:39], s56 offen offset:1024 lds
s_add_u32 s56, s53, 30720
v_mfma_f32_32x32x16_bf16 v[176:191], v[84:87], v[92:95], v[176:191]
s_mov_b64 exec, 0xffff
buffer_load_dword v15, v14, s[44:47], s69 offen
s_mov_b64 exec, -1
s_waitcnt lgkmcnt(0)
v_mfma_f32_32x32x16_bf16 v[128:143], v[64:67], v[72:75], v[128:143]
ds_read_b128 v[80:83], v4 offset:45056
ds_read_b128 v[84:87], v4 offset:46080
ds_read_b64_tr_b16 v[88:89], v6 offset:45056
v_mfma_f32_32x32x16_bf16 v[144:159], v[64:67], v[76:79], v[144:159]
ds_read_b64_tr_b16 v[90:91], v6 offset:47104
buffer_load_dwordx4 v3, s[36:39], s56 offen offset:2048 lds
ds_read_b64_tr_b16 v[92:93], v7 offset:45056
s_add_u32 s56, s53, 46080
v_mfma_f32_32x32x16_bf16 v[160:175], v[68:71], v[72:75], v[160:175]
ds_read_b64_tr_b16 v[94:95], v7 offset:47104
buffer_load_dwordx4 v3, s[36:39], s56 offen offset:3072 lds
s_add_u32 s52, s52, 4096
s_add_u32 s53, s53, 262144
v_mfma_f32_32x32x16_bf16 v[176:191], v[68:71], v[76:79], v[176:191]
s_waitcnt lgkmcnt(0)
v_mfma_f32_32x32x16_bf16 v[128:143], v[80:83], v[88:91], v[128:143]
s_waitcnt vmcnt(25)
s_barrier
v_mfma_f32_32x32x16_bf16 v[144:159], v[80:83], v[92:95], v[144:159]
ds_read_b128 v[64:67], v5
ds_read_b128 v[68:71], v5 offset:1024
ds_read_b64_tr_b16 v[72:73], v8
s_add_u32 m0, s57, 32768
s_mov_b32 s56, s52
v_mfma_f32_32x32x16_bf16 v[160:175], v[84:87], v[88:91], v[160:175]
ds_read_b64_tr_b16 v[74:75], v8 offset:2048
ds_read_b64_tr_b16 v[76:77], v9
ds_read_b64_tr_b16 v[78:79], v9 offset:2048
v_mfma_f32_32x32x16_bf16 v[176:191], v[84:87], v[92:95], v[176:191]
buffer_load_dwordx4 v2, s[40:43], s56 offen lds
s_add_u32 s56, s52, 113664
s_waitcnt lgkmcnt(0)
v_mfma_f32_32x32x16_bf16 v[128:143], v[64:67], v[72:75], v[128:143]
ds_read_b128 v[80:83], v5 offset:4096
ds_read_b128 v[84:87], v5 offset:5120
buffer_load_dwordx4 v2, s[40:43], s56 offen offset:1024 lds
s_add_u32 s56, s52, 227328
v_mfma_f32_32x32x16_bf16 v[144:159], v[64:67], v[76:79], v[144:159]
ds_read_b64_tr_b16 v[88:89], v8 offset:4096
ds_read_b64_tr_b16 v[90:91], v8 offset:6144
ds_read_b64_tr_b16 v[92:93], v9 offset:4096
v_mfma_f32_32x32x16_bf16 v[160:175], v[68:71], v[72:75], v[160:175]
ds_read_b64_tr_b16 v[94:95], v9 offset:6144
buffer_load_dwordx4 v2, s[40:43], s56 offen offset:2048 lds
s_add_u32 s56, s52, 340992
v_mfma_f32_32x32x16_bf16 v[176:191], v[68:71], v[76:79], v[176:191]
buffer_load_dwordx4 v2, s[40:43], s56 offen offset:3072 lds
s_add_u32 m0, s54, 32768
s_mov_b32 s56, s53
s_waitcnt lgkmcnt(0)
v_mfma_f32_32x32x16_bf16 v[128:143], v[80:83], v[88:91], v[128:143]
ds_read_b128 v[64:67], v5 offset:8192
ds_read_b128 v[68:71], v5 offset:9216
ds_read_b64_tr_b16 v[72:73], v8 offset:8192
v_mfma_f32_32x32x16_bf16 v[144:159], v[80:83], v[92:95], v[144:159]
ds_read_b64_tr_b16 v[74:75], v8 offset:10240
ds_read_b64_tr_b16 v[76:77], v9 offset:8192
buffer_load_dwordx4 v3, s[36:39], s56 offen lds
s_add_u32 s56, s53, 15360
v_mfma_f32_32x32x16_bf16 v[160:175], v[84:87], v[88:91], v[160:175]
ds_read_b64_tr_b16 v[78:79], v9 offset:10240
buffer_load_dwordx4 v3, s[36:39], s56 offen offset:1024 lds
s_add_u32 s56, s53, 30720
v_mfma_f32_32x32x16_bf16 v[176:191], v[84:87], v[92:95], v[176:191]
s_mov_b32 exec_lo, 0xffff0000
s_mov_b32 exec_hi, 0x0
buffer_load_dword v15, v14, s[44:47], s69 offen
s_mov_b64 exec, -1
s_waitcnt lgkmcnt(0)
v_mfma_f32_32x32x16_bf16 v[128:143], v[64:67], v[72:75], v[128:143]
ds_read_b128 v[80:83], v5 offset:12288
ds_read_b128 v[84:87], v5 offset:13312
ds_read_b64_tr_b16 v[88:89], v8 offset:12288
v_mfma_f32_32x32x16_bf16 v[144:159], v[64:67], v[76:79], v[144:159]
ds_read_b64_tr_b16 v[90:91], v8 offset:14336
buffer_load_dwordx4 v3, s[36:39], s56 offen offset:2048 lds
ds_read_b64_tr_b16 v[92:93], v9 offset:12288
s_add_u32 s56, s53, 46080
v_mfma_f32_32x32x16_bf16 v[160:175], v[68:71], v[72:75], v[160:175]
ds_read_b64_tr_b16 v[94:95], v9 offset:14336
buffer_load_dwordx4 v3, s[36:39], s56 offen offset:3072 lds
s_add_u32 s52, s52, 4096
s_add_u32 s53, s53, 262144
v_mfma_f32_32x32x16_bf16 v[176:191], v[68:71], v[76:79], v[176:191]
s_waitcnt vmcnt(19)
s_barrier
s_cmp_lg_u32 s34, 0
s_cbranch_scc1 W64
v_mov_b32 v22, 1
v_mov_b32 v23, 0
s_mov_b64 exec, 1
buffer_store_dword v22, v23, s[48:51], s101 offen sc1
s_mov_b64 exec, -1
W64:
s_waitcnt lgkmcnt(0)
v_mfma_f32_32x32x16_bf16 v[128:143], v[80:83], v[88:91], v[128:143]
s_waitcnt vmcnt(18)
s_barrier
v_mfma_f32_32x32x16_bf16 v[144:159], v[80:83], v[92:95], v[144:159]
ds_read_b128 v[64:67], v5 offset:32768
ds_read_b128 v[68:71], v5 offset:33792
ds_read_b64_tr_b16 v[72:73], v8 offset:32768
s_add_u32 m0, s57, 65536
s_mov_b32 s56, s52
v_mfma_f32_32x32x16_bf16 v[160:175], v[84:87], v[88:91], v[160:175]
ds_read_b64_tr_b16 v[74:75], v8 offset:34816
ds_read_b64_tr_b16 v[76:77], v9 offset:32768
ds_read_b64_tr_b16 v[78:79], v9 offset:34816
v_mfma_f32_32x32x16_bf16 v[176:191], v[84:87], v[92:95], v[176:191]
buffer_load_dwordx4 v2, s[40:43], s56 offen lds
s_add_u32 s56, s52, 113664
s_waitcnt lgkmcnt(0)
v_mfma_f32_32x32x16_bf16 v[128:143], v[64:67], v[72:75], v[128:143]
ds_read_b128 v[80:83], v5 offset:36864
ds_read_b128 v[84:87], v5 offset:37888
buffer_load_dwordx4 v2, s[40:43], s56 offen offset:1024 lds
s_add_u32 s56, s52, 227328
v_mfma_f32_32x32x16_bf16 v[144:159], v[64:67], v[76:79], v[144:159]
ds_read_b64_tr_b16 v[88:89], v8 offset:36864
ds_read_b64_tr_b16 v[90:91], v8 offset:38912
ds_read_b64_tr_b16 v[92:93], v9 offset:36864
v_mfma_f32_32x32x16_bf16 v[160:175], v[68:71], v[72:75], v[160:175]
ds_read_b64_tr_b16 v[94:95], v9 offset:38912
buffer_load_dwordx4 v2, s[40:43], s56 offen offset:2048 lds
s_add_u32 s56, s52, 340992
v_mfma_f32_32x32x16_bf16 v[176:191], v[68:71], v[76:79], v[176:191]
buffer_load_dwordx4 v2, s[40:43], s56 offen offset:3072 lds
s_add_u32 m0, s54, 65536
s_mov_b32 s56, s53
s_waitcnt lgkmcnt(0)
v_mfma_f32_32x32x16_bf16 v[128:143], v[80:83], v[88:91], v[128:143]
ds_read_b128 v[64:67], v5 offset:40960
ds_read_b128 v[68:71], v5 offset:41984
ds_read_b64_tr_b16 v[72:73], v8 offset:40960
v_mfma_f32_32x32x16_bf16 v[144:159], v[80:83], v[92:95], v[144:159]
ds_read_b64_tr_b16 v[74:75], v8 offset:43008
ds_read_b64_tr_b16 v[76:77], v9 offset:40960
buffer_load_dwordx4 v3, s[36:39], s56 offen lds
s_add_u32 s56, s53, 15360
v_mfma_f32_32x32x16_bf16 v[160:175], v[84:87], v[88:91], v[160:175]
ds_read_b64_tr_b16 v[78:79], v9 offset:43008
buffer_load_dwordx4 v3, s[36:39], s56 offen offset:1024 lds
s_add_u32 s56, s53, 30720
v_mfma_f32_32x32x16_bf16 v[176:191], v[84:87], v[92:95], v[176:191]
s_mov_b32 exec_lo, 0x0
s_mov_b32 exec_hi, 0xffff
buffer_load_dword v15, v14, s[44:47], s69 offen
s_mov_b64 exec, -1
s_waitcnt lgkmcnt(0)
v_mfma_f32_32x32x16_bf16 v[128:143], v[64:67], v[72:75], v[128:143]
ds_read_b128 v[80:83], v5 offset:45056
ds_read_b128 v[84:87], v5 offset:46080
ds_read_b64_tr_b16 v[88:89], v8 offset:45056
v_mfma_f32_32x32x16_bf16 v[144:159], v[64:67], v[76:79], v[144:159]
ds_read_b64_tr_b16 v[90:91], v8 offset:47104
buffer_load_dwordx4 v3, s[36:39], s56 offen offset:2048 lds
ds_read_b64_tr_b16 v[92:93], v9 offset:45056
s_add_u32 s56, s53, 46080
v_mfma_f32_32x32x16_bf16 v[160:175], v[68:71], v[72:75], v[160:175]
ds_read_b64_tr_b16 v[94:95], v9 offset:47104
buffer_load_dwordx4 v3, s[36:39], s56 offen offset:3072 lds
s_add_u32 s52, s52, 4096
s_add_u32 s53, s53, 262144
v_mfma_f32_32x32x16_bf16 v[176:191], v[68:71], v[76:79], v[176:191]
s_waitcnt lgkmcnt(0)
v_mfma_f32_32x32x16_bf16 v[128:143], v[80:83], v[88:91], v[128:143]
s_waitcnt vmcnt(18)
s_barrier
v_mfma_f32_32x32x16_bf16 v[144:159], v[80:83], v[92:95], v[144:159]
ds_read_b128 v[64:67], v4
ds_read_b128 v[68:71], v4 offset:1024
ds_read_b64_tr_b16 v[72:73], v6
v_mfma_f32_32x32x16_bf16 v[160:175], v[84:87], v[88:91], v[160:175]
ds_read_b64_tr_b16 v[74:75], v6 offset:2048
ds_read_b64_tr_b16 v[76:77], v7
ds_read_b64_tr_b16 v[78:79], v7 offset:2048
v_mfma_f32_32x32x16_bf16 v[176:191], v[84:87], v[92:95], v[176:191]
s_waitcnt lgkmcnt(0)
v_mfma_f32_32x32x16_bf16 v[128:143], v[64:67], v[72:75], v[128:143]
ds_read_b128 v[80:83], v4 offset:4096
ds_read_b128 v[84:87], v4 offset:5120
ds_read_b64_tr_b16 v[88:89], v6 offset:4096
v_mfma_f32_32x32x16_bf16 v[144:159], v[64:67], v[76:79], v[144:159]
ds_read_b64_tr_b16 v[90:91], v6 offset:6144
ds_read_b64_tr_b16 v[92:93], v7 offset:4096
ds_read_b64_tr_b16 v[94:95], v7 offset:6144
v_mfma_f32_32x32x16_bf16 v[160:175], v[68:71], v[72:75], v[160:175]
v_mfma_f32_32x32x16_bf16 v[176:191], v[68:71], v[76:79], v[176:191]
s_waitcnt lgkmcnt(0)
v_mfma_f32_32x32x16_bf16 v[128:143], v[80:83], v[88:91], v[128:143]
ds_read_b128 v[64:67], v4 offset:8192
ds_read_b128 v[68:71], v4 offset:9216
ds_read_b64_tr_b16 v[72:73], v6 offset:8192
v_mfma_f32_32x32x16_bf16 v[144:159], v[80:83], v[92:95], v[144:159]
ds_read_b64_tr_b16 v[74:75], v6 offset:10240
ds_read_b64_tr_b16 v[76:77], v7 offset:8192
ds_read_b64_tr_b16 v[78:79], v7 offset:10240
v_mfma_f32_32x32x16_bf16 v[160:175], v[84:87], v[88:91], v[160:175]
v_mfma_f32_32x32x16_bf16 v[176:191], v[84:87], v[92:95], v[176:191]
s_mov_b32 exec_lo, 0x0
s_mov_b32 exec_hi, 0xffff0000
buffer_load_dword v15, v14, s[44:47], s69 offen
s_mov_b64 exec, -1
s_waitcnt lgkmcnt(0)
v_mfma_f32_32x32x16_bf16 v[128:143], v[64:67], v[72:75], v[128:143]
ds_read_b128 v[80:83], v4 offset:12288
ds_read_b128 v[84:87], v4 offset:13312
ds_read_b64_tr_b16 v[88:89], v6 offset:12288
v_mfma_f32_32x32x16_bf16 v[144:159], v[64:67], v[76:79], v[144:159]
ds_read_b64_tr_b16 v[90:91], v6 offset:14336
ds_read_b64_tr_b16 v[92:93], v7 offset:12288
ds_read_b64_tr_b16 v[94:95], v7 offset:14336
v_mfma_f32_32x32x16_bf16 v[160:175], v[68:71], v[72:75], v[160:175]
v_mfma_f32_32x32x16_bf16 v[176:191], v[68:71], v[76:79], v[176:191]
s_waitcnt lgkmcnt(0)
v_mfma_f32_32x32x16_bf16 v[128:143], v[80:83], v[88:91], v[128:143]
s_waitcnt vmcnt(10)
s_barrier
v_mfma_f32_32x32x16_bf16 v[144:159], v[80:83], v[92:95], v[144:159]
ds_read_b128 v[64:67], v4 offset:32768
ds_read_b128 v[68:71], v4 offset:33792
ds_read_b64_tr_b16 v[72:73], v6 offset:32768
v_mfma_f32_32x32x16_bf16 v[160:175], v[84:87], v[88:91], v[160:175]
ds_read_b64_tr_b16 v[74:75], v6 offset:34816
ds_read_b64_tr_b16 v[76:77], v7 offset:32768
ds_read_b64_tr_b16 v[78:79], v7 offset:34816
v_mfma_f32_32x32x16_bf16 v[176:191], v[84:87], v[92:95], v[176:191]
s_waitcnt lgkmcnt(0)
v_mfma_f32_32x32x16_bf16 v[128:143], v[64:67], v[72:75], v[128:143]
ds_read_b128 v[80:83], v4 offset:36864
ds_read_b128 v[84:87], v4 offset:37888
ds_read_b64_tr_b16 v[88:89], v6 offset:36864
v_mfma_f32_32x32x16_bf16 v[144:159], v[64:67], v[76:79], v[144:159]
ds_read_b64_tr_b16 v[90:91], v6 offset:38912
ds_read_b64_tr_b16 v[92:93], v7 offset:36864
ds_read_b64_tr_b16 v[94:95], v7 offset:38912
v_mfma_f32_32x32x16_bf16 v[160:175], v[68:71], v[72:75], v[160:175]
v_mfma_f32_32x32x16_bf16 v[176:191], v[68:71], v[76:79], v[176:191]
s_waitcnt lgkmcnt(0)
v_mfma_f32_32x32x16_bf16 v[128:143], v[80:83], v[88:91], v[128:143]
ds_read_b128 v[64:67], v4 offset:40960
ds_read_b128 v[68:71], v4 offset:41984
ds_read_b64_tr_b16 v[72:73], v6 offset:40960
v_mfma_f32_32x32x16_bf16 v[144:159], v[80:83], v[92:95], v[144:159]
ds_read_b64_tr_b16 v[74:75], v6 offset:43008
ds_read_b64_tr_b16 v[76:77], v7 offset:40960
ds_read_b64_tr_b16 v[78:79], v7 offset:43008
v_mfma_f32_32x32x16_bf16 v[160:175], v[84:87], v[88:91], v[160:175]
v_mfma_f32_32x32x16_bf16 v[176:191], v[84:87], v[92:95], v[176:191]
s_waitcnt lgkmcnt(0)
v_mfma_f32_32x32x16_bf16 v[128:143], v[64:67], v[72:75], v[128:143]
ds_read_b128 v[80:83], v4 offset:45056
ds_read_b128 v[84:87], v4 offset:46080
ds_read_b64_tr_b16 v[88:89], v6 offset:45056
v_mfma_f32_32x32x16_bf16 v[144:159], v[64:67], v[76:79], v[144:159]
ds_read_b64_tr_b16 v[90:91], v6 offset:47104
ds_read_b64_tr_b16 v[92:93], v7 offset:45056
ds_read_b64_tr_b16 v[94:95], v7 offset:47104
v_mfma_f32_32x32x16_bf16 v[160:175], v[68:71], v[72:75], v[160:175]
v_mfma_f32_32x32x16_bf16 v[176:191], v[68:71], v[76:79], v[176:191]
s_cmp_lg_u32 s34, 0
s_cbranch_scc1 W65
s_sub_u32 s90, 15, s60
s_min_u32 s91, s60, s90
s_lshl_b32 s91, s91, 7
s_lshl_b32 s90, s62, 5
s_add_u32 s91, s91, s90
s_add_u32 s91, s91, 2297856
v_lshlrev_b32 v25, 2, v0
s_mov_b32 exec_lo, 0xff
s_mov_b32 exec_hi, 0
buffer_load_dword v27, v25, s[48:51], s91 offen sc1
s_mov_b64 exec, -1
W65:
s_waitcnt lgkmcnt(0)
v_mfma_f32_32x32x16_bf16 v[128:143], v[80:83], v[88:91], v[128:143]
s_waitcnt vmcnt(1)
s_barrier
v_mfma_f32_32x32x16_bf16 v[144:159], v[80:83], v[92:95], v[144:159]
ds_read_b128 v[64:67], v5
ds_read_b128 v[68:71], v5 offset:1024
ds_read_b64_tr_b16 v[72:73], v8
v_mfma_f32_32x32x16_bf16 v[160:175], v[84:87], v[88:91], v[160:175]
ds_read_b64_tr_b16 v[74:75], v8 offset:2048
ds_read_b64_tr_b16 v[76:77], v9
ds_read_b64_tr_b16 v[78:79], v9 offset:2048
v_mfma_f32_32x32x16_bf16 v[176:191], v[84:87], v[92:95], v[176:191]
s_waitcnt lgkmcnt(0)
v_mfma_f32_32x32x16_bf16 v[128:143], v[64:67], v[72:75], v[128:143]
ds_read_b128 v[80:83], v5 offset:4096
ds_read_b128 v[84:87], v5 offset:5120
ds_read_b64_tr_b16 v[88:89], v8 offset:4096
v_mfma_f32_32x32x16_bf16 v[144:159], v[64:67], v[76:79], v[144:159]
ds_read_b64_tr_b16 v[90:91], v8 offset:6144
ds_read_b64_tr_b16 v[92:93], v9 offset:4096
ds_read_b64_tr_b16 v[94:95], v9 offset:6144
v_mfma_f32_32x32x16_bf16 v[160:175], v[68:71], v[72:75], v[160:175]
v_mfma_f32_32x32x16_bf16 v[176:191], v[68:71], v[76:79], v[176:191]
s_waitcnt lgkmcnt(0)
v_mfma_f32_32x32x16_bf16 v[128:143], v[80:83], v[88:91], v[128:143]
ds_read_b128 v[64:67], v5 offset:8192
ds_read_b128 v[68:71], v5 offset:9216
ds_read_b64_tr_b16 v[72:73], v8 offset:8192
v_mfma_f32_32x32x16_bf16 v[144:159], v[80:83], v[92:95], v[144:159]
ds_read_b64_tr_b16 v[74:75], v8 offset:10240
ds_read_b64_tr_b16 v[76:77], v9 offset:8192
ds_read_b64_tr_b16 v[78:79], v9 offset:10240
v_mfma_f32_32x32x16_bf16 v[160:175], v[84:87], v[88:91], v[160:175]
v_mfma_f32_32x32x16_bf16 v[176:191], v[84:87], v[92:95], v[176:191]
s_waitcnt lgkmcnt(0)
v_mfma_f32_32x32x16_bf16 v[128:143], v[64:67], v[72:75], v[128:143]
ds_read_b128 v[80:83], v5 offset:12288
ds_read_b128 v[84:87], v5 offset:13312
ds_read_b64_tr_b16 v[88:89], v8 offset:12288
v_mfma_f32_32x32x16_bf16 v[144:159], v[64:67], v[76:79], v[144:159]
ds_read_b64_tr_b16 v[90:91], v8 offset:14336
ds_read_b64_tr_b16 v[92:93], v9 offset:12288
ds_read_b64_tr_b16 v[94:95], v9 offset:14336
v_mfma_f32_32x32x16_bf16 v[160:175], v[68:71], v[72:75], v[160:175]
v_mfma_f32_32x32x16_bf16 v[176:191], v[68:71], v[76:79], v[176:191]
s_waitcnt lgkmcnt(0)
v_mfma_f32_32x32x16_bf16 v[128:143], v[80:83], v[88:91], v[128:143]
v_mfma_f32_32x32x16_bf16 v[144:159], v[80:83], v[92:95], v[144:159]
v_mfma_f32_32x32x16_bf16 v[160:175], v[84:87], v[88:91], v[160:175]
v_mfma_f32_32x32x16_bf16 v[176:191], v[84:87], v[92:95], v[176:191]
s_cmp_lg_u32 s34, 0
s_cbranch_scc1 W66
s_waitcnt vmcnt(0)
s_mov_b32 exec_lo, 0xff
s_mov_b32 exec_hi, 0
v_cmp_gt_u32 vcc, 1, v27
s_mov_b64 exec, -1
s_cbranch_vccz CK67
s_sub_u32 s90, 15, s60
s_min_u32 s91, s60, s90
s_lshl_b32 s91, s91, 7
s_lshl_b32 s90, s62, 5
s_add_u32 s91, s91, s90
s_add_u32 s91, s91, 2297856
v_lshlrev_b32 v25, 2, v0
s_mov_b32 s90, 200000
s_mov_b32 exec_lo, 0xff
s_mov_b32 exec_hi, 0
PL68:
buffer_load_dword v24, v25, s[48:51], s91 offen sc1
s_waitcnt vmcnt(0)
v_cmp_gt_u32 vcc, 1, v24
s_cbranch_vccz PD69
s_sub_u32 s90, s90, 1
s_cbranch_scc1 PD69
s_sleep 1
s_branch PL68
PD69:
s_mov_b64 exec, -1
CK67:
W66:
s_barrier
s_mov_b32 s36, s14
s_mov_b32 s37, s15
s_mov_b32 s38, 0x400000
s_mov_b32 s39, 0x20000
s_mov_b32 s40, s32
s_mov_b32 s41, s33
s_mov_b32 s42, 0x5000000
s_mov_b32 s43, 0x20000
v_lshlrev_b32 v2, 4, v0
v_lshrrev_b32 v24, 4, v0
v_lshlrev_b32 v25, 2, v24
v_and_b32 v26, 15, v0
v_xor_b32 v26, v26, v25
v_lshlrev_b32 v26, 4, v26
v_mul_u32_u24 v24, 1024, v24
v_add_u32 v26, v26, v24
s_mul_i32 s56, s34, 16384
v_add_u32 v3, s56, v26
s_and_b32 s56, s34, 1
s_lshl_b32 s56, s56, 11
s_add_u32 s56, s56, 0
v_lshlrev_b32 v24, 4, v0
v_add_u32 v10, s56, v24
v_bfe_u32 v24, v0, 2, 2
v_lshrrev_b32 v25, 5, v0
v_lshl_add_u32 v25, v25, 2, v24
v_lshlrev_b32 v25, 8, v25
v_bfe_u32 v26, v0, 4, 1
v_lshlrev_b32 v26, 5, v26
v_and_b32 v27, 3, v0
v_lshl_add_u32 v26, v27, 3, v26
v_add_u32 v25, v25, v26
v_add_u32 v25, 16384, v25
v_lshlrev_b32 v24, 6, v24
s_lshr_b32 s56, s34, 1
s_lshl_b32 s56, s56, 7
s_add_u32 s55, s56, 0
v_xor_b32 v26, s55, v24
v_add_u32 v11, v25, v26
s_add_u32 s55, s56, 64
v_xor_b32 v26, s55, v24
v_add_u32 v12, v25, v26
s_lshl_b32 s57, s34, 12
s_add_u32 s57, s57, 0
s_add_u32 s54, s57, 16384
v_mov_b32 v4, v10
v_add_u32 v5, 0x10000, v10
v_mov_b32 v6, v11
v_mov_b32 v7, v12
v_add_u32 v8, 0x10000, v11
v_add_u32 v9, 0x10000, v12
s_lshl_b32 s52, s60, 20
s_lshl_b32 s63, s62, 16
s_add_u32 s52, s52, s63
s_lshl_b32 s63, s34, 10
s_add_u32 s52, s52, s63
s_add_u32 s52, s52, 41943040
s_lshl_b32 s53, s62, 20
s_lshl_b32 s63, s61, 8
s_add_u32 s53, s53, s63
s_add_u32 m0, s57, 0
s_mov_b32 s56, s52
buffer_load_dwordx4 v2, s[40:43], s56 offen lds
s_add_u32 s56, s52, 261120
buffer_load_dwordx4 v2, s[40:43], s56 offen offset:1024 lds
s_add_u32 s56, s52, 522240
buffer_load_dwordx4 v2, s[40:43], s56 offen offset:2048 lds
s_add_u32 s56, s52, 783360
buffer_load_dwordx4 v2, s[40:43], s56 offen offset:3072 lds
s_add_u32 m0, s54, 0
s_mov_b32 s56, s53
buffer_load_dwordx4 v3, s[36:39], s56 offen lds
s_add_u32 s56, s53, 3072
buffer_load_dwordx4 v3, s[36:39], s56 offen offset:1024 lds
s_add_u32 s56, s53, 6144
buffer_load_dwordx4 v3, s[36:39], s56 offen offset:2048 lds
s_add_u32 s56, s53, 9216
buffer_load_dwordx4 v3, s[36:39], s56 offen offset:3072 lds
s_add_u32 s52, s52, 4096
s_add_u32 s53, s53, 65536
s_add_u32 m0, s57, 32768
s_mov_b32 s56, s52
buffer_load_dwordx4 v2, s[40:43], s56 offen lds
s_add_u32 s56, s52, 261120
buffer_load_dwordx4 v2, s[40:43], s56 offen offset:1024 lds
s_add_u32 s56, s52, 522240
buffer_load_dwordx4 v2, s[40:43], s56 offen offset:2048 lds
s_add_u32 s56, s52, 783360
buffer_load_dwordx4 v2, s[40:43], s56 offen offset:3072 lds
s_add_u32 m0, s54, 32768
s_mov_b32 s56, s53
buffer_load_dwordx4 v3, s[36:39], s56 offen lds
s_add_u32 s56, s53, 3072
buffer_load_dwordx4 v3, s[36:39], s56 offen offset:1024 lds
s_add_u32 s56, s53, 6144
buffer_load_dwordx4 v3, s[36:39], s56 offen offset:2048 lds
s_add_u32 s56, s53, 9216
buffer_load_dwordx4 v3, s[36:39], s56 offen offset:3072 lds
s_add_u32 s52, s52, 4096
s_add_u32 s53, s53, 65536
s_add_u32 m0, s57, 65536
s_mov_b32 s56, s52
buffer_load_dwordx4 v2, s[40:43], s56 offen lds
s_add_u32 s56, s52, 261120
buffer_load_dwordx4 v2, s[40:43], s56 offen offset:1024 lds
s_add_u32 s56, s52, 522240
buffer_load_dwordx4 v2, s[40:43], s56 offen offset:2048 lds
s_add_u32 s56, s52, 783360
buffer_load_dwordx4 v2, s[40:43], s56 offen offset:3072 lds
s_add_u32 m0, s54, 65536
s_mov_b32 s56, s53
buffer_load_dwordx4 v3, s[36:39], s56 offen lds
s_add_u32 s56, s53, 3072
buffer_load_dwordx4 v3, s[36:39], s56 offen offset:1024 lds
s_add_u32 s56, s53, 6144
buffer_load_dwordx4 v3, s[36:39], s56 offen offset:2048 lds
s_add_u32 s56, s53, 9216
buffer_load_dwordx4 v3, s[36:39], s56 offen offset:3072 lds
s_add_u32 s52, s52, 4096
s_add_u32 s53, s53, 65536
v_sub_f32 v28, 1.0, v28
v_sub_f32 v29, 1.0, v29
s_nop 7
s_nop 3
v_mul_f32 v128, v128, v28
v_mul_f32 v129, v129, v28
v_mul_f32 v130, v130, v28
v_mul_f32 v131, v131, v28
v_mul_f32 v132, v132, v28
v_mul_f32 v133, v133, v28
v_mul_f32 v134, v134, v28
v_mul_f32 v135, v135, v28
v_mul_f32 v136, v136, v28
v_mul_f32 v137, v137, v28
v_mul_f32 v138, v138, v28
v_mul_f32 v139, v139, v28
v_mul_f32 v140, v140, v28
v_mul_f32 v141, v141, v28
v_mul_f32 v142, v142, v28
v_mul_f32 v143, v143, v28
v_mul_f32 v144, v144, v29
v_mul_f32 v145, v145, v29
v_mul_f32 v146, v146, v29
v_mul_f32 v147, v147, v29
v_mul_f32 v148, v148, v29
v_mul_f32 v149, v149, v29
v_mul_f32 v150, v150, v29
v_mul_f32 v151, v151, v29
v_mul_f32 v152, v152, v29
v_mul_f32 v153, v153, v29
v_mul_f32 v154, v154, v29
v_mul_f32 v155, v155, v29
v_mul_f32 v156, v156, v29
v_mul_f32 v157, v157, v29
v_mul_f32 v158, v158, v29
v_mul_f32 v159, v159, v29
v_mul_f32 v160, v160, v28
v_mul_f32 v161, v161, v28
v_mul_f32 v162, v162, v28
v_mul_f32 v163, v163, v28
v_mul_f32 v164, v164, v28
v_mul_f32 v165, v165, v28
v_mul_f32 v166, v166, v28
v_mul_f32 v167, v167, v28
v_mul_f32 v168, v168, v28
v_mul_f32 v169, v169, v28
v_mul_f32 v170, v170, v28
v_mul_f32 v171, v171, v28
v_mul_f32 v172, v172, v28
v_mul_f32 v173, v173, v28
v_mul_f32 v174, v174, v28
v_mul_f32 v175, v175, v28
v_mul_f32 v176, v176, v29
v_mul_f32 v177, v177, v29
v_mul_f32 v178, v178, v29
v_mul_f32 v179, v179, v29
v_mul_f32 v180, v180, v29
v_mul_f32 v181, v181, v29
v_mul_f32 v182, v182, v29
v_mul_f32 v183, v183, v29
v_mul_f32 v184, v184, v29
v_mul_f32 v185, v185, v29
v_mul_f32 v186, v186, v29
v_mul_f32 v187, v187, v29
v_mul_f32 v188, v188, v29
v_mul_f32 v189, v189, v29
v_mul_f32 v190, v190, v29
v_mul_f32 v191, v191, v29
s_waitcnt vmcnt(16)
s_barrier
ds_read_b128 v[64:67], v4
ds_read_b128 v[68:71], v4 offset:1024
ds_read_b64_tr_b16 v[72:73], v6
ds_read_b64_tr_b16 v[74:75], v6 offset:2048
ds_read_b64_tr_b16 v[76:77], v7
ds_read_b64_tr_b16 v[78:79], v7 offset:2048
s_waitcnt lgkmcnt(0)
v_mfma_f32_32x32x16_bf16 v[128:143], v[72:75], v[64:67], v[128:143]
ds_read_b128 v[80:83], v4 offset:4096
ds_read_b128 v[84:87], v4 offset:5120
ds_read_b64_tr_b16 v[88:89], v6 offset:4096
s_add_u32 m0, s57, 98304
s_mov_b32 s56, s52
v_mfma_f32_32x32x16_bf16 v[144:159], v[72:75], v[68:71], v[144:159]
buffer_load_dwordx4 v2, s[40:43], s56 offen lds
ds_read_b64_tr_b16 v[90:91], v6 offset:6144
ds_read_b64_tr_b16 v[92:93], v7 offset:4096
s_add_u32 s56, s52, 261120
v_mfma_f32_32x32x16_bf16 v[160:175], v[76:79], v[64:67], v[160:175]
ds_read_b64_tr_b16 v[94:95], v7 offset:6144
buffer_load_dwordx4 v2, s[40:43], s56 offen offset:1024 lds
s_add_u32 s56, s52, 522240
v_mfma_f32_32x32x16_bf16 v[176:191], v[76:79], v[68:71], v[176:191]
buffer_load_dwordx4 v2, s[40:43], s56 offen offset:2048 lds
s_add_u32 s56, s52, 783360
s_waitcnt lgkmcnt(0)
v_mfma_f32_32x32x16_bf16 v[128:143], v[88:91], v[80:83], v[128:143]
ds_read_b128 v[64:67], v4 offset:8192
ds_read_b128 v[68:71], v4 offset:9216
ds_read_b64_tr_b16 v[72:73], v6 offset:8192
v_mfma_f32_32x32x16_bf16 v[144:159], v[88:91], v[84:87], v[144:159]
ds_read_b64_tr_b16 v[74:75], v6 offset:10240
buffer_load_dwordx4 v2, s[40:43], s56 offen offset:3072 lds
ds_read_b64_tr_b16 v[76:77], v7 offset:8192
s_add_u32 m0, s54, 98304
s_mov_b32 s56, s53
v_mfma_f32_32x32x16_bf16 v[160:175], v[92:95], v[80:83], v[160:175]
ds_read_b64_tr_b16 v[78:79], v7 offset:10240
buffer_load_dwordx4 v3, s[36:39], s56 offen lds
s_add_u32 s56, s53, 3072
v_mfma_f32_32x32x16_bf16 v[176:191], v[92:95], v[84:87], v[176:191]
buffer_load_dwordx4 v3, s[36:39], s56 offen offset:1024 lds
s_add_u32 s56, s53, 6144
s_waitcnt lgkmcnt(0)
v_mfma_f32_32x32x16_bf16 v[128:143], v[72:75], v[64:67], v[128:143]
ds_read_b128 v[80:83], v4 offset:12288
ds_read_b128 v[84:87], v4 offset:13312
ds_read_b64_tr_b16 v[88:89], v6 offset:12288
v_mfma_f32_32x32x16_bf16 v[144:159], v[72:75], v[68:71], v[144:159]
ds_read_b64_tr_b16 v[90:91], v6 offset:14336
ds_read_b64_tr_b16 v[92:93], v7 offset:12288
buffer_load_dwordx4 v3, s[36:39], s56 offen offset:2048 lds
s_add_u32 s56, s53, 9216
v_mfma_f32_32x32x16_bf16 v[160:175], v[76:79], v[64:67], v[160:175]
ds_read_b64_tr_b16 v[94:95], v7 offset:14336
buffer_load_dwordx4 v3, s[36:39], s56 offen offset:3072 lds
s_add_u32 s52, s52, 4096
s_add_u32 s53, s53, 65536
v_mfma_f32_32x32x16_bf16 v[176:191], v[76:79], v[68:71], v[176:191]
s_waitcnt lgkmcnt(0)
v_mfma_f32_32x32x16_bf16 v[128:143], v[88:91], v[80:83], v[128:143]
s_waitcnt vmcnt(16)
s_barrier
v_mfma_f32_32x32x16_bf16 v[144:159], v[88:91], v[84:87], v[144:159]
ds_read_b128 v[64:67], v4 offset:32768
ds_read_b128 v[68:71], v4 offset:33792
ds_read_b64_tr_b16 v[72:73], v6 offset:32768
s_add_u32 m0, s57, 0
s_mov_b32 s56, s52
v_mfma_f32_32x32x16_bf16 v[160:175], v[92:95], v[80:83], v[160:175]
ds_read_b64_tr_b16 v[74:75], v6 offset:34816
ds_read_b64_tr_b16 v[76:77], v7 offset:32768
ds_read_b64_tr_b16 v[78:79], v7 offset:34816
v_mfma_f32_32x32x16_bf16 v[176:191], v[92:95], v[84:87], v[176:191]
buffer_load_dwordx4 v2, s[40:43], s56 offen lds
s_add_u32 s56, s52, 261120
s_waitcnt lgkmcnt(0)
v_mfma_f32_32x32x16_bf16 v[128:143], v[72:75], v[64:67], v[128:143]
ds_read_b128 v[80:83], v4 offset:36864
ds_read_b128 v[84:87], v4 offset:37888
buffer_load_dwordx4 v2, s[40:43], s56 offen offset:1024 lds
s_add_u32 s56, s52, 522240
v_mfma_f32_32x32x16_bf16 v[144:159], v[72:75], v[68:71], v[144:159]
ds_read_b64_tr_b16 v[88:89], v6 offset:36864
ds_read_b64_tr_b16 v[90:91], v6 offset:38912
ds_read_b64_tr_b16 v[92:93], v7 offset:36864
v_mfma_f32_32x32x16_bf16 v[160:175], v[76:79], v[64:67], v[160:175]
ds_read_b64_tr_b16 v[94:95], v7 offset:38912
buffer_load_dwordx4 v2, s[40:43], s56 offen offset:2048 lds
s_add_u32 s56, s52, 783360
v_mfma_f32_32x32x16_bf16 v[176:191], v[76:79], v[68:71], v[176:191]
buffer_load_dwordx4 v2, s[40:43], s56 offen offset:3072 lds
s_add_u32 m0, s54, 0
s_mov_b32 s56, s53
s_waitcnt lgkmcnt(0)
v_mfma_f32_32x32x16_bf16 v[128:143], v[88:91], v[80:83], v[128:143]
ds_read_b128 v[64:67], v4 offset:40960
ds_read_b128 v[68:71], v4 offset:41984
ds_read_b64_tr_b16 v[72:73], v6 offset:40960
v_mfma_f32_32x32x16_bf16 v[144:159], v[88:91], v[84:87], v[144:159]
ds_read_b64_tr_b16 v[74:75], v6 offset:43008
ds_read_b64_tr_b16 v[76:77], v7 offset:40960
buffer_load_dwordx4 v3, s[36:39], s56 offen lds
s_add_u32 s56, s53, 3072
v_mfma_f32_32x32x16_bf16 v[160:175], v[92:95], v[80:83], v[160:175]
ds_read_b64_tr_b16 v[78:79], v7 offset:43008
buffer_load_dwordx4 v3, s[36:39], s56 offen offset:1024 lds
s_add_u32 s56, s53, 6144
v_mfma_f32_32x32x16_bf16 v[176:191], v[92:95], v[84:87], v[176:191]
s_waitcnt lgkmcnt(0)
v_mfma_f32_32x32x16_bf16 v[128:143], v[72:75], v[64:67], v[128:143]
ds_read_b128 v[80:83], v4 offset:45056
ds_read_b128 v[84:87], v4 offset:46080
ds_read_b64_tr_b16 v[88:89], v6 offset:45056
v_mfma_f32_32x32x16_bf16 v[144:159], v[72:75], v[68:71], v[144:159]
ds_read_b64_tr_b16 v[90:91], v6 offset:47104
buffer_load_dwordx4 v3, s[36:39], s56 offen offset:2048 lds
ds_read_b64_tr_b16 v[92:93], v7 offset:45056
s_add_u32 s56, s53, 9216
v_mfma_f32_32x32x16_bf16 v[160:175], v[76:79], v[64:67], v[160:175]
ds_read_b64_tr_b16 v[94:95], v7 offset:47104
buffer_load_dwordx4 v3, s[36:39], s56 offen offset:3072 lds
s_add_u32 s52, s52, 4096
s_add_u32 s53, s53, 65536
v_mfma_f32_32x32x16_bf16 v[176:191], v[76:79], v[68:71], v[176:191]
s_waitcnt lgkmcnt(0)
v_mfma_f32_32x32x16_bf16 v[128:143], v[88:91], v[80:83], v[128:143]
s_waitcnt vmcnt(16)
s_barrier
v_mfma_f32_32x32x16_bf16 v[144:159], v[88:91], v[84:87], v[144:159]
ds_read_b128 v[64:67], v5
ds_read_b128 v[68:71], v5 offset:1024
ds_read_b64_tr_b16 v[72:73], v8
s_add_u32 m0, s57, 32768
s_mov_b32 s56, s52
v_mfma_f32_32x32x16_bf16 v[160:175], v[92:95], v[80:83], v[160:175]
ds_read_b64_tr_b16 v[74:75], v8 offset:2048
ds_read_b64_tr_b16 v[76:77], v9
ds_read_b64_tr_b16 v[78:79], v9 offset:2048
v_mfma_f32_32x32x16_bf16 v[176:191], v[92:95], v[84:87], v[176:191]
buffer_load_dwordx4 v2, s[40:43], s56 offen lds
s_add_u32 s56, s52, 261120
s_waitcnt lgkmcnt(0)
v_mfma_f32_32x32x16_bf16 v[128:143], v[72:75], v[64:67], v[128:143]
ds_read_b128 v[80:83], v5 offset:4096
ds_read_b128 v[84:87], v5 offset:5120
buffer_load_dwordx4 v2, s[40:43], s56 offen offset:1024 lds
s_add_u32 s56, s52, 522240
v_mfma_f32_32x32x16_bf16 v[144:159], v[72:75], v[68:71], v[144:159]
ds_read_b64_tr_b16 v[88:89], v8 offset:4096
ds_read_b64_tr_b16 v[90:91], v8 offset:6144
ds_read_b64_tr_b16 v[92:93], v9 offset:4096
v_mfma_f32_32x32x16_bf16 v[160:175], v[76:79], v[64:67], v[160:175]
ds_read_b64_tr_b16 v[94:95], v9 offset:6144
buffer_load_dwordx4 v2, s[40:43], s56 offen offset:2048 lds
s_add_u32 s56, s52, 783360
v_mfma_f32_32x32x16_bf16 v[176:191], v[76:79], v[68:71], v[176:191]
buffer_load_dwordx4 v2, s[40:43], s56 offen offset:3072 lds
s_add_u32 m0, s54, 32768
s_mov_b32 s56, s53
s_waitcnt lgkmcnt(0)
v_mfma_f32_32x32x16_bf16 v[128:143], v[88:91], v[80:83], v[128:143]
ds_read_b128 v[64:67], v5 offset:8192
ds_read_b128 v[68:71], v5 offset:9216
ds_read_b64_tr_b16 v[72:73], v8 offset:8192
v_mfma_f32_32x32x16_bf16 v[144:159], v[88:91], v[84:87], v[144:159]
ds_read_b64_tr_b16 v[74:75], v8 offset:10240
ds_read_b64_tr_b16 v[76:77], v9 offset:8192
buffer_load_dwordx4 v3, s[36:39], s56 offen lds
s_add_u32 s56, s53, 3072
v_mfma_f32_32x32x16_bf16 v[160:175], v[92:95], v[80:83], v[160:175]
ds_read_b64_tr_b16 v[78:79], v9 offset:10240
buffer_load_dwordx4 v3, s[36:39], s56 offen offset:1024 lds
s_add_u32 s56, s53, 6144
v_mfma_f32_32x32x16_bf16 v[176:191], v[92:95], v[84:87], v[176:191]
s_waitcnt lgkmcnt(0)
v_mfma_f32_32x32x16_bf16 v[128:143], v[72:75], v[64:67], v[128:143]
ds_read_b128 v[80:83], v5 offset:12288
ds_read_b128 v[84:87], v5 offset:13312
ds_read_b64_tr_b16 v[88:89], v8 offset:12288
v_mfma_f32_32x32x16_bf16 v[144:159], v[72:75], v[68:71], v[144:159]
ds_read_b64_tr_b16 v[90:91], v8 offset:14336
buffer_load_dwordx4 v3, s[36:39], s56 offen offset:2048 lds
ds_read_b64_tr_b16 v[92:93], v9 offset:12288
s_add_u32 s56, s53, 9216
v_mfma_f32_32x32x16_bf16 v[160:175], v[76:79], v[64:67], v[160:175]
ds_read_b64_tr_b16 v[94:95], v9 offset:14336
buffer_load_dwordx4 v3, s[36:39], s56 offen offset:3072 lds
s_add_u32 s52, s52, 4096
s_add_u32 s53, s53, 65536
v_mfma_f32_32x32x16_bf16 v[176:191], v[76:79], v[68:71], v[176:191]
s_waitcnt lgkmcnt(0)
v_mfma_f32_32x32x16_bf16 v[128:143], v[88:91], v[80:83], v[128:143]
s_waitcnt vmcnt(16)
s_barrier
v_mfma_f32_32x32x16_bf16 v[144:159], v[88:91], v[84:87], v[144:159]
ds_read_b128 v[64:67], v5 offset:32768
ds_read_b128 v[68:71], v5 offset:33792
ds_read_b64_tr_b16 v[72:73], v8 offset:32768
s_add_u32 m0, s57, 65536
s_mov_b32 s56, s52
v_mfma_f32_32x32x16_bf16 v[160:175], v[92:95], v[80:83], v[160:175]
ds_read_b64_tr_b16 v[74:75], v8 offset:34816
ds_read_b64_tr_b16 v[76:77], v9 offset:32768
ds_read_b64_tr_b16 v[78:79], v9 offset:34816
v_mfma_f32_32x32x16_bf16 v[176:191], v[92:95], v[84:87], v[176:191]
buffer_load_dwordx4 v2, s[40:43], s56 offen lds
s_add_u32 s56, s52, 261120
s_waitcnt lgkmcnt(0)
v_mfma_f32_32x32x16_bf16 v[128:143], v[72:75], v[64:67], v[128:143]
ds_read_b128 v[80:83], v5 offset:36864
ds_read_b128 v[84:87], v5 offset:37888
buffer_load_dwordx4 v2, s[40:43], s56 offen offset:1024 lds
s_add_u32 s56, s52, 522240
v_mfma_f32_32x32x16_bf16 v[144:159], v[72:75], v[68:71], v[144:159]
ds_read_b64_tr_b16 v[88:89], v8 offset:36864
ds_read_b64_tr_b16 v[90:91], v8 offset:38912
ds_read_b64_tr_b16 v[92:93], v9 offset:36864
v_mfma_f32_32x32x16_bf16 v[160:175], v[76:79], v[64:67], v[160:175]
ds_read_b64_tr_b16 v[94:95], v9 offset:38912
buffer_load_dwordx4 v2, s[40:43], s56 offen offset:2048 lds
s_add_u32 s56, s52, 783360
v_mfma_f32_32x32x16_bf16 v[176:191], v[76:79], v[68:71], v[176:191]
buffer_load_dwordx4 v2, s[40:43], s56 offen offset:3072 lds
s_add_u32 m0, s54, 65536
s_mov_b32 s56, s53
s_waitcnt lgkmcnt(0)
v_mfma_f32_32x32x16_bf16 v[128:143], v[88:91], v[80:83], v[128:143]
ds_read_b128 v[64:67], v5 offset:40960
ds_read_b128 v[68:71], v5 offset:41984
ds_read_b64_tr_b16 v[72:73], v8 offset:40960
v_mfma_f32_32x32x16_bf16 v[144:159], v[88:91], v[84:87], v[144:159]
ds_read_b64_tr_b16 v[74:75], v8 offset:43008
ds_read_b64_tr_b16 v[76:77], v9 offset:40960
buffer_load_dwordx4 v3, s[36:39], s56 offen lds
s_add_u32 s56, s53, 3072
v_mfma_f32_32x32x16_bf16 v[160:175], v[92:95], v[80:83], v[160:175]
ds_read_b64_tr_b16 v[78:79], v9 offset:43008
buffer_load_dwordx4 v3, s[36:39], s56 offen offset:1024 lds
s_add_u32 s56, s53, 6144
v_mfma_f32_32x32x16_bf16 v[176:191], v[92:95], v[84:87], v[176:191]
s_waitcnt lgkmcnt(0)
v_mfma_f32_32x32x16_bf16 v[128:143], v[72:75], v[64:67], v[128:143]
ds_read_b128 v[80:83], v5 offset:45056
ds_read_b128 v[84:87], v5 offset:46080
ds_read_b64_tr_b16 v[88:89], v8 offset:45056
v_mfma_f32_32x32x16_bf16 v[144:159], v[72:75], v[68:71], v[144:159]
ds_read_b64_tr_b16 v[90:91], v8 offset:47104
buffer_load_dwordx4 v3, s[36:39], s56 offen offset:2048 lds
ds_read_b64_tr_b16 v[92:93], v9 offset:45056
s_add_u32 s56, s53, 9216
v_mfma_f32_32x32x16_bf16 v[160:175], v[76:79], v[64:67], v[160:175]
ds_read_b64_tr_b16 v[94:95], v9 offset:47104
buffer_load_dwordx4 v3, s[36:39], s56 offen offset:3072 lds
s_add_u32 s52, s52, 4096
s_add_u32 s53, s53, 65536
v_mfma_f32_32x32x16_bf16 v[176:191], v[76:79], v[68:71], v[176:191]
s_waitcnt lgkmcnt(0)
v_mfma_f32_32x32x16_bf16 v[128:143], v[88:91], v[80:83], v[128:143]
s_waitcnt vmcnt(16)
s_barrier
v_mfma_f32_32x32x16_bf16 v[144:159], v[88:91], v[84:87], v[144:159]
ds_read_b128 v[64:67], v4
ds_read_b128 v[68:71], v4 offset:1024
ds_read_b64_tr_b16 v[72:73], v6
s_add_u32 m0, s57, 98304
s_mov_b32 s56, s52
v_mfma_f32_32x32x16_bf16 v[160:175], v[92:95], v[80:83], v[160:175]
ds_read_b64_tr_b16 v[74:75], v6 offset:2048
ds_read_b64_tr_b16 v[76:77], v7
ds_read_b64_tr_b16 v[78:79], v7 offset:2048
v_mfma_f32_32x32x16_bf16 v[176:191], v[92:95], v[84:87], v[176:191]
buffer_load_dwordx4 v2, s[40:43], s56 offen lds
s_add_u32 s56, s52, 261120
s_waitcnt lgkmcnt(0)
v_mfma_f32_32x32x16_bf16 v[128:143], v[72:75], v[64:67], v[128:143]
ds_read_b128 v[80:83], v4 offset:4096
ds_read_b128 v[84:87], v4 offset:5120
buffer_load_dwordx4 v2, s[40:43], s56 offen offset:1024 lds
s_add_u32 s56, s52, 522240
v_mfma_f32_32x32x16_bf16 v[144:159], v[72:75], v[68:71], v[144:159]
ds_read_b64_tr_b16 v[88:89], v6 offset:4096
ds_read_b64_tr_b16 v[90:91], v6 offset:6144
ds_read_b64_tr_b16 v[92:93], v7 offset:4096
v_mfma_f32_32x32x16_bf16 v[160:175], v[76:79], v[64:67], v[160:175]
ds_read_b64_tr_b16 v[94:95], v7 offset:6144
buffer_load_dwordx4 v2, s[40:43], s56 offen offset:2048 lds
s_add_u32 s56, s52, 783360
v_mfma_f32_32x32x16_bf16 v[176:191], v[76:79], v[68:71], v[176:191]
buffer_load_dwordx4 v2, s[40:43], s56 offen offset:3072 lds
s_add_u32 m0, s54, 98304
s_mov_b32 s56, s53
s_waitcnt lgkmcnt(0)
v_mfma_f32_32x32x16_bf16 v[128:143], v[88:91], v[80:83], v[128:143]
ds_read_b128 v[64:67], v4 offset:8192
ds_read_b128 v[68:71], v4 offset:9216
ds_read_b64_tr_b16 v[72:73], v6 offset:8192
v_mfma_f32_32x32x16_bf16 v[144:159], v[88:91], v[84:87], v[144:159]
ds_read_b64_tr_b16 v[74:75], v6 offset:10240
ds_read_b64_tr_b16 v[76:77], v7 offset:8192
buffer_load_dwordx4 v3, s[36:39], s56 offen lds
s_add_u32 s56, s53, 3072
v_mfma_f32_32x32x16_bf16 v[160:175], v[92:95], v[80:83], v[160:175]
ds_read_b64_tr_b16 v[78:79], v7 offset:10240
buffer_load_dwordx4 v3, s[36:39], s56 offen offset:1024 lds
s_add_u32 s56, s53, 6144
v_mfma_f32_32x32x16_bf16 v[176:191], v[92:95], v[84:87], v[176:191]
s_waitcnt lgkmcnt(0)
v_mfma_f32_32x32x16_bf16 v[128:143], v[72:75], v[64:67], v[128:143]
ds_read_b128 v[80:83], v4 offset:12288
ds_read_b128 v[84:87], v4 offset:13312
ds_read_b64_tr_b16 v[88:89], v6 offset:12288
v_mfma_f32_32x32x16_bf16 v[144:159], v[72:75], v[68:71], v[144:159]
ds_read_b64_tr_b16 v[90:91], v6 offset:14336
buffer_load_dwordx4 v3, s[36:39], s56 offen offset:2048 lds
ds_read_b64_tr_b16 v[92:93], v7 offset:12288
s_add_u32 s56, s53, 9216
v_mfma_f32_32x32x16_bf16 v[160:175], v[76:79], v[64:67], v[160:175]
ds_read_b64_tr_b16 v[94:95], v7 offset:14336
buffer_load_dwordx4 v3, s[36:39], s56 offen offset:3072 lds
s_add_u32 s52, s52, 4096
s_add_u32 s53, s53, 65536
v_mfma_f32_32x32x16_bf16 v[176:191], v[76:79], v[68:71], v[176:191]
s_waitcnt lgkmcnt(0)
v_mfma_f32_32x32x16_bf16 v[128:143], v[88:91], v[80:83], v[128:143]
s_waitcnt vmcnt(16)
s_barrier
v_mfma_f32_32x32x16_bf16 v[144:159], v[88:91], v[84:87], v[144:159]
ds_read_b128 v[64:67], v4 offset:32768
ds_read_b128 v[68:71], v4 offset:33792
ds_read_b64_tr_b16 v[72:73], v6 offset:32768
s_add_u32 m0, s57, 0
s_mov_b32 s56, s52
v_mfma_f32_32x32x16_bf16 v[160:175], v[92:95], v[80:83], v[160:175]
ds_read_b64_tr_b16 v[74:75], v6 offset:34816
ds_read_b64_tr_b16 v[76:77], v7 offset:32768
ds_read_b64_tr_b16 v[78:79], v7 offset:34816
v_mfma_f32_32x32x16_bf16 v[176:191], v[92:95], v[84:87], v[176:191]
buffer_load_dwordx4 v2, s[40:43], s56 offen lds
s_add_u32 s56, s52, 261120
s_waitcnt lgkmcnt(0)
v_mfma_f32_32x32x16_bf16 v[128:143], v[72:75], v[64:67], v[128:143]
ds_read_b128 v[80:83], v4 offset:36864
ds_read_b128 v[84:87], v4 offset:37888
buffer_load_dwordx4 v2, s[40:43], s56 offen offset:1024 lds
s_add_u32 s56, s52, 522240
v_mfma_f32_32x32x16_bf16 v[144:159], v[72:75], v[68:71], v[144:159]
ds_read_b64_tr_b16 v[88:89], v6 offset:36864
ds_read_b64_tr_b16 v[90:91], v6 offset:38912
ds_read_b64_tr_b16 v[92:93], v7 offset:36864
v_mfma_f32_32x32x16_bf16 v[160:175], v[76:79], v[64:67], v[160:175]
ds_read_b64_tr_b16 v[94:95], v7 offset:38912
buffer_load_dwordx4 v2, s[40:43], s56 offen offset:2048 lds
s_add_u32 s56, s52, 783360
v_mfma_f32_32x32x16_bf16 v[176:191], v[76:79], v[68:71], v[176:191]
buffer_load_dwordx4 v2, s[40:43], s56 offen offset:3072 lds
s_add_u32 m0, s54, 0
s_mov_b32 s56, s53
s_waitcnt lgkmcnt(0)
v_mfma_f32_32x32x16_bf16 v[128:143], v[88:91], v[80:83], v[128:143]
ds_read_b128 v[64:67], v4 offset:40960
ds_read_b128 v[68:71], v4 offset:41984
ds_read_b64_tr_b16 v[72:73], v6 offset:40960
v_mfma_f32_32x32x16_bf16 v[144:159], v[88:91], v[84:87], v[144:159]
ds_read_b64_tr_b16 v[74:75], v6 offset:43008
ds_read_b64_tr_b16 v[76:77], v7 offset:40960
buffer_load_dwordx4 v3, s[36:39], s56 offen lds
s_add_u32 s56, s53, 3072
v_mfma_f32_32x32x16_bf16 v[160:175], v[92:95], v[80:83], v[160:175]
ds_read_b64_tr_b16 v[78:79], v7 offset:43008
buffer_load_dwordx4 v3, s[36:39], s56 offen offset:1024 lds
s_add_u32 s56, s53, 6144
v_mfma_f32_32x32x16_bf16 v[176:191], v[92:95], v[84:87], v[176:191]
s_waitcnt lgkmcnt(0)
v_mfma_f32_32x32x16_bf16 v[128:143], v[72:75], v[64:67], v[128:143]
ds_read_b128 v[80:83], v4 offset:45056
ds_read_b128 v[84:87], v4 offset:46080
ds_read_b64_tr_b16 v[88:89], v6 offset:45056
v_mfma_f32_32x32x16_bf16 v[144:159], v[72:75], v[68:71], v[144:159]
ds_read_b64_tr_b16 v[90:91], v6 offset:47104
buffer_load_dwordx4 v3, s[36:39], s56 offen offset:2048 lds
ds_read_b64_tr_b16 v[92:93], v7 offset:45056
s_add_u32 s56, s53, 9216
v_mfma_f32_32x32x16_bf16 v[160:175], v[76:79], v[64:67], v[160:175]
ds_read_b64_tr_b16 v[94:95], v7 offset:47104
buffer_load_dwordx4 v3, s[36:39], s56 offen offset:3072 lds
s_add_u32 s52, s52, 4096
s_add_u32 s53, s53, 65536
v_mfma_f32_32x32x16_bf16 v[176:191], v[76:79], v[68:71], v[176:191]
s_waitcnt lgkmcnt(0)
v_mfma_f32_32x32x16_bf16 v[128:143], v[88:91], v[80:83], v[128:143]
s_waitcnt vmcnt(16)
s_barrier
v_mfma_f32_32x32x16_bf16 v[144:159], v[88:91], v[84:87], v[144:159]
ds_read_b128 v[64:67], v5
ds_read_b128 v[68:71], v5 offset:1024
ds_read_b64_tr_b16 v[72:73], v8
s_add_u32 m0, s57, 32768
s_mov_b32 s56, s52
v_mfma_f32_32x32x16_bf16 v[160:175], v[92:95], v[80:83], v[160:175]
ds_read_b64_tr_b16 v[74:75], v8 offset:2048
ds_read_b64_tr_b16 v[76:77], v9
ds_read_b64_tr_b16 v[78:79], v9 offset:2048
v_mfma_f32_32x32x16_bf16 v[176:191], v[92:95], v[84:87], v[176:191]
buffer_load_dwordx4 v2, s[40:43], s56 offen lds
s_add_u32 s56, s52, 261120
s_waitcnt lgkmcnt(0)
v_mfma_f32_32x32x16_bf16 v[128:143], v[72:75], v[64:67], v[128:143]
ds_read_b128 v[80:83], v5 offset:4096
ds_read_b128 v[84:87], v5 offset:5120
buffer_load_dwordx4 v2, s[40:43], s56 offen offset:1024 lds
s_add_u32 s56, s52, 522240
v_mfma_f32_32x32x16_bf16 v[144:159], v[72:75], v[68:71], v[144:159]
ds_read_b64_tr_b16 v[88:89], v8 offset:4096
ds_read_b64_tr_b16 v[90:91], v8 offset:6144
ds_read_b64_tr_b16 v[92:93], v9 offset:4096
v_mfma_f32_32x32x16_bf16 v[160:175], v[76:79], v[64:67], v[160:175]
ds_read_b64_tr_b16 v[94:95], v9 offset:6144
buffer_load_dwordx4 v2, s[40:43], s56 offen offset:2048 lds
s_add_u32 s56, s52, 783360
v_mfma_f32_32x32x16_bf16 v[176:191], v[76:79], v[68:71], v[176:191]
buffer_load_dwordx4 v2, s[40:43], s56 offen offset:3072 lds
s_add_u32 m0, s54, 32768
s_mov_b32 s56, s53
s_waitcnt lgkmcnt(0)
v_mfma_f32_32x32x16_bf16 v[128:143], v[88:91], v[80:83], v[128:143]
ds_read_b128 v[64:67], v5 offset:8192
ds_read_b128 v[68:71], v5 offset:9216
ds_read_b64_tr_b16 v[72:73], v8 offset:8192
v_mfma_f32_32x32x16_bf16 v[144:159], v[88:91], v[84:87], v[144:159]
ds_read_b64_tr_b16 v[74:75], v8 offset:10240
ds_read_b64_tr_b16 v[76:77], v9 offset:8192
buffer_load_dwordx4 v3, s[36:39], s56 offen lds
s_add_u32 s56, s53, 3072
v_mfma_f32_32x32x16_bf16 v[160:175], v[92:95], v[80:83], v[160:175]
ds_read_b64_tr_b16 v[78:79], v9 offset:10240
buffer_load_dwordx4 v3, s[36:39], s56 offen offset:1024 lds
s_add_u32 s56, s53, 6144
v_mfma_f32_32x32x16_bf16 v[176:191], v[92:95], v[84:87], v[176:191]
s_waitcnt lgkmcnt(0)
v_mfma_f32_32x32x16_bf16 v[128:143], v[72:75], v[64:67], v[128:143]
ds_read_b128 v[80:83], v5 offset:12288
ds_read_b128 v[84:87], v5 offset:13312
ds_read_b64_tr_b16 v[88:89], v8 offset:12288
v_mfma_f32_32x32x16_bf16 v[144:159], v[72:75], v[68:71], v[144:159]
ds_read_b64_tr_b16 v[90:91], v8 offset:14336
buffer_load_dwordx4 v3, s[36:39], s56 offen offset:2048 lds
ds_read_b64_tr_b16 v[92:93], v9 offset:12288
s_add_u32 s56, s53, 9216
v_mfma_f32_32x32x16_bf16 v[160:175], v[76:79], v[64:67], v[160:175]
ds_read_b64_tr_b16 v[94:95], v9 offset:14336
buffer_load_dwordx4 v3, s[36:39], s56 offen offset:3072 lds
s_add_u32 s52, s52, 4096
s_add_u32 s53, s53, 65536
v_mfma_f32_32x32x16_bf16 v[176:191], v[76:79], v[68:71], v[176:191]
s_waitcnt lgkmcnt(0)
v_mfma_f32_32x32x16_bf16 v[128:143], v[88:91], v[80:83], v[128:143]
s_waitcnt vmcnt(16)
s_barrier
v_mfma_f32_32x32x16_bf16 v[144:159], v[88:91], v[84:87], v[144:159]
ds_read_b128 v[64:67], v5 offset:32768
ds_read_b128 v[68:71], v5 offset:33792
ds_read_b64_tr_b16 v[72:73], v8 offset:32768
s_add_u32 m0, s57, 65536
s_mov_b32 s56, s52
v_mfma_f32_32x32x16_bf16 v[160:175], v[92:95], v[80:83], v[160:175]
ds_read_b64_tr_b16 v[74:75], v8 offset:34816
ds_read_b64_tr_b16 v[76:77], v9 offset:32768
ds_read_b64_tr_b16 v[78:79], v9 offset:34816
v_mfma_f32_32x32x16_bf16 v[176:191], v[92:95], v[84:87], v[176:191]
buffer_load_dwordx4 v2, s[40:43], s56 offen lds
s_add_u32 s56, s52, 261120
s_waitcnt lgkmcnt(0)
v_mfma_f32_32x32x16_bf16 v[128:143], v[72:75], v[64:67], v[128:143]
ds_read_b128 v[80:83], v5 offset:36864
ds_read_b128 v[84:87], v5 offset:37888
buffer_load_dwordx4 v2, s[40:43], s56 offen offset:1024 lds
s_add_u32 s56, s52, 522240
v_mfma_f32_32x32x16_bf16 v[144:159], v[72:75], v[68:71], v[144:159]
ds_read_b64_tr_b16 v[88:89], v8 offset:36864
ds_read_b64_tr_b16 v[90:91], v8 offset:38912
ds_read_b64_tr_b16 v[92:93], v9 offset:36864
v_mfma_f32_32x32x16_bf16 v[160:175], v[76:79], v[64:67], v[160:175]
ds_read_b64_tr_b16 v[94:95], v9 offset:38912
buffer_load_dwordx4 v2, s[40:43], s56 offen offset:2048 lds
s_add_u32 s56, s52, 783360
v_mfma_f32_32x32x16_bf16 v[176:191], v[76:79], v[68:71], v[176:191]
buffer_load_dwordx4 v2, s[40:43], s56 offen offset:3072 lds
s_add_u32 m0, s54, 65536
s_mov_b32 s56, s53
s_waitcnt lgkmcnt(0)
v_mfma_f32_32x32x16_bf16 v[128:143], v[88:91], v[80:83], v[128:143]
ds_read_b128 v[64:67], v5 offset:40960
ds_read_b128 v[68:71], v5 offset:41984
ds_read_b64_tr_b16 v[72:73], v8 offset:40960
v_mfma_f32_32x32x16_bf16 v[144:159], v[88:91], v[84:87], v[144:159]
ds_read_b64_tr_b16 v[74:75], v8 offset:43008
ds_read_b64_tr_b16 v[76:77], v9 offset:40960
buffer_load_dwordx4 v3, s[36:39], s56 offen lds
s_add_u32 s56, s53, 3072
v_mfma_f32_32x32x16_bf16 v[160:175], v[92:95], v[80:83], v[160:175]
ds_read_b64_tr_b16 v[78:79], v9 offset:43008
buffer_load_dwordx4 v3, s[36:39], s56 offen offset:1024 lds
s_add_u32 s56, s53, 6144
v_mfma_f32_32x32x16_bf16 v[176:191], v[92:95], v[84:87], v[176:191]
s_waitcnt lgkmcnt(0)
v_mfma_f32_32x32x16_bf16 v[128:143], v[72:75], v[64:67], v[128:143]
ds_read_b128 v[80:83], v5 offset:45056
ds_read_b128 v[84:87], v5 offset:46080
ds_read_b64_tr_b16 v[88:89], v8 offset:45056
v_mfma_f32_32x32x16_bf16 v[144:159], v[72:75], v[68:71], v[144:159]
ds_read_b64_tr_b16 v[90:91], v8 offset:47104
buffer_load_dwordx4 v3, s[36:39], s56 offen offset:2048 lds
ds_read_b64_tr_b16 v[92:93], v9 offset:45056
s_add_u32 s56, s53, 9216
v_mfma_f32_32x32x16_bf16 v[160:175], v[76:79], v[64:67], v[160:175]
ds_read_b64_tr_b16 v[94:95], v9 offset:47104
buffer_load_dwordx4 v3, s[36:39], s56 offen offset:3072 lds
s_add_u32 s52, s52, 4096
s_add_u32 s53, s53, 65536
v_mfma_f32_32x32x16_bf16 v[176:191], v[76:79], v[68:71], v[176:191]
s_waitcnt lgkmcnt(0)
v_mfma_f32_32x32x16_bf16 v[128:143], v[88:91], v[80:83], v[128:143]
s_waitcnt vmcnt(16)
s_barrier
v_mfma_f32_32x32x16_bf16 v[144:159], v[88:91], v[84:87], v[144:159]
ds_read_b128 v[64:67], v4
ds_read_b128 v[68:71], v4 offset:1024
ds_read_b64_tr_b16 v[72:73], v6
s_add_u32 m0, s57, 98304
s_mov_b32 s56, s52
v_mfma_f32_32x32x16_bf16 v[160:175], v[92:95], v[80:83], v[160:175]
ds_read_b64_tr_b16 v[74:75], v6 offset:2048
ds_read_b64_tr_b16 v[76:77], v7
ds_read_b64_tr_b16 v[78:79], v7 offset:2048
v_mfma_f32_32x32x16_bf16 v[176:191], v[92:95], v[84:87], v[176:191]
buffer_load_dwordx4 v2, s[40:43], s56 offen lds
s_add_u32 s56, s52, 261120
s_waitcnt lgkmcnt(0)
v_mfma_f32_32x32x16_bf16 v[128:143], v[72:75], v[64:67], v[128:143]
ds_read_b128 v[80:83], v4 offset:4096
ds_read_b128 v[84:87], v4 offset:5120
buffer_load_dwordx4 v2, s[40:43], s56 offen offset:1024 lds
s_add_u32 s56, s52, 522240
v_mfma_f32_32x32x16_bf16 v[144:159], v[72:75], v[68:71], v[144:159]
ds_read_b64_tr_b16 v[88:89], v6 offset:4096
ds_read_b64_tr_b16 v[90:91], v6 offset:6144
ds_read_b64_tr_b16 v[92:93], v7 offset:4096
v_mfma_f32_32x32x16_bf16 v[160:175], v[76:79], v[64:67], v[160:175]
ds_read_b64_tr_b16 v[94:95], v7 offset:6144
buffer_load_dwordx4 v2, s[40:43], s56 offen offset:2048 lds
s_add_u32 s56, s52, 783360
v_mfma_f32_32x32x16_bf16 v[176:191], v[76:79], v[68:71], v[176:191]
buffer_load_dwordx4 v2, s[40:43], s56 offen offset:3072 lds
s_add_u32 m0, s54, 98304
s_mov_b32 s56, s53
s_waitcnt lgkmcnt(0)
v_mfma_f32_32x32x16_bf16 v[128:143], v[88:91], v[80:83], v[128:143]
ds_read_b128 v[64:67], v4 offset:8192
ds_read_b128 v[68:71], v4 offset:9216
ds_read_b64_tr_b16 v[72:73], v6 offset:8192
v_mfma_f32_32x32x16_bf16 v[144:159], v[88:91], v[84:87], v[144:159]
ds_read_b64_tr_b16 v[74:75], v6 offset:10240
ds_read_b64_tr_b16 v[76:77], v7 offset:8192
buffer_load_dwordx4 v3, s[36:39], s56 offen lds
s_add_u32 s56, s53, 3072
v_mfma_f32_32x32x16_bf16 v[160:175], v[92:95], v[80:83], v[160:175]
ds_read_b64_tr_b16 v[78:79], v7 offset:10240
buffer_load_dwordx4 v3, s[36:39], s56 offen offset:1024 lds
s_add_u32 s56, s53, 6144
v_mfma_f32_32x32x16_bf16 v[176:191], v[92:95], v[84:87], v[176:191]
s_waitcnt lgkmcnt(0)
v_mfma_f32_32x32x16_bf16 v[128:143], v[72:75], v[64:67], v[128:143]
ds_read_b128 v[80:83], v4 offset:12288
ds_read_b128 v[84:87], v4 offset:13312
ds_read_b64_tr_b16 v[88:89], v6 offset:12288
v_mfma_f32_32x32x16_bf16 v[144:159], v[72:75], v[68:71], v[144:159]
ds_read_b64_tr_b16 v[90:91], v6 offset:14336
buffer_load_dwordx4 v3, s[36:39], s56 offen offset:2048 lds
ds_read_b64_tr_b16 v[92:93], v7 offset:12288
s_add_u32 s56, s53, 9216
v_mfma_f32_32x32x16_bf16 v[160:175], v[76:79], v[64:67], v[160:175]
ds_read_b64_tr_b16 v[94:95], v7 offset:14336
buffer_load_dwordx4 v3, s[36:39], s56 offen offset:3072 lds
s_add_u32 s52, s52, 4096
s_add_u32 s53, s53, 65536
v_mfma_f32_32x32x16_bf16 v[176:191], v[76:79], v[68:71], v[176:191]
s_waitcnt lgkmcnt(0)
v_mfma_f32_32x32x16_bf16 v[128:143], v[88:91], v[80:83], v[128:143]
s_waitcnt vmcnt(16)
s_barrier
v_mfma_f32_32x32x16_bf16 v[144:159], v[88:91], v[84:87], v[144:159]
ds_read_b128 v[64:67], v4 offset:32768
ds_read_b128 v[68:71], v4 offset:33792
ds_read_b64_tr_b16 v[72:73], v6 offset:32768
s_add_u32 m0, s57, 0
s_mov_b32 s56, s52
v_mfma_f32_32x32x16_bf16 v[160:175], v[92:95], v[80:83], v[160:175]
ds_read_b64_tr_b16 v[74:75], v6 offset:34816
ds_read_b64_tr_b16 v[76:77], v7 offset:32768
ds_read_b64_tr_b16 v[78:79], v7 offset:34816
v_mfma_f32_32x32x16_bf16 v[176:191], v[92:95], v[84:87], v[176:191]
buffer_load_dwordx4 v2, s[40:43], s56 offen lds
s_add_u32 s56, s52, 261120
s_waitcnt lgkmcnt(0)
v_mfma_f32_32x32x16_bf16 v[128:143], v[72:75], v[64:67], v[128:143]
ds_read_b128 v[80:83], v4 offset:36864
ds_read_b128 v[84:87], v4 offset:37888
buffer_load_dwordx4 v2, s[40:43], s56 offen offset:1024 lds
s_add_u32 s56, s52, 522240
v_mfma_f32_32x32x16_bf16 v[144:159], v[72:75], v[68:71], v[144:159]
ds_read_b64_tr_b16 v[88:89], v6 offset:36864
ds_read_b64_tr_b16 v[90:91], v6 offset:38912
ds_read_b64_tr_b16 v[92:93], v7 offset:36864
v_mfma_f32_32x32x16_bf16 v[160:175], v[76:79], v[64:67], v[160:175]
ds_read_b64_tr_b16 v[94:95], v7 offset:38912
buffer_load_dwordx4 v2, s[40:43], s56 offen offset:2048 lds
s_add_u32 s56, s52, 783360
v_mfma_f32_32x32x16_bf16 v[176:191], v[76:79], v[68:71], v[176:191]
buffer_load_dwordx4 v2, s[40:43], s56 offen offset:3072 lds
s_add_u32 m0, s54, 0
s_mov_b32 s56, s53
s_waitcnt lgkmcnt(0)
v_mfma_f32_32x32x16_bf16 v[128:143], v[88:91], v[80:83], v[128:143]
ds_read_b128 v[64:67], v4 offset:40960
ds_read_b128 v[68:71], v4 offset:41984
ds_read_b64_tr_b16 v[72:73], v6 offset:40960
v_mfma_f32_32x32x16_bf16 v[144:159], v[88:91], v[84:87], v[144:159]
ds_read_b64_tr_b16 v[74:75], v6 offset:43008
ds_read_b64_tr_b16 v[76:77], v7 offset:40960
buffer_load_dwordx4 v3, s[36:39], s56 offen lds
s_add_u32 s56, s53, 3072
v_mfma_f32_32x32x16_bf16 v[160:175], v[92:95], v[80:83], v[160:175]
ds_read_b64_tr_b16 v[78:79], v7 offset:43008
buffer_load_dwordx4 v3, s[36:39], s56 offen offset:1024 lds
s_add_u32 s56, s53, 6144
v_mfma_f32_32x32x16_bf16 v[176:191], v[92:95], v[84:87], v[176:191]
s_waitcnt lgkmcnt(0)
v_mfma_f32_32x32x16_bf16 v[128:143], v[72:75], v[64:67], v[128:143]
ds_read_b128 v[80:83], v4 offset:45056
ds_read_b128 v[84:87], v4 offset:46080
ds_read_b64_tr_b16 v[88:89], v6 offset:45056
v_mfma_f32_32x32x16_bf16 v[144:159], v[72:75], v[68:71], v[144:159]
ds_read_b64_tr_b16 v[90:91], v6 offset:47104
buffer_load_dwordx4 v3, s[36:39], s56 offen offset:2048 lds
ds_read_b64_tr_b16 v[92:93], v7 offset:45056
s_add_u32 s56, s53, 9216
v_mfma_f32_32x32x16_bf16 v[160:175], v[76:79], v[64:67], v[160:175]
ds_read_b64_tr_b16 v[94:95], v7 offset:47104
buffer_load_dwordx4 v3, s[36:39], s56 offen offset:3072 lds
s_add_u32 s52, s52, 4096
s_add_u32 s53, s53, 65536
v_mfma_f32_32x32x16_bf16 v[176:191], v[76:79], v[68:71], v[176:191]
s_waitcnt lgkmcnt(0)
v_mfma_f32_32x32x16_bf16 v[128:143], v[88:91], v[80:83], v[128:143]
s_waitcnt vmcnt(16)
s_barrier
v_mfma_f32_32x32x16_bf16 v[144:159], v[88:91], v[84:87], v[144:159]
ds_read_b128 v[64:67], v5
ds_read_b128 v[68:71], v5 offset:1024
ds_read_b64_tr_b16 v[72:73], v8
s_add_u32 m0, s57, 32768
s_mov_b32 s56, s52
v_mfma_f32_32x32x16_bf16 v[160:175], v[92:95], v[80:83], v[160:175]
ds_read_b64_tr_b16 v[74:75], v8 offset:2048
ds_read_b64_tr_b16 v[76:77], v9
ds_read_b64_tr_b16 v[78:79], v9 offset:2048
v_mfma_f32_32x32x16_bf16 v[176:191], v[92:95], v[84:87], v[176:191]
buffer_load_dwordx4 v2, s[40:43], s56 offen lds
s_add_u32 s56, s52, 261120
s_waitcnt lgkmcnt(0)
v_mfma_f32_32x32x16_bf16 v[128:143], v[72:75], v[64:67], v[128:143]
ds_read_b128 v[80:83], v5 offset:4096
ds_read_b128 v[84:87], v5 offset:5120
buffer_load_dwordx4 v2, s[40:43], s56 offen offset:1024 lds
s_add_u32 s56, s52, 522240
v_mfma_f32_32x32x16_bf16 v[144:159], v[72:75], v[68:71], v[144:159]
ds_read_b64_tr_b16 v[88:89], v8 offset:4096
ds_read_b64_tr_b16 v[90:91], v8 offset:6144
ds_read_b64_tr_b16 v[92:93], v9 offset:4096
v_mfma_f32_32x32x16_bf16 v[160:175], v[76:79], v[64:67], v[160:175]
ds_read_b64_tr_b16 v[94:95], v9 offset:6144
buffer_load_dwordx4 v2, s[40:43], s56 offen offset:2048 lds
s_add_u32 s56, s52, 783360
v_mfma_f32_32x32x16_bf16 v[176:191], v[76:79], v[68:71], v[176:191]
buffer_load_dwordx4 v2, s[40:43], s56 offen offset:3072 lds
s_add_u32 m0, s54, 32768
s_mov_b32 s56, s53
s_waitcnt lgkmcnt(0)
v_mfma_f32_32x32x16_bf16 v[128:143], v[88:91], v[80:83], v[128:143]
ds_read_b128 v[64:67], v5 offset:8192
ds_read_b128 v[68:71], v5 offset:9216
ds_read_b64_tr_b16 v[72:73], v8 offset:8192
v_mfma_f32_32x32x16_bf16 v[144:159], v[88:91], v[84:87], v[144:159]
ds_read_b64_tr_b16 v[74:75], v8 offset:10240
ds_read_b64_tr_b16 v[76:77], v9 offset:8192
buffer_load_dwordx4 v3, s[36:39], s56 offen lds
s_add_u32 s56, s53, 3072
v_mfma_f32_32x32x16_bf16 v[160:175], v[92:95], v[80:83], v[160:175]
ds_read_b64_tr_b16 v[78:79], v9 offset:10240
buffer_load_dwordx4 v3, s[36:39], s56 offen offset:1024 lds
s_add_u32 s56, s53, 6144
v_mfma_f32_32x32x16_bf16 v[176:191], v[92:95], v[84:87], v[176:191]
s_waitcnt lgkmcnt(0)
v_mfma_f32_32x32x16_bf16 v[128:143], v[72:75], v[64:67], v[128:143]
ds_read_b128 v[80:83], v5 offset:12288
ds_read_b128 v[84:87], v5 offset:13312
ds_read_b64_tr_b16 v[88:89], v8 offset:12288
v_mfma_f32_32x32x16_bf16 v[144:159], v[72:75], v[68:71], v[144:159]
ds_read_b64_tr_b16 v[90:91], v8 offset:14336
buffer_load_dwordx4 v3, s[36:39], s56 offen offset:2048 lds
ds_read_b64_tr_b16 v[92:93], v9 offset:12288
s_add_u32 s56, s53, 9216
v_mfma_f32_32x32x16_bf16 v[160:175], v[76:79], v[64:67], v[160:175]
ds_read_b64_tr_b16 v[94:95], v9 offset:14336
buffer_load_dwordx4 v3, s[36:39], s56 offen offset:3072 lds
s_add_u32 s52, s52, 4096
s_add_u32 s53, s53, 65536
v_mfma_f32_32x32x16_bf16 v[176:191], v[76:79], v[68:71], v[176:191]
s_waitcnt lgkmcnt(0)
v_mfma_f32_32x32x16_bf16 v[128:143], v[88:91], v[80:83], v[128:143]
s_waitcnt vmcnt(16)
s_barrier
v_mfma_f32_32x32x16_bf16 v[144:159], v[88:91], v[84:87], v[144:159]
ds_read_b128 v[64:67], v5 offset:32768
ds_read_b128 v[68:71], v5 offset:33792
ds_read_b64_tr_b16 v[72:73], v8 offset:32768
s_add_u32 m0, s57, 65536
s_mov_b32 s56, s52
v_mfma_f32_32x32x16_bf16 v[160:175], v[92:95], v[80:83], v[160:175]
ds_read_b64_tr_b16 v[74:75], v8 offset:34816
ds_read_b64_tr_b16 v[76:77], v9 offset:32768
ds_read_b64_tr_b16 v[78:79], v9 offset:34816
v_mfma_f32_32x32x16_bf16 v[176:191], v[92:95], v[84:87], v[176:191]
buffer_load_dwordx4 v2, s[40:43], s56 offen lds
s_add_u32 s56, s52, 261120
s_waitcnt lgkmcnt(0)
v_mfma_f32_32x32x16_bf16 v[128:143], v[72:75], v[64:67], v[128:143]
ds_read_b128 v[80:83], v5 offset:36864
ds_read_b128 v[84:87], v5 offset:37888
buffer_load_dwordx4 v2, s[40:43], s56 offen offset:1024 lds
s_add_u32 s56, s52, 522240
v_mfma_f32_32x32x16_bf16 v[144:159], v[72:75], v[68:71], v[144:159]
ds_read_b64_tr_b16 v[88:89], v8 offset:36864
ds_read_b64_tr_b16 v[90:91], v8 offset:38912
ds_read_b64_tr_b16 v[92:93], v9 offset:36864
v_mfma_f32_32x32x16_bf16 v[160:175], v[76:79], v[64:67], v[160:175]
ds_read_b64_tr_b16 v[94:95], v9 offset:38912
buffer_load_dwordx4 v2, s[40:43], s56 offen offset:2048 lds
s_add_u32 s56, s52, 783360
v_mfma_f32_32x32x16_bf16 v[176:191], v[76:79], v[68:71], v[176:191]
buffer_load_dwordx4 v2, s[40:43], s56 offen offset:3072 lds
s_add_u32 m0, s54, 65536
s_mov_b32 s56, s53
s_waitcnt lgkmcnt(0)
v_mfma_f32_32x32x16_bf16 v[128:143], v[88:91], v[80:83], v[128:143]
ds_read_b128 v[64:67], v5 offset:40960
ds_read_b128 v[68:71], v5 offset:41984
ds_read_b64_tr_b16 v[72:73], v8 offset:40960
v_mfma_f32_32x32x16_bf16 v[144:159], v[88:91], v[84:87], v[144:159]
ds_read_b64_tr_b16 v[74:75], v8 offset:43008
ds_read_b64_tr_b16 v[76:77], v9 offset:40960
buffer_load_dwordx4 v3, s[36:39], s56 offen lds
s_add_u32 s56, s53, 3072
v_mfma_f32_32x32x16_bf16 v[160:175], v[92:95], v[80:83], v[160:175]
ds_read_b64_tr_b16 v[78:79], v9 offset:43008
buffer_load_dwordx4 v3, s[36:39], s56 offen offset:1024 lds
s_add_u32 s56, s53, 6144
v_mfma_f32_32x32x16_bf16 v[176:191], v[92:95], v[84:87], v[176:191]
s_waitcnt lgkmcnt(0)
v_mfma_f32_32x32x16_bf16 v[128:143], v[72:75], v[64:67], v[128:143]
ds_read_b128 v[80:83], v5 offset:45056
ds_read_b128 v[84:87], v5 offset:46080
ds_read_b64_tr_b16 v[88:89], v8 offset:45056
v_mfma_f32_32x32x16_bf16 v[144:159], v[72:75], v[68:71], v[144:159]
ds_read_b64_tr_b16 v[90:91], v8 offset:47104
buffer_load_dwordx4 v3, s[36:39], s56 offen offset:2048 lds
ds_read_b64_tr_b16 v[92:93], v9 offset:45056
s_add_u32 s56, s53, 9216
v_mfma_f32_32x32x16_bf16 v[160:175], v[76:79], v[64:67], v[160:175]
ds_read_b64_tr_b16 v[94:95], v9 offset:47104
buffer_load_dwordx4 v3, s[36:39], s56 offen offset:3072 lds
s_add_u32 s52, s52, 4096
s_add_u32 s53, s53, 65536
v_mfma_f32_32x32x16_bf16 v[176:191], v[76:79], v[68:71], v[176:191]
s_waitcnt lgkmcnt(0)
v_mfma_f32_32x32x16_bf16 v[128:143], v[88:91], v[80:83], v[128:143]
s_waitcnt vmcnt(16)
s_barrier
v_mfma_f32_32x32x16_bf16 v[144:159], v[88:91], v[84:87], v[144:159]
ds_read_b128 v[64:67], v4
ds_read_b128 v[68:71], v4 offset:1024
ds_read_b64_tr_b16 v[72:73], v6
s_add_u32 m0, s57, 98304
s_mov_b32 s56, s52
v_mfma_f32_32x32x16_bf16 v[160:175], v[92:95], v[80:83], v[160:175]
ds_read_b64_tr_b16 v[74:75], v6 offset:2048
ds_read_b64_tr_b16 v[76:77], v7
ds_read_b64_tr_b16 v[78:79], v7 offset:2048
v_mfma_f32_32x32x16_bf16 v[176:191], v[92:95], v[84:87], v[176:191]
buffer_load_dwordx4 v2, s[40:43], s56 offen lds
s_add_u32 s56, s52, 261120
s_waitcnt lgkmcnt(0)
v_mfma_f32_32x32x16_bf16 v[128:143], v[72:75], v[64:67], v[128:143]
ds_read_b128 v[80:83], v4 offset:4096
ds_read_b128 v[84:87], v4 offset:5120
buffer_load_dwordx4 v2, s[40:43], s56 offen offset:1024 lds
s_add_u32 s56, s52, 522240
v_mfma_f32_32x32x16_bf16 v[144:159], v[72:75], v[68:71], v[144:159]
ds_read_b64_tr_b16 v[88:89], v6 offset:4096
ds_read_b64_tr_b16 v[90:91], v6 offset:6144
ds_read_b64_tr_b16 v[92:93], v7 offset:4096
v_mfma_f32_32x32x16_bf16 v[160:175], v[76:79], v[64:67], v[160:175]
ds_read_b64_tr_b16 v[94:95], v7 offset:6144
buffer_load_dwordx4 v2, s[40:43], s56 offen offset:2048 lds
s_add_u32 s56, s52, 783360
v_mfma_f32_32x32x16_bf16 v[176:191], v[76:79], v[68:71], v[176:191]
buffer_load_dwordx4 v2, s[40:43], s56 offen offset:3072 lds
s_add_u32 m0, s54, 98304
s_mov_b32 s56, s53
s_waitcnt lgkmcnt(0)
v_mfma_f32_32x32x16_bf16 v[128:143], v[88:91], v[80:83], v[128:143]
ds_read_b128 v[64:67], v4 offset:8192
ds_read_b128 v[68:71], v4 offset:9216
ds_read_b64_tr_b16 v[72:73], v6 offset:8192
v_mfma_f32_32x32x16_bf16 v[144:159], v[88:91], v[84:87], v[144:159]
ds_read_b64_tr_b16 v[74:75], v6 offset:10240
ds_read_b64_tr_b16 v[76:77], v7 offset:8192
buffer_load_dwordx4 v3, s[36:39], s56 offen lds
s_add_u32 s56, s53, 3072
v_mfma_f32_32x32x16_bf16 v[160:175], v[92:95], v[80:83], v[160:175]
ds_read_b64_tr_b16 v[78:79], v7 offset:10240
buffer_load_dwordx4 v3, s[36:39], s56 offen offset:1024 lds
s_add_u32 s56, s53, 6144
v_mfma_f32_32x32x16_bf16 v[176:191], v[92:95], v[84:87], v[176:191]
s_waitcnt lgkmcnt(0)
v_mfma_f32_32x32x16_bf16 v[128:143], v[72:75], v[64:67], v[128:143]
ds_read_b128 v[80:83], v4 offset:12288
ds_read_b128 v[84:87], v4 offset:13312
ds_read_b64_tr_b16 v[88:89], v6 offset:12288
v_mfma_f32_32x32x16_bf16 v[144:159], v[72:75], v[68:71], v[144:159]
ds_read_b64_tr_b16 v[90:91], v6 offset:14336
buffer_load_dwordx4 v3, s[36:39], s56 offen offset:2048 lds
ds_read_b64_tr_b16 v[92:93], v7 offset:12288
s_add_u32 s56, s53, 9216
v_mfma_f32_32x32x16_bf16 v[160:175], v[76:79], v[64:67], v[160:175]
ds_read_b64_tr_b16 v[94:95], v7 offset:14336
buffer_load_dwordx4 v3, s[36:39], s56 offen offset:3072 lds
s_add_u32 s52, s52, 4096
s_add_u32 s53, s53, 65536
v_mfma_f32_32x32x16_bf16 v[176:191], v[76:79], v[68:71], v[176:191]
s_waitcnt lgkmcnt(0)
v_mfma_f32_32x32x16_bf16 v[128:143], v[88:91], v[80:83], v[128:143]
s_waitcnt vmcnt(16)
s_barrier
v_mfma_f32_32x32x16_bf16 v[144:159], v[88:91], v[84:87], v[144:159]
ds_read_b128 v[64:67], v4 offset:32768
ds_read_b128 v[68:71], v4 offset:33792
ds_read_b64_tr_b16 v[72:73], v6 offset:32768
v_mfma_f32_32x32x16_bf16 v[160:175], v[92:95], v[80:83], v[160:175]
ds_read_b64_tr_b16 v[74:75], v6 offset:34816
ds_read_b64_tr_b16 v[76:77], v7 offset:32768
ds_read_b64_tr_b16 v[78:79], v7 offset:34816
v_mfma_f32_32x32x16_bf16 v[176:191], v[92:95], v[84:87], v[176:191]
s_waitcnt lgkmcnt(0)
v_mfma_f32_32x32x16_bf16 v[128:143], v[72:75], v[64:67], v[128:143]
ds_read_b128 v[80:83], v4 offset:36864
ds_read_b128 v[84:87], v4 offset:37888
ds_read_b64_tr_b16 v[88:89], v6 offset:36864
v_mfma_f32_32x32x16_bf16 v[144:159], v[72:75], v[68:71], v[144:159]
ds_read_b64_tr_b16 v[90:91], v6 offset:38912
ds_read_b64_tr_b16 v[92:93], v7 offset:36864
ds_read_b64_tr_b16 v[94:95], v7 offset:38912
v_mfma_f32_32x32x16_bf16 v[160:175], v[76:79], v[64:67], v[160:175]
v_mfma_f32_32x32x16_bf16 v[176:191], v[76:79], v[68:71], v[176:191]
s_waitcnt lgkmcnt(0)
v_mfma_f32_32x32x16_bf16 v[128:143], v[88:91], v[80:83], v[128:143]
ds_read_b128 v[64:67], v4 offset:40960
ds_read_b128 v[68:71], v4 offset:41984
ds_read_b64_tr_b16 v[72:73], v6 offset:40960
v_mfma_f32_32x32x16_bf16 v[144:159], v[88:91], v[84:87], v[144:159]
ds_read_b64_tr_b16 v[74:75], v6 offset:43008
ds_read_b64_tr_b16 v[76:77], v7 offset:40960
ds_read_b64_tr_b16 v[78:79], v7 offset:43008
v_mfma_f32_32x32x16_bf16 v[160:175], v[92:95], v[80:83], v[160:175]
v_mfma_f32_32x32x16_bf16 v[176:191], v[92:95], v[84:87], v[176:191]
s_waitcnt lgkmcnt(0)
v_mfma_f32_32x32x16_bf16 v[128:143], v[72:75], v[64:67], v[128:143]
ds_read_b128 v[80:83], v4 offset:45056
ds_read_b128 v[84:87], v4 offset:46080
ds_read_b64_tr_b16 v[88:89], v6 offset:45056
v_mfma_f32_32x32x16_bf16 v[144:159], v[72:75], v[68:71], v[144:159]
ds_read_b64_tr_b16 v[90:91], v6 offset:47104
ds_read_b64_tr_b16 v[92:93], v7 offset:45056
ds_read_b64_tr_b16 v[94:95], v7 offset:47104
v_mfma_f32_32x32x16_bf16 v[160:175], v[76:79], v[64:67], v[160:175]
v_mfma_f32_32x32x16_bf16 v[176:191], v[76:79], v[68:71], v[176:191]
s_waitcnt lgkmcnt(0)
v_mfma_f32_32x32x16_bf16 v[128:143], v[88:91], v[80:83], v[128:143]
s_waitcnt vmcnt(8)
s_barrier
v_mfma_f32_32x32x16_bf16 v[144:159], v[88:91], v[84:87], v[144:159]
ds_read_b128 v[64:67], v5
ds_read_b128 v[68:71], v5 offset:1024
ds_read_b64_tr_b16 v[72:73], v8
v_mfma_f32_32x32x16_bf16 v[160:175], v[92:95], v[80:83], v[160:175]
ds_read_b64_tr_b16 v[74:75], v8 offset:2048
ds_read_b64_tr_b16 v[76:77], v9
ds_read_b64_tr_b16 v[78:79], v9 offset:2048
v_mfma_f32_32x32x16_bf16 v[176:191], v[92:95], v[84:87], v[176:191]
s_waitcnt lgkmcnt(0)
v_mfma_f32_32x32x16_bf16 v[128:143], v[72:75], v[64:67], v[128:143]
ds_read_b128 v[80:83], v5 offset:4096
ds_read_b128 v[84:87], v5 offset:5120
ds_read_b64_tr_b16 v[88:89], v8 offset:4096
v_mfma_f32_32x32x16_bf16 v[144:159], v[72:75], v[68:71], v[144:159]
ds_read_b64_tr_b16 v[90:91], v8 offset:6144
ds_read_b64_tr_b16 v[92:93], v9 offset:4096
ds_read_b64_tr_b16 v[94:95], v9 offset:6144
v_mfma_f32_32x32x16_bf16 v[160:175], v[76:79], v[64:67], v[160:175]
v_mfma_f32_32x32x16_bf16 v[176:191], v[76:79], v[68:71], v[176:191]
s_waitcnt lgkmcnt(0)
v_mfma_f32_32x32x16_bf16 v[128:143], v[88:91], v[80:83], v[128:143]
ds_read_b128 v[64:67], v5 offset:8192
ds_read_b128 v[68:71], v5 offset:9216
ds_read_b64_tr_b16 v[72:73], v8 offset:8192
v_mfma_f32_32x32x16_bf16 v[144:159], v[88:91], v[84:87], v[144:159]
ds_read_b64_tr_b16 v[74:75], v8 offset:10240
ds_read_b64_tr_b16 v[76:77], v9 offset:8192
ds_read_b64_tr_b16 v[78:79], v9 offset:10240
v_mfma_f32_32x32x16_bf16 v[160:175], v[92:95], v[80:83], v[160:175]
v_mfma_f32_32x32x16_bf16 v[176:191], v[92:95], v[84:87], v[176:191]
s_waitcnt lgkmcnt(0)
v_mfma_f32_32x32x16_bf16 v[128:143], v[72:75], v[64:67], v[128:143]
ds_read_b128 v[80:83], v5 offset:12288
ds_read_b128 v[84:87], v5 offset:13312
ds_read_b64_tr_b16 v[88:89], v8 offset:12288
v_mfma_f32_32x32x16_bf16 v[144:159], v[72:75], v[68:71], v[144:159]
ds_read_b64_tr_b16 v[90:91], v8 offset:14336
ds_read_b64_tr_b16 v[92:93], v9 offset:12288
ds_read_b64_tr_b16 v[94:95], v9 offset:14336
v_mfma_f32_32x32x16_bf16 v[160:175], v[76:79], v[64:67], v[160:175]
v_mfma_f32_32x32x16_bf16 v[176:191], v[76:79], v[68:71], v[176:191]
s_waitcnt lgkmcnt(0)
v_mfma_f32_32x32x16_bf16 v[128:143], v[88:91], v[80:83], v[128:143]
s_waitcnt vmcnt(0)
s_barrier
v_mfma_f32_32x32x16_bf16 v[144:159], v[88:91], v[84:87], v[144:159]
ds_read_b128 v[64:67], v5 offset:32768
ds_read_b128 v[68:71], v5 offset:33792
ds_read_b64_tr_b16 v[72:73], v8 offset:32768
v_mfma_f32_32x32x16_bf16 v[160:175], v[92:95], v[80:83], v[160:175]
ds_read_b64_tr_b16 v[74:75], v8 offset:34816
ds_read_b64_tr_b16 v[76:77], v9 offset:32768
ds_read_b64_tr_b16 v[78:79], v9 offset:34816
v_mfma_f32_32x32x16_bf16 v[176:191], v[92:95], v[84:87], v[176:191]
s_waitcnt lgkmcnt(0)
v_mfma_f32_32x32x16_bf16 v[128:143], v[72:75], v[64:67], v[128:143]
ds_read_b128 v[80:83], v5 offset:36864
ds_read_b128 v[84:87], v5 offset:37888
ds_read_b64_tr_b16 v[88:89], v8 offset:36864
v_mfma_f32_32x32x16_bf16 v[144:159], v[72:75], v[68:71], v[144:159]
ds_read_b64_tr_b16 v[90:91], v8 offset:38912
ds_read_b64_tr_b16 v[92:93], v9 offset:36864
ds_read_b64_tr_b16 v[94:95], v9 offset:38912
v_mfma_f32_32x32x16_bf16 v[160:175], v[76:79], v[64:67], v[160:175]
v_mfma_f32_32x32x16_bf16 v[176:191], v[76:79], v[68:71], v[176:191]
s_waitcnt lgkmcnt(0)
v_mfma_f32_32x32x16_bf16 v[128:143], v[88:91], v[80:83], v[128:143]
ds_read_b128 v[64:67], v5 offset:40960
ds_read_b128 v[68:71], v5 offset:41984
ds_read_b64_tr_b16 v[72:73], v8 offset:40960
v_mfma_f32_32x32x16_bf16 v[144:159], v[88:91], v[84:87], v[144:159]
ds_read_b64_tr_b16 v[74:75], v8 offset:43008
ds_read_b64_tr_b16 v[76:77], v9 offset:40960
ds_read_b64_tr_b16 v[78:79], v9 offset:43008
v_mfma_f32_32x32x16_bf16 v[160:175], v[92:95], v[80:83], v[160:175]
v_mfma_f32_32x32x16_bf16 v[176:191], v[92:95], v[84:87], v[176:191]
s_waitcnt lgkmcnt(0)
v_mfma_f32_32x32x16_bf16 v[128:143], v[72:75], v[64:67], v[128:143]
ds_read_b128 v[80:83], v5 offset:45056
ds_read_b128 v[84:87], v5 offset:46080
ds_read_b64_tr_b16 v[88:89], v8 offset:45056
v_mfma_f32_32x32x16_bf16 v[144:159], v[72:75], v[68:71], v[144:159]
ds_read_b64_tr_b16 v[90:91], v8 offset:47104
ds_read_b64_tr_b16 v[92:93], v9 offset:45056
ds_read_b64_tr_b16 v[94:95], v9 offset:47104
v_mfma_f32_32x32x16_bf16 v[160:175], v[76:79], v[64:67], v[160:175]
v_mfma_f32_32x32x16_bf16 v[176:191], v[76:79], v[68:71], v[176:191]
s_waitcnt lgkmcnt(0)
v_mfma_f32_32x32x16_bf16 v[128:143], v[88:91], v[80:83], v[128:143]
v_mfma_f32_32x32x16_bf16 v[144:159], v[88:91], v[84:87], v[144:159]
v_mfma_f32_32x32x16_bf16 v[160:175], v[92:95], v[80:83], v[160:175]
v_mfma_f32_32x32x16_bf16 v[176:191], v[92:95], v[84:87], v[176:191]
s_lshl_b32 s52, s60, 2
s_add_u32 s52, s52, s61
s_lshl_b32 s53, s52, 2
s_add_u32 s53, s53, s34
s_lshl_b32 s53, s53, 2
s_add_u32 s53, s53, s62
s_lshl_b32 s53, s53, 14
s_add_u32 s53, s53, 58720256
v_lshlrev_b32 v24, 4, v0
s_nop 7
s_barrier
s_cmp_eq_u32 s34, s62
s_cbranch_scc1 XO70
v_cvt_pk_bf16_f32 v64, v128, v129
v_cvt_pk_bf16_f32 v65, v130, v131
v_cvt_pk_bf16_f32 v66, v132, v133
v_cvt_pk_bf16_f32 v67, v134, v135
v_cvt_pk_bf16_f32 v68, v136, v137
v_cvt_pk_bf16_f32 v69, v138, v139
v_cvt_pk_bf16_f32 v70, v140, v141
v_cvt_pk_bf16_f32 v71, v142, v143
buffer_store_dwordx4 v[64:67], v24, s[40:43], s53 offen sc1
buffer_store_dwordx4 v[68:71], v24, s[40:43], s53 offen offset:1024 sc1
v_cvt_pk_bf16_f32 v72, v144, v145
v_cvt_pk_bf16_f32 v73, v146, v147
v_cvt_pk_bf16_f32 v74, v148, v149
v_cvt_pk_bf16_f32 v75, v150, v151
v_cvt_pk_bf16_f32 v76, v152, v153
v_cvt_pk_bf16_f32 v77, v154, v155
v_cvt_pk_bf16_f32 v78, v156, v157
v_cvt_pk_bf16_f32 v79, v158, v159
buffer_store_dwordx4 v[72:75], v24, s[40:43], s53 offen offset:2048 sc1
buffer_store_dwordx4 v[76:79], v24, s[40:43], s53 offen offset:3072 sc1
v_cvt_pk_bf16_f32 v80, v160, v161
v_cvt_pk_bf16_f32 v81, v162, v163
v_cvt_pk_bf16_f32 v82, v164, v165
v_cvt_pk_bf16_f32 v83, v166, v167
v_cvt_pk_bf16_f32 v84, v168, v169
v_cvt_pk_bf16_f32 v85, v170, v171
v_cvt_pk_bf16_f32 v86, v172, v173
v_cvt_pk_bf16_f32 v87, v174, v175
s_add_u32 s53, s53, 4096
buffer_store_dwordx4 v[80:83], v24, s[40:43], s53 offen sc1
buffer_store_dwordx4 v[84:87], v24, s[40:43], s53 offen offset:1024 sc1
v_cvt_pk_bf16_f32 v88, v176, v177
v_cvt_pk_bf16_f32 v89, v178, v179
v_cvt_pk_bf16_f32 v90, v180, v181
v_cvt_pk_bf16_f32 v91, v182, v183
v_cvt_pk_bf16_f32 v92, v184, v185
v_cvt_pk_bf16_f32 v93, v186, v187
v_cvt_pk_bf16_f32 v94, v188, v189
v_cvt_pk_bf16_f32 v95, v190, v191
buffer_store_dwordx4 v[88:91], v24, s[40:43], s53 offen offset:2048 sc1
buffer_store_dwordx4 v[92:95], v24, s[40:43], s53 offen offset:3072 sc1
s_lshl_b32 s54, s52, 2
s_add_u32 s54, s54, s34
s_lshl_b32 s54, s54, 2
s_add_u32 s54, s54, s62
s_lshl_b32 s54, s54, 2
s_add_u32 s54, s54, 2306048
s_waitcnt vmcnt(0)
v_mov_b32 v22, 1
v_mov_b32 v23, 0
s_mov_b64 exec, 1
buffer_store_dword v22, v23, s[48:51], s54 offen sc1
s_mov_b64 exec, -1
s_branch XD71
XO70:
ds_write_b128 v24, v[128:131]
ds_write_b128 v24, v[132:135] offset:1024
ds_write_b128 v24, v[136:139] offset:2048
ds_write_b128 v24, v[140:143] offset:3072
ds_write_b128 v24, v[144:147] offset:4096
ds_write_b128 v24, v[148:151] offset:5120
ds_write_b128 v24, v[152:155] offset:6144
ds_write_b128 v24, v[156:159] offset:7168
ds_write_b128 v24, v[160:163] offset:8192
ds_write_b128 v24, v[164:167] offset:9216
ds_write_b128 v24, v[168:171] offset:10240
ds_write_b128 v24, v[172:175] offset:11264
ds_write_b128 v24, v[176:179] offset:12288
ds_write_b128 v24, v[180:183] offset:13312
ds_write_b128 v24, v[184:187] offset:14336
ds_write_b128 v24, v[188:191] offset:15360
s_waitcnt lgkmcnt(0)
XD71:
s_mov_b32 s44, s24
s_mov_b32 s45, s25
s_mov_b32 s46, 4096
s_mov_b32 s47, 0x20000
s_and_b32 s54, s62, 1
s_lshl_b32 s54, s54, 6
s_lshl_b32 s55, s60, 7
s_add_u32 s54, s54, s55
s_and_b32 s55, s34, 1
s_lshl_b32 s55, s55, 5
s_add_u32 s54, s54, s55
v_and_b32 v25, 31, v0
v_lshlrev_b32 v26, 2, v25
s_lshl_b32 s55, s54, 2
s_add_u32 s55, s55, 2228224
buffer_load_dword v30, v26, s[48:51], s55 offen
v_lshlrev_b32 v26, 1, v25
s_lshl_b32 s55, s54, 1
buffer_load_ushort v31, v26, s[44:47], s55 offen
s_cmp_lg_u32 s34, s62
s_cbranch_scc1 XN72
s_lshl_b32 s91, s52, 2
s_add_u32 s91, s91, s62
s_lshl_b32 s91, s91, 4
s_add_u32 s91, s91, 2306048
s_lshl_b32 s55, 1, s62
s_xor_b32 s55, s55, 15
v_lshlrev_b32 v27, 2, v0
s_mov_b32 s90, 200000
s_mov_b32 exec_lo, s55
s_mov_b32 exec_hi, 0
PL73:
buffer_load_dword v26, v27, s[48:51], s91 offen sc1
s_waitcnt vmcnt(0)
v_cmp_gt_u32 vcc, 1, v26
s_cbranch_vccz PD74
s_sub_u32 s90, s90, 1
s_cbranch_scc1 PD74
s_sleep 1
s_branch PL73
PD74:
s_mov_b64 exec, -1
XN72:
s_barrier
s_lshl_b32 s53, s52, 2
s_add_u32 s53, s53, s62
s_lshl_b32 s53, s53, 16
s_lshl_b32 s55, s34, 11
s_add_u32 s53, s53, s55
s_add_u32 s53, s53, 58720256
s_add_u32 s55, s62, 1
s_and_b32 s55, s55, 3
s_lshl_b32 s55, s55, 14
s_add_u32 s55, s55, s53
buffer_load_dwordx4 v[80:83], v24, s[40:43], s55 offen
buffer_load_dwordx4 v[84:87], v24, s[40:43], s55 offen offset:1024
s_add_u32 s55, s62, 2
s_and_b32 s55, s55, 3
s_lshl_b32 s55, s55, 14
s_add_u32 s55, s55, s53
buffer_load_dwordx4 v[96:99], v24, s[40:43], s55 offen
buffer_load_dwordx4 v[100:103], v24, s[40:43], s55 offen offset:1024
s_add_u32 s55, s62, 3
s_and_b32 s55, s55, 3
s_lshl_b32 s55, s55, 14
s_add_u32 s55, s55, s53
buffer_load_dwordx4 v[112:115], v24, s[40:43], s55 offen
buffer_load_dwordx4 v[116:119], v24, s[40:43], s55 offen offset:1024
s_lshl_b32 s55, s34, 12
v_add_u32 v26, s55, v24
ds_read_b128 v[64:67], v26
ds_read_b128 v[68:71], v26 offset:1024
ds_read_b128 v[72:75], v26 offset:2048
ds_read_b128 v[76:79], v26 offset:3072
s_waitcnt vmcnt(4) lgkmcnt(0)
v_lshlrev_b32 v31, 16, v31
v_sub_f32 v30, 1.0, v30
v_mul_f32 v30, v30, v31
v_lshlrev_b32 v128, 16, v80
v_and_b32 v129, 0xffff0000, v80
v_lshlrev_b32 v130, 16, v81
v_and_b32 v131, 0xffff0000, v81
v_lshlrev_b32 v132, 16, v82
v_and_b32 v133, 0xffff0000, v82
v_lshlrev_b32 v134, 16, v83
v_and_b32 v135, 0xffff0000, v83
v_lshlrev_b32 v136, 16, v84
v_and_b32 v137, 0xffff0000, v84
v_lshlrev_b32 v138, 16, v85
v_and_b32 v139, 0xffff0000, v85
v_lshlrev_b32 v140, 16, v86
v_and_b32 v141, 0xffff0000, v86
v_lshlrev_b32 v142, 16, v87
v_and_b32 v143, 0xffff0000, v87
v_add_f32 v64, v64, v128
v_add_f32 v65, v65, v129
v_add_f32 v66, v66, v130
v_add_f32 v67, v67, v131
v_add_f32 v68, v68, v132
v_add_f32 v69, v69, v133
v_add_f32 v70, v70, v134
v_add_f32 v71, v71, v135
v_add_f32 v72, v72, v136
v_add_f32 v73, v73, v137
v_add_f32 v74, v74, v138
v_add_f32 v75, v75, v139
v_add_f32 v76, v76, v140
v_add_f32 v77, v77, v141
v_add_f32 v78, v78, v142
v_add_f32 v79, v79, v143
s_waitcnt vmcnt(2)
v_lshlrev_b32 v128, 16, v96
v_and_b32 v129, 0xffff0000, v96
v_lshlrev_b32 v130, 16, v97
v_and_b32 v131, 0xffff0000, v97
v_lshlrev_b32 v132, 16, v98
v_and_b32 v133, 0xffff0000, v98
v_lshlrev_b32 v134, 16, v99
v_and_b32 v135, 0xffff0000, v99
v_lshlrev_b32 v136, 16, v100
v_and_b32 v137, 0xffff0000, v100
v_lshlrev_b32 v138, 16, v101
v_and_b32 v139, 0xffff0000, v101
v_lshlrev_b32 v140, 16, v102
v_and_b32 v141, 0xffff0000, v102
v_lshlrev_b32 v142, 16, v103
v_and_b32 v143, 0xffff0000, v103
v_add_f32 v64, v64, v128
v_add_f32 v65, v65, v129
v_add_f32 v66, v66, v130
v_add_f32 v67, v67, v131
v_add_f32 v68, v68, v132
v_add_f32 v69, v69, v133
v_add_f32 v70, v70, v134
v_add_f32 v71, v71, v135
v_add_f32 v72, v72, v136
v_add_f32 v73, v73, v137
v_add_f32 v74, v74, v138
v_add_f32 v75, v75, v139
v_add_f32 v76, v76, v140
v_add_f32 v77, v77, v141
v_add_f32 v78, v78, v142
v_add_f32 v79, v79, v143
s_waitcnt vmcnt(0)
v_lshlrev_b32 v128, 16, v112
v_and_b32 v129, 0xffff0000, v112
v_lshlrev_b32 v130, 16, v113
v_and_b32 v131, 0xffff0000, v113
v_lshlrev_b32 v132, 16, v114
v_and_b32 v133, 0xffff0000, v114
v_lshlrev_b32 v134, 16, v115
v_and_b32 v135, 0xffff0000, v115
v_lshlrev_b32 v136, 16, v116
v_and_b32 v137, 0xffff0000, v116
v_lshlrev_b32 v138, 16, v117
v_and_b32 v139, 0xffff0000, v117
v_lshlrev_b32 v140, 16, v118
v_and_b32 v141, 0xffff0000, v118
v_lshlrev_b32 v142, 16, v119
v_and_b32 v143, 0xffff0000, v119
v_add_f32 v64, v64, v128
v_add_f32 v65, v65, v129
v_add_f32 v66, v66, v130
v_add_f32 v67, v67, v131
v_add_f32 v68, v68, v132
v_add_f32 v69, v69, v133
v_add_f32 v70, v70, v134
v_add_f32 v71, v71, v135
v_add_f32 v72, v72, v136
v_add_f32 v73, v73, v137
v_add_f32 v74, v74, v138
v_add_f32 v75, v75, v139
v_add_f32 v76, v76, v140
v_add_f32 v77, v77, v141
v_add_f32 v78, v78, v142
v_add_f32 v79, v79, v143
v_add_f32 v64, v64, v30
v_add_f32 v65, v65, v30
v_add_f32 v66, v66, v30
v_add_f32 v67, v67, v30
v_add_f32 v68, v68, v30
v_add_f32 v69, v69, v30
v_add_f32 v70, v70, v30
v_add_f32 v71, v71, v30
v_add_f32 v72, v72, v30
v_add_f32 v73, v73, v30
v_add_f32 v74, v74, v30
v_add_f32 v75, v75, v30
v_add_f32 v76, v76, v30
v_add_f32 v77, v77, v30
v_add_f32 v78, v78, v30
v_add_f32 v79, v79, v30
v_cvt_pk_bf16_f32 v80, v64, v65
v_cvt_pk_bf16_f32 v81, v66, v67
v_cvt_pk_bf16_f32 v82, v68, v69
v_cvt_pk_bf16_f32 v83, v70, v71
v_cvt_pk_bf16_f32 v84, v72, v73
v_cvt_pk_bf16_f32 v85, v74, v75
v_cvt_pk_bf16_f32 v86, v76, v77
v_cvt_pk_bf16_f32 v87, v78, v79
s_nop 1
v_permlane32_swap_b32 v80, v82
v_permlane32_swap_b32 v81, v83
v_permlane32_swap_b32 v84, v86
v_permlane32_swap_b32 v85, v87
s_mov_b32 s44, s28
s_mov_b32 s45, s29
s_mov_b32 s46, 0x200000
s_mov_b32 s47, 0x20000
s_lshl_b32 s54, s54, 10
s_lshl_b32 s55, s61, 8
s_add_u32 s54, s54, s55
s_lshr_b32 s55, s62, 1
s_lshl_b32 s55, s55, 7
s_add_u32 s54, s54, s55
s_lshr_b32 s55, s34, 1
s_lshl_b32 s55, s55, 6
s_add_u32 s54, s54, s55
v_lshlrev_b32 v25, 10, v25
v_lshrrev_b32 v26, 5, v0
v_lshl_add_u32 v25, v26, 4, v25
buffer_store_dwordx4 v[80:83], v25, s[44:47], s54 offen
buffer_store_dwordx4 v[84:87], v25, s[44:47], s54 offen offset:32
s_waitcnt vmcnt(0)
END_main:
s_endpgm
RS20:
s_call_b64 s[58:59], RARE_0_0
s_call_b64 s[58:59], RARE_1_0
s_branch RR21
RS25:
s_call_b64 s[58:59], RARE_0_1
s_call_b64 s[58:59], RARE_1_1
s_branch RR26
RS27:
s_call_b64 s[58:59], RARE_0_0
s_call_b64 s[58:59], RARE_1_0
s_branch RR28
RS31:
s_call_b64 s[58:59], RARE_0_1
s_call_b64 s[58:59], RARE_1_1
s_branch RR32
RS33:
s_call_b64 s[58:59], RARE_0_0
s_call_b64 s[58:59], RARE_1_0
s_branch RR34
RS36:
s_call_b64 s[58:59], RARE_0_1
s_call_b64 s[58:59], RARE_1_1
s_branch RR37
RS38:
s_call_b64 s[58:59], RARE_1_0
s_branch RR39
RS47:
s_call_b64 s[58:59], RARE_1_1
s_branch RR48
RS49:
s_call_b64 s[58:59], RARE_1_0
s_branch RR50
RS55:
s_call_b64 s[58:59], RARE_1_1
s_branch RR56
RS57:
s_call_b64 s[58:59], RARE_1_0
s_branch RR58
RS59:
s_call_b64 s[58:59], RARE_1_1
s_branch RR60
RARE_0_0:
s_nop 15
v_max3_f32 v2, v128, v129, v130
v_max3_f32 v2, v2, v131, v132
v_max3_f32 v2, v2, v133, v134
v_max3_f32 v2, v2, v135, v136
v_max3_f32 v2, v2, v137, v138
v_max3_f32 v2, v2, v139, v140
v_max3_f32 v2, v2, v141, v142
v_max_f32 v2, v2, v143
v_mov_b32 v3, v2
s_nop 1
v_permlane32_swap_b32 v2, v3
s_nop 1
v_max_f32 v2, v2, v3
v_ceil_f32 v2, v2
v_max_f32 v2, 0, v2
v_sub_f32 v3, 0, v2
v_exp_f32 v3, v3
s_nop 0
v_mul_f32 v40, v40, v3
v_sub_f32 v128, v128, v2
v_sub_f32 v144, v144, v2
v_sub_f32 v64, v64, v2
v_sub_f32 v129, v129, v2
v_sub_f32 v145, v145, v2
v_sub_f32 v65, v65, v2
v_sub_f32 v130, v130, v2
v_sub_f32 v146, v146, v2
v_sub_f32 v66, v66, v2
v_sub_f32 v131, v131, v2
v_sub_f32 v147, v147, v2
v_sub_f32 v67, v67, v2
v_sub_f32 v132, v132, v2
v_sub_f32 v148, v148, v2
v_sub_f32 v68, v68, v2
v_sub_f32 v133, v133, v2
v_sub_f32 v149, v149, v2
v_sub_f32 v69, v69, v2
v_sub_f32 v134, v134, v2
v_sub_f32 v150, v150, v2
v_sub_f32 v70, v70, v2
v_sub_f32 v135, v135, v2
v_sub_f32 v151, v151, v2
v_sub_f32 v71, v71, v2
v_sub_f32 v136, v136, v2
v_sub_f32 v152, v152, v2
v_sub_f32 v72, v72, v2
v_sub_f32 v137, v137, v2
v_sub_f32 v153, v153, v2
v_sub_f32 v73, v73, v2
v_sub_f32 v138, v138, v2
v_sub_f32 v154, v154, v2
v_sub_f32 v74, v74, v2
v_sub_f32 v139, v139, v2
v_sub_f32 v155, v155, v2
v_sub_f32 v75, v75, v2
v_sub_f32 v140, v140, v2
v_sub_f32 v156, v156, v2
v_sub_f32 v76, v76, v2
v_sub_f32 v141, v141, v2
v_sub_f32 v157, v157, v2
v_sub_f32 v77, v77, v2
v_sub_f32 v142, v142, v2
v_sub_f32 v158, v158, v2
v_sub_f32 v78, v78, v2
v_sub_f32 v143, v143, v2
v_sub_f32 v159, v159, v2
v_sub_f32 v79, v79, v2
v_accvgpr_read_b32 v4, a0
v_accvgpr_read_b32 v5, a1
v_accvgpr_read_b32 v6, a2
v_accvgpr_read_b32 v7, a3
v_mul_f32 v4, v4, v3
v_mul_f32 v5, v5, v3
v_mul_f32 v6, v6, v3
v_mul_f32 v7, v7, v3
v_accvgpr_write_b32 a0, v4
v_accvgpr_write_b32 a1, v5
v_accvgpr_write_b32 a2, v6
v_accvgpr_write_b32 a3, v7
v_accvgpr_read_b32 v4, a4
v_accvgpr_read_b32 v5, a5
v_accvgpr_read_b32 v6, a6
v_accvgpr_read_b32 v7, a7
v_mul_f32 v4, v4, v3
v_mul_f32 v5, v5, v3
v_mul_f32 v6, v6, v3
v_mul_f32 v7, v7, v3
v_accvgpr_write_b32 a4, v4
v_accvgpr_write_b32 a5, v5
v_accvgpr_write_b32 a6, v6
v_accvgpr_write_b32 a7, v7
v_accvgpr_read_b32 v4, a8
v_accvgpr_read_b32 v5, a9
v_accvgpr_read_b32 v6, a10
v_accvgpr_read_b32 v7, a11
v_mul_f32 v4, v4, v3
v_mul_f32 v5, v5, v3
v_mul_f32 v6, v6, v3
v_mul_f32 v7, v7, v3
v_accvgpr_write_b32 a8, v4
v_accvgpr_write_b32 a9, v5
v_accvgpr_write_b32 a10, v6
v_accvgpr_write_b32 a11, v7
v_accvgpr_read_b32 v4, a12
v_accvgpr_read_b32 v5, a13
v_accvgpr_read_b32 v6, a14
v_accvgpr_read_b32 v7, a15
v_mul_f32 v4, v4, v3
v_mul_f32 v5, v5, v3
v_mul_f32 v6, v6, v3
v_mul_f32 v7, v7, v3
v_accvgpr_write_b32 a12, v4
v_accvgpr_write_b32 a13, v5
v_accvgpr_write_b32 a14, v6
v_accvgpr_write_b32 a15, v7
v_accvgpr_read_b32 v4, a16
v_accvgpr_read_b32 v5, a17
v_accvgpr_read_b32 v6, a18
v_accvgpr_read_b32 v7, a19
v_mul_f32 v4, v4, v3
v_mul_f32 v5, v5, v3
v_mul_f32 v6, v6, v3
v_mul_f32 v7, v7, v3
v_accvgpr_write_b32 a16, v4
v_accvgpr_write_b32 a17, v5
v_accvgpr_write_b32 a18, v6
v_accvgpr_write_b32 a19, v7
v_accvgpr_read_b32 v4, a20
v_accvgpr_read_b32 v5, a21
v_accvgpr_read_b32 v6, a22
v_accvgpr_read_b32 v7, a23
v_mul_f32 v4, v4, v3
v_mul_f32 v5, v5, v3
v_mul_f32 v6, v6, v3
v_mul_f32 v7, v7, v3
v_accvgpr_write_b32 a20, v4
v_accvgpr_write_b32 a21, v5
v_accvgpr_write_b32 a22, v6
v_accvgpr_write_b32 a23, v7
v_accvgpr_read_b32 v4, a24
v_accvgpr_read_b32 v5, a25
v_accvgpr_read_b32 v6, a26
v_accvgpr_read_b32 v7, a27
v_mul_f32 v4, v4, v3
v_mul_f32 v5, v5, v3
v_mul_f32 v6, v6, v3
v_mul_f32 v7, v7, v3
v_accvgpr_write_b32 a24, v4
v_accvgpr_write_b32 a25, v5
v_accvgpr_write_b32 a26, v6
v_accvgpr_write_b32 a27, v7
v_accvgpr_read_b32 v4, a28
v_accvgpr_read_b32 v5, a29
v_accvgpr_read_b32 v6, a30
v_accvgpr_read_b32 v7, a31
v_mul_f32 v4, v4, v3
v_mul_f32 v5, v5, v3
v_mul_f32 v6, v6, v3
v_mul_f32 v7, v7, v3
v_accvgpr_write_b32 a28, v4
v_accvgpr_write_b32 a29, v5
v_accvgpr_write_b32 a30, v6
v_accvgpr_write_b32 a31, v7
v_accvgpr_read_b32 v4, a32
v_accvgpr_read_b32 v5, a33
v_accvgpr_read_b32 v6, a34
v_accvgpr_read_b32 v7, a35
v_mul_f32 v4, v4, v3
v_mul_f32 v5, v5, v3
v_mul_f32 v6, v6, v3
v_mul_f32 v7, v7, v3
v_accvgpr_write_b32 a32, v4
v_accvgpr_write_b32 a33, v5
v_accvgpr_write_b32 a34, v6
v_accvgpr_write_b32 a35, v7
v_accvgpr_read_b32 v4, a36
v_accvgpr_read_b32 v5, a37
v_accvgpr_read_b32 v6, a38
v_accvgpr_read_b32 v7, a39
v_mul_f32 v4, v4, v3
v_mul_f32 v5, v5, v3
v_mul_f32 v6, v6, v3
v_mul_f32 v7, v7, v3
v_accvgpr_write_b32 a36, v4
v_accvgpr_write_b32 a37, v5
v_accvgpr_write_b32 a38, v6
v_accvgpr_write_b32 a39, v7
v_accvgpr_read_b32 v4, a40
v_accvgpr_read_b32 v5, a41
v_accvgpr_read_b32 v6, a42
v_accvgpr_read_b32 v7, a43
v_mul_f32 v4, v4, v3
v_mul_f32 v5, v5, v3
v_mul_f32 v6, v6, v3
v_mul_f32 v7, v7, v3
v_accvgpr_write_b32 a40, v4
v_accvgpr_write_b32 a41, v5
v_accvgpr_write_b32 a42, v6
v_accvgpr_write_b32 a43, v7
v_accvgpr_read_b32 v4, a44
v_accvgpr_read_b32 v5, a45
v_accvgpr_read_b32 v6, a46
v_accvgpr_read_b32 v7, a47
v_mul_f32 v4, v4, v3
v_mul_f32 v5, v5, v3
v_mul_f32 v6, v6, v3
v_mul_f32 v7, v7, v3
v_accvgpr_write_b32 a44, v4
v_accvgpr_write_b32 a45, v5
v_accvgpr_write_b32 a46, v6
v_accvgpr_write_b32 a47, v7
v_accvgpr_read_b32 v4, a48
v_accvgpr_read_b32 v5, a49
v_accvgpr_read_b32 v6, a50
v_accvgpr_read_b32 v7, a51
v_mul_f32 v4, v4, v3
v_mul_f32 v5, v5, v3
v_mul_f32 v6, v6, v3
v_mul_f32 v7, v7, v3
v_accvgpr_write_b32 a48, v4
v_accvgpr_write_b32 a49, v5
v_accvgpr_write_b32 a50, v6
v_accvgpr_write_b32 a51, v7
v_accvgpr_read_b32 v4, a52
v_accvgpr_read_b32 v5, a53
v_accvgpr_read_b32 v6, a54
v_accvgpr_read_b32 v7, a55
v_mul_f32 v4, v4, v3
v_mul_f32 v5, v5, v3
v_mul_f32 v6, v6, v3
v_mul_f32 v7, v7, v3
v_accvgpr_write_b32 a52, v4
v_accvgpr_write_b32 a53, v5
v_accvgpr_write_b32 a54, v6
v_accvgpr_write_b32 a55, v7
v_accvgpr_read_b32 v4, a56
v_accvgpr_read_b32 v5, a57
v_accvgpr_read_b32 v6, a58
v_accvgpr_read_b32 v7, a59
v_mul_f32 v4, v4, v3
v_mul_f32 v5, v5, v3
v_mul_f32 v6, v6, v3
v_mul_f32 v7, v7, v3
v_accvgpr_write_b32 a56, v4
v_accvgpr_write_b32 a57, v5
v_accvgpr_write_b32 a58, v6
v_accvgpr_write_b32 a59, v7
v_accvgpr_read_b32 v4, a60
v_accvgpr_read_b32 v5, a61
v_accvgpr_read_b32 v6, a62
v_accvgpr_read_b32 v7, a63
v_mul_f32 v4, v4, v3
v_mul_f32 v5, v5, v3
v_mul_f32 v6, v6, v3
v_mul_f32 v7, v7, v3
v_accvgpr_write_b32 a60, v4
v_accvgpr_write_b32 a61, v5
v_accvgpr_write_b32 a62, v6
v_accvgpr_write_b32 a63, v7
v_exp_f32 v2, v128
v_exp_f32 v3, v129
v_exp_f32 v4, v130
v_exp_f32 v5, v131
v_exp_f32 v6, v132
v_exp_f32 v7, v133
v_exp_f32 v8, v134
v_exp_f32 v9, v135
v_exp_f32 v10, v136
v_exp_f32 v11, v137
v_exp_f32 v12, v138
v_exp_f32 v13, v139
v_exp_f32 v14, v140
v_exp_f32 v15, v141
v_exp_f32 v16, v142
v_exp_f32 v17, v143
s_nop 0
v_add_f32 v42, v2, v3
v_add_f32 v42, v42, v4
v_add_f32 v42, v42, v5
v_add_f32 v42, v42, v6
v_add_f32 v42, v42, v7
v_add_f32 v42, v42, v8
v_add_f32 v42, v42, v9
v_add_f32 v42, v42, v10
v_add_f32 v42, v42, v11
v_add_f32 v42, v42, v12
v_add_f32 v42, v42, v13
v_add_f32 v42, v42, v14
v_add_f32 v42, v42, v15
v_add_f32 v42, v42, v16
v_add_f32 v42, v42, v17
v_cvt_pk_bf16_f32 v96, v2, v3
v_cvt_pk_bf16_f32 v97, v4, v5
v_cvt_pk_bf16_f32 v98, v6, v7
v_cvt_pk_bf16_f32 v99, v8, v9
v_cvt_pk_bf16_f32 v100, v10, v11
v_cvt_pk_bf16_f32 v101, v12, v13
v_cvt_pk_bf16_f32 v102, v14, v15
v_cvt_pk_bf16_f32 v103, v16, v17
s_nop 1
s_setpc_b64 s[58:59]
RARE_0_1:
s_nop 15
v_max3_f32 v2, v144, v145, v146
v_max3_f32 v2, v2, v147, v148
v_max3_f32 v2, v2, v149, v150
v_max3_f32 v2, v2, v151, v152
v_max3_f32 v2, v2, v153, v154
v_max3_f32 v2, v2, v155, v156
v_max3_f32 v2, v2, v157, v158
v_max_f32 v2, v2, v159
v_mov_b32 v3, v2
s_nop 1
v_permlane32_swap_b32 v2, v3
s_nop 1
v_max_f32 v2, v2, v3
v_ceil_f32 v2, v2
v_max_f32 v2, 0, v2
v_sub_f32 v3, 0, v2
v_exp_f32 v3, v3
s_nop 0
v_mul_f32 v40, v40, v3
v_sub_f32 v144, v144, v2
v_sub_f32 v128, v128, v2
v_sub_f32 v64, v64, v2
v_sub_f32 v145, v145, v2
v_sub_f32 v129, v129, v2
v_sub_f32 v65, v65, v2
v_sub_f32 v146, v146, v2
v_sub_f32 v130, v130, v2
v_sub_f32 v66, v66, v2
v_sub_f32 v147, v147, v2
v_sub_f32 v131, v131, v2
v_sub_f32 v67, v67, v2
v_sub_f32 v148, v148, v2
v_sub_f32 v132, v132, v2
v_sub_f32 v68, v68, v2
v_sub_f32 v149, v149, v2
v_sub_f32 v133, v133, v2
v_sub_f32 v69, v69, v2
v_sub_f32 v150, v150, v2
v_sub_f32 v134, v134, v2
v_sub_f32 v70, v70, v2
v_sub_f32 v151, v151, v2
v_sub_f32 v135, v135, v2
v_sub_f32 v71, v71, v2
v_sub_f32 v152, v152, v2
v_sub_f32 v136, v136, v2
v_sub_f32 v72, v72, v2
v_sub_f32 v153, v153, v2
v_sub_f32 v137, v137, v2
v_sub_f32 v73, v73, v2
v_sub_f32 v154, v154, v2
v_sub_f32 v138, v138, v2
v_sub_f32 v74, v74, v2
v_sub_f32 v155, v155, v2
v_sub_f32 v139, v139, v2
v_sub_f32 v75, v75, v2
v_sub_f32 v156, v156, v2
v_sub_f32 v140, v140, v2
v_sub_f32 v76, v76, v2
v_sub_f32 v157, v157, v2
v_sub_f32 v141, v141, v2
v_sub_f32 v77, v77, v2
v_sub_f32 v158, v158, v2
v_sub_f32 v142, v142, v2
v_sub_f32 v78, v78, v2
v_sub_f32 v159, v159, v2
v_sub_f32 v143, v143, v2
v_sub_f32 v79, v79, v2
v_accvgpr_read_b32 v4, a0
v_accvgpr_read_b32 v5, a1
v_accvgpr_read_b32 v6, a2
v_accvgpr_read_b32 v7, a3
v_mul_f32 v4, v4, v3
v_mul_f32 v5, v5, v3
v_mul_f32 v6, v6, v3
v_mul_f32 v7, v7, v3
v_accvgpr_write_b32 a0, v4
v_accvgpr_write_b32 a1, v5
v_accvgpr_write_b32 a2, v6
v_accvgpr_write_b32 a3, v7
v_accvgpr_read_b32 v4, a4
v_accvgpr_read_b32 v5, a5
v_accvgpr_read_b32 v6, a6
v_accvgpr_read_b32 v7, a7
v_mul_f32 v4, v4, v3
v_mul_f32 v5, v5, v3
v_mul_f32 v6, v6, v3
v_mul_f32 v7, v7, v3
v_accvgpr_write_b32 a4, v4
v_accvgpr_write_b32 a5, v5
v_accvgpr_write_b32 a6, v6
v_accvgpr_write_b32 a7, v7
v_accvgpr_read_b32 v4, a8
v_accvgpr_read_b32 v5, a9
v_accvgpr_read_b32 v6, a10
v_accvgpr_read_b32 v7, a11
v_mul_f32 v4, v4, v3
v_mul_f32 v5, v5, v3
v_mul_f32 v6, v6, v3
v_mul_f32 v7, v7, v3
v_accvgpr_write_b32 a8, v4
v_accvgpr_write_b32 a9, v5
v_accvgpr_write_b32 a10, v6
v_accvgpr_write_b32 a11, v7
v_accvgpr_read_b32 v4, a12
v_accvgpr_read_b32 v5, a13
v_accvgpr_read_b32 v6, a14
v_accvgpr_read_b32 v7, a15
v_mul_f32 v4, v4, v3
v_mul_f32 v5, v5, v3
v_mul_f32 v6, v6, v3
v_mul_f32 v7, v7, v3
v_accvgpr_write_b32 a12, v4
v_accvgpr_write_b32 a13, v5
v_accvgpr_write_b32 a14, v6
v_accvgpr_write_b32 a15, v7
v_accvgpr_read_b32 v4, a16
v_accvgpr_read_b32 v5, a17
v_accvgpr_read_b32 v6, a18
v_accvgpr_read_b32 v7, a19
v_mul_f32 v4, v4, v3
v_mul_f32 v5, v5, v3
v_mul_f32 v6, v6, v3
v_mul_f32 v7, v7, v3
v_accvgpr_write_b32 a16, v4
v_accvgpr_write_b32 a17, v5
v_accvgpr_write_b32 a18, v6
v_accvgpr_write_b32 a19, v7
v_accvgpr_read_b32 v4, a20
v_accvgpr_read_b32 v5, a21
v_accvgpr_read_b32 v6, a22
v_accvgpr_read_b32 v7, a23
v_mul_f32 v4, v4, v3
v_mul_f32 v5, v5, v3
v_mul_f32 v6, v6, v3
v_mul_f32 v7, v7, v3
v_accvgpr_write_b32 a20, v4
v_accvgpr_write_b32 a21, v5
v_accvgpr_write_b32 a22, v6
v_accvgpr_write_b32 a23, v7
v_accvgpr_read_b32 v4, a24
v_accvgpr_read_b32 v5, a25
v_accvgpr_read_b32 v6, a26
v_accvgpr_read_b32 v7, a27
v_mul_f32 v4, v4, v3
v_mul_f32 v5, v5, v3
v_mul_f32 v6, v6, v3
v_mul_f32 v7, v7, v3
v_accvgpr_write_b32 a24, v4
v_accvgpr_write_b32 a25, v5
v_accvgpr_write_b32 a26, v6
v_accvgpr_write_b32 a27, v7
v_accvgpr_read_b32 v4, a28
v_accvgpr_read_b32 v5, a29
v_accvgpr_read_b32 v6, a30
v_accvgpr_read_b32 v7, a31
v_mul_f32 v4, v4, v3
v_mul_f32 v5, v5, v3
v_mul_f32 v6, v6, v3
v_mul_f32 v7, v7, v3
v_accvgpr_write_b32 a28, v4
v_accvgpr_write_b32 a29, v5
v_accvgpr_write_b32 a30, v6
v_accvgpr_write_b32 a31, v7
v_accvgpr_read_b32 v4, a32
v_accvgpr_read_b32 v5, a33
v_accvgpr_read_b32 v6, a34
v_accvgpr_read_b32 v7, a35
v_mul_f32 v4, v4, v3
v_mul_f32 v5, v5, v3
v_mul_f32 v6, v6, v3
v_mul_f32 v7, v7, v3
v_accvgpr_write_b32 a32, v4
v_accvgpr_write_b32 a33, v5
v_accvgpr_write_b32 a34, v6
v_accvgpr_write_b32 a35, v7
v_accvgpr_read_b32 v4, a36
v_accvgpr_read_b32 v5, a37
v_accvgpr_read_b32 v6, a38
v_accvgpr_read_b32 v7, a39
v_mul_f32 v4, v4, v3
v_mul_f32 v5, v5, v3
v_mul_f32 v6, v6, v3
v_mul_f32 v7, v7, v3
v_accvgpr_write_b32 a36, v4
v_accvgpr_write_b32 a37, v5
v_accvgpr_write_b32 a38, v6
v_accvgpr_write_b32 a39, v7
v_accvgpr_read_b32 v4, a40
v_accvgpr_read_b32 v5, a41
v_accvgpr_read_b32 v6, a42
v_accvgpr_read_b32 v7, a43
v_mul_f32 v4, v4, v3
v_mul_f32 v5, v5, v3
v_mul_f32 v6, v6, v3
v_mul_f32 v7, v7, v3
v_accvgpr_write_b32 a40, v4
v_accvgpr_write_b32 a41, v5
v_accvgpr_write_b32 a42, v6
v_accvgpr_write_b32 a43, v7
v_accvgpr_read_b32 v4, a44
v_accvgpr_read_b32 v5, a45
v_accvgpr_read_b32 v6, a46
v_accvgpr_read_b32 v7, a47
v_mul_f32 v4, v4, v3
v_mul_f32 v5, v5, v3
v_mul_f32 v6, v6, v3
v_mul_f32 v7, v7, v3
v_accvgpr_write_b32 a44, v4
v_accvgpr_write_b32 a45, v5
v_accvgpr_write_b32 a46, v6
v_accvgpr_write_b32 a47, v7
v_accvgpr_read_b32 v4, a48
v_accvgpr_read_b32 v5, a49
v_accvgpr_read_b32 v6, a50
v_accvgpr_read_b32 v7, a51
v_mul_f32 v4, v4, v3
v_mul_f32 v5, v5, v3
v_mul_f32 v6, v6, v3
v_mul_f32 v7, v7, v3
v_accvgpr_write_b32 a48, v4
v_accvgpr_write_b32 a49, v5
v_accvgpr_write_b32 a50, v6
v_accvgpr_write_b32 a51, v7
v_accvgpr_read_b32 v4, a52
v_accvgpr_read_b32 v5, a53
v_accvgpr_read_b32 v6, a54
v_accvgpr_read_b32 v7, a55
v_mul_f32 v4, v4, v3
v_mul_f32 v5, v5, v3
v_mul_f32 v6, v6, v3
v_mul_f32 v7, v7, v3
v_accvgpr_write_b32 a52, v4
v_accvgpr_write_b32 a53, v5
v_accvgpr_write_b32 a54, v6
v_accvgpr_write_b32 a55, v7
v_accvgpr_read_b32 v4, a56
v_accvgpr_read_b32 v5, a57
v_accvgpr_read_b32 v6, a58
v_accvgpr_read_b32 v7, a59
v_mul_f32 v4, v4, v3
v_mul_f32 v5, v5, v3
v_mul_f32 v6, v6, v3
v_mul_f32 v7, v7, v3
v_accvgpr_write_b32 a56, v4
v_accvgpr_write_b32 a57, v5
v_accvgpr_write_b32 a58, v6
v_accvgpr_write_b32 a59, v7
v_accvgpr_read_b32 v4, a60
v_accvgpr_read_b32 v5, a61
v_accvgpr_read_b32 v6, a62
v_accvgpr_read_b32 v7, a63
v_mul_f32 v4, v4, v3
v_mul_f32 v5, v5, v3
v_mul_f32 v6, v6, v3
v_mul_f32 v7, v7, v3
v_accvgpr_write_b32 a60, v4
v_accvgpr_write_b32 a61, v5
v_accvgpr_write_b32 a62, v6
v_accvgpr_write_b32 a63, v7
v_exp_f32 v2, v144
v_exp_f32 v3, v145
v_exp_f32 v4, v146
v_exp_f32 v5, v147
v_exp_f32 v6, v148
v_exp_f32 v7, v149
v_exp_f32 v8, v150
v_exp_f32 v9, v151
v_exp_f32 v10, v152
v_exp_f32 v11, v153
v_exp_f32 v12, v154
v_exp_f32 v13, v155
v_exp_f32 v14, v156
v_exp_f32 v15, v157
v_exp_f32 v16, v158
v_exp_f32 v17, v159
s_nop 0
v_add_f32 v42, v2, v3
v_add_f32 v42, v42, v4
v_add_f32 v42, v42, v5
v_add_f32 v42, v42, v6
v_add_f32 v42, v42, v7
v_add_f32 v42, v42, v8
v_add_f32 v42, v42, v9
v_add_f32 v42, v42, v10
v_add_f32 v42, v42, v11
v_add_f32 v42, v42, v12
v_add_f32 v42, v42, v13
v_add_f32 v42, v42, v14
v_add_f32 v42, v42, v15
v_add_f32 v42, v42, v16
v_add_f32 v42, v42, v17
v_cvt_pk_bf16_f32 v104, v2, v3
v_cvt_pk_bf16_f32 v105, v4, v5
v_cvt_pk_bf16_f32 v106, v6, v7
v_cvt_pk_bf16_f32 v107, v8, v9
v_cvt_pk_bf16_f32 v108, v10, v11
v_cvt_pk_bf16_f32 v109, v12, v13
v_cvt_pk_bf16_f32 v110, v14, v15
v_cvt_pk_bf16_f32 v111, v16, v17
s_nop 1
s_setpc_b64 s[58:59]
RARE_1_0:
s_nop 15
v_max3_f32 v48, v160, v161, v162
v_max3_f32 v48, v48, v163, v164
v_max3_f32 v48, v48, v165, v166
v_max3_f32 v48, v48, v167, v168
v_max3_f32 v48, v48, v169, v170
v_max3_f32 v48, v48, v171, v172
v_max3_f32 v48, v48, v173, v174
v_max_f32 v48, v48, v175
v_mov_b32 v49, v48
s_nop 1
v_permlane32_swap_b32 v48, v49
s_nop 1
v_max_f32 v48, v48, v49
v_ceil_f32 v48, v48
v_max_f32 v48, 0, v48
v_sub_f32 v49, 0, v48
v_exp_f32 v49, v49
s_nop 0
v_mul_f32 v41, v41, v49
v_sub_f32 v160, v160, v48
v_sub_f32 v176, v176, v48
v_sub_f32 v80, v80, v48
v_sub_f32 v161, v161, v48
v_sub_f32 v177, v177, v48
v_sub_f32 v81, v81, v48
v_sub_f32 v162, v162, v48
v_sub_f32 v178, v178, v48
v_sub_f32 v82, v82, v48
v_sub_f32 v163, v163, v48
v_sub_f32 v179, v179, v48
v_sub_f32 v83, v83, v48
v_sub_f32 v164, v164, v48
v_sub_f32 v180, v180, v48
v_sub_f32 v84, v84, v48
v_sub_f32 v165, v165, v48
v_sub_f32 v181, v181, v48
v_sub_f32 v85, v85, v48
v_sub_f32 v166, v166, v48
v_sub_f32 v182, v182, v48
v_sub_f32 v86, v86, v48
v_sub_f32 v167, v167, v48
v_sub_f32 v183, v183, v48
v_sub_f32 v87, v87, v48
v_sub_f32 v168, v168, v48
v_sub_f32 v184, v184, v48
v_sub_f32 v88, v88, v48
v_sub_f32 v169, v169, v48
v_sub_f32 v185, v185, v48
v_sub_f32 v89, v89, v48
v_sub_f32 v170, v170, v48
v_sub_f32 v186, v186, v48
v_sub_f32 v90, v90, v48
v_sub_f32 v171, v171, v48
v_sub_f32 v187, v187, v48
v_sub_f32 v91, v91, v48
v_sub_f32 v172, v172, v48
v_sub_f32 v188, v188, v48
v_sub_f32 v92, v92, v48
v_sub_f32 v173, v173, v48
v_sub_f32 v189, v189, v48
v_sub_f32 v93, v93, v48
v_sub_f32 v174, v174, v48
v_sub_f32 v190, v190, v48
v_sub_f32 v94, v94, v48
v_sub_f32 v175, v175, v48
v_sub_f32 v191, v191, v48
v_sub_f32 v95, v95, v48
v_accvgpr_read_b32 v50, a64
v_accvgpr_read_b32 v51, a65
v_accvgpr_read_b32 v52, a66
v_accvgpr_read_b32 v53, a67
v_mul_f32 v50, v50, v49
v_mul_f32 v51, v51, v49
v_mul_f32 v52, v52, v49
v_mul_f32 v53, v53, v49
v_accvgpr_write_b32 a64, v50
v_accvgpr_write_b32 a65, v51
v_accvgpr_write_b32 a66, v52
v_accvgpr_write_b32 a67, v53
v_accvgpr_read_b32 v50, a68
v_accvgpr_read_b32 v51, a69
v_accvgpr_read_b32 v52, a70
v_accvgpr_read_b32 v53, a71
v_mul_f32 v50, v50, v49
v_mul_f32 v51, v51, v49
v_mul_f32 v52, v52, v49
v_mul_f32 v53, v53, v49
v_accvgpr_write_b32 a68, v50
v_accvgpr_write_b32 a69, v51
v_accvgpr_write_b32 a70, v52
v_accvgpr_write_b32 a71, v53
v_accvgpr_read_b32 v50, a72
v_accvgpr_read_b32 v51, a73
v_accvgpr_read_b32 v52, a74
v_accvgpr_read_b32 v53, a75
v_mul_f32 v50, v50, v49
v_mul_f32 v51, v51, v49
v_mul_f32 v52, v52, v49
v_mul_f32 v53, v53, v49
v_accvgpr_write_b32 a72, v50
v_accvgpr_write_b32 a73, v51
v_accvgpr_write_b32 a74, v52
v_accvgpr_write_b32 a75, v53
v_accvgpr_read_b32 v50, a76
v_accvgpr_read_b32 v51, a77
v_accvgpr_read_b32 v52, a78
v_accvgpr_read_b32 v53, a79
v_mul_f32 v50, v50, v49
v_mul_f32 v51, v51, v49
v_mul_f32 v52, v52, v49
v_mul_f32 v53, v53, v49
v_accvgpr_write_b32 a76, v50
v_accvgpr_write_b32 a77, v51
v_accvgpr_write_b32 a78, v52
v_accvgpr_write_b32 a79, v53
v_accvgpr_read_b32 v50, a80
v_accvgpr_read_b32 v51, a81
v_accvgpr_read_b32 v52, a82
v_accvgpr_read_b32 v53, a83
v_mul_f32 v50, v50, v49
v_mul_f32 v51, v51, v49
v_mul_f32 v52, v52, v49
v_mul_f32 v53, v53, v49
v_accvgpr_write_b32 a80, v50
v_accvgpr_write_b32 a81, v51
v_accvgpr_write_b32 a82, v52
v_accvgpr_write_b32 a83, v53
v_accvgpr_read_b32 v50, a84
v_accvgpr_read_b32 v51, a85
v_accvgpr_read_b32 v52, a86
v_accvgpr_read_b32 v53, a87
v_mul_f32 v50, v50, v49
v_mul_f32 v51, v51, v49
v_mul_f32 v52, v52, v49
v_mul_f32 v53, v53, v49
v_accvgpr_write_b32 a84, v50
v_accvgpr_write_b32 a85, v51
v_accvgpr_write_b32 a86, v52
v_accvgpr_write_b32 a87, v53
v_accvgpr_read_b32 v50, a88
v_accvgpr_read_b32 v51, a89
v_accvgpr_read_b32 v52, a90
v_accvgpr_read_b32 v53, a91
v_mul_f32 v50, v50, v49
v_mul_f32 v51, v51, v49
v_mul_f32 v52, v52, v49
v_mul_f32 v53, v53, v49
v_accvgpr_write_b32 a88, v50
v_accvgpr_write_b32 a89, v51
v_accvgpr_write_b32 a90, v52
v_accvgpr_write_b32 a91, v53
v_accvgpr_read_b32 v50, a92
v_accvgpr_read_b32 v51, a93
v_accvgpr_read_b32 v52, a94
v_accvgpr_read_b32 v53, a95
v_mul_f32 v50, v50, v49
v_mul_f32 v51, v51, v49
v_mul_f32 v52, v52, v49
v_mul_f32 v53, v53, v49
v_accvgpr_write_b32 a92, v50
v_accvgpr_write_b32 a93, v51
v_accvgpr_write_b32 a94, v52
v_accvgpr_write_b32 a95, v53
v_accvgpr_read_b32 v50, a96
v_accvgpr_read_b32 v51, a97
v_accvgpr_read_b32 v52, a98
v_accvgpr_read_b32 v53, a99
v_mul_f32 v50, v50, v49
v_mul_f32 v51, v51, v49
v_mul_f32 v52, v52, v49
v_mul_f32 v53, v53, v49
v_accvgpr_write_b32 a96, v50
v_accvgpr_write_b32 a97, v51
v_accvgpr_write_b32 a98, v52
v_accvgpr_write_b32 a99, v53
v_accvgpr_read_b32 v50, a100
v_accvgpr_read_b32 v51, a101
v_accvgpr_read_b32 v52, a102
v_accvgpr_read_b32 v53, a103
v_mul_f32 v50, v50, v49
v_mul_f32 v51, v51, v49
v_mul_f32 v52, v52, v49
v_mul_f32 v53, v53, v49
v_accvgpr_write_b32 a100, v50
v_accvgpr_write_b32 a101, v51
v_accvgpr_write_b32 a102, v52
v_accvgpr_write_b32 a103, v53
v_accvgpr_read_b32 v50, a104
v_accvgpr_read_b32 v51, a105
v_accvgpr_read_b32 v52, a106
v_accvgpr_read_b32 v53, a107
v_mul_f32 v50, v50, v49
v_mul_f32 v51, v51, v49
v_mul_f32 v52, v52, v49
v_mul_f32 v53, v53, v49
v_accvgpr_write_b32 a104, v50
v_accvgpr_write_b32 a105, v51
v_accvgpr_write_b32 a106, v52
v_accvgpr_write_b32 a107, v53
v_accvgpr_read_b32 v50, a108
v_accvgpr_read_b32 v51, a109
v_accvgpr_read_b32 v52, a110
v_accvgpr_read_b32 v53, a111
v_mul_f32 v50, v50, v49
v_mul_f32 v51, v51, v49
v_mul_f32 v52, v52, v49
v_mul_f32 v53, v53, v49
v_accvgpr_write_b32 a108, v50
v_accvgpr_write_b32 a109, v51
v_accvgpr_write_b32 a110, v52
v_accvgpr_write_b32 a111, v53
v_accvgpr_read_b32 v50, a112
v_accvgpr_read_b32 v51, a113
v_accvgpr_read_b32 v52, a114
v_accvgpr_read_b32 v53, a115
v_mul_f32 v50, v50, v49
v_mul_f32 v51, v51, v49
v_mul_f32 v52, v52, v49
v_mul_f32 v53, v53, v49
v_accvgpr_write_b32 a112, v50
v_accvgpr_write_b32 a113, v51
v_accvgpr_write_b32 a114, v52
v_accvgpr_write_b32 a115, v53
v_accvgpr_read_b32 v50, a116
v_accvgpr_read_b32 v51, a117
v_accvgpr_read_b32 v52, a118
v_accvgpr_read_b32 v53, a119
v_mul_f32 v50, v50, v49
v_mul_f32 v51, v51, v49
v_mul_f32 v52, v52, v49
v_mul_f32 v53, v53, v49
v_accvgpr_write_b32 a116, v50
v_accvgpr_write_b32 a117, v51
v_accvgpr_write_b32 a118, v52
v_accvgpr_write_b32 a119, v53
v_accvgpr_read_b32 v50, a120
v_accvgpr_read_b32 v51, a121
v_accvgpr_read_b32 v52, a122
v_accvgpr_read_b32 v53, a123
v_mul_f32 v50, v50, v49
v_mul_f32 v51, v51, v49
v_mul_f32 v52, v52, v49
v_mul_f32 v53, v53, v49
v_accvgpr_write_b32 a120, v50
v_accvgpr_write_b32 a121, v51
v_accvgpr_write_b32 a122, v52
v_accvgpr_write_b32 a123, v53
v_accvgpr_read_b32 v50, a124
v_accvgpr_read_b32 v51, a125
v_accvgpr_read_b32 v52, a126
v_accvgpr_read_b32 v53, a127
v_mul_f32 v50, v50, v49
v_mul_f32 v51, v51, v49
v_mul_f32 v52, v52, v49
v_mul_f32 v53, v53, v49
v_accvgpr_write_b32 a124, v50
v_accvgpr_write_b32 a125, v51
v_accvgpr_write_b32 a126, v52
v_accvgpr_write_b32 a127, v53
v_exp_f32 v48, v160
v_exp_f32 v49, v161
v_exp_f32 v50, v162
v_exp_f32 v51, v163
v_exp_f32 v52, v164
v_exp_f32 v53, v165
v_exp_f32 v54, v166
v_exp_f32 v55, v167
v_exp_f32 v56, v168
v_exp_f32 v57, v169
v_exp_f32 v58, v170
v_exp_f32 v59, v171
v_exp_f32 v60, v172
v_exp_f32 v61, v173
v_exp_f32 v62, v174
v_exp_f32 v63, v175
s_nop 0
v_add_f32 v43, v48, v49
v_add_f32 v43, v43, v50
v_add_f32 v43, v43, v51
v_add_f32 v43, v43, v52
v_add_f32 v43, v43, v53
v_add_f32 v43, v43, v54
v_add_f32 v43, v43, v55
v_add_f32 v43, v43, v56
v_add_f32 v43, v43, v57
v_add_f32 v43, v43, v58
v_add_f32 v43, v43, v59
v_add_f32 v43, v43, v60
v_add_f32 v43, v43, v61
v_add_f32 v43, v43, v62
v_add_f32 v43, v43, v63
v_cvt_pk_bf16_f32 v112, v48, v49
v_cvt_pk_bf16_f32 v113, v50, v51
v_cvt_pk_bf16_f32 v114, v52, v53
v_cvt_pk_bf16_f32 v115, v54, v55
v_cvt_pk_bf16_f32 v116, v56, v57
v_cvt_pk_bf16_f32 v117, v58, v59
v_cvt_pk_bf16_f32 v118, v60, v61
v_cvt_pk_bf16_f32 v119, v62, v63
s_nop 1
s_setpc_b64 s[58:59]
RARE_1_1:
s_nop 15
v_max3_f32 v48, v176, v177, v178
v_max3_f32 v48, v48, v179, v180
v_max3_f32 v48, v48, v181, v182
v_max3_f32 v48, v48, v183, v184
v_max3_f32 v48, v48, v185, v186
v_max3_f32 v48, v48, v187, v188
v_max3_f32 v48, v48, v189, v190
v_max_f32 v48, v48, v191
v_mov_b32 v49, v48
s_nop 1
v_permlane32_swap_b32 v48, v49
s_nop 1
v_max_f32 v48, v48, v49
v_ceil_f32 v48, v48
v_max_f32 v48, 0, v48
v_sub_f32 v49, 0, v48
v_exp_f32 v49, v49
s_nop 0
v_mul_f32 v41, v41, v49
v_sub_f32 v176, v176, v48
v_sub_f32 v160, v160, v48
v_sub_f32 v80, v80, v48
v_sub_f32 v177, v177, v48
v_sub_f32 v161, v161, v48
v_sub_f32 v81, v81, v48
v_sub_f32 v178, v178, v48
v_sub_f32 v162, v162, v48
v_sub_f32 v82, v82, v48
v_sub_f32 v179, v179, v48
v_sub_f32 v163, v163, v48
v_sub_f32 v83, v83, v48
v_sub_f32 v180, v180, v48
v_sub_f32 v164, v164, v48
v_sub_f32 v84, v84, v48
v_sub_f32 v181, v181, v48
v_sub_f32 v165, v165, v48
v_sub_f32 v85, v85, v48
v_sub_f32 v182, v182, v48
v_sub_f32 v166, v166, v48
v_sub_f32 v86, v86, v48
v_sub_f32 v183, v183, v48
v_sub_f32 v167, v167, v48
v_sub_f32 v87, v87, v48
v_sub_f32 v184, v184, v48
v_sub_f32 v168, v168, v48
v_sub_f32 v88, v88, v48
v_sub_f32 v185, v185, v48
v_sub_f32 v169, v169, v48
v_sub_f32 v89, v89, v48
v_sub_f32 v186, v186, v48
v_sub_f32 v170, v170, v48
v_sub_f32 v90, v90, v48
v_sub_f32 v187, v187, v48
v_sub_f32 v171, v171, v48
v_sub_f32 v91, v91, v48
v_sub_f32 v188, v188, v48
v_sub_f32 v172, v172, v48
v_sub_f32 v92, v92, v48
v_sub_f32 v189, v189, v48
v_sub_f32 v173, v173, v48
v_sub_f32 v93, v93, v48
v_sub_f32 v190, v190, v48
v_sub_f32 v174, v174, v48
v_sub_f32 v94, v94, v48
v_sub_f32 v191, v191, v48
v_sub_f32 v175, v175, v48
v_sub_f32 v95, v95, v48
v_accvgpr_read_b32 v50, a64
v_accvgpr_read_b32 v51, a65
v_accvgpr_read_b32 v52, a66
v_accvgpr_read_b32 v53, a67
v_mul_f32 v50, v50, v49
v_mul_f32 v51, v51, v49
v_mul_f32 v52, v52, v49
v_mul_f32 v53, v53, v49
v_accvgpr_write_b32 a64, v50
v_accvgpr_write_b32 a65, v51
v_accvgpr_write_b32 a66, v52
v_accvgpr_write_b32 a67, v53
v_accvgpr_read_b32 v50, a68
v_accvgpr_read_b32 v51, a69
v_accvgpr_read_b32 v52, a70
v_accvgpr_read_b32 v53, a71
v_mul_f32 v50, v50, v49
v_mul_f32 v51, v51, v49
v_mul_f32 v52, v52, v49
v_mul_f32 v53, v53, v49
v_accvgpr_write_b32 a68, v50
v_accvgpr_write_b32 a69, v51
v_accvgpr_write_b32 a70, v52
v_accvgpr_write_b32 a71, v53
v_accvgpr_read_b32 v50, a72
v_accvgpr_read_b32 v51, a73
v_accvgpr_read_b32 v52, a74
v_accvgpr_read_b32 v53, a75
v_mul_f32 v50, v50, v49
v_mul_f32 v51, v51, v49
v_mul_f32 v52, v52, v49
v_mul_f32 v53, v53, v49
v_accvgpr_write_b32 a72, v50
v_accvgpr_write_b32 a73, v51
v_accvgpr_write_b32 a74, v52
v_accvgpr_write_b32 a75, v53
v_accvgpr_read_b32 v50, a76
v_accvgpr_read_b32 v51, a77
v_accvgpr_read_b32 v52, a78
v_accvgpr_read_b32 v53, a79
v_mul_f32 v50, v50, v49
v_mul_f32 v51, v51, v49
v_mul_f32 v52, v52, v49
v_mul_f32 v53, v53, v49
v_accvgpr_write_b32 a76, v50
v_accvgpr_write_b32 a77, v51
v_accvgpr_write_b32 a78, v52
v_accvgpr_write_b32 a79, v53
v_accvgpr_read_b32 v50, a80
v_accvgpr_read_b32 v51, a81
v_accvgpr_read_b32 v52, a82
v_accvgpr_read_b32 v53, a83
v_mul_f32 v50, v50, v49
v_mul_f32 v51, v51, v49
v_mul_f32 v52, v52, v49
v_mul_f32 v53, v53, v49
v_accvgpr_write_b32 a80, v50
v_accvgpr_write_b32 a81, v51
v_accvgpr_write_b32 a82, v52
v_accvgpr_write_b32 a83, v53
v_accvgpr_read_b32 v50, a84
v_accvgpr_read_b32 v51, a85
v_accvgpr_read_b32 v52, a86
v_accvgpr_read_b32 v53, a87
v_mul_f32 v50, v50, v49
v_mul_f32 v51, v51, v49
v_mul_f32 v52, v52, v49
v_mul_f32 v53, v53, v49
v_accvgpr_write_b32 a84, v50
v_accvgpr_write_b32 a85, v51
v_accvgpr_write_b32 a86, v52
v_accvgpr_write_b32 a87, v53
v_accvgpr_read_b32 v50, a88
v_accvgpr_read_b32 v51, a89
v_accvgpr_read_b32 v52, a90
v_accvgpr_read_b32 v53, a91
v_mul_f32 v50, v50, v49
v_mul_f32 v51, v51, v49
v_mul_f32 v52, v52, v49
v_mul_f32 v53, v53, v49
v_accvgpr_write_b32 a88, v50
v_accvgpr_write_b32 a89, v51
v_accvgpr_write_b32 a90, v52
v_accvgpr_write_b32 a91, v53
v_accvgpr_read_b32 v50, a92
v_accvgpr_read_b32 v51, a93
v_accvgpr_read_b32 v52, a94
v_accvgpr_read_b32 v53, a95
v_mul_f32 v50, v50, v49
v_mul_f32 v51, v51, v49
v_mul_f32 v52, v52, v49
v_mul_f32 v53, v53, v49
v_accvgpr_write_b32 a92, v50
v_accvgpr_write_b32 a93, v51
v_accvgpr_write_b32 a94, v52
v_accvgpr_write_b32 a95, v53
v_accvgpr_read_b32 v50, a96
v_accvgpr_read_b32 v51, a97
v_accvgpr_read_b32 v52, a98
v_accvgpr_read_b32 v53, a99
v_mul_f32 v50, v50, v49
v_mul_f32 v51, v51, v49
v_mul_f32 v52, v52, v49
v_mul_f32 v53, v53, v49
v_accvgpr_write_b32 a96, v50
v_accvgpr_write_b32 a97, v51
v_accvgpr_write_b32 a98, v52
v_accvgpr_write_b32 a99, v53
v_accvgpr_read_b32 v50, a100
v_accvgpr_read_b32 v51, a101
v_accvgpr_read_b32 v52, a102
v_accvgpr_read_b32 v53, a103
v_mul_f32 v50, v50, v49
v_mul_f32 v51, v51, v49
v_mul_f32 v52, v52, v49
v_mul_f32 v53, v53, v49
v_accvgpr_write_b32 a100, v50
v_accvgpr_write_b32 a101, v51
v_accvgpr_write_b32 a102, v52
v_accvgpr_write_b32 a103, v53
v_accvgpr_read_b32 v50, a104
v_accvgpr_read_b32 v51, a105
v_accvgpr_read_b32 v52, a106
v_accvgpr_read_b32 v53, a107
v_mul_f32 v50, v50, v49
v_mul_f32 v51, v51, v49
v_mul_f32 v52, v52, v49
v_mul_f32 v53, v53, v49
v_accvgpr_write_b32 a104, v50
v_accvgpr_write_b32 a105, v51
v_accvgpr_write_b32 a106, v52
v_accvgpr_write_b32 a107, v53
v_accvgpr_read_b32 v50, a108
v_accvgpr_read_b32 v51, a109
v_accvgpr_read_b32 v52, a110
v_accvgpr_read_b32 v53, a111
v_mul_f32 v50, v50, v49
v_mul_f32 v51, v51, v49
v_mul_f32 v52, v52, v49
v_mul_f32 v53, v53, v49
v_accvgpr_write_b32 a108, v50
v_accvgpr_write_b32 a109, v51
v_accvgpr_write_b32 a110, v52
v_accvgpr_write_b32 a111, v53
v_accvgpr_read_b32 v50, a112
v_accvgpr_read_b32 v51, a113
v_accvgpr_read_b32 v52, a114
v_accvgpr_read_b32 v53, a115
v_mul_f32 v50, v50, v49
v_mul_f32 v51, v51, v49
v_mul_f32 v52, v52, v49
v_mul_f32 v53, v53, v49
v_accvgpr_write_b32 a112, v50
v_accvgpr_write_b32 a113, v51
v_accvgpr_write_b32 a114, v52
v_accvgpr_write_b32 a115, v53
v_accvgpr_read_b32 v50, a116
v_accvgpr_read_b32 v51, a117
v_accvgpr_read_b32 v52, a118
v_accvgpr_read_b32 v53, a119
v_mul_f32 v50, v50, v49
v_mul_f32 v51, v51, v49
v_mul_f32 v52, v52, v49
v_mul_f32 v53, v53, v49
v_accvgpr_write_b32 a116, v50
v_accvgpr_write_b32 a117, v51
v_accvgpr_write_b32 a118, v52
v_accvgpr_write_b32 a119, v53
v_accvgpr_read_b32 v50, a120
v_accvgpr_read_b32 v51, a121
v_accvgpr_read_b32 v52, a122
v_accvgpr_read_b32 v53, a123
v_mul_f32 v50, v50, v49
v_mul_f32 v51, v51, v49
v_mul_f32 v52, v52, v49
v_mul_f32 v53, v53, v49
v_accvgpr_write_b32 a120, v50
v_accvgpr_write_b32 a121, v51
v_accvgpr_write_b32 a122, v52
v_accvgpr_write_b32 a123, v53
v_accvgpr_read_b32 v50, a124
v_accvgpr_read_b32 v51, a125
v_accvgpr_read_b32 v52, a126
v_accvgpr_read_b32 v53, a127
v_mul_f32 v50, v50, v49
v_mul_f32 v51, v51, v49
v_mul_f32 v52, v52, v49
v_mul_f32 v53, v53, v49
v_accvgpr_write_b32 a124, v50
v_accvgpr_write_b32 a125, v51
v_accvgpr_write_b32 a126, v52
v_accvgpr_write_b32 a127, v53
v_exp_f32 v48, v176
v_exp_f32 v49, v177
v_exp_f32 v50, v178
v_exp_f32 v51, v179
v_exp_f32 v52, v180
v_exp_f32 v53, v181
v_exp_f32 v54, v182
v_exp_f32 v55, v183
v_exp_f32 v56, v184
v_exp_f32 v57, v185
v_exp_f32 v58, v186
v_exp_f32 v59, v187
v_exp_f32 v60, v188
v_exp_f32 v61, v189
v_exp_f32 v62, v190
v_exp_f32 v63, v191
s_nop 0
v_add_f32 v43, v48, v49
v_add_f32 v43, v43, v50
v_add_f32 v43, v43, v51
v_add_f32 v43, v43, v52
v_add_f32 v43, v43, v53
v_add_f32 v43, v43, v54
v_add_f32 v43, v43, v55
v_add_f32 v43, v43, v56
v_add_f32 v43, v43, v57
v_add_f32 v43, v43, v58
v_add_f32 v43, v43, v59
v_add_f32 v43, v43, v60
v_add_f32 v43, v43, v61
v_add_f32 v43, v43, v62
v_add_f32 v43, v43, v63
v_cvt_pk_bf16_f32 v120, v48, v49
v_cvt_pk_bf16_f32 v121, v50, v51
v_cvt_pk_bf16_f32 v122, v52, v53
v_cvt_pk_bf16_f32 v123, v54, v55
v_cvt_pk_bf16_f32 v124, v56, v57
v_cvt_pk_bf16_f32 v125, v58, v59
v_cvt_pk_bf16_f32 v126, v60, v61
v_cvt_pk_bf16_f32 v127, v62, v63
s_nop 1
s_setpc_b64 s[58:59]
.section .rodata,"a"
.p2align 6
.amdhsa_kernel gated_mix__compressed_kv_cla__mixer_token_mlp__prompt_kernel
.amdhsa_next_free_vgpr 512
.amdhsa_next_free_sgpr 102
.amdhsa_accum_offset 256
.amdhsa_group_segment_fixed_size 0
.amdhsa_kernarg_size 120
.amdhsa_user_sgpr_count 2
.amdhsa_user_sgpr_kernarg_segment_ptr 1
.amdhsa_system_sgpr_workgroup_id_x 1
.end_amdhsa_kernel
.text
```
